```python
import torch

def _softmax(x, axis=-1):
    return torch.softmax(x, dim=axis)

def _gelu(x):
    return torch.nn.functional.gelu(x, approximate='tanh')

def _silu(x):
    return torch.nn.functional.silu(x)

def _sigmoid(x):
    return torch.sigmoid(x)

def _layernorm(x, axis=-1, eps=1e-05):
    m = x.mean(dim=axis, keepdim=True)
    v = x.var(dim=axis, keepdim=True, unbiased=False)
    return (x - m) / torch.sqrt(v + eps)

def _scatter_add(tgt, idx, src, axis=0):
    return tgt.clone().index_add_(axis, idx, src)

def _segment_sum(src, seg, n):
    out = torch.zeros((n,) + src.shape[1:], dtype=src.dtype)
    return out.index_add_(0, seg, src)

def _pad(x, pw):
    flat = tuple((v for pair in reversed(pw) for v in pair))
    return torch.nn.functional.pad(x, flat)
kernel_name = 'gated_mix__memory_aug_recurrent_mem_tr__mixer_channel_mlp__prompt'

def setup_inputs():

    _w = lambda a: (lambda t: t.to(torch.bfloat16) if t.is_floating_point() else t)(torch.as_tensor(a))

    def _A_setup():
        B, S, Dm = (1, 2048, 1024)
        H, Dh = (32, 128)
        M, seg = (8, 32)
        seg = min(seg, S)
        S = S // seg * seg
        return {'x': _w((lambda *s: torch.randn(*s, dtype=torch.bfloat16) * 0.05)(B, S, Dm)), 'mem0': _w((lambda *s: torch.randn(*s, dtype=torch.bfloat16) * 0.8)(B, M, Dm)), 'Wq': _w((lambda *s: torch.randn(*s, dtype=torch.bfloat16) * 3.2)(Dm, H, Dh) * Dm ** (-0.5)), 'Wk': _w((lambda *s: torch.randn(*s, dtype=torch.bfloat16) * 3.2)(Dm, H, Dh) * Dm ** (-0.5)), 'Wv': _w((lambda *s: torch.randn(*s, dtype=torch.bfloat16) * 0.8)(Dm, H, Dh) * Dm ** (-0.5)), 'Wo': _w((lambda *s: torch.randn(*s, dtype=torch.bfloat16) * 0.8)(H, Dh, Dm) * (H * Dh) ** (-0.5)), 'seg_len': seg}
    _A_in = _A_setup()

    def _B_setup():
        B, S, D, F = (1, 2048, 1024, 3584)
        return {'x': _w((lambda *s: torch.randn(*s, dtype=torch.bfloat16) * 0.05)(B, S, D)), 'w1': _w((lambda *s: torch.randn(*s, dtype=torch.bfloat16) * 1.6)(D, F) * D ** (-0.5)), 'b1': _w((lambda *s: torch.randn(*s, dtype=torch.bfloat16) * 0.8)(F)), 'w2': _w((lambda *s: torch.randn(*s, dtype=torch.bfloat16) * 0.05)(F, D) * F ** (-0.5)), 'b2': _w((lambda *s: torch.randn(*s, dtype=torch.bfloat16) * 0.05)(D))}
    _B_in = _B_setup()
    return {'A_x': _A_in['x'], 'A_mem0': _A_in['mem0'], 'A_Wq': _A_in['Wq'], 'A_Wk': _A_in['Wk'], 'A_Wv': _A_in['Wv'], 'A_Wo': _A_in['Wo'], 'A_seg_len': _A_in['seg_len'], 'B_x': _B_in['x'], 'B_w1': _B_in['w1'], 'B_b1': _B_in['b1'], 'B_w2': _B_in['w2'], 'B_b2': _B_in['b2'], 'gate_w': _w((lambda *s: torch.randn(*s, dtype=torch.bfloat16) * 0.05)(1024) * 16.0)}

def reference(A_x, A_mem0, A_Wq, A_Wk, A_Wv, A_Wo, A_seg_len, B_x, B_w1, B_b1, B_w2, B_b2, gate_w):

    def _A_ref(x, mem0, Wq, Wk, Wv, Wo, seg_len):
        B, S, Dm = x.shape
        H, Dh = (Wq.shape[1], Wq.shape[2])
        M = mem0.shape[1]
        scale = Dh ** (-0.5)
        n_seg = S // seg_len
        L = M + seg_len
        idx = torch.arange(L)
        mask = (idx[:, None] < M) | (idx[:, None] >= idx[None, :])
        mem = mem0
        outs = []
        for s in range(n_seg):
            xs = x[:, s * seg_len:(s + 1) * seg_len, :].clone()
            h = torch.concatenate([mem, xs], axis=1)
            q = torch.einsum('btd,dhe->bhte', h, Wq)
            k = torch.einsum('btd,dhe->bhte', h, Wk)
            v = torch.einsum('btd,dhe->bhte', h, Wv)
            scores = torch.einsum('bhqe,bhke->bhqk', q, k) * scale
            scores = torch.where(mask[None, None], scores, -1000000000.0)
            p = _softmax(scores, axis=-1)
            o = torch.einsum('bhqk,bhke->bhqe', p, v)
            o = torch.einsum('bhte,hed->btd', o, Wo)
            mem = o[:, :M, :].clone()
            outs.append(o[:, M:, :])
        return torch.concatenate(outs, axis=1)

    def _B_ref(x, w1, b1, w2, b2):
        y = _layernorm(x, axis=-1)
        h = _gelu(torch.einsum('bsd,df->bsf', y, w1) + b1)
        return torch.einsum('bsf,fd->bsd', h, w2) + b2
    x = A_x
    g = _sigmoid((x * gate_w).sum(-1, keepdims=True))
    a = _A_ref(x, A_mem0, A_Wq, A_Wk, A_Wv, A_Wo, A_seg_len)
    b = _B_ref(x, B_w1, B_b1, B_w2, B_b2)
    return g * a + (1 - g) * b
```

```asm
; @launch grid=(256,1,1) block=(256,1,1) lds=160000
.amdgcn_target "amdgcn-amd-amdhsa--gfx950"
.text
.globl gated_mix__memory_aug_recurrent_mem_tr__mixer_channel_mlp__prompt_kernel
.p2align 8
.type gated_mix__memory_aug_recurrent_mem_tr__mixer_channel_mlp__prompt_kernel,@function
gated_mix__memory_aug_recurrent_mem_tr__mixer_channel_mlp__prompt_kernel:
  s_load_dwordx2 s[4:5], s[0:1], 120
  s_mov_b32 s6, 268435456
  s_mov_b32 s7, 0x00020000
  s_load_dwordx2 s[40:41], s[0:1], 112
  s_mov_b32 s42, 256
  s_mov_b32 s43, 0x00020000
  v_and_b32 v1, 63, v0
  v_lshrrev_b32 v2, 6, v0
  s_nop 0
  v_readfirstlane_b32 s14, v2
  v_mov_b32 v3, 0
  s_getreg_b32 s12, hwreg(HW_REG_XCC_ID, 0, 4)
  s_waitcnt lgkmcnt(0)
  s_cmp_lg_u32 s14, 0
  s_cbranch_scc1 role_wait
  s_mov_b64 exec, 1
  s_and_b32 s12, s12, 7
  s_lshl_b32 s30, s12, 2
  v_mov_b32 v4, 1
  v_mov_b32 v5, s30
  buffer_atomic_add v4, v5, s[40:43], 0 offen sc0 sc1
  s_waitcnt vmcnt(0)
  v_readfirstlane_b32 s13, v4
  s_lshl_b32 s3, s12, 5
  s_add_u32 s3, s3, s13
  s_cmp_lt_u32 s13, 32
  s_cbranch_scc1 role_done
  buffer_load_dwordx4 v[8:11], v3, s[40:43], 0 offen sc1
  buffer_load_dwordx4 v[12:15], v3, s[40:43], 0 offen offset:16 sc1
  s_waitcnt vmcnt(0)
  v_min3_u32 v8, v8, v9, v10
  v_min3_u32 v8, v8, v11, v12
  v_min3_u32 v8, v8, v13, v14
  v_min_u32 v8, v8, v15
  s_nop 0
  v_readfirstlane_b32 s30, v8
  s_mov_b32 s3, 256
  s_cmp_ge_u32 s30, 32
  s_cbranch_scc1 role_done
  v_mov_b32 v4, 1
  v_mov_b32 v5, 32
  buffer_atomic_add v4, v5, s[40:43], 0 offen sc0 sc1
  s_waitcnt vmcnt(0)
  v_readfirstlane_b32 s13, v4
  v_mov_b32 v4, 1
  v_mov_b32 v5, 0
  buffer_atomic_add v4, v5, s[40:43], 0 offen sc0 sc1
  s_waitcnt vmcnt(0)
  v_readfirstlane_b32 s13, v4
  s_add_u32 s3, s13, 0
  s_cmp_lt_u32 s13, 32
  s_cbranch_scc1 role_done
  v_mov_b32 v4, 1
  v_mov_b32 v5, 4
  buffer_atomic_add v4, v5, s[40:43], 0 offen sc0 sc1
  s_waitcnt vmcnt(0)
  v_readfirstlane_b32 s13, v4
  s_add_u32 s3, s13, 32
  s_cmp_lt_u32 s13, 32
  s_cbranch_scc1 role_done
  v_mov_b32 v4, 1
  v_mov_b32 v5, 8
  buffer_atomic_add v4, v5, s[40:43], 0 offen sc0 sc1
  s_waitcnt vmcnt(0)
  v_readfirstlane_b32 s13, v4
  s_add_u32 s3, s13, 64
  s_cmp_lt_u32 s13, 32
  s_cbranch_scc1 role_done
  v_mov_b32 v4, 1
  v_mov_b32 v5, 12
  buffer_atomic_add v4, v5, s[40:43], 0 offen sc0 sc1
  s_waitcnt vmcnt(0)
  v_readfirstlane_b32 s13, v4
  s_add_u32 s3, s13, 96
  s_cmp_lt_u32 s13, 32
  s_cbranch_scc1 role_done
  v_mov_b32 v4, 1
  v_mov_b32 v5, 16
  buffer_atomic_add v4, v5, s[40:43], 0 offen sc0 sc1
  s_waitcnt vmcnt(0)
  v_readfirstlane_b32 s13, v4
  s_add_u32 s3, s13, 128
  s_cmp_lt_u32 s13, 32
  s_cbranch_scc1 role_done
  v_mov_b32 v4, 1
  v_mov_b32 v5, 20
  buffer_atomic_add v4, v5, s[40:43], 0 offen sc0 sc1
  s_waitcnt vmcnt(0)
  v_readfirstlane_b32 s13, v4
  s_add_u32 s3, s13, 160
  s_cmp_lt_u32 s13, 32
  s_cbranch_scc1 role_done
  v_mov_b32 v4, 1
  v_mov_b32 v5, 24
  buffer_atomic_add v4, v5, s[40:43], 0 offen sc0 sc1
  s_waitcnt vmcnt(0)
  v_readfirstlane_b32 s13, v4
  s_add_u32 s3, s13, 192
  s_cmp_lt_u32 s13, 32
  s_cbranch_scc1 role_done
  v_mov_b32 v4, 1
  v_mov_b32 v5, 28
  buffer_atomic_add v4, v5, s[40:43], 0 offen sc0 sc1
  s_waitcnt vmcnt(0)
  v_readfirstlane_b32 s13, v4
  s_add_u32 s3, s13, 224
  s_cmp_lt_u32 s13, 32
  s_cbranch_scc1 role_done
  s_mov_b32 s3, 256
role_done:
  v_mov_b32 v4, s3
  ds_write_b32 v3, v4
  s_mov_b64 exec, -1
  s_waitcnt lgkmcnt(0)
role_wait:
  s_barrier
  ds_read_b32 v4, v3
  s_waitcnt lgkmcnt(0)
  v_readfirstlane_b32 s3, v4
  s_barrier
  s_cmp_ge_u32 s3, 256
  s_cbranch_scc1 rec_exit
  s_lshr_b32 s12, s3, 5
  s_and_b32 s13, s3, 31
  s_cmp_ge_u32 s3, 128
  s_cbranch_scc1 worker
  v_lshlrev_b32 v2, 4, v0
  v_mov_b32 v8, -1
  v_mov_b32 v9, -1
  v_mov_b32 v10, -1
  v_mov_b32 v11, -1
  v_mov_b32 v3, 0
  s_lshl_b32 s30, s3, 14
  s_add_u32 s30, s30, 101711872
  s_lshr_b32 s38, s3, 2
  s_lshl_b32 s38, s38, 7
  s_and_b32 s31, s3, 3
  s_lshl_b32 s31, s31, 2
  s_add_u32 s38, s38, s31
  s_add_u32 s38, s38, 100679680
  buffer_store_dwordx4 v[8:11], v2, s[4:7], s30 offen sc1
  s_add_u32 s30, s30, 4096
  buffer_store_dwordx4 v[8:11], v2, s[4:7], s30 offen sc1
  s_add_u32 s30, s30, 4096
  buffer_store_dwordx4 v[8:11], v2, s[4:7], s30 offen sc1
  s_add_u32 s30, s30, 4096
  buffer_store_dwordx4 v[8:11], v2, s[4:7], s30 offen sc1
  s_add_u32 s30, s30, 4096
  s_mov_b64 exec, 1
  buffer_store_dword v3, v3, s[4:7], s38 offen sc1
  s_mov_b64 exec, -1
  s_lshl_b32 s30, s14, 15
  v_lshrrev_b32 v12, 2, v1
  v_and_b32 v13, 3, v1
  v_lshlrev_b32 v13, 4, v13
  v_lshrrev_b32 v14, 4, v1
  v_lshlrev_b32 v14, 9, v14
  v_and_b32 v15, 3, v12
  v_lshl_add_u32 v14, v15, 6, v14
  v_add3_u32 v14, v14, v13, s30
  v_lshl_add_u32 v15, v12, 13, v13
  v_lshl_add_u32 v13, v12, 11, v13
  s_lshl_b32 s31, s14, 21
  s_lshl_b32 s32, s12, 11
  s_lshl_b32 s33, s13, 6
  s_add_u32 s31, s31, s32
  s_add_u32 s31, s31, s33
  s_lshl_b32 s32, s12, 21
  s_lshl_b32 s34, s14, 19
  s_add_u32 s32, s32, s34
  s_add_u32 s32, s32, s33
  s_load_dwordx2 s[8:9], s[0:1], 16
  s_mov_b32 s10, 8388608
  s_mov_b32 s11, 0x00020000
  s_add_u32 s35, s30, 0
  s_mov_b32 s36, s31
  s_waitcnt lgkmcnt(0)
  s_mov_b32 m0, s35
  s_add_u32 s35, s35, 1024
  buffer_load_dwordx4 v15, s[8:11], s36 offen lds
  s_add_u32 s36, s36, 131072
  s_mov_b32 m0, s35
  s_add_u32 s35, s35, 1024
  buffer_load_dwordx4 v15, s[8:11], s36 offen lds
  s_add_u32 s36, s36, 131072
  s_mov_b32 m0, s35
  s_add_u32 s35, s35, 1024
  buffer_load_dwordx4 v15, s[8:11], s36 offen lds
  s_add_u32 s36, s36, 131072
  s_mov_b32 m0, s35
  s_add_u32 s35, s35, 1024
  buffer_load_dwordx4 v15, s[8:11], s36 offen lds
  s_add_u32 s36, s36, 131072
  s_mov_b32 m0, s35
  s_add_u32 s35, s35, 1024
  buffer_load_dwordx4 v15, s[8:11], s36 offen lds
  s_add_u32 s36, s36, 131072
  s_mov_b32 m0, s35
  s_add_u32 s35, s35, 1024
  buffer_load_dwordx4 v15, s[8:11], s36 offen lds
  s_add_u32 s36, s36, 131072
  s_mov_b32 m0, s35
  s_add_u32 s35, s35, 1024
  buffer_load_dwordx4 v15, s[8:11], s36 offen lds
  s_add_u32 s36, s36, 131072
  s_mov_b32 m0, s35
  s_add_u32 s35, s35, 1024
  buffer_load_dwordx4 v15, s[8:11], s36 offen lds
  s_add_u32 s36, s36, 131072
  s_mov_b32 m0, s35
  s_add_u32 s35, s35, 1024
  buffer_load_dwordx4 v15, s[8:11], s36 offen lds
  s_add_u32 s36, s36, 131072
  s_mov_b32 m0, s35
  s_add_u32 s35, s35, 1024
  buffer_load_dwordx4 v15, s[8:11], s36 offen lds
  s_add_u32 s36, s36, 131072
  s_mov_b32 m0, s35
  s_add_u32 s35, s35, 1024
  buffer_load_dwordx4 v15, s[8:11], s36 offen lds
  s_add_u32 s36, s36, 131072
  s_mov_b32 m0, s35
  s_add_u32 s35, s35, 1024
  buffer_load_dwordx4 v15, s[8:11], s36 offen lds
  s_add_u32 s36, s36, 131072
  s_mov_b32 m0, s35
  s_add_u32 s35, s35, 1024
  buffer_load_dwordx4 v15, s[8:11], s36 offen lds
  s_add_u32 s36, s36, 131072
  s_mov_b32 m0, s35
  s_add_u32 s35, s35, 1024
  buffer_load_dwordx4 v15, s[8:11], s36 offen lds
  s_add_u32 s36, s36, 131072
  s_mov_b32 m0, s35
  s_add_u32 s35, s35, 1024
  buffer_load_dwordx4 v15, s[8:11], s36 offen lds
  s_add_u32 s36, s36, 131072
  s_mov_b32 m0, s35
  s_add_u32 s35, s35, 1024
  buffer_load_dwordx4 v15, s[8:11], s36 offen lds
  s_add_u32 s36, s36, 131072
  s_load_dwordx2 s[8:9], s[0:1], 24
  s_mov_b32 s10, 8388608
  s_mov_b32 s11, 0x00020000
  s_add_u32 s35, s30, 16384
  s_mov_b32 s36, s31
  s_waitcnt lgkmcnt(0)
  s_mov_b32 m0, s35
  s_add_u32 s35, s35, 1024
  buffer_load_dwordx4 v15, s[8:11], s36 offen lds
  s_add_u32 s36, s36, 131072
  s_mov_b32 m0, s35
  s_add_u32 s35, s35, 1024
  buffer_load_dwordx4 v15, s[8:11], s36 offen lds
  s_add_u32 s36, s36, 131072
  s_mov_b32 m0, s35
  s_add_u32 s35, s35, 1024
  buffer_load_dwordx4 v15, s[8:11], s36 offen lds
  s_add_u32 s36, s36, 131072
  s_mov_b32 m0, s35
  s_add_u32 s35, s35, 1024
  buffer_load_dwordx4 v15, s[8:11], s36 offen lds
  s_add_u32 s36, s36, 131072
  s_mov_b32 m0, s35
  s_add_u32 s35, s35, 1024
  buffer_load_dwordx4 v15, s[8:11], s36 offen lds
  s_add_u32 s36, s36, 131072
  s_mov_b32 m0, s35
  s_add_u32 s35, s35, 1024
  buffer_load_dwordx4 v15, s[8:11], s36 offen lds
  s_add_u32 s36, s36, 131072
  s_mov_b32 m0, s35
  s_add_u32 s35, s35, 1024
  buffer_load_dwordx4 v15, s[8:11], s36 offen lds
  s_add_u32 s36, s36, 131072
  s_mov_b32 m0, s35
  s_add_u32 s35, s35, 1024
  buffer_load_dwordx4 v15, s[8:11], s36 offen lds
  s_add_u32 s36, s36, 131072
  s_mov_b32 m0, s35
  s_add_u32 s35, s35, 1024
  buffer_load_dwordx4 v15, s[8:11], s36 offen lds
  s_add_u32 s36, s36, 131072
  s_mov_b32 m0, s35
  s_add_u32 s35, s35, 1024
  buffer_load_dwordx4 v15, s[8:11], s36 offen lds
  s_add_u32 s36, s36, 131072
  s_mov_b32 m0, s35
  s_add_u32 s35, s35, 1024
  buffer_load_dwordx4 v15, s[8:11], s36 offen lds
  s_add_u32 s36, s36, 131072
  s_mov_b32 m0, s35
  s_add_u32 s35, s35, 1024
  buffer_load_dwordx4 v15, s[8:11], s36 offen lds
  s_add_u32 s36, s36, 131072
  s_mov_b32 m0, s35
  s_add_u32 s35, s35, 1024
  buffer_load_dwordx4 v15, s[8:11], s36 offen lds
  s_add_u32 s36, s36, 131072
  s_mov_b32 m0, s35
  s_add_u32 s35, s35, 1024
  buffer_load_dwordx4 v15, s[8:11], s36 offen lds
  s_add_u32 s36, s36, 131072
  s_mov_b32 m0, s35
  s_add_u32 s35, s35, 1024
  buffer_load_dwordx4 v15, s[8:11], s36 offen lds
  s_add_u32 s36, s36, 131072
  s_mov_b32 m0, s35
  s_add_u32 s35, s35, 1024
  buffer_load_dwordx4 v15, s[8:11], s36 offen lds
  s_add_u32 s36, s36, 131072
  s_waitcnt vmcnt(16)
  s_barrier
  s_cmp_lg_u32 s14, 0
  s_cbranch_scc1 rdy_done
  v_mov_b32 v4, 1
  s_mov_b64 exec, 1
  buffer_atomic_add v4, v3, s[40:43], 0 offen offset:36 sc1
  s_mov_b64 exec, -1
  s_waitcnt vmcnt(16)
rdy_done:
  ds_read_b64_tr_b16 a[0:1], v14 offset:0
  ds_read_b64_tr_b16 a[2:3], v14 offset:256
  ds_read_b64_tr_b16 a[4:5], v14 offset:8
  ds_read_b64_tr_b16 a[6:7], v14 offset:264
  ds_read_b64_tr_b16 a[16:17], v14 offset:2048
  ds_read_b64_tr_b16 a[18:19], v14 offset:2304
  ds_read_b64_tr_b16 a[20:21], v14 offset:2056
  ds_read_b64_tr_b16 a[22:23], v14 offset:2312
  s_waitcnt lgkmcnt(0)
  ds_read_b64_tr_b16 a[32:33], v14 offset:4096
  ds_read_b64_tr_b16 a[34:35], v14 offset:4352
  ds_read_b64_tr_b16 a[36:37], v14 offset:4104
  ds_read_b64_tr_b16 a[38:39], v14 offset:4360
  ds_read_b64_tr_b16 a[48:49], v14 offset:6144
  ds_read_b64_tr_b16 a[50:51], v14 offset:6400
  ds_read_b64_tr_b16 a[52:53], v14 offset:6152
  ds_read_b64_tr_b16 a[54:55], v14 offset:6408
  s_waitcnt lgkmcnt(0)
  ds_read_b64_tr_b16 a[64:65], v14 offset:8192
  ds_read_b64_tr_b16 a[66:67], v14 offset:8448
  ds_read_b64_tr_b16 a[68:69], v14 offset:8200
  ds_read_b64_tr_b16 a[70:71], v14 offset:8456
  ds_read_b64_tr_b16 a[80:81], v14 offset:10240
  ds_read_b64_tr_b16 a[82:83], v14 offset:10496
  ds_read_b64_tr_b16 a[84:85], v14 offset:10248
  ds_read_b64_tr_b16 a[86:87], v14 offset:10504
  s_waitcnt lgkmcnt(0)
  ds_read_b64_tr_b16 a[96:97], v14 offset:12288
  ds_read_b64_tr_b16 a[98:99], v14 offset:12544
  ds_read_b64_tr_b16 a[100:101], v14 offset:12296
  ds_read_b64_tr_b16 a[102:103], v14 offset:12552
  ds_read_b64_tr_b16 a[112:113], v14 offset:14336
  ds_read_b64_tr_b16 a[114:115], v14 offset:14592
  ds_read_b64_tr_b16 a[116:117], v14 offset:14344
  ds_read_b64_tr_b16 a[118:119], v14 offset:14600
  s_waitcnt lgkmcnt(0)
  s_load_dwordx2 s[8:9], s[0:1], 32
  s_mov_b32 s10, 8388608
  s_mov_b32 s11, 0x00020000
  s_add_u32 s35, s30, 0
  s_mov_b32 s36, s31
  s_waitcnt lgkmcnt(0)
  s_mov_b32 m0, s35
  s_add_u32 s35, s35, 1024
  buffer_load_dwordx4 v15, s[8:11], s36 offen lds
  s_add_u32 s36, s36, 131072
  s_mov_b32 m0, s35
  s_add_u32 s35, s35, 1024
  buffer_load_dwordx4 v15, s[8:11], s36 offen lds
  s_add_u32 s36, s36, 131072
  s_mov_b32 m0, s35
  s_add_u32 s35, s35, 1024
  buffer_load_dwordx4 v15, s[8:11], s36 offen lds
  s_add_u32 s36, s36, 131072
  s_mov_b32 m0, s35
  s_add_u32 s35, s35, 1024
  buffer_load_dwordx4 v15, s[8:11], s36 offen lds
  s_add_u32 s36, s36, 131072
  s_mov_b32 m0, s35
  s_add_u32 s35, s35, 1024
  buffer_load_dwordx4 v15, s[8:11], s36 offen lds
  s_add_u32 s36, s36, 131072
  s_mov_b32 m0, s35
  s_add_u32 s35, s35, 1024
  buffer_load_dwordx4 v15, s[8:11], s36 offen lds
  s_add_u32 s36, s36, 131072
  s_mov_b32 m0, s35
  s_add_u32 s35, s35, 1024
  buffer_load_dwordx4 v15, s[8:11], s36 offen lds
  s_add_u32 s36, s36, 131072
  s_mov_b32 m0, s35
  s_add_u32 s35, s35, 1024
  buffer_load_dwordx4 v15, s[8:11], s36 offen lds
  s_add_u32 s36, s36, 131072
  s_mov_b32 m0, s35
  s_add_u32 s35, s35, 1024
  buffer_load_dwordx4 v15, s[8:11], s36 offen lds
  s_add_u32 s36, s36, 131072
  s_mov_b32 m0, s35
  s_add_u32 s35, s35, 1024
  buffer_load_dwordx4 v15, s[8:11], s36 offen lds
  s_add_u32 s36, s36, 131072
  s_mov_b32 m0, s35
  s_add_u32 s35, s35, 1024
  buffer_load_dwordx4 v15, s[8:11], s36 offen lds
  s_add_u32 s36, s36, 131072
  s_mov_b32 m0, s35
  s_add_u32 s35, s35, 1024
  buffer_load_dwordx4 v15, s[8:11], s36 offen lds
  s_add_u32 s36, s36, 131072
  s_mov_b32 m0, s35
  s_add_u32 s35, s35, 1024
  buffer_load_dwordx4 v15, s[8:11], s36 offen lds
  s_add_u32 s36, s36, 131072
  s_mov_b32 m0, s35
  s_add_u32 s35, s35, 1024
  buffer_load_dwordx4 v15, s[8:11], s36 offen lds
  s_add_u32 s36, s36, 131072
  s_mov_b32 m0, s35
  s_add_u32 s35, s35, 1024
  buffer_load_dwordx4 v15, s[8:11], s36 offen lds
  s_add_u32 s36, s36, 131072
  s_mov_b32 m0, s35
  s_add_u32 s35, s35, 1024
  buffer_load_dwordx4 v15, s[8:11], s36 offen lds
  s_add_u32 s36, s36, 131072
  s_waitcnt vmcnt(16)
  ds_read_b64_tr_b16 a[8:9], v14 offset:16384
  ds_read_b64_tr_b16 a[10:11], v14 offset:16640
  ds_read_b64_tr_b16 a[12:13], v14 offset:16392
  ds_read_b64_tr_b16 a[14:15], v14 offset:16648
  ds_read_b64_tr_b16 a[24:25], v14 offset:18432
  ds_read_b64_tr_b16 a[26:27], v14 offset:18688
  ds_read_b64_tr_b16 a[28:29], v14 offset:18440
  ds_read_b64_tr_b16 a[30:31], v14 offset:18696
  s_waitcnt lgkmcnt(0)
  ds_read_b64_tr_b16 a[40:41], v14 offset:20480
  ds_read_b64_tr_b16 a[42:43], v14 offset:20736
  ds_read_b64_tr_b16 a[44:45], v14 offset:20488
  ds_read_b64_tr_b16 a[46:47], v14 offset:20744
  ds_read_b64_tr_b16 a[56:57], v14 offset:22528
  ds_read_b64_tr_b16 a[58:59], v14 offset:22784
  ds_read_b64_tr_b16 a[60:61], v14 offset:22536
  ds_read_b64_tr_b16 a[62:63], v14 offset:22792
  s_waitcnt lgkmcnt(0)
  ds_read_b64_tr_b16 a[72:73], v14 offset:24576
  ds_read_b64_tr_b16 a[74:75], v14 offset:24832
  ds_read_b64_tr_b16 a[76:77], v14 offset:24584
  ds_read_b64_tr_b16 a[78:79], v14 offset:24840
  ds_read_b64_tr_b16 a[88:89], v14 offset:26624
  ds_read_b64_tr_b16 a[90:91], v14 offset:26880
  ds_read_b64_tr_b16 a[92:93], v14 offset:26632
  ds_read_b64_tr_b16 a[94:95], v14 offset:26888
  s_waitcnt lgkmcnt(0)
  ds_read_b64_tr_b16 a[104:105], v14 offset:28672
  ds_read_b64_tr_b16 a[106:107], v14 offset:28928
  ds_read_b64_tr_b16 a[108:109], v14 offset:28680
  ds_read_b64_tr_b16 a[110:111], v14 offset:28936
  ds_read_b64_tr_b16 a[120:121], v14 offset:30720
  ds_read_b64_tr_b16 a[122:123], v14 offset:30976
  ds_read_b64_tr_b16 a[124:125], v14 offset:30728
  ds_read_b64_tr_b16 a[126:127], v14 offset:30984
  s_waitcnt lgkmcnt(0)
  s_load_dwordx2 s[8:9], s[0:1], 40
  s_mov_b32 s10, 8388608
  s_mov_b32 s11, 0x00020000
  s_add_u32 s35, s30, 16384
  s_mov_b32 s36, s32
  s_waitcnt lgkmcnt(0)
  s_mov_b32 m0, s35
  s_add_u32 s35, s35, 1024
  buffer_load_dwordx4 v13, s[8:11], s36 offen lds
  s_add_u32 s36, s36, 32768
  s_mov_b32 m0, s35
  s_add_u32 s35, s35, 1024
  buffer_load_dwordx4 v13, s[8:11], s36 offen lds
  s_add_u32 s36, s36, 32768
  s_mov_b32 m0, s35
  s_add_u32 s35, s35, 1024
  buffer_load_dwordx4 v13, s[8:11], s36 offen lds
  s_add_u32 s36, s36, 32768
  s_mov_b32 m0, s35
  s_add_u32 s35, s35, 1024
  buffer_load_dwordx4 v13, s[8:11], s36 offen lds
  s_add_u32 s36, s36, 32768
  s_mov_b32 m0, s35
  s_add_u32 s35, s35, 1024
  buffer_load_dwordx4 v13, s[8:11], s36 offen lds
  s_add_u32 s36, s36, 32768
  s_mov_b32 m0, s35
  s_add_u32 s35, s35, 1024
  buffer_load_dwordx4 v13, s[8:11], s36 offen lds
  s_add_u32 s36, s36, 32768
  s_mov_b32 m0, s35
  s_add_u32 s35, s35, 1024
  buffer_load_dwordx4 v13, s[8:11], s36 offen lds
  s_add_u32 s36, s36, 32768
  s_mov_b32 m0, s35
  s_add_u32 s35, s35, 1024
  buffer_load_dwordx4 v13, s[8:11], s36 offen lds
  s_add_u32 s36, s36, 32768
  s_mov_b32 m0, s35
  s_add_u32 s35, s35, 1024
  buffer_load_dwordx4 v13, s[8:11], s36 offen lds
  s_add_u32 s36, s36, 32768
  s_mov_b32 m0, s35
  s_add_u32 s35, s35, 1024
  buffer_load_dwordx4 v13, s[8:11], s36 offen lds
  s_add_u32 s36, s36, 32768
  s_mov_b32 m0, s35
  s_add_u32 s35, s35, 1024
  buffer_load_dwordx4 v13, s[8:11], s36 offen lds
  s_add_u32 s36, s36, 32768
  s_mov_b32 m0, s35
  s_add_u32 s35, s35, 1024
  buffer_load_dwordx4 v13, s[8:11], s36 offen lds
  s_add_u32 s36, s36, 32768
  s_mov_b32 m0, s35
  s_add_u32 s35, s35, 1024
  buffer_load_dwordx4 v13, s[8:11], s36 offen lds
  s_add_u32 s36, s36, 32768
  s_mov_b32 m0, s35
  s_add_u32 s35, s35, 1024
  buffer_load_dwordx4 v13, s[8:11], s36 offen lds
  s_add_u32 s36, s36, 32768
  s_mov_b32 m0, s35
  s_add_u32 s35, s35, 1024
  buffer_load_dwordx4 v13, s[8:11], s36 offen lds
  s_add_u32 s36, s36, 32768
  s_mov_b32 m0, s35
  s_add_u32 s35, s35, 1024
  buffer_load_dwordx4 v13, s[8:11], s36 offen lds
  s_add_u32 s36, s36, 32768
  s_waitcnt vmcnt(16)
  ds_read_b64_tr_b16 a[128:129], v14 offset:0
  ds_read_b64_tr_b16 a[130:131], v14 offset:256
  ds_read_b64_tr_b16 a[132:133], v14 offset:8
  ds_read_b64_tr_b16 a[134:135], v14 offset:264
  ds_read_b64_tr_b16 a[136:137], v14 offset:2048
  ds_read_b64_tr_b16 a[138:139], v14 offset:2304
  ds_read_b64_tr_b16 a[140:141], v14 offset:2056
  ds_read_b64_tr_b16 a[142:143], v14 offset:2312
  s_waitcnt lgkmcnt(0)
  ds_read_b64_tr_b16 a[144:145], v14 offset:4096
  ds_read_b64_tr_b16 a[146:147], v14 offset:4352
  ds_read_b64_tr_b16 a[148:149], v14 offset:4104
  ds_read_b64_tr_b16 a[150:151], v14 offset:4360
  ds_read_b64_tr_b16 a[152:153], v14 offset:6144
  ds_read_b64_tr_b16 a[154:155], v14 offset:6400
  ds_read_b64_tr_b16 a[156:157], v14 offset:6152
  ds_read_b64_tr_b16 a[158:159], v14 offset:6408
  s_waitcnt lgkmcnt(0)
  ds_read_b64_tr_b16 a[160:161], v14 offset:8192
  ds_read_b64_tr_b16 a[162:163], v14 offset:8448
  ds_read_b64_tr_b16 a[164:165], v14 offset:8200
  ds_read_b64_tr_b16 a[166:167], v14 offset:8456
  ds_read_b64_tr_b16 a[168:169], v14 offset:10240
  ds_read_b64_tr_b16 a[170:171], v14 offset:10496
  ds_read_b64_tr_b16 a[172:173], v14 offset:10248
  ds_read_b64_tr_b16 a[174:175], v14 offset:10504
  s_waitcnt lgkmcnt(0)
  ds_read_b64_tr_b16 a[176:177], v14 offset:12288
  ds_read_b64_tr_b16 a[178:179], v14 offset:12544
  ds_read_b64_tr_b16 a[180:181], v14 offset:12296
  ds_read_b64_tr_b16 a[182:183], v14 offset:12552
  ds_read_b64_tr_b16 a[184:185], v14 offset:14336
  ds_read_b64_tr_b16 a[186:187], v14 offset:14592
  ds_read_b64_tr_b16 a[188:189], v14 offset:14344
  ds_read_b64_tr_b16 a[190:191], v14 offset:14600
  s_waitcnt lgkmcnt(0)
  s_waitcnt vmcnt(0)
  ds_read_b64_tr_b16 a[192:193], v14 offset:16384
  ds_read_b64_tr_b16 a[194:195], v14 offset:16640
  ds_read_b64_tr_b16 a[196:197], v14 offset:16392
  ds_read_b64_tr_b16 a[198:199], v14 offset:16648
  ds_read_b64_tr_b16 a[200:201], v14 offset:18432
  ds_read_b64_tr_b16 a[202:203], v14 offset:18688
  ds_read_b64_tr_b16 a[204:205], v14 offset:18440
  ds_read_b64_tr_b16 a[206:207], v14 offset:18696
  s_waitcnt lgkmcnt(0)
  ds_read_b64_tr_b16 a[208:209], v14 offset:20480
  ds_read_b64_tr_b16 a[210:211], v14 offset:20736
  ds_read_b64_tr_b16 a[212:213], v14 offset:20488
  ds_read_b64_tr_b16 a[214:215], v14 offset:20744
  ds_read_b64_tr_b16 a[216:217], v14 offset:22528
  ds_read_b64_tr_b16 a[218:219], v14 offset:22784
  ds_read_b64_tr_b16 a[220:221], v14 offset:22536
  ds_read_b64_tr_b16 a[222:223], v14 offset:22792
  s_waitcnt lgkmcnt(0)
  ds_read_b64_tr_b16 a[224:225], v14 offset:24576
  ds_read_b64_tr_b16 a[226:227], v14 offset:24832
  ds_read_b64_tr_b16 a[228:229], v14 offset:24584
  ds_read_b64_tr_b16 a[230:231], v14 offset:24840
  ds_read_b64_tr_b16 a[232:233], v14 offset:26624
  ds_read_b64_tr_b16 a[234:235], v14 offset:26880
  ds_read_b64_tr_b16 a[236:237], v14 offset:26632
  ds_read_b64_tr_b16 a[238:239], v14 offset:26888
  s_waitcnt lgkmcnt(0)
  ds_read_b64_tr_b16 a[240:241], v14 offset:28672
  ds_read_b64_tr_b16 a[242:243], v14 offset:28928
  ds_read_b64_tr_b16 a[244:245], v14 offset:28680
  ds_read_b64_tr_b16 a[246:247], v14 offset:28936
  ds_read_b64_tr_b16 a[248:249], v14 offset:30720
  ds_read_b64_tr_b16 a[250:251], v14 offset:30976
  ds_read_b64_tr_b16 a[252:253], v14 offset:30728
  ds_read_b64_tr_b16 a[254:255], v14 offset:30984
  s_waitcnt lgkmcnt(0)
  v_and_b32 v12, 7, v1
  v_bfe_u32 v13, v1, 3, 1
  v_lshrrev_b32 v14, 4, v1
  v_and_b32 v15, 15, v1
  v_lshlrev_b32 v2, 4, v12
  v_lshl_add_u32 v2, v14, 7, v2
  v_mov_b32 v6, v2
  v_lshl_add_u32 v2, v13, 9, v2
  s_lshl_b32 s30, s12, 14
  s_lshl_b32 s31, s14, 12
  s_mul_i32 s30, s12, 16384
  s_mul_i32 s32, s14, 4096
  s_add_u32 s32, s30, s32
  v_add_u32 v2, s32, v2
  v_lshlrev_b32 v3, 4, v1
  v_mov_b32 v7, v3
  s_lshl_b32 s32, s14, 11
  v_add_u32 v5, s32, v3
  v_add_u32 v3, s31, v3
  v_mov_b32 v8, -1
  v_mov_b32 v9, -1
  v_mov_b32 v10, -1
  v_mov_b32 v11, -1
  s_mov_b32 s24, 0x00ff00ff
  s_mov_b32 s25, 0x00ff00ff
  s_mov_b32 s26, 0xff00ff00
  s_mov_b32 s27, 0xff00ff00
  s_mov_b32 s28, 0
  s_mov_b32 s29, 0x00ff00ff
  s_mov_b32 s15, 0
  s_mov_b32 s23, 0x40000
  s_lshl_b32 s33, s12, 5
  s_add_u32 s33, s33, s13
  s_lshl_b32 s34, s13, 9
  s_add_u32 s34, s34, s30
  s_lshr_b32 s32, s13, 3
  s_mul_i32 s32, s32, 0
  s_add_u32 s34, s34, s32
  v_lshrrev_b32 v100, 2, v15
  v_and_b32 v101, 3, v15
  v_lshl_add_u32 v102, v100, 3, v101
  v_mov_b32 v20, 0
wl_1:
  s_sub_u32 s23, s23, 1
  s_cbranch_scc1 rec_exit
  buffer_load_dword v24, v20, s[40:43], 0 offen offset:36 sc1
  buffer_load_dword v25, v20, s[40:43], 0 offen offset:60 sc1
  s_waitcnt vmcnt(0)
  v_min_u32 v24, v24, v25
  v_cmp_gt_u32 vcc, 128, v24
  s_cbranch_vccz wl_1_ok
  s_sleep 4
  s_branch wl_1
wl_1_ok:
  buffer_load_dword v24, v20, s[40:43], 0 offen offset:32 sc1
  s_waitcnt vmcnt(0)
  v_readfirstlane_b32 s30, v24
  s_barrier
  s_cmp_lg_u32 s30, 0
  s_cbranch_scc1 rec_slow
rec_fast:
  s_cmp_eq_u32 s14, 1
  s_cbranch_scc1 rec_fast1
  s_cmp_eq_u32 s14, 2
  s_cbranch_scc1 rec_fast2
  s_cmp_eq_u32 s14, 3
  s_cbranch_scc1 rec_fast3
rec_fast0:
  v_lshlrev_b32 v80, 11, v13
  v_lshl_add_u32 v80, v14, 8, v80
  v_lshl_add_u32 v80, v12, 4, v80
  s_lshl_b32 s30, s33, 10
  v_add_u32 v81, s30, v7
  v_add_u32 v82, 131072, v81
  s_mul_i32 s31, s33, 1280
  s_add_u32 s31, s31, 327680
  v_add_u32 v83, s31, v7
  s_add_u32 s31, s31, 768
  v_add_u32 v84, s31, v6
  s_lshl_b32 s30, s33, 9
  v_add_u32 v85, s30, v6
  s_mov_b32 s20, 0
  s_mov_b32 s22, 92274688
  buffer_load_dwordx4 v[72:75], v81, s[4:7], s20 offen sc1
  buffer_load_dwordx4 v[76:79], v82, s[4:7], s20 offen sc1
  s_mov_b32 s16, 103284736
  s_mov_b32 s17, 101711872
  s_mov_b32 s18, 102236160
  s_mov_b32 s19, 102760448
top_2:
  buffer_load_dwordx4 v[16:19], v2, s[4:7], s17 offen offset:0 sc1
  s_nop 3
  buffer_load_dwordx4 v[20:23], v2, s[4:7], s17 offen offset:1024 sc1
  s_nop 3
  buffer_load_dwordx4 v[24:27], v2, s[4:7], s17 offen offset:2048 sc1
  s_nop 3
  buffer_load_dwordx4 v[28:31], v2, s[4:7], s17 offen offset:3072 sc1
  s_mov_b32 s35, s16
  s_mov_b32 s16, s17
  s_mov_b32 s17, s18
  s_mov_b32 s18, s19
  s_mov_b32 s19, s35
  s_add_u32 s35, s16, 98304
  s_waitcnt vmcnt(3)
  v_max3_u32 v4, v16, v17, v18
  v_max_u32 v4, v4, v19
  v_cmp_eq_u32 vcc, -1, v4
  s_cbranch_vccnz ret_8
cont_4:
  v_mfma_f32_16x16x32_bf16 v[48:51], a[0:3], v[16:19], 0
  v_mov_b32_dpp v32, v16 row_ror:8 row_mask:0xf bank_mask:0xf
  v_mov_b32_dpp v33, v17 row_ror:8 row_mask:0xf bank_mask:0xf
  v_mfma_f32_16x16x32_bf16 v[52:55], a[4:7], v[16:19], 0
  v_mov_b32_dpp v34, v18 row_ror:8 row_mask:0xf bank_mask:0xf
  v_mov_b32_dpp v35, v19 row_ror:8 row_mask:0xf bank_mask:0xf
  v_mfma_f32_16x16x32_bf16 v[56:59], a[8:11], v[16:19], 0
  v_mfma_f32_16x16x32_bf16 v[60:63], a[12:15], v[16:19], 0
  v_mfma_f32_16x16x32_bf16 v[48:51], a[16:19], v[32:35], v[48:51]
  s_waitcnt vmcnt(2)
  v_max3_u32 v4, v20, v21, v22
  v_mfma_f32_16x16x32_bf16 v[56:59], a[24:27], v[32:35], v[56:59]
  v_max_u32 v4, v4, v23
  v_cmp_eq_u32 vcc, -1, v4
  v_mfma_f32_16x16x32_bf16 v[52:55], a[20:23], v[32:35], v[52:55]
  v_mfma_f32_16x16x32_bf16 v[60:63], a[28:31], v[32:35], v[60:63]
  s_cbranch_vccnz ret_9
cont_5:
  v_mfma_f32_16x16x32_bf16 v[48:51], a[32:35], v[20:23], v[48:51]
  v_mov_b32_dpp v36, v20 row_ror:8 row_mask:0xf bank_mask:0xf
  v_mov_b32_dpp v37, v21 row_ror:8 row_mask:0xf bank_mask:0xf
  v_mfma_f32_16x16x32_bf16 v[52:55], a[36:39], v[20:23], v[52:55]
  v_mov_b32_dpp v38, v22 row_ror:8 row_mask:0xf bank_mask:0xf
  v_mov_b32_dpp v39, v23 row_ror:8 row_mask:0xf bank_mask:0xf
  v_mfma_f32_16x16x32_bf16 v[56:59], a[40:43], v[20:23], v[56:59]
  v_mfma_f32_16x16x32_bf16 v[60:63], a[44:47], v[20:23], v[60:63]
  v_mfma_f32_16x16x32_bf16 v[48:51], a[48:51], v[36:39], v[48:51]
  s_waitcnt vmcnt(1)
  v_max3_u32 v4, v24, v25, v26
  v_mfma_f32_16x16x32_bf16 v[56:59], a[56:59], v[36:39], v[56:59]
  v_max_u32 v4, v4, v27
  v_cmp_eq_u32 vcc, -1, v4
  v_mfma_f32_16x16x32_bf16 v[52:55], a[52:55], v[36:39], v[52:55]
  v_mfma_f32_16x16x32_bf16 v[60:63], a[60:63], v[36:39], v[60:63]
  s_cbranch_vccnz ret_10
cont_6:
  v_mfma_f32_16x16x32_bf16 v[48:51], a[64:67], v[24:27], v[48:51]
  v_mov_b32_dpp v40, v24 row_ror:8 row_mask:0xf bank_mask:0xf
  v_mov_b32_dpp v41, v25 row_ror:8 row_mask:0xf bank_mask:0xf
  v_mfma_f32_16x16x32_bf16 v[52:55], a[68:71], v[24:27], v[52:55]
  v_mov_b32_dpp v42, v26 row_ror:8 row_mask:0xf bank_mask:0xf
  v_mov_b32_dpp v43, v27 row_ror:8 row_mask:0xf bank_mask:0xf
  v_mfma_f32_16x16x32_bf16 v[56:59], a[72:75], v[24:27], v[56:59]
  v_mfma_f32_16x16x32_bf16 v[60:63], a[76:79], v[24:27], v[60:63]
  v_mfma_f32_16x16x32_bf16 v[48:51], a[80:83], v[40:43], v[48:51]
  s_waitcnt vmcnt(0)
  v_max3_u32 v4, v28, v29, v30
  v_mfma_f32_16x16x32_bf16 v[56:59], a[88:91], v[40:43], v[56:59]
  v_max_u32 v4, v4, v31
  v_cmp_eq_u32 vcc, -1, v4
  v_mfma_f32_16x16x32_bf16 v[52:55], a[84:87], v[40:43], v[52:55]
  v_mfma_f32_16x16x32_bf16 v[60:63], a[92:95], v[40:43], v[60:63]
  s_cbranch_vccnz ret_11
cont_7:
  v_mfma_f32_16x16x32_bf16 v[48:51], a[96:99], v[28:31], v[48:51]
  v_mov_b32_dpp v44, v28 row_ror:8 row_mask:0xf bank_mask:0xf
  v_mov_b32_dpp v45, v29 row_ror:8 row_mask:0xf bank_mask:0xf
  v_mfma_f32_16x16x32_bf16 v[52:55], a[100:103], v[28:31], v[52:55]
  v_mov_b32_dpp v46, v30 row_ror:8 row_mask:0xf bank_mask:0xf
  v_mov_b32_dpp v47, v31 row_ror:8 row_mask:0xf bank_mask:0xf
  v_mfma_f32_16x16x32_bf16 v[56:59], a[104:107], v[28:31], v[56:59]
  v_mfma_f32_16x16x32_bf16 v[60:63], a[108:111], v[28:31], v[60:63]
  v_mfma_f32_16x16x32_bf16 v[48:51], a[112:115], v[44:47], v[48:51]
  v_mfma_f32_16x16x32_bf16 v[56:59], a[120:123], v[44:47], v[56:59]
  v_mfma_f32_16x16x32_bf16 v[52:55], a[116:119], v[44:47], v[52:55]
  v_mfma_f32_16x16x32_bf16 v[60:63], a[124:127], v[44:47], v[60:63]
  s_nop 5
  v_mov_b32_dpp v48, v56 row_ror:8 row_mask:0xf bank_mask:0xc
  v_mov_b32_dpp v49, v57 row_ror:8 row_mask:0xf bank_mask:0xc
  v_mov_b32_dpp v50, v58 row_ror:8 row_mask:0xf bank_mask:0xc
  v_mov_b32_dpp v51, v59 row_ror:8 row_mask:0xf bank_mask:0xc
  v_mov_b32_dpp v52, v60 row_ror:8 row_mask:0xf bank_mask:0xc
  v_mov_b32_dpp v53, v61 row_ror:8 row_mask:0xf bank_mask:0xc
  v_mov_b32_dpp v54, v62 row_ror:8 row_mask:0xf bank_mask:0xc
  v_mov_b32_dpp v55, v63 row_ror:8 row_mask:0xf bank_mask:0xc
  s_barrier
  ds_read_b128 v[120:123], v7 offset:2048
  ds_read_b128 v[124:127], v7 offset:3072
  ds_read_b128 v[128:131], v7 offset:4096
  ds_read_b128 v[132:135], v7 offset:5120
  ds_read_b128 v[136:139], v7 offset:6144
  ds_read_b128 v[140:143], v7 offset:7168
  s_waitcnt lgkmcnt(4)
  v_pk_add_f32 v[112:113], v[48:49], v[120:121]
  v_pk_add_f32 v[114:115], v[50:51], v[122:123]
  v_pk_add_f32 v[116:117], v[52:53], v[124:125]
  v_pk_add_f32 v[118:119], v[54:55], v[126:127]
  s_waitcnt lgkmcnt(2)
  v_pk_add_f32 v[112:113], v[112:113], v[128:129]
  v_pk_add_f32 v[114:115], v[114:115], v[130:131]
  v_pk_add_f32 v[116:117], v[116:117], v[132:133]
  v_pk_add_f32 v[118:119], v[118:119], v[134:135]
  s_waitcnt lgkmcnt(0)
  v_pk_add_f32 v[112:113], v[112:113], v[136:137]
  v_pk_add_f32 v[114:115], v[114:115], v[138:139]
  v_pk_add_f32 v[116:117], v[116:117], v[140:141]
  v_pk_add_f32 v[118:119], v[118:119], v[142:143]
  v_cvt_pk_bf16_f32 v96, v112, v113
  v_cvt_pk_bf16_f32 v97, v114, v115
  v_cvt_pk_bf16_f32 v98, v116, v117
  v_cvt_pk_bf16_f32 v99, v118, v119
  s_nop 1
  v_mfma_f32_16x16x32_bf16 v[148:151], v[76:79], v[96:99], 0
  v_mfma_f32_16x16x32_bf16 v[144:147], v[72:75], v[96:99], 0
  v_mfma_f32_16x16x32_bf16 v[152:155], v[96:99], v[96:99], 0
  s_nop 6
  v_mov_b32_dpp v144, v148 row_ror:8 row_mask:0xf bank_mask:0xc
  v_mov_b32_dpp v145, v149 row_ror:8 row_mask:0xf bank_mask:0xc
  v_mov_b32_dpp v146, v150 row_ror:8 row_mask:0xf bank_mask:0xc
  v_mov_b32_dpp v147, v151 row_ror:8 row_mask:0xf bank_mask:0xc
  buffer_store_dwordx4 v[144:147], v83, s[4:7], s16 offen
  s_mov_b64 exec, s[28:29]
  buffer_store_dwordx4 v[152:155], v84, s[4:7], s16 offen
  s_mov_b64 exec, -1
  v_mfma_f32_16x16x32_bf16 v[64:67], a[128:131], v[16:19], 0
  v_mfma_f32_16x16x32_bf16 v[68:71], a[132:135], v[16:19], 0
  v_mfma_f32_16x16x32_bf16 v[64:67], a[136:139], v[32:35], v[64:67]
  v_mfma_f32_16x16x32_bf16 v[68:71], a[140:143], v[32:35], v[68:71]
  v_mfma_f32_16x16x32_bf16 v[64:67], a[144:147], v[20:23], v[64:67]
  v_mfma_f32_16x16x32_bf16 v[68:71], a[148:151], v[20:23], v[68:71]
  v_mfma_f32_16x16x32_bf16 v[64:67], a[152:155], v[36:39], v[64:67]
  v_mfma_f32_16x16x32_bf16 v[68:71], a[156:159], v[36:39], v[68:71]
  v_mfma_f32_16x16x32_bf16 v[64:67], a[160:163], v[24:27], v[64:67]
  v_mfma_f32_16x16x32_bf16 v[68:71], a[164:167], v[24:27], v[68:71]
  v_mfma_f32_16x16x32_bf16 v[64:67], a[168:171], v[40:43], v[64:67]
  v_mfma_f32_16x16x32_bf16 v[68:71], a[172:175], v[40:43], v[68:71]
  v_mfma_f32_16x16x32_bf16 v[64:67], a[176:179], v[28:31], v[64:67]
  v_mfma_f32_16x16x32_bf16 v[68:71], a[180:183], v[28:31], v[68:71]
  v_mfma_f32_16x16x32_bf16 v[64:67], a[184:187], v[44:47], v[64:67]
  v_mfma_f32_16x16x32_bf16 v[68:71], a[188:191], v[44:47], v[68:71]
  s_nop 7
  v_mov_b32_dpp v64, v68 row_ror:8 row_mask:0xf bank_mask:0xc
  v_mov_b32_dpp v65, v69 row_ror:8 row_mask:0xf bank_mask:0xc
  v_mov_b32_dpp v66, v70 row_ror:8 row_mask:0xf bank_mask:0xc
  v_mov_b32_dpp v67, v71 row_ror:8 row_mask:0xf bank_mask:0xc
  ds_write_b128 v5, v[64:67] offset:16384
  s_waitcnt lgkmcnt(0)
  s_barrier
  s_cmp_eq_u32 s15, 63
  s_cbranch_scc1 fin_3
  s_barrier
  s_nop 15
  s_nop 15
  s_nop 7
  buffer_load_dwordx4 v[16:19], v2, s[4:7], s35 offen offset:0 sc1
  s_nop 3
  buffer_load_dwordx4 v[20:23], v2, s[4:7], s35 offen offset:1024 sc1
  s_nop 3
  buffer_load_dwordx4 v[24:27], v2, s[4:7], s35 offen offset:2048 sc1
  s_nop 3
  buffer_load_dwordx4 v[28:31], v2, s[4:7], s35 offen offset:3072 sc1
  s_waitcnt vmcnt(3)
  v_max3_u32 v4, v16, v17, v18
  v_max_u32 v4, v4, v19
  v_cmp_eq_u32 vcc, -1, v4
  s_cbranch_vccnz ret_16
cont_12:
  v_mfma_f32_16x16x32_bf16 v[48:51], a[192:195], v[16:19], 0
  v_mov_b32_dpp v32, v16 row_ror:8 row_mask:0xf bank_mask:0xf
  v_mov_b32_dpp v33, v17 row_ror:8 row_mask:0xf bank_mask:0xf
  v_mov_b32_dpp v34, v18 row_ror:8 row_mask:0xf bank_mask:0xf
  v_mov_b32_dpp v35, v19 row_ror:8 row_mask:0xf bank_mask:0xf
  v_mfma_f32_16x16x32_bf16 v[52:55], a[196:199], v[16:19], 0
  s_waitcnt vmcnt(2)
  v_max3_u32 v4, v20, v21, v22
  v_max_u32 v4, v4, v23
  v_cmp_eq_u32 vcc, -1, v4
  v_mfma_f32_16x16x32_bf16 v[48:51], a[200:203], v[32:35], v[48:51]
  v_mfma_f32_16x16x32_bf16 v[52:55], a[204:207], v[32:35], v[52:55]
  s_cbranch_vccnz ret_17
cont_13:
  v_mfma_f32_16x16x32_bf16 v[48:51], a[208:211], v[20:23], v[48:51]
  v_mov_b32_dpp v36, v20 row_ror:8 row_mask:0xf bank_mask:0xf
  v_mov_b32_dpp v37, v21 row_ror:8 row_mask:0xf bank_mask:0xf
  v_mov_b32_dpp v38, v22 row_ror:8 row_mask:0xf bank_mask:0xf
  v_mov_b32_dpp v39, v23 row_ror:8 row_mask:0xf bank_mask:0xf
  v_mfma_f32_16x16x32_bf16 v[52:55], a[212:215], v[20:23], v[52:55]
  s_waitcnt vmcnt(1)
  v_max3_u32 v4, v24, v25, v26
  v_max_u32 v4, v4, v27
  v_cmp_eq_u32 vcc, -1, v4
  v_mfma_f32_16x16x32_bf16 v[48:51], a[216:219], v[36:39], v[48:51]
  v_mfma_f32_16x16x32_bf16 v[52:55], a[220:223], v[36:39], v[52:55]
  s_cbranch_vccnz ret_18
cont_14:
  v_mfma_f32_16x16x32_bf16 v[48:51], a[224:227], v[24:27], v[48:51]
  v_mov_b32_dpp v40, v24 row_ror:8 row_mask:0xf bank_mask:0xf
  v_mov_b32_dpp v41, v25 row_ror:8 row_mask:0xf bank_mask:0xf
  v_mov_b32_dpp v42, v26 row_ror:8 row_mask:0xf bank_mask:0xf
  v_mov_b32_dpp v43, v27 row_ror:8 row_mask:0xf bank_mask:0xf
  v_mfma_f32_16x16x32_bf16 v[52:55], a[228:231], v[24:27], v[52:55]
  s_waitcnt vmcnt(0)
  v_max3_u32 v4, v28, v29, v30
  v_max_u32 v4, v4, v31
  v_cmp_eq_u32 vcc, -1, v4
  v_mfma_f32_16x16x32_bf16 v[48:51], a[232:235], v[40:43], v[48:51]
  v_mfma_f32_16x16x32_bf16 v[52:55], a[236:239], v[40:43], v[52:55]
  s_cbranch_vccnz ret_19
cont_15:
  v_mfma_f32_16x16x32_bf16 v[48:51], a[240:243], v[28:31], v[48:51]
  v_mov_b32_dpp v44, v28 row_ror:8 row_mask:0xf bank_mask:0xf
  v_mov_b32_dpp v45, v29 row_ror:8 row_mask:0xf bank_mask:0xf
  v_mov_b32_dpp v46, v30 row_ror:8 row_mask:0xf bank_mask:0xf
  v_mov_b32_dpp v47, v31 row_ror:8 row_mask:0xf bank_mask:0xf
  v_mfma_f32_16x16x32_bf16 v[52:55], a[244:247], v[28:31], v[52:55]
  s_nop 0
  v_mfma_f32_16x16x32_bf16 v[48:51], a[248:251], v[44:47], v[48:51]
  v_mfma_f32_16x16x32_bf16 v[52:55], a[252:255], v[44:47], v[52:55]
  s_nop 7
  v_mov_b32_dpp v48, v52 row_ror:8 row_mask:0xf bank_mask:0xc
  v_mov_b32_dpp v49, v53 row_ror:8 row_mask:0xf bank_mask:0xc
  v_mov_b32_dpp v50, v54 row_ror:8 row_mask:0xf bank_mask:0xc
  v_mov_b32_dpp v51, v55 row_ror:8 row_mask:0xf bank_mask:0xc
  ds_write_b128 v5, v[48:51] offset:24576
  s_waitcnt lgkmcnt(0)
  s_barrier
  s_add_u32 s20, s20, 262144
  buffer_load_dwordx4 v[72:75], v81, s[4:7], s20 offen sc1
  buffer_load_dwordx4 v[76:79], v82, s[4:7], s20 offen sc1
  buffer_store_dwordx4 v[8:11], v83, s[4:7], s18 offen
  s_mov_b64 exec, s[28:29]
  buffer_store_dwordx4 v[8:11], v84, s[4:7], s18 offen
  s_mov_b64 exec, s[26:27]
  buffer_store_dwordx4 v[96:99], v85, s[4:7], s22 offen sc1
  s_add_u32 s22, s22, 65536
  s_mov_b64 exec, -1
  s_barrier
  s_add_u32 s15, s15, 1
  s_nop 15
  s_nop 15
  s_nop 7
  s_branch top_2
ret_8:
  s_sub_u32 s23, s23, 1
  s_cbranch_scc1 rec_exit
  buffer_load_dwordx4 v[16:19], v2, s[4:7], s16 offen offset:0 sc1
  buffer_load_dwordx4 v[20:23], v2, s[4:7], s16 offen offset:1024 sc1
  buffer_load_dwordx4 v[24:27], v2, s[4:7], s16 offen offset:2048 sc1
  buffer_load_dwordx4 v[28:31], v2, s[4:7], s16 offen offset:3072 sc1
  s_waitcnt vmcnt(3)
  v_max3_u32 v4, v16, v17, v18
  v_max_u32 v4, v4, v19
  v_cmp_eq_u32 vcc, -1, v4
  s_cbranch_vccnz ret_8
  s_branch cont_4
ret_9:
  s_sub_u32 s23, s23, 1
  s_cbranch_scc1 rec_exit
  buffer_load_dwordx4 v[20:23], v2, s[4:7], s16 offen offset:1024 sc1
  buffer_load_dwordx4 v[24:27], v2, s[4:7], s16 offen offset:2048 sc1
  buffer_load_dwordx4 v[28:31], v2, s[4:7], s16 offen offset:3072 sc1
  s_waitcnt vmcnt(2)
  v_max3_u32 v4, v20, v21, v22
  v_max_u32 v4, v4, v23
  v_cmp_eq_u32 vcc, -1, v4
  s_cbranch_vccnz ret_9
  s_branch cont_5
ret_10:
  s_sub_u32 s23, s23, 1
  s_cbranch_scc1 rec_exit
  buffer_load_dwordx4 v[24:27], v2, s[4:7], s16 offen offset:2048 sc1
  buffer_load_dwordx4 v[28:31], v2, s[4:7], s16 offen offset:3072 sc1
  s_waitcnt vmcnt(1)
  v_max3_u32 v4, v24, v25, v26
  v_max_u32 v4, v4, v27
  v_cmp_eq_u32 vcc, -1, v4
  s_cbranch_vccnz ret_10
  s_branch cont_6
ret_11:
  s_sub_u32 s23, s23, 1
  s_cbranch_scc1 rec_exit
  buffer_load_dwordx4 v[28:31], v2, s[4:7], s16 offen offset:3072 sc1
  s_waitcnt vmcnt(0)
  v_max3_u32 v4, v28, v29, v30
  v_max_u32 v4, v4, v31
  v_cmp_eq_u32 vcc, -1, v4
  s_cbranch_vccnz ret_11
  s_branch cont_7
ret_16:
  s_sub_u32 s23, s23, 1
  s_cbranch_scc1 rec_exit
  buffer_load_dwordx4 v[16:19], v2, s[4:7], s35 offen offset:0 sc1
  buffer_load_dwordx4 v[20:23], v2, s[4:7], s35 offen offset:1024 sc1
  buffer_load_dwordx4 v[24:27], v2, s[4:7], s35 offen offset:2048 sc1
  buffer_load_dwordx4 v[28:31], v2, s[4:7], s35 offen offset:3072 sc1
  s_waitcnt vmcnt(3)
  v_max3_u32 v4, v16, v17, v18
  v_max_u32 v4, v4, v19
  v_cmp_eq_u32 vcc, -1, v4
  s_cbranch_vccnz ret_16
  s_branch cont_12
ret_17:
  s_sub_u32 s23, s23, 1
  s_cbranch_scc1 rec_exit
  buffer_load_dwordx4 v[20:23], v2, s[4:7], s35 offen offset:1024 sc1
  buffer_load_dwordx4 v[24:27], v2, s[4:7], s35 offen offset:2048 sc1
  buffer_load_dwordx4 v[28:31], v2, s[4:7], s35 offen offset:3072 sc1
  s_waitcnt vmcnt(2)
  v_max3_u32 v4, v20, v21, v22
  v_max_u32 v4, v4, v23
  v_cmp_eq_u32 vcc, -1, v4
  s_cbranch_vccnz ret_17
  s_branch cont_13
ret_18:
  s_sub_u32 s23, s23, 1
  s_cbranch_scc1 rec_exit
  buffer_load_dwordx4 v[24:27], v2, s[4:7], s35 offen offset:2048 sc1
  buffer_load_dwordx4 v[28:31], v2, s[4:7], s35 offen offset:3072 sc1
  s_waitcnt vmcnt(1)
  v_max3_u32 v4, v24, v25, v26
  v_max_u32 v4, v4, v27
  v_cmp_eq_u32 vcc, -1, v4
  s_cbranch_vccnz ret_18
  s_branch cont_14
ret_19:
  s_sub_u32 s23, s23, 1
  s_cbranch_scc1 rec_exit
  buffer_load_dwordx4 v[28:31], v2, s[4:7], s35 offen offset:3072 sc1
  s_waitcnt vmcnt(0)
  v_max3_u32 v4, v28, v29, v30
  v_max_u32 v4, v4, v31
  v_cmp_eq_u32 vcc, -1, v4
  s_cbranch_vccnz ret_19
  s_branch cont_15
fin_3:
  s_mov_b64 exec, s[26:27]
  buffer_store_dwordx4 v[96:99], v85, s[4:7], s22 offen sc1
  s_mov_b64 exec, -1
  s_waitcnt vmcnt(0)
  s_barrier
  s_branch rec_exit
rec_fast1:
  s_and_b32 s31, s33, 0xfc
  s_mul_i32 s31, s31, 1280
  s_add_u32 s31, s31, 327680
  v_add_u32 v80, s31, v7
  v_add_u32 v81, 4096, v80
  v_lshrrev_b32 v82, 1, v14
  v_lshlrev_b32 v82, 7, v82
  v_lshl_add_u32 v82, v12, 4, v82
  v_and_b32 v83, 1, v14
  v_lshl_add_u32 v83, v83, 1, v13
  v_lshl_add_u32 v82, v83, 2, v82
  s_add_u32 s31, s31, 1024
  v_add_u32 v82, s31, v82
  v_add_u32 v83, 4096, v82
  v_lshlrev_b32 v84, 8, v100
  v_lshl_add_u32 v84, v14, 5, v84
  v_lshl_add_u32 v84, v101, 2, v84
  v_add_u32 v84, 16384, v84
  s_lshl_b32 s30, s33, 5
  v_add_u32 v86, s30, v102
  v_and_b32 v85, 15, v102
  v_lshlrev_b32 v85, 4, v85
  v_lshl_add_u32 v85, v14, 8, v85
  v_lshl_add_u32 v86, v13, 2, v85
  v_lshl_add_u32 v85, v13, 10, v85
  s_lshl_b32 s30, s33, 11
  v_add_u32 v85, s30, v85
  s_lshr_b32 s30, s33, 1
  s_lshl_b32 s30, s30, 10
  s_and_b32 s31, s33, 1
  s_lshl_b32 s31, s31, 3
  s_add_u32 s30, s30, s31
  v_add_u32 v86, s30, v86
  s_add_u32 s30, s34, 98304
  v_add_u32 v87, s30, v6
  v_mov_b32 v88, 0x3f803f80
  v_mov_b32 v89, 0x3f803f80
  v_mov_b32 v90, 0x3f803f80
  v_mov_b32 v91, 0x3f803f80
  v_mov_b32 v93, 0
  v_mov_b32 v95, 0
  v_mov_b32 v97, 0
  s_mov_b32 s20, 16777216
  s_mov_b32 s22, 96468992
  s_mov_b32 s21, 1040356334
  buffer_load_dwordx4 v[72:75], v85, s[4:7], s20 offen sc1
  buffer_load_dwordx4 v[76:79], v85, s[4:7], s20 offen offset:64 sc1
  v_add_u32 v105, 128, v84
  v_add_u32 v106, 2048, v84
  v_add_u32 v107, 2176, v84
  v_add_u32 v108, 4096, v84
  v_add_u32 v109, 4224, v84
  v_add_u32 v110, 6144, v84
  v_add_u32 v111, 6272, v84
  v_mov_b32 v104, v84
  s_mov_b32 s16, 103284736
  s_mov_b32 s17, 101711872
  s_mov_b32 s18, 102236160
  s_mov_b32 s19, 102760448
top_20:
  buffer_load_dwordx4 v[16:19], v2, s[4:7], s17 offen offset:0 sc1
  s_nop 3
  buffer_load_dwordx4 v[20:23], v2, s[4:7], s17 offen offset:1024 sc1
  s_nop 3
  buffer_load_dwordx4 v[24:27], v2, s[4:7], s17 offen offset:2048 sc1
  s_nop 3
  buffer_load_dwordx4 v[28:31], v2, s[4:7], s17 offen offset:3072 sc1
  s_mov_b32 s35, s16
  s_mov_b32 s16, s17
  s_mov_b32 s17, s18
  s_mov_b32 s18, s19
  s_mov_b32 s19, s35
  s_add_u32 s35, s16, 98304
  s_waitcnt vmcnt(3)
  v_max3_u32 v4, v16, v17, v18
  v_max_u32 v4, v4, v19
  v_cmp_eq_u32 vcc, -1, v4
  s_cbranch_vccnz ret_26
cont_22:
  v_mfma_f32_16x16x32_bf16 v[48:51], a[0:3], v[16:19], 0
  v_mov_b32_dpp v32, v16 row_ror:8 row_mask:0xf bank_mask:0xf
  v_mov_b32_dpp v33, v17 row_ror:8 row_mask:0xf bank_mask:0xf
  v_mfma_f32_16x16x32_bf16 v[52:55], a[4:7], v[16:19], 0
  v_mov_b32_dpp v34, v18 row_ror:8 row_mask:0xf bank_mask:0xf
  v_mov_b32_dpp v35, v19 row_ror:8 row_mask:0xf bank_mask:0xf
  v_mfma_f32_16x16x32_bf16 v[56:59], a[8:11], v[16:19], 0
  v_mfma_f32_16x16x32_bf16 v[60:63], a[12:15], v[16:19], 0
  v_mfma_f32_16x16x32_bf16 v[48:51], a[16:19], v[32:35], v[48:51]
  s_waitcnt vmcnt(2)
  v_max3_u32 v4, v20, v21, v22
  v_mfma_f32_16x16x32_bf16 v[56:59], a[24:27], v[32:35], v[56:59]
  v_max_u32 v4, v4, v23
  v_cmp_eq_u32 vcc, -1, v4
  v_mfma_f32_16x16x32_bf16 v[52:55], a[20:23], v[32:35], v[52:55]
  v_mfma_f32_16x16x32_bf16 v[60:63], a[28:31], v[32:35], v[60:63]
  s_cbranch_vccnz ret_27
cont_23:
  v_mfma_f32_16x16x32_bf16 v[48:51], a[32:35], v[20:23], v[48:51]
  v_mov_b32_dpp v36, v20 row_ror:8 row_mask:0xf bank_mask:0xf
  v_mov_b32_dpp v37, v21 row_ror:8 row_mask:0xf bank_mask:0xf
  v_mfma_f32_16x16x32_bf16 v[52:55], a[36:39], v[20:23], v[52:55]
  v_mov_b32_dpp v38, v22 row_ror:8 row_mask:0xf bank_mask:0xf
  v_mov_b32_dpp v39, v23 row_ror:8 row_mask:0xf bank_mask:0xf
  v_mfma_f32_16x16x32_bf16 v[56:59], a[40:43], v[20:23], v[56:59]
  v_mfma_f32_16x16x32_bf16 v[60:63], a[44:47], v[20:23], v[60:63]
  v_mfma_f32_16x16x32_bf16 v[48:51], a[48:51], v[36:39], v[48:51]
  s_waitcnt vmcnt(1)
  v_max3_u32 v4, v24, v25, v26
  v_mfma_f32_16x16x32_bf16 v[56:59], a[56:59], v[36:39], v[56:59]
  v_max_u32 v4, v4, v27
  v_cmp_eq_u32 vcc, -1, v4
  v_mfma_f32_16x16x32_bf16 v[52:55], a[52:55], v[36:39], v[52:55]
  v_mfma_f32_16x16x32_bf16 v[60:63], a[60:63], v[36:39], v[60:63]
  s_cbranch_vccnz ret_28
cont_24:
  v_mfma_f32_16x16x32_bf16 v[48:51], a[64:67], v[24:27], v[48:51]
  v_mov_b32_dpp v40, v24 row_ror:8 row_mask:0xf bank_mask:0xf
  v_mov_b32_dpp v41, v25 row_ror:8 row_mask:0xf bank_mask:0xf
  v_mfma_f32_16x16x32_bf16 v[52:55], a[68:71], v[24:27], v[52:55]
  v_mov_b32_dpp v42, v26 row_ror:8 row_mask:0xf bank_mask:0xf
  v_mov_b32_dpp v43, v27 row_ror:8 row_mask:0xf bank_mask:0xf
  v_mfma_f32_16x16x32_bf16 v[56:59], a[72:75], v[24:27], v[56:59]
  v_mfma_f32_16x16x32_bf16 v[60:63], a[76:79], v[24:27], v[60:63]
  v_mfma_f32_16x16x32_bf16 v[48:51], a[80:83], v[40:43], v[48:51]
  s_waitcnt vmcnt(0)
  v_max3_u32 v4, v28, v29, v30
  v_mfma_f32_16x16x32_bf16 v[56:59], a[88:91], v[40:43], v[56:59]
  v_max_u32 v4, v4, v31
  v_cmp_eq_u32 vcc, -1, v4
  v_mfma_f32_16x16x32_bf16 v[52:55], a[84:87], v[40:43], v[52:55]
  v_mfma_f32_16x16x32_bf16 v[60:63], a[92:95], v[40:43], v[60:63]
  s_cbranch_vccnz ret_29
cont_25:
  v_mfma_f32_16x16x32_bf16 v[48:51], a[96:99], v[28:31], v[48:51]
  v_mov_b32_dpp v44, v28 row_ror:8 row_mask:0xf bank_mask:0xf
  v_mov_b32_dpp v45, v29 row_ror:8 row_mask:0xf bank_mask:0xf
  v_mfma_f32_16x16x32_bf16 v[52:55], a[100:103], v[28:31], v[52:55]
  v_mov_b32_dpp v46, v30 row_ror:8 row_mask:0xf bank_mask:0xf
  v_mov_b32_dpp v47, v31 row_ror:8 row_mask:0xf bank_mask:0xf
  v_mfma_f32_16x16x32_bf16 v[56:59], a[104:107], v[28:31], v[56:59]
  v_mfma_f32_16x16x32_bf16 v[60:63], a[108:111], v[28:31], v[60:63]
  v_mfma_f32_16x16x32_bf16 v[48:51], a[112:115], v[44:47], v[48:51]
  v_mfma_f32_16x16x32_bf16 v[56:59], a[120:123], v[44:47], v[56:59]
  v_mfma_f32_16x16x32_bf16 v[52:55], a[116:119], v[44:47], v[52:55]
  v_mfma_f32_16x16x32_bf16 v[60:63], a[124:127], v[44:47], v[60:63]
  s_nop 5
  v_mov_b32_dpp v48, v56 row_ror:8 row_mask:0xf bank_mask:0xc
  v_mov_b32_dpp v49, v57 row_ror:8 row_mask:0xf bank_mask:0xc
  v_mov_b32_dpp v50, v58 row_ror:8 row_mask:0xf bank_mask:0xc
  v_mov_b32_dpp v51, v59 row_ror:8 row_mask:0xf bank_mask:0xc
  ds_write_b128 v5, v[48:51] offset:0
  v_mov_b32_dpp v52, v60 row_ror:8 row_mask:0xf bank_mask:0xc
  v_mov_b32_dpp v53, v61 row_ror:8 row_mask:0xf bank_mask:0xc
  v_mov_b32_dpp v54, v62 row_ror:8 row_mask:0xf bank_mask:0xc
  v_mov_b32_dpp v55, v63 row_ror:8 row_mask:0xf bank_mask:0xc
  ds_write_b128 v5, v[52:55] offset:1024
  s_waitcnt lgkmcnt(0)
  s_barrier
  v_mfma_f32_16x16x32_bf16 v[64:67], a[128:131], v[16:19], 0
  v_mfma_f32_16x16x32_bf16 v[68:71], a[132:135], v[16:19], 0
  v_mfma_f32_16x16x32_bf16 v[64:67], a[136:139], v[32:35], v[64:67]
  v_mfma_f32_16x16x32_bf16 v[68:71], a[140:143], v[32:35], v[68:71]
  v_mfma_f32_16x16x32_bf16 v[64:67], a[144:147], v[20:23], v[64:67]
  v_mfma_f32_16x16x32_bf16 v[68:71], a[148:151], v[20:23], v[68:71]
  v_mfma_f32_16x16x32_bf16 v[64:67], a[152:155], v[36:39], v[64:67]
  v_mfma_f32_16x16x32_bf16 v[68:71], a[156:159], v[36:39], v[68:71]
  v_mfma_f32_16x16x32_bf16 v[64:67], a[160:163], v[24:27], v[64:67]
  v_mfma_f32_16x16x32_bf16 v[68:71], a[164:167], v[24:27], v[68:71]
  v_mfma_f32_16x16x32_bf16 v[64:67], a[168:171], v[40:43], v[64:67]
  v_mfma_f32_16x16x32_bf16 v[68:71], a[172:175], v[40:43], v[68:71]
  v_mfma_f32_16x16x32_bf16 v[64:67], a[176:179], v[28:31], v[64:67]
  v_mfma_f32_16x16x32_bf16 v[68:71], a[180:183], v[28:31], v[68:71]
  v_mfma_f32_16x16x32_bf16 v[64:67], a[184:187], v[44:47], v[64:67]
  v_mfma_f32_16x16x32_bf16 v[68:71], a[188:191], v[44:47], v[68:71]
  s_nop 7
  v_mov_b32_dpp v64, v68 row_ror:8 row_mask:0xf bank_mask:0xc
  v_mov_b32_dpp v65, v69 row_ror:8 row_mask:0xf bank_mask:0xc
  v_mov_b32_dpp v66, v70 row_ror:8 row_mask:0xf bank_mask:0xc
  v_mov_b32_dpp v67, v71 row_ror:8 row_mask:0xf bank_mask:0xc
  ds_write_b128 v5, v[64:67] offset:16384
  s_cmp_eq_u32 s15, 63
  s_cbranch_scc1 fin_21
  s_nop 9
  buffer_load_dwordx4 v[168:171], v80, s[4:7], s16 offen offset:0 sc1
  buffer_load_dword v184, v82, s[4:7], s16 offen offset:0 sc1
  buffer_load_dwordx4 v[172:175], v80, s[4:7], s16 offen offset:1280 sc1
  buffer_load_dword v185, v82, s[4:7], s16 offen offset:1280 sc1
  buffer_load_dwordx4 v[176:179], v80, s[4:7], s16 offen offset:2560 sc1
  buffer_load_dword v186, v82, s[4:7], s16 offen offset:2560 sc1
  buffer_load_dwordx4 v[180:183], v80, s[4:7], s16 offen offset:3840 sc1
  buffer_load_dword v187, v82, s[4:7], s16 offen offset:3840 sc1
  s_nop 15
  s_nop 7
  buffer_load_dwordx4 v[188:191], v80, s[4:7], s16 offen offset:0 sc1
  buffer_load_dword v204, v82, s[4:7], s16 offen offset:0 sc1
  buffer_load_dwordx4 v[192:195], v80, s[4:7], s16 offen offset:1280 sc1
  buffer_load_dword v205, v82, s[4:7], s16 offen offset:1280 sc1
  buffer_load_dwordx4 v[196:199], v80, s[4:7], s16 offen offset:2560 sc1
  buffer_load_dword v206, v82, s[4:7], s16 offen offset:2560 sc1
  buffer_load_dwordx4 v[200:203], v80, s[4:7], s16 offen offset:3840 sc1
  buffer_load_dword v207, v82, s[4:7], s16 offen offset:3840 sc1
pp_31:
  s_waitcnt vmcnt(14)
  v_max3_u32 v4, v168, v169, v184
  v_max3_u32 v4, v170, v171, v4
  s_waitcnt vmcnt(12)
  v_max3_u32 v4, v172, v173, v4
  v_max_u32 v4, v185, v4
  v_max3_u32 v4, v174, v175, v4
  v_pk_add_f32 v[128:129], v[168:169], v[172:173]
  v_pk_add_f32 v[130:131], v[170:171], v[174:175]
  v_add_f32 v144, v184, v185
  s_waitcnt vmcnt(10)
  v_max3_u32 v4, v176, v177, v4
  v_max_u32 v4, v186, v4
  v_max3_u32 v4, v178, v179, v4
  v_pk_add_f32 v[128:129], v[128:129], v[176:177]
  v_pk_add_f32 v[130:131], v[130:131], v[178:179]
  v_add_f32 v144, v144, v186
  s_waitcnt vmcnt(8)
  v_max3_u32 v4, v180, v181, v4
  v_max_u32 v4, v187, v4
  v_max3_u32 v4, v182, v183, v4
  v_pk_add_f32 v[128:129], v[128:129], v[180:181]
  v_pk_add_f32 v[130:131], v[130:131], v[182:183]
  v_add_f32 v144, v144, v187
  v_cmp_eq_u32 vcc, -1, v4
  s_cbranch_vccz ppd_33
  buffer_load_dwordx4 v[168:171], v80, s[4:7], s16 offen offset:0 sc1
  buffer_load_dword v184, v82, s[4:7], s16 offen offset:0 sc1
  buffer_load_dwordx4 v[172:175], v80, s[4:7], s16 offen offset:1280 sc1
  buffer_load_dword v185, v82, s[4:7], s16 offen offset:1280 sc1
  buffer_load_dwordx4 v[176:179], v80, s[4:7], s16 offen offset:2560 sc1
  buffer_load_dword v186, v82, s[4:7], s16 offen offset:2560 sc1
  buffer_load_dwordx4 v[180:183], v80, s[4:7], s16 offen offset:3840 sc1
  buffer_load_dword v187, v82, s[4:7], s16 offen offset:3840 sc1
  s_waitcnt vmcnt(14)
  v_max3_u32 v4, v188, v189, v204
  v_max3_u32 v4, v190, v191, v4
  s_waitcnt vmcnt(12)
  v_max3_u32 v4, v192, v193, v4
  v_max_u32 v4, v205, v4
  v_max3_u32 v4, v194, v195, v4
  v_pk_add_f32 v[128:129], v[188:189], v[192:193]
  v_pk_add_f32 v[130:131], v[190:191], v[194:195]
  v_add_f32 v144, v204, v205
  s_waitcnt vmcnt(10)
  v_max3_u32 v4, v196, v197, v4
  v_max_u32 v4, v206, v4
  v_max3_u32 v4, v198, v199, v4
  v_pk_add_f32 v[128:129], v[128:129], v[196:197]
  v_pk_add_f32 v[130:131], v[130:131], v[198:199]
  v_add_f32 v144, v144, v206
  s_waitcnt vmcnt(8)
  v_max3_u32 v4, v200, v201, v4
  v_max_u32 v4, v207, v4
  v_max3_u32 v4, v202, v203, v4
  v_pk_add_f32 v[128:129], v[128:129], v[200:201]
  v_pk_add_f32 v[130:131], v[130:131], v[202:203]
  v_add_f32 v144, v144, v207
  v_cmp_eq_u32 vcc, -1, v4
  s_cbranch_vccz ppd_34
  buffer_load_dwordx4 v[188:191], v80, s[4:7], s16 offen offset:0 sc1
  buffer_load_dword v204, v82, s[4:7], s16 offen offset:0 sc1
  buffer_load_dwordx4 v[192:195], v80, s[4:7], s16 offen offset:1280 sc1
  buffer_load_dword v205, v82, s[4:7], s16 offen offset:1280 sc1
  buffer_load_dwordx4 v[196:199], v80, s[4:7], s16 offen offset:2560 sc1
  buffer_load_dword v206, v82, s[4:7], s16 offen offset:2560 sc1
  buffer_load_dwordx4 v[200:203], v80, s[4:7], s16 offen offset:3840 sc1
  buffer_load_dword v207, v82, s[4:7], s16 offen offset:3840 sc1
  s_sub_u32 s23, s23, 1
  s_cbranch_scc1 rec_exit
  s_branch pp_31
ppd_33:
  s_branch ppe_32
ppd_34:
ppe_32:
  s_waitcnt lgkmcnt(0)
  s_barrier
  v_max3_f32 v150, v128, v129, v130
  v_max3_f32 v150, v131, v144, v150
  ds_read2_b32 v[112:113], v104 offset1:4
  ds_read2_b32 v[114:115], v105 offset1:4
  ds_read2_b32 v[116:117], v106 offset1:4
  ds_read2_b32 v[118:119], v107 offset1:4
  ds_read2_b32 v[120:121], v108 offset1:4
  ds_read2_b32 v[122:123], v109 offset1:4
  ds_read2_b32 v[124:125], v110 offset1:4
  ds_read2_b32 v[126:127], v111 offset1:4
  v_max_f32_dpp v150, v150, v150 row_ror:8 row_mask:0xf bank_mask:0xf
  v_mov_b32 v151, v150
  s_nop 1
  v_permlane16_swap_b32 v150, v151
  s_nop 0
  v_max_f32 v150, v150, v151
  v_mov_b32 v151, v150
  s_nop 1
  v_permlane32_swap_b32 v150, v151
  s_nop 0
  v_max_f32 v150, v150, v151
  v_mul_f32 v150, s21, v150
  v_fma_f32 v144, v144, s21, -v150
  v_fma_f32 v128, v128, s21, -v150
  v_fma_f32 v129, v129, s21, -v150
  v_fma_f32 v130, v130, s21, -v150
  v_fma_f32 v131, v131, s21, -v150
  v_exp_f32 v144, v144
  v_exp_f32 v128, v128
  v_exp_f32 v129, v129
  v_exp_f32 v130, v130
  v_exp_f32 v131, v131
  v_mov_b32_dpp v151, v144 row_ror:8 row_mask:0xf bank_mask:0xf
  v_cvt_pk_bf16_f32 v152, v128, v129
  v_cvt_pk_bf16_f32 v153, v130, v131
  v_cvt_pk_bf16_f32 v96, v144, v151
  v_mov_b32_dpp v154, v152 row_ror:8 row_mask:0xf bank_mask:0xf
  v_mov_b32_dpp v155, v153 row_ror:8 row_mask:0xf bank_mask:0xf
  s_nop 1
  v_mfma_f32_16x16x32_bf16 v[156:159], v[88:91], v[152:155], 0
  v_mfma_f32_16x16x32_bf16 v[160:163], v[72:75], v[152:155], 0
  v_mfma_f32_16x16x32_bf16 v[164:167], v[76:79], v[152:155], 0
  s_waitcnt lgkmcnt(0)
  v_pk_add_f32 v[112:113], v[112:113], v[116:117]
  v_pk_add_f32 v[114:115], v[114:115], v[118:119]
  v_pk_add_f32 v[120:121], v[120:121], v[124:125]
  v_pk_add_f32 v[122:123], v[122:123], v[126:127]
  v_pk_add_f32 v[112:113], v[112:113], v[120:121]
  v_pk_add_f32 v[114:115], v[114:115], v[122:123]
  v_cvt_pk_bf16_f32 v92, v112, v113
  v_cvt_pk_bf16_f32 v94, v114, v115
  v_mfma_f32_16x16x16_bf16 v[156:159], v[88:89], v[96:97], v[156:159]
  s_nop 0
  v_mfma_f32_16x16x16_bf16 v[160:163], v[92:93], v[96:97], v[160:163]
  v_mfma_f32_16x16x16_bf16 v[164:167], v[94:95], v[96:97], v[164:167]
  s_nop 4
  v_rcp_f32 v156, v156
  s_nop 1
  v_pk_mul_f32 v[160:161], v[160:161], v[156:157] op_sel_hi:[1,0]
  v_pk_mul_f32 v[162:163], v[162:163], v[156:157] op_sel_hi:[1,0]
  v_pk_mul_f32 v[164:165], v[164:165], v[156:157] op_sel_hi:[1,0]
  v_pk_mul_f32 v[166:167], v[166:167], v[156:157] op_sel_hi:[1,0]
  v_cvt_pk_bf16_f32 v152, v160, v161
  v_cvt_pk_bf16_f32 v153, v162, v163
  v_cvt_pk_bf16_f32 v154, v164, v165
  v_cvt_pk_bf16_f32 v155, v166, v167
  s_mov_b64 exec, s[24:25]
  buffer_store_dwordx4 v[152:155], v87, s[4:7], s16 offen
  s_mov_b64 exec, -1
  s_barrier
  s_nop 15
  s_nop 15
  s_nop 7
  buffer_load_dwordx4 v[16:19], v2, s[4:7], s35 offen offset:0 sc1
  s_nop 3
  buffer_load_dwordx4 v[20:23], v2, s[4:7], s35 offen offset:1024 sc1
  s_nop 3
  buffer_load_dwordx4 v[24:27], v2, s[4:7], s35 offen offset:2048 sc1
  s_nop 3
  buffer_load_dwordx4 v[28:31], v2, s[4:7], s35 offen offset:3072 sc1
  s_waitcnt vmcnt(3)
  v_max3_u32 v4, v16, v17, v18
  v_max_u32 v4, v4, v19
  v_cmp_eq_u32 vcc, -1, v4
  s_cbranch_vccnz ret_39
cont_35:
  v_mfma_f32_16x16x32_bf16 v[48:51], a[192:195], v[16:19], 0
  v_mov_b32_dpp v32, v16 row_ror:8 row_mask:0xf bank_mask:0xf
  v_mov_b32_dpp v33, v17 row_ror:8 row_mask:0xf bank_mask:0xf
  v_mov_b32_dpp v34, v18 row_ror:8 row_mask:0xf bank_mask:0xf
  v_mov_b32_dpp v35, v19 row_ror:8 row_mask:0xf bank_mask:0xf
  v_mfma_f32_16x16x32_bf16 v[52:55], a[196:199], v[16:19], 0
  s_waitcnt vmcnt(2)
  v_max3_u32 v4, v20, v21, v22
  v_max_u32 v4, v4, v23
  v_cmp_eq_u32 vcc, -1, v4
  v_mfma_f32_16x16x32_bf16 v[48:51], a[200:203], v[32:35], v[48:51]
  v_mfma_f32_16x16x32_bf16 v[52:55], a[204:207], v[32:35], v[52:55]
  s_cbranch_vccnz ret_40
cont_36:
  v_mfma_f32_16x16x32_bf16 v[48:51], a[208:211], v[20:23], v[48:51]
  v_mov_b32_dpp v36, v20 row_ror:8 row_mask:0xf bank_mask:0xf
  v_mov_b32_dpp v37, v21 row_ror:8 row_mask:0xf bank_mask:0xf
  v_mov_b32_dpp v38, v22 row_ror:8 row_mask:0xf bank_mask:0xf
  v_mov_b32_dpp v39, v23 row_ror:8 row_mask:0xf bank_mask:0xf
  v_mfma_f32_16x16x32_bf16 v[52:55], a[212:215], v[20:23], v[52:55]
  s_waitcnt vmcnt(1)
  v_max3_u32 v4, v24, v25, v26
  v_max_u32 v4, v4, v27
  v_cmp_eq_u32 vcc, -1, v4
  v_mfma_f32_16x16x32_bf16 v[48:51], a[216:219], v[36:39], v[48:51]
  v_mfma_f32_16x16x32_bf16 v[52:55], a[220:223], v[36:39], v[52:55]
  s_cbranch_vccnz ret_41
cont_37:
  v_mfma_f32_16x16x32_bf16 v[48:51], a[224:227], v[24:27], v[48:51]
  v_mov_b32_dpp v40, v24 row_ror:8 row_mask:0xf bank_mask:0xf
  v_mov_b32_dpp v41, v25 row_ror:8 row_mask:0xf bank_mask:0xf
  v_mov_b32_dpp v42, v26 row_ror:8 row_mask:0xf bank_mask:0xf
  v_mov_b32_dpp v43, v27 row_ror:8 row_mask:0xf bank_mask:0xf
  v_mfma_f32_16x16x32_bf16 v[52:55], a[228:231], v[24:27], v[52:55]
  s_waitcnt vmcnt(0)
  v_max3_u32 v4, v28, v29, v30
  v_max_u32 v4, v4, v31
  v_cmp_eq_u32 vcc, -1, v4
  v_mfma_f32_16x16x32_bf16 v[48:51], a[232:235], v[40:43], v[48:51]
  v_mfma_f32_16x16x32_bf16 v[52:55], a[236:239], v[40:43], v[52:55]
  s_cbranch_vccnz ret_42
cont_38:
  v_mfma_f32_16x16x32_bf16 v[48:51], a[240:243], v[28:31], v[48:51]
  v_mov_b32_dpp v44, v28 row_ror:8 row_mask:0xf bank_mask:0xf
  v_mov_b32_dpp v45, v29 row_ror:8 row_mask:0xf bank_mask:0xf
  v_mov_b32_dpp v46, v30 row_ror:8 row_mask:0xf bank_mask:0xf
  v_mov_b32_dpp v47, v31 row_ror:8 row_mask:0xf bank_mask:0xf
  v_mfma_f32_16x16x32_bf16 v[52:55], a[244:247], v[28:31], v[52:55]
  s_nop 0
  v_mfma_f32_16x16x32_bf16 v[48:51], a[248:251], v[44:47], v[48:51]
  v_mfma_f32_16x16x32_bf16 v[52:55], a[252:255], v[44:47], v[52:55]
  s_nop 7
  v_mov_b32_dpp v48, v52 row_ror:8 row_mask:0xf bank_mask:0xc
  v_mov_b32_dpp v49, v53 row_ror:8 row_mask:0xf bank_mask:0xc
  v_mov_b32_dpp v50, v54 row_ror:8 row_mask:0xf bank_mask:0xc
  v_mov_b32_dpp v51, v55 row_ror:8 row_mask:0xf bank_mask:0xc
  ds_write_b128 v5, v[48:51] offset:24576
  s_waitcnt lgkmcnt(0)
  s_barrier
  s_add_u32 s20, s20, 262144
  buffer_load_dwordx4 v[72:75], v85, s[4:7], s20 offen sc1
  buffer_load_dwordx4 v[76:79], v85, s[4:7], s20 offen offset:64 sc1
  buffer_store_dword v92, v86, s[4:7], s22 offen sc1
  buffer_store_dword v94, v86, s[4:7], s22 offen offset:64 sc1
  s_add_u32 s22, s22, 65536
  s_mov_b64 exec, s[24:25]
  buffer_store_dwordx4 v[8:11], v87, s[4:7], s18 offen
  s_mov_b64 exec, -1
  s_barrier
  s_add_u32 s15, s15, 1
  s_nop 15
  s_nop 15
  s_nop 7
  s_branch top_20
ret_26:
  s_sub_u32 s23, s23, 1
  s_cbranch_scc1 rec_exit
  buffer_load_dwordx4 v[16:19], v2, s[4:7], s16 offen offset:0 sc1
  buffer_load_dwordx4 v[20:23], v2, s[4:7], s16 offen offset:1024 sc1
  buffer_load_dwordx4 v[24:27], v2, s[4:7], s16 offen offset:2048 sc1
  buffer_load_dwordx4 v[28:31], v2, s[4:7], s16 offen offset:3072 sc1
  s_waitcnt vmcnt(3)
  v_max3_u32 v4, v16, v17, v18
  v_max_u32 v4, v4, v19
  v_cmp_eq_u32 vcc, -1, v4
  s_cbranch_vccnz ret_26
  s_branch cont_22
ret_27:
  s_sub_u32 s23, s23, 1
  s_cbranch_scc1 rec_exit
  buffer_load_dwordx4 v[20:23], v2, s[4:7], s16 offen offset:1024 sc1
  buffer_load_dwordx4 v[24:27], v2, s[4:7], s16 offen offset:2048 sc1
  buffer_load_dwordx4 v[28:31], v2, s[4:7], s16 offen offset:3072 sc1
  s_waitcnt vmcnt(2)
  v_max3_u32 v4, v20, v21, v22
  v_max_u32 v4, v4, v23
  v_cmp_eq_u32 vcc, -1, v4
  s_cbranch_vccnz ret_27
  s_branch cont_23
ret_28:
  s_sub_u32 s23, s23, 1
  s_cbranch_scc1 rec_exit
  buffer_load_dwordx4 v[24:27], v2, s[4:7], s16 offen offset:2048 sc1
  buffer_load_dwordx4 v[28:31], v2, s[4:7], s16 offen offset:3072 sc1
  s_waitcnt vmcnt(1)
  v_max3_u32 v4, v24, v25, v26
  v_max_u32 v4, v4, v27
  v_cmp_eq_u32 vcc, -1, v4
  s_cbranch_vccnz ret_28
  s_branch cont_24
ret_29:
  s_sub_u32 s23, s23, 1
  s_cbranch_scc1 rec_exit
  buffer_load_dwordx4 v[28:31], v2, s[4:7], s16 offen offset:3072 sc1
  s_waitcnt vmcnt(0)
  v_max3_u32 v4, v28, v29, v30
  v_max_u32 v4, v4, v31
  v_cmp_eq_u32 vcc, -1, v4
  s_cbranch_vccnz ret_29
  s_branch cont_25
ret_39:
  s_sub_u32 s23, s23, 1
  s_cbranch_scc1 rec_exit
  buffer_load_dwordx4 v[16:19], v2, s[4:7], s35 offen offset:0 sc1
  buffer_load_dwordx4 v[20:23], v2, s[4:7], s35 offen offset:1024 sc1
  buffer_load_dwordx4 v[24:27], v2, s[4:7], s35 offen offset:2048 sc1
  buffer_load_dwordx4 v[28:31], v2, s[4:7], s35 offen offset:3072 sc1
  s_waitcnt vmcnt(3)
  v_max3_u32 v4, v16, v17, v18
  v_max_u32 v4, v4, v19
  v_cmp_eq_u32 vcc, -1, v4
  s_cbranch_vccnz ret_39
  s_branch cont_35
ret_40:
  s_sub_u32 s23, s23, 1
  s_cbranch_scc1 rec_exit
  buffer_load_dwordx4 v[20:23], v2, s[4:7], s35 offen offset:1024 sc1
  buffer_load_dwordx4 v[24:27], v2, s[4:7], s35 offen offset:2048 sc1
  buffer_load_dwordx4 v[28:31], v2, s[4:7], s35 offen offset:3072 sc1
  s_waitcnt vmcnt(2)
  v_max3_u32 v4, v20, v21, v22
  v_max_u32 v4, v4, v23
  v_cmp_eq_u32 vcc, -1, v4
  s_cbranch_vccnz ret_40
  s_branch cont_36
ret_41:
  s_sub_u32 s23, s23, 1
  s_cbranch_scc1 rec_exit
  buffer_load_dwordx4 v[24:27], v2, s[4:7], s35 offen offset:2048 sc1
  buffer_load_dwordx4 v[28:31], v2, s[4:7], s35 offen offset:3072 sc1
  s_waitcnt vmcnt(1)
  v_max3_u32 v4, v24, v25, v26
  v_max_u32 v4, v4, v27
  v_cmp_eq_u32 vcc, -1, v4
  s_cbranch_vccnz ret_41
  s_branch cont_37
ret_42:
  s_sub_u32 s23, s23, 1
  s_cbranch_scc1 rec_exit
  buffer_load_dwordx4 v[28:31], v2, s[4:7], s35 offen offset:3072 sc1
  s_waitcnt vmcnt(0)
  v_max3_u32 v4, v28, v29, v30
  v_max_u32 v4, v4, v31
  v_cmp_eq_u32 vcc, -1, v4
  s_cbranch_vccnz ret_42
  s_branch cont_38
fin_21:
  s_waitcnt lgkmcnt(0)
  s_barrier
  ds_read2_b32 v[112:113], v104 offset1:4
  ds_read2_b32 v[114:115], v105 offset1:4
  ds_read2_b32 v[116:117], v106 offset1:4
  ds_read2_b32 v[118:119], v107 offset1:4
  ds_read2_b32 v[120:121], v108 offset1:4
  ds_read2_b32 v[122:123], v109 offset1:4
  ds_read2_b32 v[124:125], v110 offset1:4
  ds_read2_b32 v[126:127], v111 offset1:4
  s_waitcnt lgkmcnt(0)
  v_pk_add_f32 v[112:113], v[112:113], v[116:117]
  v_pk_add_f32 v[114:115], v[114:115], v[118:119]
  v_pk_add_f32 v[120:121], v[120:121], v[124:125]
  v_pk_add_f32 v[122:123], v[122:123], v[126:127]
  v_pk_add_f32 v[112:113], v[112:113], v[120:121]
  v_pk_add_f32 v[114:115], v[114:115], v[122:123]
  v_cvt_pk_bf16_f32 v92, v112, v113
  v_cvt_pk_bf16_f32 v94, v114, v115
  buffer_store_dword v92, v86, s[4:7], s22 offen sc1
  buffer_store_dword v94, v86, s[4:7], s22 offen offset:64 sc1
  s_waitcnt vmcnt(0)
  s_barrier
  s_branch rec_exit
rec_fast2:
  v_lshlrev_b32 v80, 10, v13
  v_lshl_add_u32 v80, v14, 8, v80
  v_lshl_add_u32 v80, v12, 4, v80
  s_lshl_b32 s30, s13, 12
  s_add_u32 s30, s30, 196608
  v_lshl_add_u32 v82, v13, 3, v6
  v_add_u32 v82, s30, v82
  s_lshl_b32 s31, s12, 10
  v_add_u32 v81, s31, v82
  v_xor_b32 v85, 1024, v81
  v_xor_b32 v86, 2048, v81
  v_xor_b32 v87, 3072, v81
  v_xor_b32 v88, 520, v85
  v_xor_b32 v89, 520, v86
  v_xor_b32 v90, 520, v87
  v_mul_u32_u24 v91, 504, v13
  v_add_u32 v81, v81, v91
  v_lshl_add_u32 v83, v13, 3, v6
  v_add_u32 v83, s34, v83
  s_load_dwordx2 s[8:9], s[0:1], 8
  s_mov_b32 s10, 16384
  s_mov_b32 s11, 0x00020000
  v_lshlrev_b32 v84, 11, v12
  v_lshl_add_u32 v84, v14, 4, v84
  v_lshl_add_u32 v84, v13, 3, v84
  s_lshl_b32 s30, s13, 6
  s_mov_b32 s16, 101711872
  s_waitcnt lgkmcnt(0)
  buffer_load_dwordx2 v[72:73], v84, s[8:11], s30 offen
  s_waitcnt vmcnt(0)
  v_min_u32 v72, -2, v72
  v_min_u32 v73, -2, v73
  buffer_store_dwordx2 v[72:73], v83, s[4:7], s16 offen
  s_mov_b32 s16, 103284736
  s_mov_b32 s17, 101711872
  s_mov_b32 s18, 102236160
  s_mov_b32 s19, 102760448
top_43:
  buffer_load_dwordx4 v[16:19], v2, s[4:7], s17 offen offset:0 sc1
  s_nop 3
  buffer_load_dwordx4 v[20:23], v2, s[4:7], s17 offen offset:1024 sc1
  s_nop 3
  buffer_load_dwordx4 v[24:27], v2, s[4:7], s17 offen offset:2048 sc1
  s_nop 3
  buffer_load_dwordx4 v[28:31], v2, s[4:7], s17 offen offset:3072 sc1
  s_mov_b32 s35, s16
  s_mov_b32 s16, s17
  s_mov_b32 s17, s18
  s_mov_b32 s18, s19
  s_mov_b32 s19, s35
  s_add_u32 s35, s16, 98304
  s_waitcnt vmcnt(3)
  v_max3_u32 v4, v16, v17, v18
  v_max_u32 v4, v4, v19
  v_cmp_eq_u32 vcc, -1, v4
  s_cbranch_vccnz ret_49
cont_45:
  v_mfma_f32_16x16x32_bf16 v[48:51], a[0:3], v[16:19], 0
  v_mov_b32_dpp v32, v16 row_ror:8 row_mask:0xf bank_mask:0xf
  v_mov_b32_dpp v33, v17 row_ror:8 row_mask:0xf bank_mask:0xf
  v_mfma_f32_16x16x32_bf16 v[52:55], a[4:7], v[16:19], 0
  v_mov_b32_dpp v34, v18 row_ror:8 row_mask:0xf bank_mask:0xf
  v_mov_b32_dpp v35, v19 row_ror:8 row_mask:0xf bank_mask:0xf
  v_mfma_f32_16x16x32_bf16 v[56:59], a[8:11], v[16:19], 0
  v_mfma_f32_16x16x32_bf16 v[60:63], a[12:15], v[16:19], 0
  v_mfma_f32_16x16x32_bf16 v[48:51], a[16:19], v[32:35], v[48:51]
  s_waitcnt vmcnt(2)
  v_max3_u32 v4, v20, v21, v22
  v_mfma_f32_16x16x32_bf16 v[56:59], a[24:27], v[32:35], v[56:59]
  v_max_u32 v4, v4, v23
  v_cmp_eq_u32 vcc, -1, v4
  v_mfma_f32_16x16x32_bf16 v[52:55], a[20:23], v[32:35], v[52:55]
  v_mfma_f32_16x16x32_bf16 v[60:63], a[28:31], v[32:35], v[60:63]
  s_cbranch_vccnz ret_50
cont_46:
  v_mfma_f32_16x16x32_bf16 v[48:51], a[32:35], v[20:23], v[48:51]
  v_mov_b32_dpp v36, v20 row_ror:8 row_mask:0xf bank_mask:0xf
  v_mov_b32_dpp v37, v21 row_ror:8 row_mask:0xf bank_mask:0xf
  v_mfma_f32_16x16x32_bf16 v[52:55], a[36:39], v[20:23], v[52:55]
  v_mov_b32_dpp v38, v22 row_ror:8 row_mask:0xf bank_mask:0xf
  v_mov_b32_dpp v39, v23 row_ror:8 row_mask:0xf bank_mask:0xf
  v_mfma_f32_16x16x32_bf16 v[56:59], a[40:43], v[20:23], v[56:59]
  v_mfma_f32_16x16x32_bf16 v[60:63], a[44:47], v[20:23], v[60:63]
  v_mfma_f32_16x16x32_bf16 v[48:51], a[48:51], v[36:39], v[48:51]
  s_waitcnt vmcnt(1)
  v_max3_u32 v4, v24, v25, v26
  v_mfma_f32_16x16x32_bf16 v[56:59], a[56:59], v[36:39], v[56:59]
  v_max_u32 v4, v4, v27
  v_cmp_eq_u32 vcc, -1, v4
  v_mfma_f32_16x16x32_bf16 v[52:55], a[52:55], v[36:39], v[52:55]
  v_mfma_f32_16x16x32_bf16 v[60:63], a[60:63], v[36:39], v[60:63]
  s_cbranch_vccnz ret_51
cont_47:
  v_mfma_f32_16x16x32_bf16 v[48:51], a[64:67], v[24:27], v[48:51]
  v_mov_b32_dpp v40, v24 row_ror:8 row_mask:0xf bank_mask:0xf
  v_mov_b32_dpp v41, v25 row_ror:8 row_mask:0xf bank_mask:0xf
  v_mfma_f32_16x16x32_bf16 v[52:55], a[68:71], v[24:27], v[52:55]
  v_mov_b32_dpp v42, v26 row_ror:8 row_mask:0xf bank_mask:0xf
  v_mov_b32_dpp v43, v27 row_ror:8 row_mask:0xf bank_mask:0xf
  v_mfma_f32_16x16x32_bf16 v[56:59], a[72:75], v[24:27], v[56:59]
  v_mfma_f32_16x16x32_bf16 v[60:63], a[76:79], v[24:27], v[60:63]
  v_mfma_f32_16x16x32_bf16 v[48:51], a[80:83], v[40:43], v[48:51]
  s_waitcnt vmcnt(0)
  v_max3_u32 v4, v28, v29, v30
  v_mfma_f32_16x16x32_bf16 v[56:59], a[88:91], v[40:43], v[56:59]
  v_max_u32 v4, v4, v31
  v_cmp_eq_u32 vcc, -1, v4
  v_mfma_f32_16x16x32_bf16 v[52:55], a[84:87], v[40:43], v[52:55]
  v_mfma_f32_16x16x32_bf16 v[60:63], a[92:95], v[40:43], v[60:63]
  s_cbranch_vccnz ret_52
cont_48:
  v_mfma_f32_16x16x32_bf16 v[48:51], a[96:99], v[28:31], v[48:51]
  v_mov_b32_dpp v44, v28 row_ror:8 row_mask:0xf bank_mask:0xf
  v_mov_b32_dpp v45, v29 row_ror:8 row_mask:0xf bank_mask:0xf
  v_mfma_f32_16x16x32_bf16 v[52:55], a[100:103], v[28:31], v[52:55]
  v_mov_b32_dpp v46, v30 row_ror:8 row_mask:0xf bank_mask:0xf
  v_mov_b32_dpp v47, v31 row_ror:8 row_mask:0xf bank_mask:0xf
  v_mfma_f32_16x16x32_bf16 v[56:59], a[104:107], v[28:31], v[56:59]
  v_mfma_f32_16x16x32_bf16 v[60:63], a[108:111], v[28:31], v[60:63]
  v_mfma_f32_16x16x32_bf16 v[48:51], a[112:115], v[44:47], v[48:51]
  v_mfma_f32_16x16x32_bf16 v[56:59], a[120:123], v[44:47], v[56:59]
  v_mfma_f32_16x16x32_bf16 v[52:55], a[116:119], v[44:47], v[52:55]
  v_mfma_f32_16x16x32_bf16 v[60:63], a[124:127], v[44:47], v[60:63]
  s_nop 5
  v_mov_b32_dpp v48, v56 row_ror:8 row_mask:0xf bank_mask:0xc
  v_mov_b32_dpp v49, v57 row_ror:8 row_mask:0xf bank_mask:0xc
  v_mov_b32_dpp v50, v58 row_ror:8 row_mask:0xf bank_mask:0xc
  v_mov_b32_dpp v51, v59 row_ror:8 row_mask:0xf bank_mask:0xc
  ds_write_b128 v5, v[48:51] offset:0
  v_mov_b32_dpp v52, v60 row_ror:8 row_mask:0xf bank_mask:0xc
  v_mov_b32_dpp v53, v61 row_ror:8 row_mask:0xf bank_mask:0xc
  v_mov_b32_dpp v54, v62 row_ror:8 row_mask:0xf bank_mask:0xc
  v_mov_b32_dpp v55, v63 row_ror:8 row_mask:0xf bank_mask:0xc
  ds_write_b128 v5, v[52:55] offset:1024
  s_waitcnt lgkmcnt(0)
  s_barrier
  v_mfma_f32_16x16x32_bf16 v[64:67], a[128:131], v[16:19], 0
  v_mfma_f32_16x16x32_bf16 v[68:71], a[132:135], v[16:19], 0
  v_mfma_f32_16x16x32_bf16 v[64:67], a[136:139], v[32:35], v[64:67]
  v_mfma_f32_16x16x32_bf16 v[68:71], a[140:143], v[32:35], v[68:71]
  v_mfma_f32_16x16x32_bf16 v[64:67], a[144:147], v[20:23], v[64:67]
  v_mfma_f32_16x16x32_bf16 v[68:71], a[148:151], v[20:23], v[68:71]
  v_mfma_f32_16x16x32_bf16 v[64:67], a[152:155], v[36:39], v[64:67]
  v_mfma_f32_16x16x32_bf16 v[68:71], a[156:159], v[36:39], v[68:71]
  v_mfma_f32_16x16x32_bf16 v[64:67], a[160:163], v[24:27], v[64:67]
  v_mfma_f32_16x16x32_bf16 v[68:71], a[164:167], v[24:27], v[68:71]
  v_mfma_f32_16x16x32_bf16 v[64:67], a[168:171], v[40:43], v[64:67]
  v_mfma_f32_16x16x32_bf16 v[68:71], a[172:175], v[40:43], v[68:71]
  v_mfma_f32_16x16x32_bf16 v[64:67], a[176:179], v[28:31], v[64:67]
  v_mfma_f32_16x16x32_bf16 v[68:71], a[180:183], v[28:31], v[68:71]
  v_mfma_f32_16x16x32_bf16 v[64:67], a[184:187], v[44:47], v[64:67]
  v_mfma_f32_16x16x32_bf16 v[68:71], a[188:191], v[44:47], v[68:71]
  s_nop 7
  v_mov_b32_dpp v64, v68 row_ror:8 row_mask:0xf bank_mask:0xc
  v_mov_b32_dpp v65, v69 row_ror:8 row_mask:0xf bank_mask:0xc
  v_mov_b32_dpp v66, v70 row_ror:8 row_mask:0xf bank_mask:0xc
  v_mov_b32_dpp v67, v71 row_ror:8 row_mask:0xf bank_mask:0xc
  ds_write_b128 v5, v[64:67] offset:16384
  s_waitcnt lgkmcnt(0)
  s_barrier
  s_cmp_eq_u32 s15, 63
  s_cbranch_scc1 fin_44
  s_barrier
  s_nop 15
  s_nop 15
  s_nop 7
  buffer_load_dwordx4 v[16:19], v2, s[4:7], s35 offen offset:0 sc1
  s_nop 3
  buffer_load_dwordx4 v[20:23], v2, s[4:7], s35 offen offset:1024 sc1
  s_nop 3
  buffer_load_dwordx4 v[24:27], v2, s[4:7], s35 offen offset:2048 sc1
  s_nop 3
  buffer_load_dwordx4 v[28:31], v2, s[4:7], s35 offen offset:3072 sc1
  s_waitcnt vmcnt(3)
  v_max3_u32 v4, v16, v17, v18
  v_max_u32 v4, v4, v19
  v_cmp_eq_u32 vcc, -1, v4
  s_cbranch_vccnz ret_57
cont_53:
  v_mfma_f32_16x16x32_bf16 v[48:51], a[192:195], v[16:19], 0
  v_mov_b32_dpp v32, v16 row_ror:8 row_mask:0xf bank_mask:0xf
  v_mov_b32_dpp v33, v17 row_ror:8 row_mask:0xf bank_mask:0xf
  v_mov_b32_dpp v34, v18 row_ror:8 row_mask:0xf bank_mask:0xf
  v_mov_b32_dpp v35, v19 row_ror:8 row_mask:0xf bank_mask:0xf
  v_mfma_f32_16x16x32_bf16 v[52:55], a[196:199], v[16:19], 0
  s_waitcnt vmcnt(2)
  v_max3_u32 v4, v20, v21, v22
  v_max_u32 v4, v4, v23
  v_cmp_eq_u32 vcc, -1, v4
  v_mfma_f32_16x16x32_bf16 v[48:51], a[200:203], v[32:35], v[48:51]
  v_mfma_f32_16x16x32_bf16 v[52:55], a[204:207], v[32:35], v[52:55]
  s_cbranch_vccnz ret_58
cont_54:
  v_mfma_f32_16x16x32_bf16 v[48:51], a[208:211], v[20:23], v[48:51]
  v_mov_b32_dpp v36, v20 row_ror:8 row_mask:0xf bank_mask:0xf
  v_mov_b32_dpp v37, v21 row_ror:8 row_mask:0xf bank_mask:0xf
  v_mov_b32_dpp v38, v22 row_ror:8 row_mask:0xf bank_mask:0xf
  v_mov_b32_dpp v39, v23 row_ror:8 row_mask:0xf bank_mask:0xf
  v_mfma_f32_16x16x32_bf16 v[52:55], a[212:215], v[20:23], v[52:55]
  s_waitcnt vmcnt(1)
  v_max3_u32 v4, v24, v25, v26
  v_max_u32 v4, v4, v27
  v_cmp_eq_u32 vcc, -1, v4
  v_mfma_f32_16x16x32_bf16 v[48:51], a[216:219], v[36:39], v[48:51]
  v_mfma_f32_16x16x32_bf16 v[52:55], a[220:223], v[36:39], v[52:55]
  s_cbranch_vccnz ret_59
cont_55:
  v_mfma_f32_16x16x32_bf16 v[48:51], a[224:227], v[24:27], v[48:51]
  v_mov_b32_dpp v40, v24 row_ror:8 row_mask:0xf bank_mask:0xf
  v_mov_b32_dpp v41, v25 row_ror:8 row_mask:0xf bank_mask:0xf
  v_mov_b32_dpp v42, v26 row_ror:8 row_mask:0xf bank_mask:0xf
  v_mov_b32_dpp v43, v27 row_ror:8 row_mask:0xf bank_mask:0xf
  v_mfma_f32_16x16x32_bf16 v[52:55], a[228:231], v[24:27], v[52:55]
  s_waitcnt vmcnt(0)
  v_max3_u32 v4, v28, v29, v30
  v_max_u32 v4, v4, v31
  v_cmp_eq_u32 vcc, -1, v4
  v_mfma_f32_16x16x32_bf16 v[48:51], a[232:235], v[40:43], v[48:51]
  v_mfma_f32_16x16x32_bf16 v[52:55], a[236:239], v[40:43], v[52:55]
  s_cbranch_vccnz ret_60
cont_56:
  v_mfma_f32_16x16x32_bf16 v[48:51], a[240:243], v[28:31], v[48:51]
  v_mov_b32_dpp v44, v28 row_ror:8 row_mask:0xf bank_mask:0xf
  v_mov_b32_dpp v45, v29 row_ror:8 row_mask:0xf bank_mask:0xf
  v_mov_b32_dpp v46, v30 row_ror:8 row_mask:0xf bank_mask:0xf
  v_mov_b32_dpp v47, v31 row_ror:8 row_mask:0xf bank_mask:0xf
  v_mfma_f32_16x16x32_bf16 v[52:55], a[244:247], v[28:31], v[52:55]
  s_nop 0
  v_mfma_f32_16x16x32_bf16 v[48:51], a[248:251], v[44:47], v[48:51]
  v_mfma_f32_16x16x32_bf16 v[52:55], a[252:255], v[44:47], v[52:55]
  s_nop 7
  v_mov_b32_dpp v48, v52 row_ror:8 row_mask:0xf bank_mask:0xc
  v_mov_b32_dpp v49, v53 row_ror:8 row_mask:0xf bank_mask:0xc
  v_mov_b32_dpp v50, v54 row_ror:8 row_mask:0xf bank_mask:0xc
  v_mov_b32_dpp v51, v55 row_ror:8 row_mask:0xf bank_mask:0xc
  s_barrier
  ds_read_b128 v[112:115], v7 offset:24576
  ds_read_b128 v[116:119], v7 offset:26624
  ds_read_b128 v[120:123], v7 offset:30720
  s_waitcnt lgkmcnt(2)
  v_pk_add_f32 v[128:129], v[48:49], v[112:113]
  v_pk_add_f32 v[130:131], v[50:51], v[114:115]
  s_waitcnt lgkmcnt(0)
  v_pk_add_f32 v[116:117], v[116:117], v[120:121]
  v_pk_add_f32 v[118:119], v[118:119], v[122:123]
  v_pk_add_f32 v[128:129], v[128:129], v[116:117]
  v_pk_add_f32 v[130:131], v[130:131], v[118:119]
  v_cvt_pk_bf16_f32 v132, v128, v129
  v_cvt_pk_bf16_f32 v133, v130, v131
  s_nop 0
  v_mov_b32_dpp v134, v132 row_ror:8 row_mask:0xf bank_mask:0xf
  v_mov_b32_dpp v135, v133 row_ror:8 row_mask:0xf bank_mask:0xf
  s_mov_b64 exec, s[24:25]
  buffer_store_dwordx4 v[132:135], v81, s[4:7], s16 offen sc1
  buffer_store_dwordx4 v[8:11], v81, s[4:7], s18 offen sc1
  s_mov_b64 exec, -1
  s_nop 15
  s_nop 15
  s_nop 15
  s_nop 15
  s_nop 15
  s_nop 15
  s_nop 15
  s_nop 15
  s_nop 15
  s_nop 15
  s_nop 15
  s_nop 15
  s_nop 7
  buffer_load_dwordx2 v[136:137], v85, s[4:7], s16 offen sc1
  buffer_load_dwordx2 v[138:139], v86, s[4:7], s16 offen sc1
  buffer_load_dwordx2 v[140:141], v87, s[4:7], s16 offen sc1
pp_62:
  s_waitcnt vmcnt(2)
  v_max_u32 v4, v136, v137
  v_lshlrev_b32 v120, 16, v136
  v_and_b32 v121, 0xffff0000, v136
  v_lshlrev_b32 v122, 16, v137
  v_and_b32 v123, 0xffff0000, v137
  v_pk_add_f32 v[112:113], v[128:129], v[120:121]
  v_pk_add_f32 v[114:115], v[130:131], v[122:123]
  s_waitcnt vmcnt(1)
  v_max3_u32 v4, v138, v139, v4
  v_lshlrev_b32 v120, 16, v138
  v_and_b32 v121, 0xffff0000, v138
  v_lshlrev_b32 v122, 16, v139
  v_and_b32 v123, 0xffff0000, v139
  v_pk_add_f32 v[112:113], v[112:113], v[120:121]
  v_pk_add_f32 v[114:115], v[114:115], v[122:123]
  s_waitcnt vmcnt(0)
  v_max3_u32 v4, v140, v141, v4
  v_cmp_eq_u32 vcc, -1, v4
  v_lshlrev_b32 v120, 16, v140
  v_and_b32 v121, 0xffff0000, v140
  v_lshlrev_b32 v122, 16, v141
  v_and_b32 v123, 0xffff0000, v141
  v_pk_add_f32 v[112:113], v[112:113], v[120:121]
  v_pk_add_f32 v[114:115], v[114:115], v[122:123]
  v_cvt_pk_bf16_f32 v72, v112, v113
  v_cvt_pk_bf16_f32 v73, v114, v115
  s_cbranch_vccz ppd_64
  buffer_load_dwordx2 v[136:137], v85, s[4:7], s16 offen sc1
  buffer_load_dwordx2 v[138:139], v86, s[4:7], s16 offen sc1
  buffer_load_dwordx2 v[140:141], v87, s[4:7], s16 offen sc1
  s_sub_u32 s23, s23, 1
  s_cbranch_scc1 rec_exit
  s_branch pp_62
ppd_64:
ppe_63:
  buffer_store_dwordx2 v[72:73], v83, s[4:7], s17 offen
  s_barrier
  s_add_u32 s15, s15, 1
  s_nop 15
  s_nop 15
  s_nop 7
  s_branch top_43
ret_49:
  s_sub_u32 s23, s23, 1
  s_cbranch_scc1 rec_exit
  buffer_load_dwordx4 v[16:19], v2, s[4:7], s16 offen offset:0 sc1
  buffer_load_dwordx4 v[20:23], v2, s[4:7], s16 offen offset:1024 sc1
  buffer_load_dwordx4 v[24:27], v2, s[4:7], s16 offen offset:2048 sc1
  buffer_load_dwordx4 v[28:31], v2, s[4:7], s16 offen offset:3072 sc1
  s_waitcnt vmcnt(3)
  v_max3_u32 v4, v16, v17, v18
  v_max_u32 v4, v4, v19
  v_cmp_eq_u32 vcc, -1, v4
  s_cbranch_vccnz ret_49
  s_branch cont_45
ret_50:
  s_sub_u32 s23, s23, 1
  s_cbranch_scc1 rec_exit
  buffer_load_dwordx4 v[20:23], v2, s[4:7], s16 offen offset:1024 sc1
  buffer_load_dwordx4 v[24:27], v2, s[4:7], s16 offen offset:2048 sc1
  buffer_load_dwordx4 v[28:31], v2, s[4:7], s16 offen offset:3072 sc1
  s_waitcnt vmcnt(2)
  v_max3_u32 v4, v20, v21, v22
  v_max_u32 v4, v4, v23
  v_cmp_eq_u32 vcc, -1, v4
  s_cbranch_vccnz ret_50
  s_branch cont_46
ret_51:
  s_sub_u32 s23, s23, 1
  s_cbranch_scc1 rec_exit
  buffer_load_dwordx4 v[24:27], v2, s[4:7], s16 offen offset:2048 sc1
  buffer_load_dwordx4 v[28:31], v2, s[4:7], s16 offen offset:3072 sc1
  s_waitcnt vmcnt(1)
  v_max3_u32 v4, v24, v25, v26
  v_max_u32 v4, v4, v27
  v_cmp_eq_u32 vcc, -1, v4
  s_cbranch_vccnz ret_51
  s_branch cont_47
ret_52:
  s_sub_u32 s23, s23, 1
  s_cbranch_scc1 rec_exit
  buffer_load_dwordx4 v[28:31], v2, s[4:7], s16 offen offset:3072 sc1
  s_waitcnt vmcnt(0)
  v_max3_u32 v4, v28, v29, v30
  v_max_u32 v4, v4, v31
  v_cmp_eq_u32 vcc, -1, v4
  s_cbranch_vccnz ret_52
  s_branch cont_48
ret_57:
  s_sub_u32 s23, s23, 1
  s_cbranch_scc1 rec_exit
  buffer_load_dwordx4 v[16:19], v2, s[4:7], s35 offen offset:0 sc1
  buffer_load_dwordx4 v[20:23], v2, s[4:7], s35 offen offset:1024 sc1
  buffer_load_dwordx4 v[24:27], v2, s[4:7], s35 offen offset:2048 sc1
  buffer_load_dwordx4 v[28:31], v2, s[4:7], s35 offen offset:3072 sc1
  s_waitcnt vmcnt(3)
  v_max3_u32 v4, v16, v17, v18
  v_max_u32 v4, v4, v19
  v_cmp_eq_u32 vcc, -1, v4
  s_cbranch_vccnz ret_57
  s_branch cont_53
ret_58:
  s_sub_u32 s23, s23, 1
  s_cbranch_scc1 rec_exit
  buffer_load_dwordx4 v[20:23], v2, s[4:7], s35 offen offset:1024 sc1
  buffer_load_dwordx4 v[24:27], v2, s[4:7], s35 offen offset:2048 sc1
  buffer_load_dwordx4 v[28:31], v2, s[4:7], s35 offen offset:3072 sc1
  s_waitcnt vmcnt(2)
  v_max3_u32 v4, v20, v21, v22
  v_max_u32 v4, v4, v23
  v_cmp_eq_u32 vcc, -1, v4
  s_cbranch_vccnz ret_58
  s_branch cont_54
ret_59:
  s_sub_u32 s23, s23, 1
  s_cbranch_scc1 rec_exit
  buffer_load_dwordx4 v[24:27], v2, s[4:7], s35 offen offset:2048 sc1
  buffer_load_dwordx4 v[28:31], v2, s[4:7], s35 offen offset:3072 sc1
  s_waitcnt vmcnt(1)
  v_max3_u32 v4, v24, v25, v26
  v_max_u32 v4, v4, v27
  v_cmp_eq_u32 vcc, -1, v4
  s_cbranch_vccnz ret_59
  s_branch cont_55
ret_60:
  s_sub_u32 s23, s23, 1
  s_cbranch_scc1 rec_exit
  buffer_load_dwordx4 v[28:31], v2, s[4:7], s35 offen offset:3072 sc1
  s_waitcnt vmcnt(0)
  v_max3_u32 v4, v28, v29, v30
  v_max_u32 v4, v4, v31
  v_cmp_eq_u32 vcc, -1, v4
  s_cbranch_vccnz ret_60
  s_branch cont_56
fin_44:
  s_waitcnt vmcnt(0)
  s_barrier
  s_branch rec_exit
rec_fast3:
  v_lshlrev_b32 v80, 10, v13
  v_lshl_add_u32 v80, v14, 8, v80
  v_lshl_add_u32 v80, v12, 4, v80
  s_lshl_b32 s30, s13, 12
  s_add_u32 s30, s30, 196608
  v_lshl_add_u32 v82, v13, 3, v6
  v_add_u32 v82, s30, v82
  s_lshl_b32 s31, s12, 10
  v_add_u32 v81, s31, v82
  v_xor_b32 v85, 1024, v81
  v_xor_b32 v86, 2048, v81
  v_xor_b32 v87, 3072, v81
  v_xor_b32 v88, 520, v85
  v_xor_b32 v89, 520, v86
  v_xor_b32 v90, 520, v87
  v_mul_u32_u24 v91, 504, v13
  v_add_u32 v81, v81, v91
  v_lshl_add_u32 v83, v13, 3, v6
  v_add_u32 v83, s34, v83
  s_mov_b32 s20, s38
  s_mov_b32 s36, 0x40404044
  s_mov_b32 s37, 0x00404040
  s_mov_b32 s16, 103284736
  s_mov_b32 s17, 101711872
  s_mov_b32 s18, 102236160
  s_mov_b32 s19, 102760448
top_65:
  buffer_load_dwordx4 v[16:19], v2, s[4:7], s17 offen offset:0 sc1
  s_nop 3
  buffer_load_dwordx4 v[20:23], v2, s[4:7], s17 offen offset:1024 sc1
  s_nop 3
  buffer_load_dwordx4 v[24:27], v2, s[4:7], s17 offen offset:2048 sc1
  s_nop 3
  buffer_load_dwordx4 v[28:31], v2, s[4:7], s17 offen offset:3072 sc1
  s_mov_b32 s35, s16
  s_mov_b32 s16, s17
  s_mov_b32 s17, s18
  s_mov_b32 s18, s19
  s_mov_b32 s19, s35
  s_add_u32 s35, s16, 98304
  s_waitcnt vmcnt(3)
  v_max3_u32 v4, v16, v17, v18
  v_max_u32 v4, v4, v19
  v_cmp_eq_u32 vcc, -1, v4
  s_cbranch_vccnz ret_71
cont_67:
  v_mfma_f32_16x16x32_bf16 v[48:51], a[0:3], v[16:19], 0
  v_mov_b32_dpp v32, v16 row_ror:8 row_mask:0xf bank_mask:0xf
  v_mov_b32_dpp v33, v17 row_ror:8 row_mask:0xf bank_mask:0xf
  v_mfma_f32_16x16x32_bf16 v[52:55], a[4:7], v[16:19], 0
  v_mov_b32_dpp v34, v18 row_ror:8 row_mask:0xf bank_mask:0xf
  v_mov_b32_dpp v35, v19 row_ror:8 row_mask:0xf bank_mask:0xf
  v_mfma_f32_16x16x32_bf16 v[56:59], a[8:11], v[16:19], 0
  v_mfma_f32_16x16x32_bf16 v[60:63], a[12:15], v[16:19], 0
  v_mfma_f32_16x16x32_bf16 v[48:51], a[16:19], v[32:35], v[48:51]
  s_waitcnt vmcnt(2)
  v_max3_u32 v4, v20, v21, v22
  v_mfma_f32_16x16x32_bf16 v[56:59], a[24:27], v[32:35], v[56:59]
  v_max_u32 v4, v4, v23
  v_cmp_eq_u32 vcc, -1, v4
  v_mfma_f32_16x16x32_bf16 v[52:55], a[20:23], v[32:35], v[52:55]
  v_mfma_f32_16x16x32_bf16 v[60:63], a[28:31], v[32:35], v[60:63]
  s_cbranch_vccnz ret_72
cont_68:
  v_mfma_f32_16x16x32_bf16 v[48:51], a[32:35], v[20:23], v[48:51]
  v_mov_b32_dpp v36, v20 row_ror:8 row_mask:0xf bank_mask:0xf
  v_mov_b32_dpp v37, v21 row_ror:8 row_mask:0xf bank_mask:0xf
  v_mfma_f32_16x16x32_bf16 v[52:55], a[36:39], v[20:23], v[52:55]
  v_mov_b32_dpp v38, v22 row_ror:8 row_mask:0xf bank_mask:0xf
  v_mov_b32_dpp v39, v23 row_ror:8 row_mask:0xf bank_mask:0xf
  v_mfma_f32_16x16x32_bf16 v[56:59], a[40:43], v[20:23], v[56:59]
  v_mfma_f32_16x16x32_bf16 v[60:63], a[44:47], v[20:23], v[60:63]
  v_mfma_f32_16x16x32_bf16 v[48:51], a[48:51], v[36:39], v[48:51]
  s_waitcnt vmcnt(1)
  v_max3_u32 v4, v24, v25, v26
  v_mfma_f32_16x16x32_bf16 v[56:59], a[56:59], v[36:39], v[56:59]
  v_max_u32 v4, v4, v27
  v_cmp_eq_u32 vcc, -1, v4
  v_mfma_f32_16x16x32_bf16 v[52:55], a[52:55], v[36:39], v[52:55]
  v_mfma_f32_16x16x32_bf16 v[60:63], a[60:63], v[36:39], v[60:63]
  s_cbranch_vccnz ret_73
cont_69:
  v_mfma_f32_16x16x32_bf16 v[48:51], a[64:67], v[24:27], v[48:51]
  v_mov_b32_dpp v40, v24 row_ror:8 row_mask:0xf bank_mask:0xf
  v_mov_b32_dpp v41, v25 row_ror:8 row_mask:0xf bank_mask:0xf
  v_mfma_f32_16x16x32_bf16 v[52:55], a[68:71], v[24:27], v[52:55]
  v_mov_b32_dpp v42, v26 row_ror:8 row_mask:0xf bank_mask:0xf
  v_mov_b32_dpp v43, v27 row_ror:8 row_mask:0xf bank_mask:0xf
  v_mfma_f32_16x16x32_bf16 v[56:59], a[72:75], v[24:27], v[56:59]
  v_mfma_f32_16x16x32_bf16 v[60:63], a[76:79], v[24:27], v[60:63]
  v_mfma_f32_16x16x32_bf16 v[48:51], a[80:83], v[40:43], v[48:51]
  s_waitcnt vmcnt(0)
  v_max3_u32 v4, v28, v29, v30
  v_mfma_f32_16x16x32_bf16 v[56:59], a[88:91], v[40:43], v[56:59]
  v_max_u32 v4, v4, v31
  v_cmp_eq_u32 vcc, -1, v4
  v_mfma_f32_16x16x32_bf16 v[52:55], a[84:87], v[40:43], v[52:55]
  v_mfma_f32_16x16x32_bf16 v[60:63], a[92:95], v[40:43], v[60:63]
  s_cbranch_vccnz ret_74
cont_70:
  v_mfma_f32_16x16x32_bf16 v[48:51], a[96:99], v[28:31], v[48:51]
  v_mov_b32_dpp v44, v28 row_ror:8 row_mask:0xf bank_mask:0xf
  v_mov_b32_dpp v45, v29 row_ror:8 row_mask:0xf bank_mask:0xf
  v_mfma_f32_16x16x32_bf16 v[52:55], a[100:103], v[28:31], v[52:55]
  v_mov_b32_dpp v46, v30 row_ror:8 row_mask:0xf bank_mask:0xf
  v_mov_b32_dpp v47, v31 row_ror:8 row_mask:0xf bank_mask:0xf
  v_mfma_f32_16x16x32_bf16 v[56:59], a[104:107], v[28:31], v[56:59]
  v_mfma_f32_16x16x32_bf16 v[60:63], a[108:111], v[28:31], v[60:63]
  v_mfma_f32_16x16x32_bf16 v[48:51], a[112:115], v[44:47], v[48:51]
  v_mfma_f32_16x16x32_bf16 v[56:59], a[120:123], v[44:47], v[56:59]
  v_mfma_f32_16x16x32_bf16 v[52:55], a[116:119], v[44:47], v[52:55]
  v_mfma_f32_16x16x32_bf16 v[60:63], a[124:127], v[44:47], v[60:63]
  s_nop 5
  v_mov_b32_dpp v48, v56 row_ror:8 row_mask:0xf bank_mask:0xc
  v_mov_b32_dpp v49, v57 row_ror:8 row_mask:0xf bank_mask:0xc
  v_mov_b32_dpp v50, v58 row_ror:8 row_mask:0xf bank_mask:0xc
  v_mov_b32_dpp v51, v59 row_ror:8 row_mask:0xf bank_mask:0xc
  ds_write_b128 v5, v[48:51] offset:0
  v_mov_b32_dpp v52, v60 row_ror:8 row_mask:0xf bank_mask:0xc
  v_mov_b32_dpp v53, v61 row_ror:8 row_mask:0xf bank_mask:0xc
  v_mov_b32_dpp v54, v62 row_ror:8 row_mask:0xf bank_mask:0xc
  v_mov_b32_dpp v55, v63 row_ror:8 row_mask:0xf bank_mask:0xc
  ds_write_b128 v5, v[52:55] offset:1024
  s_waitcnt lgkmcnt(0)
  s_barrier
  v_mfma_f32_16x16x32_bf16 v[64:67], a[128:131], v[16:19], 0
  v_mfma_f32_16x16x32_bf16 v[68:71], a[132:135], v[16:19], 0
  v_mfma_f32_16x16x32_bf16 v[64:67], a[136:139], v[32:35], v[64:67]
  v_mfma_f32_16x16x32_bf16 v[68:71], a[140:143], v[32:35], v[68:71]
  v_mfma_f32_16x16x32_bf16 v[64:67], a[144:147], v[20:23], v[64:67]
  v_mfma_f32_16x16x32_bf16 v[68:71], a[148:151], v[20:23], v[68:71]
  v_mfma_f32_16x16x32_bf16 v[64:67], a[152:155], v[36:39], v[64:67]
  v_mfma_f32_16x16x32_bf16 v[68:71], a[156:159], v[36:39], v[68:71]
  v_mfma_f32_16x16x32_bf16 v[64:67], a[160:163], v[24:27], v[64:67]
  v_mfma_f32_16x16x32_bf16 v[68:71], a[164:167], v[24:27], v[68:71]
  v_mfma_f32_16x16x32_bf16 v[64:67], a[168:171], v[40:43], v[64:67]
  v_mfma_f32_16x16x32_bf16 v[68:71], a[172:175], v[40:43], v[68:71]
  v_mfma_f32_16x16x32_bf16 v[64:67], a[176:179], v[28:31], v[64:67]
  v_mfma_f32_16x16x32_bf16 v[68:71], a[180:183], v[28:31], v[68:71]
  v_mfma_f32_16x16x32_bf16 v[64:67], a[184:187], v[44:47], v[64:67]
  v_mfma_f32_16x16x32_bf16 v[68:71], a[188:191], v[44:47], v[68:71]
  s_nop 7
  v_mov_b32_dpp v64, v68 row_ror:8 row_mask:0xf bank_mask:0xc
  v_mov_b32_dpp v65, v69 row_ror:8 row_mask:0xf bank_mask:0xc
  v_mov_b32_dpp v66, v70 row_ror:8 row_mask:0xf bank_mask:0xc
  v_mov_b32_dpp v67, v71 row_ror:8 row_mask:0xf bank_mask:0xc
  ds_write_b128 v5, v[64:67] offset:16384
  s_waitcnt lgkmcnt(0)
  s_barrier
  s_cmp_eq_u32 s15, 63
  s_cbranch_scc1 fin_66
  s_mov_b64 exec, s[24:25]
  buffer_store_dwordx4 v[8:11], v83, s[4:7], s19 offen
  s_mov_b64 exec, -1
  s_barrier
  s_nop 15
  s_nop 15
  s_nop 7
  buffer_load_dwordx4 v[16:19], v2, s[4:7], s35 offen offset:0 sc1
  s_nop 3
  buffer_load_dwordx4 v[20:23], v2, s[4:7], s35 offen offset:1024 sc1
  s_nop 3
  buffer_load_dwordx4 v[24:27], v2, s[4:7], s35 offen offset:2048 sc1
  s_nop 3
  buffer_load_dwordx4 v[28:31], v2, s[4:7], s35 offen offset:3072 sc1
  s_waitcnt vmcnt(3)
  v_max3_u32 v4, v16, v17, v18
  v_max_u32 v4, v4, v19
  v_cmp_eq_u32 vcc, -1, v4
  s_cbranch_vccnz ret_79
cont_75:
  v_mfma_f32_16x16x32_bf16 v[48:51], a[192:195], v[16:19], 0
  v_mov_b32_dpp v32, v16 row_ror:8 row_mask:0xf bank_mask:0xf
  v_mov_b32_dpp v33, v17 row_ror:8 row_mask:0xf bank_mask:0xf
  v_mov_b32_dpp v34, v18 row_ror:8 row_mask:0xf bank_mask:0xf
  v_mov_b32_dpp v35, v19 row_ror:8 row_mask:0xf bank_mask:0xf
  v_mfma_f32_16x16x32_bf16 v[52:55], a[196:199], v[16:19], 0
  s_waitcnt vmcnt(2)
  v_max3_u32 v4, v20, v21, v22
  v_max_u32 v4, v4, v23
  v_cmp_eq_u32 vcc, -1, v4
  v_mfma_f32_16x16x32_bf16 v[48:51], a[200:203], v[32:35], v[48:51]
  v_mfma_f32_16x16x32_bf16 v[52:55], a[204:207], v[32:35], v[52:55]
  s_cbranch_vccnz ret_80
cont_76:
  v_mfma_f32_16x16x32_bf16 v[48:51], a[208:211], v[20:23], v[48:51]
  v_mov_b32_dpp v36, v20 row_ror:8 row_mask:0xf bank_mask:0xf
  v_mov_b32_dpp v37, v21 row_ror:8 row_mask:0xf bank_mask:0xf
  v_mov_b32_dpp v38, v22 row_ror:8 row_mask:0xf bank_mask:0xf
  v_mov_b32_dpp v39, v23 row_ror:8 row_mask:0xf bank_mask:0xf
  v_mfma_f32_16x16x32_bf16 v[52:55], a[212:215], v[20:23], v[52:55]
  s_waitcnt vmcnt(1)
  v_max3_u32 v4, v24, v25, v26
  v_max_u32 v4, v4, v27
  v_cmp_eq_u32 vcc, -1, v4
  v_mfma_f32_16x16x32_bf16 v[48:51], a[216:219], v[36:39], v[48:51]
  v_mfma_f32_16x16x32_bf16 v[52:55], a[220:223], v[36:39], v[52:55]
  s_cbranch_vccnz ret_81
cont_77:
  v_mfma_f32_16x16x32_bf16 v[48:51], a[224:227], v[24:27], v[48:51]
  v_mov_b32_dpp v40, v24 row_ror:8 row_mask:0xf bank_mask:0xf
  v_mov_b32_dpp v41, v25 row_ror:8 row_mask:0xf bank_mask:0xf
  v_mov_b32_dpp v42, v26 row_ror:8 row_mask:0xf bank_mask:0xf
  v_mov_b32_dpp v43, v27 row_ror:8 row_mask:0xf bank_mask:0xf
  v_mfma_f32_16x16x32_bf16 v[52:55], a[228:231], v[24:27], v[52:55]
  s_waitcnt vmcnt(0)
  v_max3_u32 v4, v28, v29, v30
  v_max_u32 v4, v4, v31
  v_cmp_eq_u32 vcc, -1, v4
  v_mfma_f32_16x16x32_bf16 v[48:51], a[232:235], v[40:43], v[48:51]
  v_mfma_f32_16x16x32_bf16 v[52:55], a[236:239], v[40:43], v[52:55]
  s_cbranch_vccnz ret_82
cont_78:
  v_mfma_f32_16x16x32_bf16 v[48:51], a[240:243], v[28:31], v[48:51]
  v_mov_b32_dpp v44, v28 row_ror:8 row_mask:0xf bank_mask:0xf
  v_mov_b32_dpp v45, v29 row_ror:8 row_mask:0xf bank_mask:0xf
  v_mov_b32_dpp v46, v30 row_ror:8 row_mask:0xf bank_mask:0xf
  v_mov_b32_dpp v47, v31 row_ror:8 row_mask:0xf bank_mask:0xf
  v_mfma_f32_16x16x32_bf16 v[52:55], a[244:247], v[28:31], v[52:55]
  s_nop 0
  v_mfma_f32_16x16x32_bf16 v[48:51], a[248:251], v[44:47], v[48:51]
  v_mfma_f32_16x16x32_bf16 v[52:55], a[252:255], v[44:47], v[52:55]
  s_nop 7
  v_mov_b32_dpp v48, v52 row_ror:8 row_mask:0xf bank_mask:0xc
  v_mov_b32_dpp v49, v53 row_ror:8 row_mask:0xf bank_mask:0xc
  v_mov_b32_dpp v50, v54 row_ror:8 row_mask:0xf bank_mask:0xc
  v_mov_b32_dpp v51, v55 row_ror:8 row_mask:0xf bank_mask:0xc
  ds_write_b128 v5, v[48:51] offset:24576
  s_waitcnt lgkmcnt(0)
  s_barrier
  v_mov_b32 v72, s15
  s_mov_b64 exec, 1
  buffer_store_dword v72, v7, s[4:7], s20 offen sc1
  s_mov_b64 exec, -1
  s_bitcmp1_b64 s[36:37], s15
  s_cbranch_scc0 kv_83_ok
  s_add_u32 s30, s15, 2
  s_lshr_b32 s30, s30, 3
  s_lshl_b32 s30, s30, 2
  v_mov_b32 v73, s30
kv_83:
  s_sub_u32 s23, s23, 1
  s_cbranch_scc1 rec_exit
  buffer_load_dword v72, v73, s[40:43], 0 offen offset:64 sc1
  s_waitcnt vmcnt(0)
  v_cmp_gt_u32 vcc, 128, v72
  s_cbranch_vccnz kv_83
kv_83_ok:
  s_barrier
  s_add_u32 s15, s15, 1
  s_nop 15
  s_nop 15
  s_nop 7
  s_branch top_65
ret_71:
  s_sub_u32 s23, s23, 1
  s_cbranch_scc1 rec_exit
  buffer_load_dwordx4 v[16:19], v2, s[4:7], s16 offen offset:0 sc1
  buffer_load_dwordx4 v[20:23], v2, s[4:7], s16 offen offset:1024 sc1
  buffer_load_dwordx4 v[24:27], v2, s[4:7], s16 offen offset:2048 sc1
  buffer_load_dwordx4 v[28:31], v2, s[4:7], s16 offen offset:3072 sc1
  s_waitcnt vmcnt(3)
  v_max3_u32 v4, v16, v17, v18
  v_max_u32 v4, v4, v19
  v_cmp_eq_u32 vcc, -1, v4
  s_cbranch_vccnz ret_71
  s_branch cont_67
ret_72:
  s_sub_u32 s23, s23, 1
  s_cbranch_scc1 rec_exit
  buffer_load_dwordx4 v[20:23], v2, s[4:7], s16 offen offset:1024 sc1
  buffer_load_dwordx4 v[24:27], v2, s[4:7], s16 offen offset:2048 sc1
  buffer_load_dwordx4 v[28:31], v2, s[4:7], s16 offen offset:3072 sc1
  s_waitcnt vmcnt(2)
  v_max3_u32 v4, v20, v21, v22
  v_max_u32 v4, v4, v23
  v_cmp_eq_u32 vcc, -1, v4
  s_cbranch_vccnz ret_72
  s_branch cont_68
ret_73:
  s_sub_u32 s23, s23, 1
  s_cbranch_scc1 rec_exit
  buffer_load_dwordx4 v[24:27], v2, s[4:7], s16 offen offset:2048 sc1
  buffer_load_dwordx4 v[28:31], v2, s[4:7], s16 offen offset:3072 sc1
  s_waitcnt vmcnt(1)
  v_max3_u32 v4, v24, v25, v26
  v_max_u32 v4, v4, v27
  v_cmp_eq_u32 vcc, -1, v4
  s_cbranch_vccnz ret_73
  s_branch cont_69
ret_74:
  s_sub_u32 s23, s23, 1
  s_cbranch_scc1 rec_exit
  buffer_load_dwordx4 v[28:31], v2, s[4:7], s16 offen offset:3072 sc1
  s_waitcnt vmcnt(0)
  v_max3_u32 v4, v28, v29, v30
  v_max_u32 v4, v4, v31
  v_cmp_eq_u32 vcc, -1, v4
  s_cbranch_vccnz ret_74
  s_branch cont_70
ret_79:
  s_sub_u32 s23, s23, 1
  s_cbranch_scc1 rec_exit
  buffer_load_dwordx4 v[16:19], v2, s[4:7], s35 offen offset:0 sc1
  buffer_load_dwordx4 v[20:23], v2, s[4:7], s35 offen offset:1024 sc1
  buffer_load_dwordx4 v[24:27], v2, s[4:7], s35 offen offset:2048 sc1
  buffer_load_dwordx4 v[28:31], v2, s[4:7], s35 offen offset:3072 sc1
  s_waitcnt vmcnt(3)
  v_max3_u32 v4, v16, v17, v18
  v_max_u32 v4, v4, v19
  v_cmp_eq_u32 vcc, -1, v4
  s_cbranch_vccnz ret_79
  s_branch cont_75
ret_80:
  s_sub_u32 s23, s23, 1
  s_cbranch_scc1 rec_exit
  buffer_load_dwordx4 v[20:23], v2, s[4:7], s35 offen offset:1024 sc1
  buffer_load_dwordx4 v[24:27], v2, s[4:7], s35 offen offset:2048 sc1
  buffer_load_dwordx4 v[28:31], v2, s[4:7], s35 offen offset:3072 sc1
  s_waitcnt vmcnt(2)
  v_max3_u32 v4, v20, v21, v22
  v_max_u32 v4, v4, v23
  v_cmp_eq_u32 vcc, -1, v4
  s_cbranch_vccnz ret_80
  s_branch cont_76
ret_81:
  s_sub_u32 s23, s23, 1
  s_cbranch_scc1 rec_exit
  buffer_load_dwordx4 v[24:27], v2, s[4:7], s35 offen offset:2048 sc1
  buffer_load_dwordx4 v[28:31], v2, s[4:7], s35 offen offset:3072 sc1
  s_waitcnt vmcnt(1)
  v_max3_u32 v4, v24, v25, v26
  v_max_u32 v4, v4, v27
  v_cmp_eq_u32 vcc, -1, v4
  s_cbranch_vccnz ret_81
  s_branch cont_77
ret_82:
  s_sub_u32 s23, s23, 1
  s_cbranch_scc1 rec_exit
  buffer_load_dwordx4 v[28:31], v2, s[4:7], s35 offen offset:3072 sc1
  s_waitcnt vmcnt(0)
  v_max3_u32 v4, v28, v29, v30
  v_max_u32 v4, v4, v31
  v_cmp_eq_u32 vcc, -1, v4
  s_cbranch_vccnz ret_82
  s_branch cont_78
fin_66:
  s_waitcnt vmcnt(0)
  s_barrier
  v_mov_b32 v72, 64
  s_mov_b64 exec, 1
  buffer_store_dword v72, v7, s[4:7], s20 offen sc1
  s_mov_b64 exec, -1
  s_branch rec_exit
rec_slow:
  s_cmp_eq_u32 s14, 1
  s_cbranch_scc1 rec_slow1
  s_cmp_eq_u32 s14, 2
  s_cbranch_scc1 rec_slow2
  s_cmp_eq_u32 s14, 3
  s_cbranch_scc1 rec_slow3
rec_slow0:
  v_lshlrev_b32 v80, 11, v13
  v_lshl_add_u32 v80, v14, 8, v80
  v_lshl_add_u32 v80, v12, 4, v80
  s_lshl_b32 s30, s33, 10
  v_add_u32 v81, s30, v7
  v_add_u32 v82, 131072, v81
  s_mul_i32 s31, s33, 1280
  s_add_u32 s31, s31, 327680
  v_add_u32 v83, s31, v7
  s_add_u32 s31, s31, 768
  v_add_u32 v84, s31, v6
  s_lshl_b32 s30, s33, 9
  v_add_u32 v85, s30, v6
  s_mov_b32 s20, 0
  s_mov_b32 s22, 92274688
  buffer_load_dwordx4 v[72:75], v81, s[4:7], s20 offen sc1
  buffer_load_dwordx4 v[76:79], v82, s[4:7], s20 offen sc1
  s_mov_b32 s16, 103284736
  s_mov_b32 s17, 101711872
  s_mov_b32 s18, 102236160
  s_mov_b32 s19, 102760448
top_84:
  buffer_load_dwordx4 v[16:19], v2, s[4:7], s17 offen offset:0 sc1
  s_nop 3
  buffer_load_dwordx4 v[20:23], v2, s[4:7], s17 offen offset:1024 sc1
  s_nop 3
  buffer_load_dwordx4 v[24:27], v2, s[4:7], s17 offen offset:2048 sc1
  s_nop 3
  buffer_load_dwordx4 v[28:31], v2, s[4:7], s17 offen offset:3072 sc1
  s_mov_b32 s35, s16
  s_mov_b32 s16, s17
  s_mov_b32 s17, s18
  s_mov_b32 s18, s19
  s_mov_b32 s19, s35
  s_add_u32 s35, s16, 98304
  s_waitcnt vmcnt(3)
  v_max3_u32 v4, v16, v17, v18
  v_max_u32 v4, v4, v19
  v_cmp_eq_u32 vcc, -1, v4
  s_cbranch_vccnz ret_90
cont_86:
  v_mfma_f32_16x16x32_bf16 v[48:51], a[0:3], v[16:19], 0
  v_mov_b32_dpp v32, v16 row_ror:8 row_mask:0xf bank_mask:0xf
  v_mov_b32_dpp v33, v17 row_ror:8 row_mask:0xf bank_mask:0xf
  v_mfma_f32_16x16x32_bf16 v[52:55], a[4:7], v[16:19], 0
  v_mov_b32_dpp v34, v18 row_ror:8 row_mask:0xf bank_mask:0xf
  v_mov_b32_dpp v35, v19 row_ror:8 row_mask:0xf bank_mask:0xf
  v_mfma_f32_16x16x32_bf16 v[56:59], a[8:11], v[16:19], 0
  v_mfma_f32_16x16x32_bf16 v[60:63], a[12:15], v[16:19], 0
  v_mfma_f32_16x16x32_bf16 v[48:51], a[16:19], v[32:35], v[48:51]
  s_waitcnt vmcnt(2)
  v_max3_u32 v4, v20, v21, v22
  v_mfma_f32_16x16x32_bf16 v[56:59], a[24:27], v[32:35], v[56:59]
  v_max_u32 v4, v4, v23
  v_cmp_eq_u32 vcc, -1, v4
  v_mfma_f32_16x16x32_bf16 v[52:55], a[20:23], v[32:35], v[52:55]
  v_mfma_f32_16x16x32_bf16 v[60:63], a[28:31], v[32:35], v[60:63]
  s_cbranch_vccnz ret_91
cont_87:
  v_mfma_f32_16x16x32_bf16 v[48:51], a[32:35], v[20:23], v[48:51]
  v_mov_b32_dpp v36, v20 row_ror:8 row_mask:0xf bank_mask:0xf
  v_mov_b32_dpp v37, v21 row_ror:8 row_mask:0xf bank_mask:0xf
  v_mfma_f32_16x16x32_bf16 v[52:55], a[36:39], v[20:23], v[52:55]
  v_mov_b32_dpp v38, v22 row_ror:8 row_mask:0xf bank_mask:0xf
  v_mov_b32_dpp v39, v23 row_ror:8 row_mask:0xf bank_mask:0xf
  v_mfma_f32_16x16x32_bf16 v[56:59], a[40:43], v[20:23], v[56:59]
  v_mfma_f32_16x16x32_bf16 v[60:63], a[44:47], v[20:23], v[60:63]
  v_mfma_f32_16x16x32_bf16 v[48:51], a[48:51], v[36:39], v[48:51]
  s_waitcnt vmcnt(1)
  v_max3_u32 v4, v24, v25, v26
  v_mfma_f32_16x16x32_bf16 v[56:59], a[56:59], v[36:39], v[56:59]
  v_max_u32 v4, v4, v27
  v_cmp_eq_u32 vcc, -1, v4
  v_mfma_f32_16x16x32_bf16 v[52:55], a[52:55], v[36:39], v[52:55]
  v_mfma_f32_16x16x32_bf16 v[60:63], a[60:63], v[36:39], v[60:63]
  s_cbranch_vccnz ret_92
cont_88:
  v_mfma_f32_16x16x32_bf16 v[48:51], a[64:67], v[24:27], v[48:51]
  v_mov_b32_dpp v40, v24 row_ror:8 row_mask:0xf bank_mask:0xf
  v_mov_b32_dpp v41, v25 row_ror:8 row_mask:0xf bank_mask:0xf
  v_mfma_f32_16x16x32_bf16 v[52:55], a[68:71], v[24:27], v[52:55]
  v_mov_b32_dpp v42, v26 row_ror:8 row_mask:0xf bank_mask:0xf
  v_mov_b32_dpp v43, v27 row_ror:8 row_mask:0xf bank_mask:0xf
  v_mfma_f32_16x16x32_bf16 v[56:59], a[72:75], v[24:27], v[56:59]
  v_mfma_f32_16x16x32_bf16 v[60:63], a[76:79], v[24:27], v[60:63]
  v_mfma_f32_16x16x32_bf16 v[48:51], a[80:83], v[40:43], v[48:51]
  s_waitcnt vmcnt(0)
  v_max3_u32 v4, v28, v29, v30
  v_mfma_f32_16x16x32_bf16 v[56:59], a[88:91], v[40:43], v[56:59]
  v_max_u32 v4, v4, v31
  v_cmp_eq_u32 vcc, -1, v4
  v_mfma_f32_16x16x32_bf16 v[52:55], a[84:87], v[40:43], v[52:55]
  v_mfma_f32_16x16x32_bf16 v[60:63], a[92:95], v[40:43], v[60:63]
  s_cbranch_vccnz ret_93
cont_89:
  v_mfma_f32_16x16x32_bf16 v[48:51], a[96:99], v[28:31], v[48:51]
  v_mov_b32_dpp v44, v28 row_ror:8 row_mask:0xf bank_mask:0xf
  v_mov_b32_dpp v45, v29 row_ror:8 row_mask:0xf bank_mask:0xf
  v_mfma_f32_16x16x32_bf16 v[52:55], a[100:103], v[28:31], v[52:55]
  v_mov_b32_dpp v46, v30 row_ror:8 row_mask:0xf bank_mask:0xf
  v_mov_b32_dpp v47, v31 row_ror:8 row_mask:0xf bank_mask:0xf
  v_mfma_f32_16x16x32_bf16 v[56:59], a[104:107], v[28:31], v[56:59]
  v_mfma_f32_16x16x32_bf16 v[60:63], a[108:111], v[28:31], v[60:63]
  v_mfma_f32_16x16x32_bf16 v[48:51], a[112:115], v[44:47], v[48:51]
  v_mfma_f32_16x16x32_bf16 v[56:59], a[120:123], v[44:47], v[56:59]
  v_mfma_f32_16x16x32_bf16 v[52:55], a[116:119], v[44:47], v[52:55]
  v_mfma_f32_16x16x32_bf16 v[60:63], a[124:127], v[44:47], v[60:63]
  s_nop 5
  v_mov_b32_dpp v48, v56 row_ror:8 row_mask:0xf bank_mask:0xc
  v_mov_b32_dpp v49, v57 row_ror:8 row_mask:0xf bank_mask:0xc
  v_mov_b32_dpp v50, v58 row_ror:8 row_mask:0xf bank_mask:0xc
  v_mov_b32_dpp v51, v59 row_ror:8 row_mask:0xf bank_mask:0xc
  v_mov_b32_dpp v52, v60 row_ror:8 row_mask:0xf bank_mask:0xc
  v_mov_b32_dpp v53, v61 row_ror:8 row_mask:0xf bank_mask:0xc
  v_mov_b32_dpp v54, v62 row_ror:8 row_mask:0xf bank_mask:0xc
  v_mov_b32_dpp v55, v63 row_ror:8 row_mask:0xf bank_mask:0xc
  s_barrier
  ds_read_b128 v[120:123], v7 offset:2048
  ds_read_b128 v[124:127], v7 offset:3072
  ds_read_b128 v[128:131], v7 offset:4096
  ds_read_b128 v[132:135], v7 offset:5120
  ds_read_b128 v[136:139], v7 offset:6144
  ds_read_b128 v[140:143], v7 offset:7168
  s_waitcnt lgkmcnt(4)
  v_pk_add_f32 v[112:113], v[48:49], v[120:121]
  v_pk_add_f32 v[114:115], v[50:51], v[122:123]
  v_pk_add_f32 v[116:117], v[52:53], v[124:125]
  v_pk_add_f32 v[118:119], v[54:55], v[126:127]
  s_waitcnt lgkmcnt(2)
  v_pk_add_f32 v[112:113], v[112:113], v[128:129]
  v_pk_add_f32 v[114:115], v[114:115], v[130:131]
  v_pk_add_f32 v[116:117], v[116:117], v[132:133]
  v_pk_add_f32 v[118:119], v[118:119], v[134:135]
  s_waitcnt lgkmcnt(0)
  v_pk_add_f32 v[112:113], v[112:113], v[136:137]
  v_pk_add_f32 v[114:115], v[114:115], v[138:139]
  v_pk_add_f32 v[116:117], v[116:117], v[140:141]
  v_pk_add_f32 v[118:119], v[118:119], v[142:143]
  v_cvt_pk_bf16_f32 v96, v112, v113
  v_cvt_pk_bf16_f32 v97, v114, v115
  v_cvt_pk_bf16_f32 v98, v116, v117
  v_cvt_pk_bf16_f32 v99, v118, v119
  s_nop 1
  v_mfma_f32_16x16x32_bf16 v[148:151], v[76:79], v[96:99], 0
  v_mfma_f32_16x16x32_bf16 v[144:147], v[72:75], v[96:99], 0
  v_mfma_f32_16x16x32_bf16 v[152:155], v[96:99], v[96:99], 0
  s_nop 6
  v_mov_b32_dpp v144, v148 row_ror:8 row_mask:0xf bank_mask:0xc
  v_mov_b32_dpp v145, v149 row_ror:8 row_mask:0xf bank_mask:0xc
  v_mov_b32_dpp v146, v150 row_ror:8 row_mask:0xf bank_mask:0xc
  v_mov_b32_dpp v147, v151 row_ror:8 row_mask:0xf bank_mask:0xc
  buffer_store_dwordx4 v[144:147], v83, s[4:7], s16 offen sc1
  s_mov_b64 exec, s[28:29]
  buffer_store_dwordx4 v[152:155], v84, s[4:7], s16 offen sc1
  s_mov_b64 exec, -1
  v_mfma_f32_16x16x32_bf16 v[64:67], a[128:131], v[16:19], 0
  v_mfma_f32_16x16x32_bf16 v[68:71], a[132:135], v[16:19], 0
  v_mfma_f32_16x16x32_bf16 v[64:67], a[136:139], v[32:35], v[64:67]
  v_mfma_f32_16x16x32_bf16 v[68:71], a[140:143], v[32:35], v[68:71]
  v_mfma_f32_16x16x32_bf16 v[64:67], a[144:147], v[20:23], v[64:67]
  v_mfma_f32_16x16x32_bf16 v[68:71], a[148:151], v[20:23], v[68:71]
  v_mfma_f32_16x16x32_bf16 v[64:67], a[152:155], v[36:39], v[64:67]
  v_mfma_f32_16x16x32_bf16 v[68:71], a[156:159], v[36:39], v[68:71]
  v_mfma_f32_16x16x32_bf16 v[64:67], a[160:163], v[24:27], v[64:67]
  v_mfma_f32_16x16x32_bf16 v[68:71], a[164:167], v[24:27], v[68:71]
  v_mfma_f32_16x16x32_bf16 v[64:67], a[168:171], v[40:43], v[64:67]
  v_mfma_f32_16x16x32_bf16 v[68:71], a[172:175], v[40:43], v[68:71]
  v_mfma_f32_16x16x32_bf16 v[64:67], a[176:179], v[28:31], v[64:67]
  v_mfma_f32_16x16x32_bf16 v[68:71], a[180:183], v[28:31], v[68:71]
  v_mfma_f32_16x16x32_bf16 v[64:67], a[184:187], v[44:47], v[64:67]
  v_mfma_f32_16x16x32_bf16 v[68:71], a[188:191], v[44:47], v[68:71]
  s_nop 7
  v_mov_b32_dpp v64, v68 row_ror:8 row_mask:0xf bank_mask:0xc
  v_mov_b32_dpp v65, v69 row_ror:8 row_mask:0xf bank_mask:0xc
  v_mov_b32_dpp v66, v70 row_ror:8 row_mask:0xf bank_mask:0xc
  v_mov_b32_dpp v67, v71 row_ror:8 row_mask:0xf bank_mask:0xc
  ds_write_b128 v5, v[64:67] offset:16384
  s_waitcnt lgkmcnt(0)
  s_barrier
  s_cmp_eq_u32 s15, 63
  s_cbranch_scc1 fin_85
  s_barrier
  s_nop 15
  s_nop 15
  s_nop 7
  buffer_load_dwordx4 v[16:19], v2, s[4:7], s35 offen offset:0 sc1
  s_nop 3
  buffer_load_dwordx4 v[20:23], v2, s[4:7], s35 offen offset:1024 sc1
  s_nop 3
  buffer_load_dwordx4 v[24:27], v2, s[4:7], s35 offen offset:2048 sc1
  s_nop 3
  buffer_load_dwordx4 v[28:31], v2, s[4:7], s35 offen offset:3072 sc1
  s_waitcnt vmcnt(3)
  v_max3_u32 v4, v16, v17, v18
  v_max_u32 v4, v4, v19
  v_cmp_eq_u32 vcc, -1, v4
  s_cbranch_vccnz ret_98
cont_94:
  v_mfma_f32_16x16x32_bf16 v[48:51], a[192:195], v[16:19], 0
  v_mov_b32_dpp v32, v16 row_ror:8 row_mask:0xf bank_mask:0xf
  v_mov_b32_dpp v33, v17 row_ror:8 row_mask:0xf bank_mask:0xf
  v_mov_b32_dpp v34, v18 row_ror:8 row_mask:0xf bank_mask:0xf
  v_mov_b32_dpp v35, v19 row_ror:8 row_mask:0xf bank_mask:0xf
  v_mfma_f32_16x16x32_bf16 v[52:55], a[196:199], v[16:19], 0
  s_waitcnt vmcnt(2)
  v_max3_u32 v4, v20, v21, v22
  v_max_u32 v4, v4, v23
  v_cmp_eq_u32 vcc, -1, v4
  v_mfma_f32_16x16x32_bf16 v[48:51], a[200:203], v[32:35], v[48:51]
  v_mfma_f32_16x16x32_bf16 v[52:55], a[204:207], v[32:35], v[52:55]
  s_cbranch_vccnz ret_99
cont_95:
  v_mfma_f32_16x16x32_bf16 v[48:51], a[208:211], v[20:23], v[48:51]
  v_mov_b32_dpp v36, v20 row_ror:8 row_mask:0xf bank_mask:0xf
  v_mov_b32_dpp v37, v21 row_ror:8 row_mask:0xf bank_mask:0xf
  v_mov_b32_dpp v38, v22 row_ror:8 row_mask:0xf bank_mask:0xf
  v_mov_b32_dpp v39, v23 row_ror:8 row_mask:0xf bank_mask:0xf
  v_mfma_f32_16x16x32_bf16 v[52:55], a[212:215], v[20:23], v[52:55]
  s_waitcnt vmcnt(1)
  v_max3_u32 v4, v24, v25, v26
  v_max_u32 v4, v4, v27
  v_cmp_eq_u32 vcc, -1, v4
  v_mfma_f32_16x16x32_bf16 v[48:51], a[216:219], v[36:39], v[48:51]
  v_mfma_f32_16x16x32_bf16 v[52:55], a[220:223], v[36:39], v[52:55]
  s_cbranch_vccnz ret_100
cont_96:
  v_mfma_f32_16x16x32_bf16 v[48:51], a[224:227], v[24:27], v[48:51]
  v_mov_b32_dpp v40, v24 row_ror:8 row_mask:0xf bank_mask:0xf
  v_mov_b32_dpp v41, v25 row_ror:8 row_mask:0xf bank_mask:0xf
  v_mov_b32_dpp v42, v26 row_ror:8 row_mask:0xf bank_mask:0xf
  v_mov_b32_dpp v43, v27 row_ror:8 row_mask:0xf bank_mask:0xf
  v_mfma_f32_16x16x32_bf16 v[52:55], a[228:231], v[24:27], v[52:55]
  s_waitcnt vmcnt(0)
  v_max3_u32 v4, v28, v29, v30
  v_max_u32 v4, v4, v31
  v_cmp_eq_u32 vcc, -1, v4
  v_mfma_f32_16x16x32_bf16 v[48:51], a[232:235], v[40:43], v[48:51]
  v_mfma_f32_16x16x32_bf16 v[52:55], a[236:239], v[40:43], v[52:55]
  s_cbranch_vccnz ret_101
cont_97:
  v_mfma_f32_16x16x32_bf16 v[48:51], a[240:243], v[28:31], v[48:51]
  v_mov_b32_dpp v44, v28 row_ror:8 row_mask:0xf bank_mask:0xf
  v_mov_b32_dpp v45, v29 row_ror:8 row_mask:0xf bank_mask:0xf
  v_mov_b32_dpp v46, v30 row_ror:8 row_mask:0xf bank_mask:0xf
  v_mov_b32_dpp v47, v31 row_ror:8 row_mask:0xf bank_mask:0xf
  v_mfma_f32_16x16x32_bf16 v[52:55], a[244:247], v[28:31], v[52:55]
  s_nop 0
  v_mfma_f32_16x16x32_bf16 v[48:51], a[248:251], v[44:47], v[48:51]
  v_mfma_f32_16x16x32_bf16 v[52:55], a[252:255], v[44:47], v[52:55]
  s_nop 7
  v_mov_b32_dpp v48, v52 row_ror:8 row_mask:0xf bank_mask:0xc
  v_mov_b32_dpp v49, v53 row_ror:8 row_mask:0xf bank_mask:0xc
  v_mov_b32_dpp v50, v54 row_ror:8 row_mask:0xf bank_mask:0xc
  v_mov_b32_dpp v51, v55 row_ror:8 row_mask:0xf bank_mask:0xc
  ds_write_b128 v5, v[48:51] offset:24576
  s_waitcnt lgkmcnt(0)
  s_barrier
  s_add_u32 s20, s20, 262144
  buffer_load_dwordx4 v[72:75], v81, s[4:7], s20 offen sc1
  buffer_load_dwordx4 v[76:79], v82, s[4:7], s20 offen sc1
  buffer_store_dwordx4 v[8:11], v83, s[4:7], s18 offen sc1
  s_mov_b64 exec, s[28:29]
  buffer_store_dwordx4 v[8:11], v84, s[4:7], s18 offen sc1
  s_mov_b64 exec, s[26:27]
  buffer_store_dwordx4 v[96:99], v85, s[4:7], s22 offen sc1
  s_add_u32 s22, s22, 65536
  s_mov_b64 exec, -1
  s_barrier
  s_add_u32 s15, s15, 1
  s_nop 15
  s_nop 15
  s_nop 7
  s_branch top_84
ret_90:
  s_sub_u32 s23, s23, 1
  s_cbranch_scc1 rec_exit
  buffer_load_dwordx4 v[16:19], v2, s[4:7], s16 offen offset:0 sc1
  buffer_load_dwordx4 v[20:23], v2, s[4:7], s16 offen offset:1024 sc1
  buffer_load_dwordx4 v[24:27], v2, s[4:7], s16 offen offset:2048 sc1
  buffer_load_dwordx4 v[28:31], v2, s[4:7], s16 offen offset:3072 sc1
  s_waitcnt vmcnt(3)
  v_max3_u32 v4, v16, v17, v18
  v_max_u32 v4, v4, v19
  v_cmp_eq_u32 vcc, -1, v4
  s_cbranch_vccnz ret_90
  s_branch cont_86
ret_91:
  s_sub_u32 s23, s23, 1
  s_cbranch_scc1 rec_exit
  buffer_load_dwordx4 v[20:23], v2, s[4:7], s16 offen offset:1024 sc1
  buffer_load_dwordx4 v[24:27], v2, s[4:7], s16 offen offset:2048 sc1
  buffer_load_dwordx4 v[28:31], v2, s[4:7], s16 offen offset:3072 sc1
  s_waitcnt vmcnt(2)
  v_max3_u32 v4, v20, v21, v22
  v_max_u32 v4, v4, v23
  v_cmp_eq_u32 vcc, -1, v4
  s_cbranch_vccnz ret_91
  s_branch cont_87
ret_92:
  s_sub_u32 s23, s23, 1
  s_cbranch_scc1 rec_exit
  buffer_load_dwordx4 v[24:27], v2, s[4:7], s16 offen offset:2048 sc1
  buffer_load_dwordx4 v[28:31], v2, s[4:7], s16 offen offset:3072 sc1
  s_waitcnt vmcnt(1)
  v_max3_u32 v4, v24, v25, v26
  v_max_u32 v4, v4, v27
  v_cmp_eq_u32 vcc, -1, v4
  s_cbranch_vccnz ret_92
  s_branch cont_88
ret_93:
  s_sub_u32 s23, s23, 1
  s_cbranch_scc1 rec_exit
  buffer_load_dwordx4 v[28:31], v2, s[4:7], s16 offen offset:3072 sc1
  s_waitcnt vmcnt(0)
  v_max3_u32 v4, v28, v29, v30
  v_max_u32 v4, v4, v31
  v_cmp_eq_u32 vcc, -1, v4
  s_cbranch_vccnz ret_93
  s_branch cont_89
ret_98:
  s_sub_u32 s23, s23, 1
  s_cbranch_scc1 rec_exit
  buffer_load_dwordx4 v[16:19], v2, s[4:7], s35 offen offset:0 sc1
  buffer_load_dwordx4 v[20:23], v2, s[4:7], s35 offen offset:1024 sc1
  buffer_load_dwordx4 v[24:27], v2, s[4:7], s35 offen offset:2048 sc1
  buffer_load_dwordx4 v[28:31], v2, s[4:7], s35 offen offset:3072 sc1
  s_waitcnt vmcnt(3)
  v_max3_u32 v4, v16, v17, v18
  v_max_u32 v4, v4, v19
  v_cmp_eq_u32 vcc, -1, v4
  s_cbranch_vccnz ret_98
  s_branch cont_94
ret_99:
  s_sub_u32 s23, s23, 1
  s_cbranch_scc1 rec_exit
  buffer_load_dwordx4 v[20:23], v2, s[4:7], s35 offen offset:1024 sc1
  buffer_load_dwordx4 v[24:27], v2, s[4:7], s35 offen offset:2048 sc1
  buffer_load_dwordx4 v[28:31], v2, s[4:7], s35 offen offset:3072 sc1
  s_waitcnt vmcnt(2)
  v_max3_u32 v4, v20, v21, v22
  v_max_u32 v4, v4, v23
  v_cmp_eq_u32 vcc, -1, v4
  s_cbranch_vccnz ret_99
  s_branch cont_95
ret_100:
  s_sub_u32 s23, s23, 1
  s_cbranch_scc1 rec_exit
  buffer_load_dwordx4 v[24:27], v2, s[4:7], s35 offen offset:2048 sc1
  buffer_load_dwordx4 v[28:31], v2, s[4:7], s35 offen offset:3072 sc1
  s_waitcnt vmcnt(1)
  v_max3_u32 v4, v24, v25, v26
  v_max_u32 v4, v4, v27
  v_cmp_eq_u32 vcc, -1, v4
  s_cbranch_vccnz ret_100
  s_branch cont_96
ret_101:
  s_sub_u32 s23, s23, 1
  s_cbranch_scc1 rec_exit
  buffer_load_dwordx4 v[28:31], v2, s[4:7], s35 offen offset:3072 sc1
  s_waitcnt vmcnt(0)
  v_max3_u32 v4, v28, v29, v30
  v_max_u32 v4, v4, v31
  v_cmp_eq_u32 vcc, -1, v4
  s_cbranch_vccnz ret_101
  s_branch cont_97
fin_85:
  s_mov_b64 exec, s[26:27]
  buffer_store_dwordx4 v[96:99], v85, s[4:7], s22 offen sc1
  s_mov_b64 exec, -1
  s_waitcnt vmcnt(0)
  s_barrier
  s_branch rec_exit
rec_slow1:
  s_and_b32 s31, s33, 0xfc
  s_mul_i32 s31, s31, 1280
  s_add_u32 s31, s31, 327680
  v_add_u32 v80, s31, v7
  v_add_u32 v81, 4096, v80
  v_lshrrev_b32 v82, 1, v14
  v_lshlrev_b32 v82, 7, v82
  v_lshl_add_u32 v82, v12, 4, v82
  v_and_b32 v83, 1, v14
  v_lshl_add_u32 v83, v83, 1, v13
  v_lshl_add_u32 v82, v83, 2, v82
  s_add_u32 s31, s31, 1024
  v_add_u32 v82, s31, v82
  v_add_u32 v83, 4096, v82
  v_lshlrev_b32 v84, 8, v100
  v_lshl_add_u32 v84, v14, 5, v84
  v_lshl_add_u32 v84, v101, 2, v84
  v_add_u32 v84, 16384, v84
  s_lshl_b32 s30, s33, 5
  v_add_u32 v86, s30, v102
  v_and_b32 v85, 15, v102
  v_lshlrev_b32 v85, 4, v85
  v_lshl_add_u32 v85, v14, 8, v85
  v_lshl_add_u32 v86, v13, 2, v85
  v_lshl_add_u32 v85, v13, 10, v85
  s_lshl_b32 s30, s33, 11
  v_add_u32 v85, s30, v85
  s_lshr_b32 s30, s33, 1
  s_lshl_b32 s30, s30, 10
  s_and_b32 s31, s33, 1
  s_lshl_b32 s31, s31, 3
  s_add_u32 s30, s30, s31
  v_add_u32 v86, s30, v86
  s_add_u32 s30, s34, 98304
  v_add_u32 v87, s30, v6
  v_mov_b32 v88, 0x3f803f80
  v_mov_b32 v89, 0x3f803f80
  v_mov_b32 v90, 0x3f803f80
  v_mov_b32 v91, 0x3f803f80
  v_mov_b32 v93, 0
  v_mov_b32 v95, 0
  v_mov_b32 v97, 0
  s_mov_b32 s20, 16777216
  s_mov_b32 s22, 96468992
  s_mov_b32 s21, 1040356334
  buffer_load_dwordx4 v[72:75], v85, s[4:7], s20 offen sc1
  buffer_load_dwordx4 v[76:79], v85, s[4:7], s20 offen offset:64 sc1
  v_add_u32 v105, 128, v84
  v_add_u32 v106, 2048, v84
  v_add_u32 v107, 2176, v84
  v_add_u32 v108, 4096, v84
  v_add_u32 v109, 4224, v84
  v_add_u32 v110, 6144, v84
  v_add_u32 v111, 6272, v84
  v_mov_b32 v104, v84
  s_mov_b32 s16, 103284736
  s_mov_b32 s17, 101711872
  s_mov_b32 s18, 102236160
  s_mov_b32 s19, 102760448
top_102:
  buffer_load_dwordx4 v[16:19], v2, s[4:7], s17 offen offset:0 sc1
  s_nop 3
  buffer_load_dwordx4 v[20:23], v2, s[4:7], s17 offen offset:1024 sc1
  s_nop 3
  buffer_load_dwordx4 v[24:27], v2, s[4:7], s17 offen offset:2048 sc1
  s_nop 3
  buffer_load_dwordx4 v[28:31], v2, s[4:7], s17 offen offset:3072 sc1
  s_mov_b32 s35, s16
  s_mov_b32 s16, s17
  s_mov_b32 s17, s18
  s_mov_b32 s18, s19
  s_mov_b32 s19, s35
  s_add_u32 s35, s16, 98304
  s_waitcnt vmcnt(3)
  v_max3_u32 v4, v16, v17, v18
  v_max_u32 v4, v4, v19
  v_cmp_eq_u32 vcc, -1, v4
  s_cbranch_vccnz ret_108
cont_104:
  v_mfma_f32_16x16x32_bf16 v[48:51], a[0:3], v[16:19], 0
  v_mov_b32_dpp v32, v16 row_ror:8 row_mask:0xf bank_mask:0xf
  v_mov_b32_dpp v33, v17 row_ror:8 row_mask:0xf bank_mask:0xf
  v_mfma_f32_16x16x32_bf16 v[52:55], a[4:7], v[16:19], 0
  v_mov_b32_dpp v34, v18 row_ror:8 row_mask:0xf bank_mask:0xf
  v_mov_b32_dpp v35, v19 row_ror:8 row_mask:0xf bank_mask:0xf
  v_mfma_f32_16x16x32_bf16 v[56:59], a[8:11], v[16:19], 0
  v_mfma_f32_16x16x32_bf16 v[60:63], a[12:15], v[16:19], 0
  v_mfma_f32_16x16x32_bf16 v[48:51], a[16:19], v[32:35], v[48:51]
  s_waitcnt vmcnt(2)
  v_max3_u32 v4, v20, v21, v22
  v_mfma_f32_16x16x32_bf16 v[56:59], a[24:27], v[32:35], v[56:59]
  v_max_u32 v4, v4, v23
  v_cmp_eq_u32 vcc, -1, v4
  v_mfma_f32_16x16x32_bf16 v[52:55], a[20:23], v[32:35], v[52:55]
  v_mfma_f32_16x16x32_bf16 v[60:63], a[28:31], v[32:35], v[60:63]
  s_cbranch_vccnz ret_109
cont_105:
  v_mfma_f32_16x16x32_bf16 v[48:51], a[32:35], v[20:23], v[48:51]
  v_mov_b32_dpp v36, v20 row_ror:8 row_mask:0xf bank_mask:0xf
  v_mov_b32_dpp v37, v21 row_ror:8 row_mask:0xf bank_mask:0xf
  v_mfma_f32_16x16x32_bf16 v[52:55], a[36:39], v[20:23], v[52:55]
  v_mov_b32_dpp v38, v22 row_ror:8 row_mask:0xf bank_mask:0xf
  v_mov_b32_dpp v39, v23 row_ror:8 row_mask:0xf bank_mask:0xf
  v_mfma_f32_16x16x32_bf16 v[56:59], a[40:43], v[20:23], v[56:59]
  v_mfma_f32_16x16x32_bf16 v[60:63], a[44:47], v[20:23], v[60:63]
  v_mfma_f32_16x16x32_bf16 v[48:51], a[48:51], v[36:39], v[48:51]
  s_waitcnt vmcnt(1)
  v_max3_u32 v4, v24, v25, v26
  v_mfma_f32_16x16x32_bf16 v[56:59], a[56:59], v[36:39], v[56:59]
  v_max_u32 v4, v4, v27
  v_cmp_eq_u32 vcc, -1, v4
  v_mfma_f32_16x16x32_bf16 v[52:55], a[52:55], v[36:39], v[52:55]
  v_mfma_f32_16x16x32_bf16 v[60:63], a[60:63], v[36:39], v[60:63]
  s_cbranch_vccnz ret_110
cont_106:
  v_mfma_f32_16x16x32_bf16 v[48:51], a[64:67], v[24:27], v[48:51]
  v_mov_b32_dpp v40, v24 row_ror:8 row_mask:0xf bank_mask:0xf
  v_mov_b32_dpp v41, v25 row_ror:8 row_mask:0xf bank_mask:0xf
  v_mfma_f32_16x16x32_bf16 v[52:55], a[68:71], v[24:27], v[52:55]
  v_mov_b32_dpp v42, v26 row_ror:8 row_mask:0xf bank_mask:0xf
  v_mov_b32_dpp v43, v27 row_ror:8 row_mask:0xf bank_mask:0xf
  v_mfma_f32_16x16x32_bf16 v[56:59], a[72:75], v[24:27], v[56:59]
  v_mfma_f32_16x16x32_bf16 v[60:63], a[76:79], v[24:27], v[60:63]
  v_mfma_f32_16x16x32_bf16 v[48:51], a[80:83], v[40:43], v[48:51]
  s_waitcnt vmcnt(0)
  v_max3_u32 v4, v28, v29, v30
  v_mfma_f32_16x16x32_bf16 v[56:59], a[88:91], v[40:43], v[56:59]
  v_max_u32 v4, v4, v31
  v_cmp_eq_u32 vcc, -1, v4
  v_mfma_f32_16x16x32_bf16 v[52:55], a[84:87], v[40:43], v[52:55]
  v_mfma_f32_16x16x32_bf16 v[60:63], a[92:95], v[40:43], v[60:63]
  s_cbranch_vccnz ret_111
cont_107:
  v_mfma_f32_16x16x32_bf16 v[48:51], a[96:99], v[28:31], v[48:51]
  v_mov_b32_dpp v44, v28 row_ror:8 row_mask:0xf bank_mask:0xf
  v_mov_b32_dpp v45, v29 row_ror:8 row_mask:0xf bank_mask:0xf
  v_mfma_f32_16x16x32_bf16 v[52:55], a[100:103], v[28:31], v[52:55]
  v_mov_b32_dpp v46, v30 row_ror:8 row_mask:0xf bank_mask:0xf
  v_mov_b32_dpp v47, v31 row_ror:8 row_mask:0xf bank_mask:0xf
  v_mfma_f32_16x16x32_bf16 v[56:59], a[104:107], v[28:31], v[56:59]
  v_mfma_f32_16x16x32_bf16 v[60:63], a[108:111], v[28:31], v[60:63]
  v_mfma_f32_16x16x32_bf16 v[48:51], a[112:115], v[44:47], v[48:51]
  v_mfma_f32_16x16x32_bf16 v[56:59], a[120:123], v[44:47], v[56:59]
  v_mfma_f32_16x16x32_bf16 v[52:55], a[116:119], v[44:47], v[52:55]
  v_mfma_f32_16x16x32_bf16 v[60:63], a[124:127], v[44:47], v[60:63]
  s_nop 5
  v_mov_b32_dpp v48, v56 row_ror:8 row_mask:0xf bank_mask:0xc
  v_mov_b32_dpp v49, v57 row_ror:8 row_mask:0xf bank_mask:0xc
  v_mov_b32_dpp v50, v58 row_ror:8 row_mask:0xf bank_mask:0xc
  v_mov_b32_dpp v51, v59 row_ror:8 row_mask:0xf bank_mask:0xc
  ds_write_b128 v5, v[48:51] offset:0
  v_mov_b32_dpp v52, v60 row_ror:8 row_mask:0xf bank_mask:0xc
  v_mov_b32_dpp v53, v61 row_ror:8 row_mask:0xf bank_mask:0xc
  v_mov_b32_dpp v54, v62 row_ror:8 row_mask:0xf bank_mask:0xc
  v_mov_b32_dpp v55, v63 row_ror:8 row_mask:0xf bank_mask:0xc
  ds_write_b128 v5, v[52:55] offset:1024
  s_waitcnt lgkmcnt(0)
  s_barrier
  v_mfma_f32_16x16x32_bf16 v[64:67], a[128:131], v[16:19], 0
  v_mfma_f32_16x16x32_bf16 v[68:71], a[132:135], v[16:19], 0
  v_mfma_f32_16x16x32_bf16 v[64:67], a[136:139], v[32:35], v[64:67]
  v_mfma_f32_16x16x32_bf16 v[68:71], a[140:143], v[32:35], v[68:71]
  v_mfma_f32_16x16x32_bf16 v[64:67], a[144:147], v[20:23], v[64:67]
  v_mfma_f32_16x16x32_bf16 v[68:71], a[148:151], v[20:23], v[68:71]
  v_mfma_f32_16x16x32_bf16 v[64:67], a[152:155], v[36:39], v[64:67]
  v_mfma_f32_16x16x32_bf16 v[68:71], a[156:159], v[36:39], v[68:71]
  v_mfma_f32_16x16x32_bf16 v[64:67], a[160:163], v[24:27], v[64:67]
  v_mfma_f32_16x16x32_bf16 v[68:71], a[164:167], v[24:27], v[68:71]
  v_mfma_f32_16x16x32_bf16 v[64:67], a[168:171], v[40:43], v[64:67]
  v_mfma_f32_16x16x32_bf16 v[68:71], a[172:175], v[40:43], v[68:71]
  v_mfma_f32_16x16x32_bf16 v[64:67], a[176:179], v[28:31], v[64:67]
  v_mfma_f32_16x16x32_bf16 v[68:71], a[180:183], v[28:31], v[68:71]
  v_mfma_f32_16x16x32_bf16 v[64:67], a[184:187], v[44:47], v[64:67]
  v_mfma_f32_16x16x32_bf16 v[68:71], a[188:191], v[44:47], v[68:71]
  s_nop 7
  v_mov_b32_dpp v64, v68 row_ror:8 row_mask:0xf bank_mask:0xc
  v_mov_b32_dpp v65, v69 row_ror:8 row_mask:0xf bank_mask:0xc
  v_mov_b32_dpp v66, v70 row_ror:8 row_mask:0xf bank_mask:0xc
  v_mov_b32_dpp v67, v71 row_ror:8 row_mask:0xf bank_mask:0xc
  ds_write_b128 v5, v[64:67] offset:16384
  s_cmp_eq_u32 s15, 63
  s_cbranch_scc1 fin_103
  s_nop 9
  buffer_load_dwordx4 v[168:171], v80, s[4:7], s16 offen offset:0 sc1
  buffer_load_dword v184, v82, s[4:7], s16 offen offset:0 sc1
  buffer_load_dwordx4 v[172:175], v80, s[4:7], s16 offen offset:1280 sc1
  buffer_load_dword v185, v82, s[4:7], s16 offen offset:1280 sc1
  buffer_load_dwordx4 v[176:179], v80, s[4:7], s16 offen offset:2560 sc1
  buffer_load_dword v186, v82, s[4:7], s16 offen offset:2560 sc1
  buffer_load_dwordx4 v[180:183], v80, s[4:7], s16 offen offset:3840 sc1
  buffer_load_dword v187, v82, s[4:7], s16 offen offset:3840 sc1
  s_nop 15
  s_nop 7
  buffer_load_dwordx4 v[188:191], v80, s[4:7], s16 offen offset:0 sc1
  buffer_load_dword v204, v82, s[4:7], s16 offen offset:0 sc1
  buffer_load_dwordx4 v[192:195], v80, s[4:7], s16 offen offset:1280 sc1
  buffer_load_dword v205, v82, s[4:7], s16 offen offset:1280 sc1
  buffer_load_dwordx4 v[196:199], v80, s[4:7], s16 offen offset:2560 sc1
  buffer_load_dword v206, v82, s[4:7], s16 offen offset:2560 sc1
  buffer_load_dwordx4 v[200:203], v80, s[4:7], s16 offen offset:3840 sc1
  buffer_load_dword v207, v82, s[4:7], s16 offen offset:3840 sc1
pp_113:
  s_waitcnt vmcnt(14)
  v_max3_u32 v4, v168, v169, v184
  v_max3_u32 v4, v170, v171, v4
  s_waitcnt vmcnt(12)
  v_max3_u32 v4, v172, v173, v4
  v_max_u32 v4, v185, v4
  v_max3_u32 v4, v174, v175, v4
  v_pk_add_f32 v[128:129], v[168:169], v[172:173]
  v_pk_add_f32 v[130:131], v[170:171], v[174:175]
  v_add_f32 v144, v184, v185
  s_waitcnt vmcnt(10)
  v_max3_u32 v4, v176, v177, v4
  v_max_u32 v4, v186, v4
  v_max3_u32 v4, v178, v179, v4
  v_pk_add_f32 v[128:129], v[128:129], v[176:177]
  v_pk_add_f32 v[130:131], v[130:131], v[178:179]
  v_add_f32 v144, v144, v186
  s_waitcnt vmcnt(8)
  v_max3_u32 v4, v180, v181, v4
  v_max_u32 v4, v187, v4
  v_max3_u32 v4, v182, v183, v4
  v_pk_add_f32 v[128:129], v[128:129], v[180:181]
  v_pk_add_f32 v[130:131], v[130:131], v[182:183]
  v_add_f32 v144, v144, v187
  v_cmp_eq_u32 vcc, -1, v4
  s_cbranch_vccz ppd_115
  buffer_load_dwordx4 v[168:171], v80, s[4:7], s16 offen offset:0 sc1
  buffer_load_dword v184, v82, s[4:7], s16 offen offset:0 sc1
  buffer_load_dwordx4 v[172:175], v80, s[4:7], s16 offen offset:1280 sc1
  buffer_load_dword v185, v82, s[4:7], s16 offen offset:1280 sc1
  buffer_load_dwordx4 v[176:179], v80, s[4:7], s16 offen offset:2560 sc1
  buffer_load_dword v186, v82, s[4:7], s16 offen offset:2560 sc1
  buffer_load_dwordx4 v[180:183], v80, s[4:7], s16 offen offset:3840 sc1
  buffer_load_dword v187, v82, s[4:7], s16 offen offset:3840 sc1
  s_waitcnt vmcnt(14)
  v_max3_u32 v4, v188, v189, v204
  v_max3_u32 v4, v190, v191, v4
  s_waitcnt vmcnt(12)
  v_max3_u32 v4, v192, v193, v4
  v_max_u32 v4, v205, v4
  v_max3_u32 v4, v194, v195, v4
  v_pk_add_f32 v[128:129], v[188:189], v[192:193]
  v_pk_add_f32 v[130:131], v[190:191], v[194:195]
  v_add_f32 v144, v204, v205
  s_waitcnt vmcnt(10)
  v_max3_u32 v4, v196, v197, v4
  v_max_u32 v4, v206, v4
  v_max3_u32 v4, v198, v199, v4
  v_pk_add_f32 v[128:129], v[128:129], v[196:197]
  v_pk_add_f32 v[130:131], v[130:131], v[198:199]
  v_add_f32 v144, v144, v206
  s_waitcnt vmcnt(8)
  v_max3_u32 v4, v200, v201, v4
  v_max_u32 v4, v207, v4
  v_max3_u32 v4, v202, v203, v4
  v_pk_add_f32 v[128:129], v[128:129], v[200:201]
  v_pk_add_f32 v[130:131], v[130:131], v[202:203]
  v_add_f32 v144, v144, v207
  v_cmp_eq_u32 vcc, -1, v4
  s_cbranch_vccz ppd_116
  buffer_load_dwordx4 v[188:191], v80, s[4:7], s16 offen offset:0 sc1
  buffer_load_dword v204, v82, s[4:7], s16 offen offset:0 sc1
  buffer_load_dwordx4 v[192:195], v80, s[4:7], s16 offen offset:1280 sc1
  buffer_load_dword v205, v82, s[4:7], s16 offen offset:1280 sc1
  buffer_load_dwordx4 v[196:199], v80, s[4:7], s16 offen offset:2560 sc1
  buffer_load_dword v206, v82, s[4:7], s16 offen offset:2560 sc1
  buffer_load_dwordx4 v[200:203], v80, s[4:7], s16 offen offset:3840 sc1
  buffer_load_dword v207, v82, s[4:7], s16 offen offset:3840 sc1
  s_sub_u32 s23, s23, 1
  s_cbranch_scc1 rec_exit
  s_branch pp_113
ppd_115:
  s_branch ppe_114
ppd_116:
ppe_114:
  s_waitcnt lgkmcnt(0)
  s_barrier
  v_max3_f32 v150, v128, v129, v130
  v_max3_f32 v150, v131, v144, v150
  ds_read2_b32 v[112:113], v104 offset1:4
  ds_read2_b32 v[114:115], v105 offset1:4
  ds_read2_b32 v[116:117], v106 offset1:4
  ds_read2_b32 v[118:119], v107 offset1:4
  ds_read2_b32 v[120:121], v108 offset1:4
  ds_read2_b32 v[122:123], v109 offset1:4
  ds_read2_b32 v[124:125], v110 offset1:4
  ds_read2_b32 v[126:127], v111 offset1:4
  v_max_f32_dpp v150, v150, v150 row_ror:8 row_mask:0xf bank_mask:0xf
  v_mov_b32 v151, v150
  s_nop 1
  v_permlane16_swap_b32 v150, v151
  s_nop 0
  v_max_f32 v150, v150, v151
  v_mov_b32 v151, v150
  s_nop 1
  v_permlane32_swap_b32 v150, v151
  s_nop 0
  v_max_f32 v150, v150, v151
  v_mul_f32 v150, s21, v150
  v_fma_f32 v144, v144, s21, -v150
  v_fma_f32 v128, v128, s21, -v150
  v_fma_f32 v129, v129, s21, -v150
  v_fma_f32 v130, v130, s21, -v150
  v_fma_f32 v131, v131, s21, -v150
  v_exp_f32 v144, v144
  v_exp_f32 v128, v128
  v_exp_f32 v129, v129
  v_exp_f32 v130, v130
  v_exp_f32 v131, v131
  v_mov_b32_dpp v151, v144 row_ror:8 row_mask:0xf bank_mask:0xf
  v_cvt_pk_bf16_f32 v152, v128, v129
  v_cvt_pk_bf16_f32 v153, v130, v131
  v_cvt_pk_bf16_f32 v96, v144, v151
  v_mov_b32_dpp v154, v152 row_ror:8 row_mask:0xf bank_mask:0xf
  v_mov_b32_dpp v155, v153 row_ror:8 row_mask:0xf bank_mask:0xf
  s_nop 1
  v_mfma_f32_16x16x32_bf16 v[156:159], v[88:91], v[152:155], 0
  v_mfma_f32_16x16x32_bf16 v[160:163], v[72:75], v[152:155], 0
  v_mfma_f32_16x16x32_bf16 v[164:167], v[76:79], v[152:155], 0
  s_waitcnt lgkmcnt(0)
  v_pk_add_f32 v[112:113], v[112:113], v[116:117]
  v_pk_add_f32 v[114:115], v[114:115], v[118:119]
  v_pk_add_f32 v[120:121], v[120:121], v[124:125]
  v_pk_add_f32 v[122:123], v[122:123], v[126:127]
  v_pk_add_f32 v[112:113], v[112:113], v[120:121]
  v_pk_add_f32 v[114:115], v[114:115], v[122:123]
  v_cvt_pk_bf16_f32 v92, v112, v113
  v_cvt_pk_bf16_f32 v94, v114, v115
  v_mfma_f32_16x16x16_bf16 v[156:159], v[88:89], v[96:97], v[156:159]
  s_nop 0
  v_mfma_f32_16x16x16_bf16 v[160:163], v[92:93], v[96:97], v[160:163]
  v_mfma_f32_16x16x16_bf16 v[164:167], v[94:95], v[96:97], v[164:167]
  s_nop 4
  v_rcp_f32 v156, v156
  s_nop 1
  v_pk_mul_f32 v[160:161], v[160:161], v[156:157] op_sel_hi:[1,0]
  v_pk_mul_f32 v[162:163], v[162:163], v[156:157] op_sel_hi:[1,0]
  v_pk_mul_f32 v[164:165], v[164:165], v[156:157] op_sel_hi:[1,0]
  v_pk_mul_f32 v[166:167], v[166:167], v[156:157] op_sel_hi:[1,0]
  v_cvt_pk_bf16_f32 v152, v160, v161
  v_cvt_pk_bf16_f32 v153, v162, v163
  v_cvt_pk_bf16_f32 v154, v164, v165
  v_cvt_pk_bf16_f32 v155, v166, v167
  s_mov_b64 exec, s[24:25]
  buffer_store_dwordx4 v[152:155], v87, s[4:7], s16 offen sc1
  s_mov_b64 exec, -1
  s_barrier
  s_nop 15
  s_nop 15
  s_nop 7
  buffer_load_dwordx4 v[16:19], v2, s[4:7], s35 offen offset:0 sc1
  s_nop 3
  buffer_load_dwordx4 v[20:23], v2, s[4:7], s35 offen offset:1024 sc1
  s_nop 3
  buffer_load_dwordx4 v[24:27], v2, s[4:7], s35 offen offset:2048 sc1
  s_nop 3
  buffer_load_dwordx4 v[28:31], v2, s[4:7], s35 offen offset:3072 sc1
  s_waitcnt vmcnt(3)
  v_max3_u32 v4, v16, v17, v18
  v_max_u32 v4, v4, v19
  v_cmp_eq_u32 vcc, -1, v4
  s_cbranch_vccnz ret_121
cont_117:
  v_mfma_f32_16x16x32_bf16 v[48:51], a[192:195], v[16:19], 0
  v_mov_b32_dpp v32, v16 row_ror:8 row_mask:0xf bank_mask:0xf
  v_mov_b32_dpp v33, v17 row_ror:8 row_mask:0xf bank_mask:0xf
  v_mov_b32_dpp v34, v18 row_ror:8 row_mask:0xf bank_mask:0xf
  v_mov_b32_dpp v35, v19 row_ror:8 row_mask:0xf bank_mask:0xf
  v_mfma_f32_16x16x32_bf16 v[52:55], a[196:199], v[16:19], 0
  s_waitcnt vmcnt(2)
  v_max3_u32 v4, v20, v21, v22
  v_max_u32 v4, v4, v23
  v_cmp_eq_u32 vcc, -1, v4
  v_mfma_f32_16x16x32_bf16 v[48:51], a[200:203], v[32:35], v[48:51]
  v_mfma_f32_16x16x32_bf16 v[52:55], a[204:207], v[32:35], v[52:55]
  s_cbranch_vccnz ret_122
cont_118:
  v_mfma_f32_16x16x32_bf16 v[48:51], a[208:211], v[20:23], v[48:51]
  v_mov_b32_dpp v36, v20 row_ror:8 row_mask:0xf bank_mask:0xf
  v_mov_b32_dpp v37, v21 row_ror:8 row_mask:0xf bank_mask:0xf
  v_mov_b32_dpp v38, v22 row_ror:8 row_mask:0xf bank_mask:0xf
  v_mov_b32_dpp v39, v23 row_ror:8 row_mask:0xf bank_mask:0xf
  v_mfma_f32_16x16x32_bf16 v[52:55], a[212:215], v[20:23], v[52:55]
  s_waitcnt vmcnt(1)
  v_max3_u32 v4, v24, v25, v26
  v_max_u32 v4, v4, v27
  v_cmp_eq_u32 vcc, -1, v4
  v_mfma_f32_16x16x32_bf16 v[48:51], a[216:219], v[36:39], v[48:51]
  v_mfma_f32_16x16x32_bf16 v[52:55], a[220:223], v[36:39], v[52:55]
  s_cbranch_vccnz ret_123
cont_119:
  v_mfma_f32_16x16x32_bf16 v[48:51], a[224:227], v[24:27], v[48:51]
  v_mov_b32_dpp v40, v24 row_ror:8 row_mask:0xf bank_mask:0xf
  v_mov_b32_dpp v41, v25 row_ror:8 row_mask:0xf bank_mask:0xf
  v_mov_b32_dpp v42, v26 row_ror:8 row_mask:0xf bank_mask:0xf
  v_mov_b32_dpp v43, v27 row_ror:8 row_mask:0xf bank_mask:0xf
  v_mfma_f32_16x16x32_bf16 v[52:55], a[228:231], v[24:27], v[52:55]
  s_waitcnt vmcnt(0)
  v_max3_u32 v4, v28, v29, v30
  v_max_u32 v4, v4, v31
  v_cmp_eq_u32 vcc, -1, v4
  v_mfma_f32_16x16x32_bf16 v[48:51], a[232:235], v[40:43], v[48:51]
  v_mfma_f32_16x16x32_bf16 v[52:55], a[236:239], v[40:43], v[52:55]
  s_cbranch_vccnz ret_124
cont_120:
  v_mfma_f32_16x16x32_bf16 v[48:51], a[240:243], v[28:31], v[48:51]
  v_mov_b32_dpp v44, v28 row_ror:8 row_mask:0xf bank_mask:0xf
  v_mov_b32_dpp v45, v29 row_ror:8 row_mask:0xf bank_mask:0xf
  v_mov_b32_dpp v46, v30 row_ror:8 row_mask:0xf bank_mask:0xf
  v_mov_b32_dpp v47, v31 row_ror:8 row_mask:0xf bank_mask:0xf
  v_mfma_f32_16x16x32_bf16 v[52:55], a[244:247], v[28:31], v[52:55]
  s_nop 0
  v_mfma_f32_16x16x32_bf16 v[48:51], a[248:251], v[44:47], v[48:51]
  v_mfma_f32_16x16x32_bf16 v[52:55], a[252:255], v[44:47], v[52:55]
  s_nop 7
  v_mov_b32_dpp v48, v52 row_ror:8 row_mask:0xf bank_mask:0xc
  v_mov_b32_dpp v49, v53 row_ror:8 row_mask:0xf bank_mask:0xc
  v_mov_b32_dpp v50, v54 row_ror:8 row_mask:0xf bank_mask:0xc
  v_mov_b32_dpp v51, v55 row_ror:8 row_mask:0xf bank_mask:0xc
  ds_write_b128 v5, v[48:51] offset:24576
  s_waitcnt lgkmcnt(0)
  s_barrier
  s_add_u32 s20, s20, 262144
  buffer_load_dwordx4 v[72:75], v85, s[4:7], s20 offen sc1
  buffer_load_dwordx4 v[76:79], v85, s[4:7], s20 offen offset:64 sc1
  buffer_store_dword v92, v86, s[4:7], s22 offen sc1
  buffer_store_dword v94, v86, s[4:7], s22 offen offset:64 sc1
  s_add_u32 s22, s22, 65536
  s_mov_b64 exec, s[24:25]
  buffer_store_dwordx4 v[8:11], v87, s[4:7], s18 offen sc1
  s_mov_b64 exec, -1
  s_barrier
  s_add_u32 s15, s15, 1
  s_nop 15
  s_nop 15
  s_nop 7
  s_branch top_102
ret_108:
  s_sub_u32 s23, s23, 1
  s_cbranch_scc1 rec_exit
  buffer_load_dwordx4 v[16:19], v2, s[4:7], s16 offen offset:0 sc1
  buffer_load_dwordx4 v[20:23], v2, s[4:7], s16 offen offset:1024 sc1
  buffer_load_dwordx4 v[24:27], v2, s[4:7], s16 offen offset:2048 sc1
  buffer_load_dwordx4 v[28:31], v2, s[4:7], s16 offen offset:3072 sc1
  s_waitcnt vmcnt(3)
  v_max3_u32 v4, v16, v17, v18
  v_max_u32 v4, v4, v19
  v_cmp_eq_u32 vcc, -1, v4
  s_cbranch_vccnz ret_108
  s_branch cont_104
ret_109:
  s_sub_u32 s23, s23, 1
  s_cbranch_scc1 rec_exit
  buffer_load_dwordx4 v[20:23], v2, s[4:7], s16 offen offset:1024 sc1
  buffer_load_dwordx4 v[24:27], v2, s[4:7], s16 offen offset:2048 sc1
  buffer_load_dwordx4 v[28:31], v2, s[4:7], s16 offen offset:3072 sc1
  s_waitcnt vmcnt(2)
  v_max3_u32 v4, v20, v21, v22
  v_max_u32 v4, v4, v23
  v_cmp_eq_u32 vcc, -1, v4
  s_cbranch_vccnz ret_109
  s_branch cont_105
ret_110:
  s_sub_u32 s23, s23, 1
  s_cbranch_scc1 rec_exit
  buffer_load_dwordx4 v[24:27], v2, s[4:7], s16 offen offset:2048 sc1
  buffer_load_dwordx4 v[28:31], v2, s[4:7], s16 offen offset:3072 sc1
  s_waitcnt vmcnt(1)
  v_max3_u32 v4, v24, v25, v26
  v_max_u32 v4, v4, v27
  v_cmp_eq_u32 vcc, -1, v4
  s_cbranch_vccnz ret_110
  s_branch cont_106
ret_111:
  s_sub_u32 s23, s23, 1
  s_cbranch_scc1 rec_exit
  buffer_load_dwordx4 v[28:31], v2, s[4:7], s16 offen offset:3072 sc1
  s_waitcnt vmcnt(0)
  v_max3_u32 v4, v28, v29, v30
  v_max_u32 v4, v4, v31
  v_cmp_eq_u32 vcc, -1, v4
  s_cbranch_vccnz ret_111
  s_branch cont_107
ret_121:
  s_sub_u32 s23, s23, 1
  s_cbranch_scc1 rec_exit
  buffer_load_dwordx4 v[16:19], v2, s[4:7], s35 offen offset:0 sc1
  buffer_load_dwordx4 v[20:23], v2, s[4:7], s35 offen offset:1024 sc1
  buffer_load_dwordx4 v[24:27], v2, s[4:7], s35 offen offset:2048 sc1
  buffer_load_dwordx4 v[28:31], v2, s[4:7], s35 offen offset:3072 sc1
  s_waitcnt vmcnt(3)
  v_max3_u32 v4, v16, v17, v18
  v_max_u32 v4, v4, v19
  v_cmp_eq_u32 vcc, -1, v4
  s_cbranch_vccnz ret_121
  s_branch cont_117
ret_122:
  s_sub_u32 s23, s23, 1
  s_cbranch_scc1 rec_exit
  buffer_load_dwordx4 v[20:23], v2, s[4:7], s35 offen offset:1024 sc1
  buffer_load_dwordx4 v[24:27], v2, s[4:7], s35 offen offset:2048 sc1
  buffer_load_dwordx4 v[28:31], v2, s[4:7], s35 offen offset:3072 sc1
  s_waitcnt vmcnt(2)
  v_max3_u32 v4, v20, v21, v22
  v_max_u32 v4, v4, v23
  v_cmp_eq_u32 vcc, -1, v4
  s_cbranch_vccnz ret_122
  s_branch cont_118
ret_123:
  s_sub_u32 s23, s23, 1
  s_cbranch_scc1 rec_exit
  buffer_load_dwordx4 v[24:27], v2, s[4:7], s35 offen offset:2048 sc1
  buffer_load_dwordx4 v[28:31], v2, s[4:7], s35 offen offset:3072 sc1
  s_waitcnt vmcnt(1)
  v_max3_u32 v4, v24, v25, v26
  v_max_u32 v4, v4, v27
  v_cmp_eq_u32 vcc, -1, v4
  s_cbranch_vccnz ret_123
  s_branch cont_119
ret_124:
  s_sub_u32 s23, s23, 1
  s_cbranch_scc1 rec_exit
  buffer_load_dwordx4 v[28:31], v2, s[4:7], s35 offen offset:3072 sc1
  s_waitcnt vmcnt(0)
  v_max3_u32 v4, v28, v29, v30
  v_max_u32 v4, v4, v31
  v_cmp_eq_u32 vcc, -1, v4
  s_cbranch_vccnz ret_124
  s_branch cont_120
fin_103:
  s_waitcnt lgkmcnt(0)
  s_barrier
  ds_read2_b32 v[112:113], v104 offset1:4
  ds_read2_b32 v[114:115], v105 offset1:4
  ds_read2_b32 v[116:117], v106 offset1:4
  ds_read2_b32 v[118:119], v107 offset1:4
  ds_read2_b32 v[120:121], v108 offset1:4
  ds_read2_b32 v[122:123], v109 offset1:4
  ds_read2_b32 v[124:125], v110 offset1:4
  ds_read2_b32 v[126:127], v111 offset1:4
  s_waitcnt lgkmcnt(0)
  v_pk_add_f32 v[112:113], v[112:113], v[116:117]
  v_pk_add_f32 v[114:115], v[114:115], v[118:119]
  v_pk_add_f32 v[120:121], v[120:121], v[124:125]
  v_pk_add_f32 v[122:123], v[122:123], v[126:127]
  v_pk_add_f32 v[112:113], v[112:113], v[120:121]
  v_pk_add_f32 v[114:115], v[114:115], v[122:123]
  v_cvt_pk_bf16_f32 v92, v112, v113
  v_cvt_pk_bf16_f32 v94, v114, v115
  buffer_store_dword v92, v86, s[4:7], s22 offen sc1
  buffer_store_dword v94, v86, s[4:7], s22 offen offset:64 sc1
  s_waitcnt vmcnt(0)
  s_barrier
  s_branch rec_exit
rec_slow2:
  v_lshlrev_b32 v80, 10, v13
  v_lshl_add_u32 v80, v14, 8, v80
  v_lshl_add_u32 v80, v12, 4, v80
  s_lshl_b32 s30, s13, 12
  s_add_u32 s30, s30, 196608
  v_lshl_add_u32 v82, v13, 3, v6
  v_add_u32 v82, s30, v82
  s_lshl_b32 s31, s12, 10
  v_add_u32 v81, s31, v82
  v_xor_b32 v85, 1024, v81
  v_xor_b32 v86, 2048, v81
  v_xor_b32 v87, 3072, v81
  v_xor_b32 v88, 520, v85
  v_xor_b32 v89, 520, v86
  v_xor_b32 v90, 520, v87
  v_mul_u32_u24 v91, 504, v13
  v_add_u32 v81, v81, v91
  v_lshl_add_u32 v83, v13, 3, v6
  v_add_u32 v83, s34, v83
  s_load_dwordx2 s[8:9], s[0:1], 8
  s_mov_b32 s10, 16384
  s_mov_b32 s11, 0x00020000
  v_lshlrev_b32 v84, 11, v12
  v_lshl_add_u32 v84, v14, 4, v84
  v_lshl_add_u32 v84, v13, 3, v84
  s_lshl_b32 s30, s13, 6
  s_mov_b32 s16, 101711872
  s_waitcnt lgkmcnt(0)
  buffer_load_dwordx2 v[72:73], v84, s[8:11], s30 offen
  s_waitcnt vmcnt(0)
  v_min_u32 v72, -2, v72
  v_min_u32 v73, -2, v73
  buffer_store_dwordx2 v[72:73], v83, s[4:7], s16 offen sc1
  s_mov_b32 s16, 103284736
  s_mov_b32 s17, 101711872
  s_mov_b32 s18, 102236160
  s_mov_b32 s19, 102760448
top_125:
  buffer_load_dwordx4 v[16:19], v2, s[4:7], s17 offen offset:0 sc1
  s_nop 3
  buffer_load_dwordx4 v[20:23], v2, s[4:7], s17 offen offset:1024 sc1
  s_nop 3
  buffer_load_dwordx4 v[24:27], v2, s[4:7], s17 offen offset:2048 sc1
  s_nop 3
  buffer_load_dwordx4 v[28:31], v2, s[4:7], s17 offen offset:3072 sc1
  s_mov_b32 s35, s16
  s_mov_b32 s16, s17
  s_mov_b32 s17, s18
  s_mov_b32 s18, s19
  s_mov_b32 s19, s35
  s_add_u32 s35, s16, 98304
  s_waitcnt vmcnt(3)
  v_max3_u32 v4, v16, v17, v18
  v_max_u32 v4, v4, v19
  v_cmp_eq_u32 vcc, -1, v4
  s_cbranch_vccnz ret_131
cont_127:
  v_mfma_f32_16x16x32_bf16 v[48:51], a[0:3], v[16:19], 0
  v_mov_b32_dpp v32, v16 row_ror:8 row_mask:0xf bank_mask:0xf
  v_mov_b32_dpp v33, v17 row_ror:8 row_mask:0xf bank_mask:0xf
  v_mfma_f32_16x16x32_bf16 v[52:55], a[4:7], v[16:19], 0
  v_mov_b32_dpp v34, v18 row_ror:8 row_mask:0xf bank_mask:0xf
  v_mov_b32_dpp v35, v19 row_ror:8 row_mask:0xf bank_mask:0xf
  v_mfma_f32_16x16x32_bf16 v[56:59], a[8:11], v[16:19], 0
  v_mfma_f32_16x16x32_bf16 v[60:63], a[12:15], v[16:19], 0
  v_mfma_f32_16x16x32_bf16 v[48:51], a[16:19], v[32:35], v[48:51]
  s_waitcnt vmcnt(2)
  v_max3_u32 v4, v20, v21, v22
  v_mfma_f32_16x16x32_bf16 v[56:59], a[24:27], v[32:35], v[56:59]
  v_max_u32 v4, v4, v23
  v_cmp_eq_u32 vcc, -1, v4
  v_mfma_f32_16x16x32_bf16 v[52:55], a[20:23], v[32:35], v[52:55]
  v_mfma_f32_16x16x32_bf16 v[60:63], a[28:31], v[32:35], v[60:63]
  s_cbranch_vccnz ret_132
cont_128:
  v_mfma_f32_16x16x32_bf16 v[48:51], a[32:35], v[20:23], v[48:51]
  v_mov_b32_dpp v36, v20 row_ror:8 row_mask:0xf bank_mask:0xf
  v_mov_b32_dpp v37, v21 row_ror:8 row_mask:0xf bank_mask:0xf
  v_mfma_f32_16x16x32_bf16 v[52:55], a[36:39], v[20:23], v[52:55]
  v_mov_b32_dpp v38, v22 row_ror:8 row_mask:0xf bank_mask:0xf
  v_mov_b32_dpp v39, v23 row_ror:8 row_mask:0xf bank_mask:0xf
  v_mfma_f32_16x16x32_bf16 v[56:59], a[40:43], v[20:23], v[56:59]
  v_mfma_f32_16x16x32_bf16 v[60:63], a[44:47], v[20:23], v[60:63]
  v_mfma_f32_16x16x32_bf16 v[48:51], a[48:51], v[36:39], v[48:51]
  s_waitcnt vmcnt(1)
  v_max3_u32 v4, v24, v25, v26
  v_mfma_f32_16x16x32_bf16 v[56:59], a[56:59], v[36:39], v[56:59]
  v_max_u32 v4, v4, v27
  v_cmp_eq_u32 vcc, -1, v4
  v_mfma_f32_16x16x32_bf16 v[52:55], a[52:55], v[36:39], v[52:55]
  v_mfma_f32_16x16x32_bf16 v[60:63], a[60:63], v[36:39], v[60:63]
  s_cbranch_vccnz ret_133
cont_129:
  v_mfma_f32_16x16x32_bf16 v[48:51], a[64:67], v[24:27], v[48:51]
  v_mov_b32_dpp v40, v24 row_ror:8 row_mask:0xf bank_mask:0xf
  v_mov_b32_dpp v41, v25 row_ror:8 row_mask:0xf bank_mask:0xf
  v_mfma_f32_16x16x32_bf16 v[52:55], a[68:71], v[24:27], v[52:55]
  v_mov_b32_dpp v42, v26 row_ror:8 row_mask:0xf bank_mask:0xf
  v_mov_b32_dpp v43, v27 row_ror:8 row_mask:0xf bank_mask:0xf
  v_mfma_f32_16x16x32_bf16 v[56:59], a[72:75], v[24:27], v[56:59]
  v_mfma_f32_16x16x32_bf16 v[60:63], a[76:79], v[24:27], v[60:63]
  v_mfma_f32_16x16x32_bf16 v[48:51], a[80:83], v[40:43], v[48:51]
  s_waitcnt vmcnt(0)
  v_max3_u32 v4, v28, v29, v30
  v_mfma_f32_16x16x32_bf16 v[56:59], a[88:91], v[40:43], v[56:59]
  v_max_u32 v4, v4, v31
  v_cmp_eq_u32 vcc, -1, v4
  v_mfma_f32_16x16x32_bf16 v[52:55], a[84:87], v[40:43], v[52:55]
  v_mfma_f32_16x16x32_bf16 v[60:63], a[92:95], v[40:43], v[60:63]
  s_cbranch_vccnz ret_134
cont_130:
  v_mfma_f32_16x16x32_bf16 v[48:51], a[96:99], v[28:31], v[48:51]
  v_mov_b32_dpp v44, v28 row_ror:8 row_mask:0xf bank_mask:0xf
  v_mov_b32_dpp v45, v29 row_ror:8 row_mask:0xf bank_mask:0xf
  v_mfma_f32_16x16x32_bf16 v[52:55], a[100:103], v[28:31], v[52:55]
  v_mov_b32_dpp v46, v30 row_ror:8 row_mask:0xf bank_mask:0xf
  v_mov_b32_dpp v47, v31 row_ror:8 row_mask:0xf bank_mask:0xf
  v_mfma_f32_16x16x32_bf16 v[56:59], a[104:107], v[28:31], v[56:59]
  v_mfma_f32_16x16x32_bf16 v[60:63], a[108:111], v[28:31], v[60:63]
  v_mfma_f32_16x16x32_bf16 v[48:51], a[112:115], v[44:47], v[48:51]
  v_mfma_f32_16x16x32_bf16 v[56:59], a[120:123], v[44:47], v[56:59]
  v_mfma_f32_16x16x32_bf16 v[52:55], a[116:119], v[44:47], v[52:55]
  v_mfma_f32_16x16x32_bf16 v[60:63], a[124:127], v[44:47], v[60:63]
  s_nop 5
  v_mov_b32_dpp v48, v56 row_ror:8 row_mask:0xf bank_mask:0xc
  v_mov_b32_dpp v49, v57 row_ror:8 row_mask:0xf bank_mask:0xc
  v_mov_b32_dpp v50, v58 row_ror:8 row_mask:0xf bank_mask:0xc
  v_mov_b32_dpp v51, v59 row_ror:8 row_mask:0xf bank_mask:0xc
  ds_write_b128 v5, v[48:51] offset:0
  v_mov_b32_dpp v52, v60 row_ror:8 row_mask:0xf bank_mask:0xc
  v_mov_b32_dpp v53, v61 row_ror:8 row_mask:0xf bank_mask:0xc
  v_mov_b32_dpp v54, v62 row_ror:8 row_mask:0xf bank_mask:0xc
  v_mov_b32_dpp v55, v63 row_ror:8 row_mask:0xf bank_mask:0xc
  ds_write_b128 v5, v[52:55] offset:1024
  s_waitcnt lgkmcnt(0)
  s_barrier
  v_mfma_f32_16x16x32_bf16 v[64:67], a[128:131], v[16:19], 0
  v_mfma_f32_16x16x32_bf16 v[68:71], a[132:135], v[16:19], 0
  v_mfma_f32_16x16x32_bf16 v[64:67], a[136:139], v[32:35], v[64:67]
  v_mfma_f32_16x16x32_bf16 v[68:71], a[140:143], v[32:35], v[68:71]
  v_mfma_f32_16x16x32_bf16 v[64:67], a[144:147], v[20:23], v[64:67]
  v_mfma_f32_16x16x32_bf16 v[68:71], a[148:151], v[20:23], v[68:71]
  v_mfma_f32_16x16x32_bf16 v[64:67], a[152:155], v[36:39], v[64:67]
  v_mfma_f32_16x16x32_bf16 v[68:71], a[156:159], v[36:39], v[68:71]
  v_mfma_f32_16x16x32_bf16 v[64:67], a[160:163], v[24:27], v[64:67]
  v_mfma_f32_16x16x32_bf16 v[68:71], a[164:167], v[24:27], v[68:71]
  v_mfma_f32_16x16x32_bf16 v[64:67], a[168:171], v[40:43], v[64:67]
  v_mfma_f32_16x16x32_bf16 v[68:71], a[172:175], v[40:43], v[68:71]
  v_mfma_f32_16x16x32_bf16 v[64:67], a[176:179], v[28:31], v[64:67]
  v_mfma_f32_16x16x32_bf16 v[68:71], a[180:183], v[28:31], v[68:71]
  v_mfma_f32_16x16x32_bf16 v[64:67], a[184:187], v[44:47], v[64:67]
  v_mfma_f32_16x16x32_bf16 v[68:71], a[188:191], v[44:47], v[68:71]
  s_nop 7
  v_mov_b32_dpp v64, v68 row_ror:8 row_mask:0xf bank_mask:0xc
  v_mov_b32_dpp v65, v69 row_ror:8 row_mask:0xf bank_mask:0xc
  v_mov_b32_dpp v66, v70 row_ror:8 row_mask:0xf bank_mask:0xc
  v_mov_b32_dpp v67, v71 row_ror:8 row_mask:0xf bank_mask:0xc
  ds_write_b128 v5, v[64:67] offset:16384
  s_waitcnt lgkmcnt(0)
  s_barrier
  s_cmp_eq_u32 s15, 63
  s_cbranch_scc1 fin_126
  s_barrier
  s_nop 15
  s_nop 15
  s_nop 7
  buffer_load_dwordx4 v[16:19], v2, s[4:7], s35 offen offset:0 sc1
  s_nop 3
  buffer_load_dwordx4 v[20:23], v2, s[4:7], s35 offen offset:1024 sc1
  s_nop 3
  buffer_load_dwordx4 v[24:27], v2, s[4:7], s35 offen offset:2048 sc1
  s_nop 3
  buffer_load_dwordx4 v[28:31], v2, s[4:7], s35 offen offset:3072 sc1
  s_waitcnt vmcnt(3)
  v_max3_u32 v4, v16, v17, v18
  v_max_u32 v4, v4, v19
  v_cmp_eq_u32 vcc, -1, v4
  s_cbranch_vccnz ret_139
cont_135:
  v_mfma_f32_16x16x32_bf16 v[48:51], a[192:195], v[16:19], 0
  v_mov_b32_dpp v32, v16 row_ror:8 row_mask:0xf bank_mask:0xf
  v_mov_b32_dpp v33, v17 row_ror:8 row_mask:0xf bank_mask:0xf
  v_mov_b32_dpp v34, v18 row_ror:8 row_mask:0xf bank_mask:0xf
  v_mov_b32_dpp v35, v19 row_ror:8 row_mask:0xf bank_mask:0xf
  v_mfma_f32_16x16x32_bf16 v[52:55], a[196:199], v[16:19], 0
  s_waitcnt vmcnt(2)
  v_max3_u32 v4, v20, v21, v22
  v_max_u32 v4, v4, v23
  v_cmp_eq_u32 vcc, -1, v4
  v_mfma_f32_16x16x32_bf16 v[48:51], a[200:203], v[32:35], v[48:51]
  v_mfma_f32_16x16x32_bf16 v[52:55], a[204:207], v[32:35], v[52:55]
  s_cbranch_vccnz ret_140
cont_136:
  v_mfma_f32_16x16x32_bf16 v[48:51], a[208:211], v[20:23], v[48:51]
  v_mov_b32_dpp v36, v20 row_ror:8 row_mask:0xf bank_mask:0xf
  v_mov_b32_dpp v37, v21 row_ror:8 row_mask:0xf bank_mask:0xf
  v_mov_b32_dpp v38, v22 row_ror:8 row_mask:0xf bank_mask:0xf
  v_mov_b32_dpp v39, v23 row_ror:8 row_mask:0xf bank_mask:0xf
  v_mfma_f32_16x16x32_bf16 v[52:55], a[212:215], v[20:23], v[52:55]
  s_waitcnt vmcnt(1)
  v_max3_u32 v4, v24, v25, v26
  v_max_u32 v4, v4, v27
  v_cmp_eq_u32 vcc, -1, v4
  v_mfma_f32_16x16x32_bf16 v[48:51], a[216:219], v[36:39], v[48:51]
  v_mfma_f32_16x16x32_bf16 v[52:55], a[220:223], v[36:39], v[52:55]
  s_cbranch_vccnz ret_141
cont_137:
  v_mfma_f32_16x16x32_bf16 v[48:51], a[224:227], v[24:27], v[48:51]
  v_mov_b32_dpp v40, v24 row_ror:8 row_mask:0xf bank_mask:0xf
  v_mov_b32_dpp v41, v25 row_ror:8 row_mask:0xf bank_mask:0xf
  v_mov_b32_dpp v42, v26 row_ror:8 row_mask:0xf bank_mask:0xf
  v_mov_b32_dpp v43, v27 row_ror:8 row_mask:0xf bank_mask:0xf
  v_mfma_f32_16x16x32_bf16 v[52:55], a[228:231], v[24:27], v[52:55]
  s_waitcnt vmcnt(0)
  v_max3_u32 v4, v28, v29, v30
  v_max_u32 v4, v4, v31
  v_cmp_eq_u32 vcc, -1, v4
  v_mfma_f32_16x16x32_bf16 v[48:51], a[232:235], v[40:43], v[48:51]
  v_mfma_f32_16x16x32_bf16 v[52:55], a[236:239], v[40:43], v[52:55]
  s_cbranch_vccnz ret_142
cont_138:
  v_mfma_f32_16x16x32_bf16 v[48:51], a[240:243], v[28:31], v[48:51]
  v_mov_b32_dpp v44, v28 row_ror:8 row_mask:0xf bank_mask:0xf
  v_mov_b32_dpp v45, v29 row_ror:8 row_mask:0xf bank_mask:0xf
  v_mov_b32_dpp v46, v30 row_ror:8 row_mask:0xf bank_mask:0xf
  v_mov_b32_dpp v47, v31 row_ror:8 row_mask:0xf bank_mask:0xf
  v_mfma_f32_16x16x32_bf16 v[52:55], a[244:247], v[28:31], v[52:55]
  s_nop 0
  v_mfma_f32_16x16x32_bf16 v[48:51], a[248:251], v[44:47], v[48:51]
  v_mfma_f32_16x16x32_bf16 v[52:55], a[252:255], v[44:47], v[52:55]
  s_nop 7
  v_mov_b32_dpp v48, v52 row_ror:8 row_mask:0xf bank_mask:0xc
  v_mov_b32_dpp v49, v53 row_ror:8 row_mask:0xf bank_mask:0xc
  v_mov_b32_dpp v50, v54 row_ror:8 row_mask:0xf bank_mask:0xc
  v_mov_b32_dpp v51, v55 row_ror:8 row_mask:0xf bank_mask:0xc
  s_barrier
  ds_read_b128 v[112:115], v7 offset:24576
  ds_read_b128 v[116:119], v7 offset:26624
  ds_read_b128 v[120:123], v7 offset:30720
  s_waitcnt lgkmcnt(2)
  v_pk_add_f32 v[128:129], v[48:49], v[112:113]
  v_pk_add_f32 v[130:131], v[50:51], v[114:115]
  s_waitcnt lgkmcnt(0)
  v_pk_add_f32 v[116:117], v[116:117], v[120:121]
  v_pk_add_f32 v[118:119], v[118:119], v[122:123]
  v_pk_add_f32 v[128:129], v[128:129], v[116:117]
  v_pk_add_f32 v[130:131], v[130:131], v[118:119]
  v_cvt_pk_bf16_f32 v132, v128, v129
  v_cvt_pk_bf16_f32 v133, v130, v131
  s_nop 0
  v_mov_b32_dpp v134, v132 row_ror:8 row_mask:0xf bank_mask:0xf
  v_mov_b32_dpp v135, v133 row_ror:8 row_mask:0xf bank_mask:0xf
  s_mov_b64 exec, s[24:25]
  buffer_store_dwordx4 v[132:135], v81, s[4:7], s16 offen sc1
  buffer_store_dwordx4 v[8:11], v81, s[4:7], s18 offen sc1
  s_mov_b64 exec, -1
  s_nop 15
  s_nop 15
  s_nop 15
  s_nop 15
  s_nop 15
  s_nop 15
  s_nop 15
  s_nop 15
  s_nop 15
  s_nop 15
  s_nop 15
  s_nop 15
  s_nop 7
  buffer_load_dwordx2 v[136:137], v85, s[4:7], s16 offen sc1
  buffer_load_dwordx2 v[138:139], v86, s[4:7], s16 offen sc1
  buffer_load_dwordx2 v[140:141], v87, s[4:7], s16 offen sc1
pp_144:
  s_waitcnt vmcnt(2)
  v_max_u32 v4, v136, v137
  v_lshlrev_b32 v120, 16, v136
  v_and_b32 v121, 0xffff0000, v136
  v_lshlrev_b32 v122, 16, v137
  v_and_b32 v123, 0xffff0000, v137
  v_pk_add_f32 v[112:113], v[128:129], v[120:121]
  v_pk_add_f32 v[114:115], v[130:131], v[122:123]
  s_waitcnt vmcnt(1)
  v_max3_u32 v4, v138, v139, v4
  v_lshlrev_b32 v120, 16, v138
  v_and_b32 v121, 0xffff0000, v138
  v_lshlrev_b32 v122, 16, v139
  v_and_b32 v123, 0xffff0000, v139
  v_pk_add_f32 v[112:113], v[112:113], v[120:121]
  v_pk_add_f32 v[114:115], v[114:115], v[122:123]
  s_waitcnt vmcnt(0)
  v_max3_u32 v4, v140, v141, v4
  v_cmp_eq_u32 vcc, -1, v4
  v_lshlrev_b32 v120, 16, v140
  v_and_b32 v121, 0xffff0000, v140
  v_lshlrev_b32 v122, 16, v141
  v_and_b32 v123, 0xffff0000, v141
  v_pk_add_f32 v[112:113], v[112:113], v[120:121]
  v_pk_add_f32 v[114:115], v[114:115], v[122:123]
  v_cvt_pk_bf16_f32 v72, v112, v113
  v_cvt_pk_bf16_f32 v73, v114, v115
  s_cbranch_vccz ppd_146
  buffer_load_dwordx2 v[136:137], v85, s[4:7], s16 offen sc1
  buffer_load_dwordx2 v[138:139], v86, s[4:7], s16 offen sc1
  buffer_load_dwordx2 v[140:141], v87, s[4:7], s16 offen sc1
  s_sub_u32 s23, s23, 1
  s_cbranch_scc1 rec_exit
  s_branch pp_144
ppd_146:
ppe_145:
  buffer_store_dwordx2 v[72:73], v83, s[4:7], s17 offen sc1
  s_barrier
  s_add_u32 s15, s15, 1
  s_nop 15
  s_nop 15
  s_nop 7
  s_branch top_125
ret_131:
  s_sub_u32 s23, s23, 1
  s_cbranch_scc1 rec_exit
  buffer_load_dwordx4 v[16:19], v2, s[4:7], s16 offen offset:0 sc1
  buffer_load_dwordx4 v[20:23], v2, s[4:7], s16 offen offset:1024 sc1
  buffer_load_dwordx4 v[24:27], v2, s[4:7], s16 offen offset:2048 sc1
  buffer_load_dwordx4 v[28:31], v2, s[4:7], s16 offen offset:3072 sc1
  s_waitcnt vmcnt(3)
  v_max3_u32 v4, v16, v17, v18
  v_max_u32 v4, v4, v19
  v_cmp_eq_u32 vcc, -1, v4
  s_cbranch_vccnz ret_131
  s_branch cont_127
ret_132:
  s_sub_u32 s23, s23, 1
  s_cbranch_scc1 rec_exit
  buffer_load_dwordx4 v[20:23], v2, s[4:7], s16 offen offset:1024 sc1
  buffer_load_dwordx4 v[24:27], v2, s[4:7], s16 offen offset:2048 sc1
  buffer_load_dwordx4 v[28:31], v2, s[4:7], s16 offen offset:3072 sc1
  s_waitcnt vmcnt(2)
  v_max3_u32 v4, v20, v21, v22
  v_max_u32 v4, v4, v23
  v_cmp_eq_u32 vcc, -1, v4
  s_cbranch_vccnz ret_132
  s_branch cont_128
ret_133:
  s_sub_u32 s23, s23, 1
  s_cbranch_scc1 rec_exit
  buffer_load_dwordx4 v[24:27], v2, s[4:7], s16 offen offset:2048 sc1
  buffer_load_dwordx4 v[28:31], v2, s[4:7], s16 offen offset:3072 sc1
  s_waitcnt vmcnt(1)
  v_max3_u32 v4, v24, v25, v26
  v_max_u32 v4, v4, v27
  v_cmp_eq_u32 vcc, -1, v4
  s_cbranch_vccnz ret_133
  s_branch cont_129
ret_134:
  s_sub_u32 s23, s23, 1
  s_cbranch_scc1 rec_exit
  buffer_load_dwordx4 v[28:31], v2, s[4:7], s16 offen offset:3072 sc1
  s_waitcnt vmcnt(0)
  v_max3_u32 v4, v28, v29, v30
  v_max_u32 v4, v4, v31
  v_cmp_eq_u32 vcc, -1, v4
  s_cbranch_vccnz ret_134
  s_branch cont_130
ret_139:
  s_sub_u32 s23, s23, 1
  s_cbranch_scc1 rec_exit
  buffer_load_dwordx4 v[16:19], v2, s[4:7], s35 offen offset:0 sc1
  buffer_load_dwordx4 v[20:23], v2, s[4:7], s35 offen offset:1024 sc1
  buffer_load_dwordx4 v[24:27], v2, s[4:7], s35 offen offset:2048 sc1
  buffer_load_dwordx4 v[28:31], v2, s[4:7], s35 offen offset:3072 sc1
  s_waitcnt vmcnt(3)
  v_max3_u32 v4, v16, v17, v18
  v_max_u32 v4, v4, v19
  v_cmp_eq_u32 vcc, -1, v4
  s_cbranch_vccnz ret_139
  s_branch cont_135
ret_140:
  s_sub_u32 s23, s23, 1
  s_cbranch_scc1 rec_exit
  buffer_load_dwordx4 v[20:23], v2, s[4:7], s35 offen offset:1024 sc1
  buffer_load_dwordx4 v[24:27], v2, s[4:7], s35 offen offset:2048 sc1
  buffer_load_dwordx4 v[28:31], v2, s[4:7], s35 offen offset:3072 sc1
  s_waitcnt vmcnt(2)
  v_max3_u32 v4, v20, v21, v22
  v_max_u32 v4, v4, v23
  v_cmp_eq_u32 vcc, -1, v4
  s_cbranch_vccnz ret_140
  s_branch cont_136
ret_141:
  s_sub_u32 s23, s23, 1
  s_cbranch_scc1 rec_exit
  buffer_load_dwordx4 v[24:27], v2, s[4:7], s35 offen offset:2048 sc1
  buffer_load_dwordx4 v[28:31], v2, s[4:7], s35 offen offset:3072 sc1
  s_waitcnt vmcnt(1)
  v_max3_u32 v4, v24, v25, v26
  v_max_u32 v4, v4, v27
  v_cmp_eq_u32 vcc, -1, v4
  s_cbranch_vccnz ret_141
  s_branch cont_137
ret_142:
  s_sub_u32 s23, s23, 1
  s_cbranch_scc1 rec_exit
  buffer_load_dwordx4 v[28:31], v2, s[4:7], s35 offen offset:3072 sc1
  s_waitcnt vmcnt(0)
  v_max3_u32 v4, v28, v29, v30
  v_max_u32 v4, v4, v31
  v_cmp_eq_u32 vcc, -1, v4
  s_cbranch_vccnz ret_142
  s_branch cont_138
fin_126:
  s_waitcnt vmcnt(0)
  s_barrier
  s_branch rec_exit
rec_slow3:
  v_lshlrev_b32 v80, 10, v13
  v_lshl_add_u32 v80, v14, 8, v80
  v_lshl_add_u32 v80, v12, 4, v80
  s_lshl_b32 s30, s13, 12
  s_add_u32 s30, s30, 196608
  v_lshl_add_u32 v82, v13, 3, v6
  v_add_u32 v82, s30, v82
  s_lshl_b32 s31, s12, 10
  v_add_u32 v81, s31, v82
  v_xor_b32 v85, 1024, v81
  v_xor_b32 v86, 2048, v81
  v_xor_b32 v87, 3072, v81
  v_xor_b32 v88, 520, v85
  v_xor_b32 v89, 520, v86
  v_xor_b32 v90, 520, v87
  v_mul_u32_u24 v91, 504, v13
  v_add_u32 v81, v81, v91
  v_lshl_add_u32 v83, v13, 3, v6
  v_add_u32 v83, s34, v83
  s_mov_b32 s20, s38
  s_mov_b32 s36, 0x40404044
  s_mov_b32 s37, 0x00404040
  s_mov_b32 s16, 103284736
  s_mov_b32 s17, 101711872
  s_mov_b32 s18, 102236160
  s_mov_b32 s19, 102760448
top_147:
  buffer_load_dwordx4 v[16:19], v2, s[4:7], s17 offen offset:0 sc1
  s_nop 3
  buffer_load_dwordx4 v[20:23], v2, s[4:7], s17 offen offset:1024 sc1
  s_nop 3
  buffer_load_dwordx4 v[24:27], v2, s[4:7], s17 offen offset:2048 sc1
  s_nop 3
  buffer_load_dwordx4 v[28:31], v2, s[4:7], s17 offen offset:3072 sc1
  s_mov_b32 s35, s16
  s_mov_b32 s16, s17
  s_mov_b32 s17, s18
  s_mov_b32 s18, s19
  s_mov_b32 s19, s35
  s_add_u32 s35, s16, 98304
  s_waitcnt vmcnt(3)
  v_max3_u32 v4, v16, v17, v18
  v_max_u32 v4, v4, v19
  v_cmp_eq_u32 vcc, -1, v4
  s_cbranch_vccnz ret_153
cont_149:
  v_mfma_f32_16x16x32_bf16 v[48:51], a[0:3], v[16:19], 0
  v_mov_b32_dpp v32, v16 row_ror:8 row_mask:0xf bank_mask:0xf
  v_mov_b32_dpp v33, v17 row_ror:8 row_mask:0xf bank_mask:0xf
  v_mfma_f32_16x16x32_bf16 v[52:55], a[4:7], v[16:19], 0
  v_mov_b32_dpp v34, v18 row_ror:8 row_mask:0xf bank_mask:0xf
  v_mov_b32_dpp v35, v19 row_ror:8 row_mask:0xf bank_mask:0xf
  v_mfma_f32_16x16x32_bf16 v[56:59], a[8:11], v[16:19], 0
  v_mfma_f32_16x16x32_bf16 v[60:63], a[12:15], v[16:19], 0
  v_mfma_f32_16x16x32_bf16 v[48:51], a[16:19], v[32:35], v[48:51]
  s_waitcnt vmcnt(2)
  v_max3_u32 v4, v20, v21, v22
  v_mfma_f32_16x16x32_bf16 v[56:59], a[24:27], v[32:35], v[56:59]
  v_max_u32 v4, v4, v23
  v_cmp_eq_u32 vcc, -1, v4
  v_mfma_f32_16x16x32_bf16 v[52:55], a[20:23], v[32:35], v[52:55]
  v_mfma_f32_16x16x32_bf16 v[60:63], a[28:31], v[32:35], v[60:63]
  s_cbranch_vccnz ret_154
cont_150:
  v_mfma_f32_16x16x32_bf16 v[48:51], a[32:35], v[20:23], v[48:51]
  v_mov_b32_dpp v36, v20 row_ror:8 row_mask:0xf bank_mask:0xf
  v_mov_b32_dpp v37, v21 row_ror:8 row_mask:0xf bank_mask:0xf
  v_mfma_f32_16x16x32_bf16 v[52:55], a[36:39], v[20:23], v[52:55]
  v_mov_b32_dpp v38, v22 row_ror:8 row_mask:0xf bank_mask:0xf
  v_mov_b32_dpp v39, v23 row_ror:8 row_mask:0xf bank_mask:0xf
  v_mfma_f32_16x16x32_bf16 v[56:59], a[40:43], v[20:23], v[56:59]
  v_mfma_f32_16x16x32_bf16 v[60:63], a[44:47], v[20:23], v[60:63]
  v_mfma_f32_16x16x32_bf16 v[48:51], a[48:51], v[36:39], v[48:51]
  s_waitcnt vmcnt(1)
  v_max3_u32 v4, v24, v25, v26
  v_mfma_f32_16x16x32_bf16 v[56:59], a[56:59], v[36:39], v[56:59]
  v_max_u32 v4, v4, v27
  v_cmp_eq_u32 vcc, -1, v4
  v_mfma_f32_16x16x32_bf16 v[52:55], a[52:55], v[36:39], v[52:55]
  v_mfma_f32_16x16x32_bf16 v[60:63], a[60:63], v[36:39], v[60:63]
  s_cbranch_vccnz ret_155
cont_151:
  v_mfma_f32_16x16x32_bf16 v[48:51], a[64:67], v[24:27], v[48:51]
  v_mov_b32_dpp v40, v24 row_ror:8 row_mask:0xf bank_mask:0xf
  v_mov_b32_dpp v41, v25 row_ror:8 row_mask:0xf bank_mask:0xf
  v_mfma_f32_16x16x32_bf16 v[52:55], a[68:71], v[24:27], v[52:55]
  v_mov_b32_dpp v42, v26 row_ror:8 row_mask:0xf bank_mask:0xf
  v_mov_b32_dpp v43, v27 row_ror:8 row_mask:0xf bank_mask:0xf
  v_mfma_f32_16x16x32_bf16 v[56:59], a[72:75], v[24:27], v[56:59]
  v_mfma_f32_16x16x32_bf16 v[60:63], a[76:79], v[24:27], v[60:63]
  v_mfma_f32_16x16x32_bf16 v[48:51], a[80:83], v[40:43], v[48:51]
  s_waitcnt vmcnt(0)
  v_max3_u32 v4, v28, v29, v30
  v_mfma_f32_16x16x32_bf16 v[56:59], a[88:91], v[40:43], v[56:59]
  v_max_u32 v4, v4, v31
  v_cmp_eq_u32 vcc, -1, v4
  v_mfma_f32_16x16x32_bf16 v[52:55], a[84:87], v[40:43], v[52:55]
  v_mfma_f32_16x16x32_bf16 v[60:63], a[92:95], v[40:43], v[60:63]
  s_cbranch_vccnz ret_156
cont_152:
  v_mfma_f32_16x16x32_bf16 v[48:51], a[96:99], v[28:31], v[48:51]
  v_mov_b32_dpp v44, v28 row_ror:8 row_mask:0xf bank_mask:0xf
  v_mov_b32_dpp v45, v29 row_ror:8 row_mask:0xf bank_mask:0xf
  v_mfma_f32_16x16x32_bf16 v[52:55], a[100:103], v[28:31], v[52:55]
  v_mov_b32_dpp v46, v30 row_ror:8 row_mask:0xf bank_mask:0xf
  v_mov_b32_dpp v47, v31 row_ror:8 row_mask:0xf bank_mask:0xf
  v_mfma_f32_16x16x32_bf16 v[56:59], a[104:107], v[28:31], v[56:59]
  v_mfma_f32_16x16x32_bf16 v[60:63], a[108:111], v[28:31], v[60:63]
  v_mfma_f32_16x16x32_bf16 v[48:51], a[112:115], v[44:47], v[48:51]
  v_mfma_f32_16x16x32_bf16 v[56:59], a[120:123], v[44:47], v[56:59]
  v_mfma_f32_16x16x32_bf16 v[52:55], a[116:119], v[44:47], v[52:55]
  v_mfma_f32_16x16x32_bf16 v[60:63], a[124:127], v[44:47], v[60:63]
  s_nop 5
  v_mov_b32_dpp v48, v56 row_ror:8 row_mask:0xf bank_mask:0xc
  v_mov_b32_dpp v49, v57 row_ror:8 row_mask:0xf bank_mask:0xc
  v_mov_b32_dpp v50, v58 row_ror:8 row_mask:0xf bank_mask:0xc
  v_mov_b32_dpp v51, v59 row_ror:8 row_mask:0xf bank_mask:0xc
  ds_write_b128 v5, v[48:51] offset:0
  v_mov_b32_dpp v52, v60 row_ror:8 row_mask:0xf bank_mask:0xc
  v_mov_b32_dpp v53, v61 row_ror:8 row_mask:0xf bank_mask:0xc
  v_mov_b32_dpp v54, v62 row_ror:8 row_mask:0xf bank_mask:0xc
  v_mov_b32_dpp v55, v63 row_ror:8 row_mask:0xf bank_mask:0xc
  ds_write_b128 v5, v[52:55] offset:1024
  s_waitcnt lgkmcnt(0)
  s_barrier
  v_mfma_f32_16x16x32_bf16 v[64:67], a[128:131], v[16:19], 0
  v_mfma_f32_16x16x32_bf16 v[68:71], a[132:135], v[16:19], 0
  v_mfma_f32_16x16x32_bf16 v[64:67], a[136:139], v[32:35], v[64:67]
  v_mfma_f32_16x16x32_bf16 v[68:71], a[140:143], v[32:35], v[68:71]
  v_mfma_f32_16x16x32_bf16 v[64:67], a[144:147], v[20:23], v[64:67]
  v_mfma_f32_16x16x32_bf16 v[68:71], a[148:151], v[20:23], v[68:71]
  v_mfma_f32_16x16x32_bf16 v[64:67], a[152:155], v[36:39], v[64:67]
  v_mfma_f32_16x16x32_bf16 v[68:71], a[156:159], v[36:39], v[68:71]
  v_mfma_f32_16x16x32_bf16 v[64:67], a[160:163], v[24:27], v[64:67]
  v_mfma_f32_16x16x32_bf16 v[68:71], a[164:167], v[24:27], v[68:71]
  v_mfma_f32_16x16x32_bf16 v[64:67], a[168:171], v[40:43], v[64:67]
  v_mfma_f32_16x16x32_bf16 v[68:71], a[172:175], v[40:43], v[68:71]
  v_mfma_f32_16x16x32_bf16 v[64:67], a[176:179], v[28:31], v[64:67]
  v_mfma_f32_16x16x32_bf16 v[68:71], a[180:183], v[28:31], v[68:71]
  v_mfma_f32_16x16x32_bf16 v[64:67], a[184:187], v[44:47], v[64:67]
  v_mfma_f32_16x16x32_bf16 v[68:71], a[188:191], v[44:47], v[68:71]
  s_nop 7
  v_mov_b32_dpp v64, v68 row_ror:8 row_mask:0xf bank_mask:0xc
  v_mov_b32_dpp v65, v69 row_ror:8 row_mask:0xf bank_mask:0xc
  v_mov_b32_dpp v66, v70 row_ror:8 row_mask:0xf bank_mask:0xc
  v_mov_b32_dpp v67, v71 row_ror:8 row_mask:0xf bank_mask:0xc
  ds_write_b128 v5, v[64:67] offset:16384
  s_waitcnt lgkmcnt(0)
  s_barrier
  s_cmp_eq_u32 s15, 63
  s_cbranch_scc1 fin_148
  s_mov_b64 exec, s[24:25]
  buffer_store_dwordx4 v[8:11], v83, s[4:7], s19 offen sc1
  s_mov_b64 exec, -1
  s_barrier
  s_nop 15
  s_nop 15
  s_nop 7
  buffer_load_dwordx4 v[16:19], v2, s[4:7], s35 offen offset:0 sc1
  s_nop 3
  buffer_load_dwordx4 v[20:23], v2, s[4:7], s35 offen offset:1024 sc1
  s_nop 3
  buffer_load_dwordx4 v[24:27], v2, s[4:7], s35 offen offset:2048 sc1
  s_nop 3
  buffer_load_dwordx4 v[28:31], v2, s[4:7], s35 offen offset:3072 sc1
  s_waitcnt vmcnt(3)
  v_max3_u32 v4, v16, v17, v18
  v_max_u32 v4, v4, v19
  v_cmp_eq_u32 vcc, -1, v4
  s_cbranch_vccnz ret_161
cont_157:
  v_mfma_f32_16x16x32_bf16 v[48:51], a[192:195], v[16:19], 0
  v_mov_b32_dpp v32, v16 row_ror:8 row_mask:0xf bank_mask:0xf
  v_mov_b32_dpp v33, v17 row_ror:8 row_mask:0xf bank_mask:0xf
  v_mov_b32_dpp v34, v18 row_ror:8 row_mask:0xf bank_mask:0xf
  v_mov_b32_dpp v35, v19 row_ror:8 row_mask:0xf bank_mask:0xf
  v_mfma_f32_16x16x32_bf16 v[52:55], a[196:199], v[16:19], 0
  s_waitcnt vmcnt(2)
  v_max3_u32 v4, v20, v21, v22
  v_max_u32 v4, v4, v23
  v_cmp_eq_u32 vcc, -1, v4
  v_mfma_f32_16x16x32_bf16 v[48:51], a[200:203], v[32:35], v[48:51]
  v_mfma_f32_16x16x32_bf16 v[52:55], a[204:207], v[32:35], v[52:55]
  s_cbranch_vccnz ret_162
cont_158:
  v_mfma_f32_16x16x32_bf16 v[48:51], a[208:211], v[20:23], v[48:51]
  v_mov_b32_dpp v36, v20 row_ror:8 row_mask:0xf bank_mask:0xf
  v_mov_b32_dpp v37, v21 row_ror:8 row_mask:0xf bank_mask:0xf
  v_mov_b32_dpp v38, v22 row_ror:8 row_mask:0xf bank_mask:0xf
  v_mov_b32_dpp v39, v23 row_ror:8 row_mask:0xf bank_mask:0xf
  v_mfma_f32_16x16x32_bf16 v[52:55], a[212:215], v[20:23], v[52:55]
  s_waitcnt vmcnt(1)
  v_max3_u32 v4, v24, v25, v26
  v_max_u32 v4, v4, v27
  v_cmp_eq_u32 vcc, -1, v4
  v_mfma_f32_16x16x32_bf16 v[48:51], a[216:219], v[36:39], v[48:51]
  v_mfma_f32_16x16x32_bf16 v[52:55], a[220:223], v[36:39], v[52:55]
  s_cbranch_vccnz ret_163
cont_159:
  v_mfma_f32_16x16x32_bf16 v[48:51], a[224:227], v[24:27], v[48:51]
  v_mov_b32_dpp v40, v24 row_ror:8 row_mask:0xf bank_mask:0xf
  v_mov_b32_dpp v41, v25 row_ror:8 row_mask:0xf bank_mask:0xf
  v_mov_b32_dpp v42, v26 row_ror:8 row_mask:0xf bank_mask:0xf
  v_mov_b32_dpp v43, v27 row_ror:8 row_mask:0xf bank_mask:0xf
  v_mfma_f32_16x16x32_bf16 v[52:55], a[228:231], v[24:27], v[52:55]
  s_waitcnt vmcnt(0)
  v_max3_u32 v4, v28, v29, v30
  v_max_u32 v4, v4, v31
  v_cmp_eq_u32 vcc, -1, v4
  v_mfma_f32_16x16x32_bf16 v[48:51], a[232:235], v[40:43], v[48:51]
  v_mfma_f32_16x16x32_bf16 v[52:55], a[236:239], v[40:43], v[52:55]
  s_cbranch_vccnz ret_164
cont_160:
  v_mfma_f32_16x16x32_bf16 v[48:51], a[240:243], v[28:31], v[48:51]
  v_mov_b32_dpp v44, v28 row_ror:8 row_mask:0xf bank_mask:0xf
  v_mov_b32_dpp v45, v29 row_ror:8 row_mask:0xf bank_mask:0xf
  v_mov_b32_dpp v46, v30 row_ror:8 row_mask:0xf bank_mask:0xf
  v_mov_b32_dpp v47, v31 row_ror:8 row_mask:0xf bank_mask:0xf
  v_mfma_f32_16x16x32_bf16 v[52:55], a[244:247], v[28:31], v[52:55]
  s_nop 0
  v_mfma_f32_16x16x32_bf16 v[48:51], a[248:251], v[44:47], v[48:51]
  v_mfma_f32_16x16x32_bf16 v[52:55], a[252:255], v[44:47], v[52:55]
  s_nop 7
  v_mov_b32_dpp v48, v52 row_ror:8 row_mask:0xf bank_mask:0xc
  v_mov_b32_dpp v49, v53 row_ror:8 row_mask:0xf bank_mask:0xc
  v_mov_b32_dpp v50, v54 row_ror:8 row_mask:0xf bank_mask:0xc
  v_mov_b32_dpp v51, v55 row_ror:8 row_mask:0xf bank_mask:0xc
  ds_write_b128 v5, v[48:51] offset:24576
  s_waitcnt lgkmcnt(0)
  s_barrier
  v_mov_b32 v72, s15
  s_mov_b64 exec, 1
  buffer_store_dword v72, v7, s[4:7], s20 offen sc1
  s_mov_b64 exec, -1
  s_bitcmp1_b64 s[36:37], s15
  s_cbranch_scc0 kv_165_ok
  s_add_u32 s30, s15, 2
  s_lshr_b32 s30, s30, 3
  s_lshl_b32 s30, s30, 2
  v_mov_b32 v73, s30
kv_165:
  s_sub_u32 s23, s23, 1
  s_cbranch_scc1 rec_exit
  buffer_load_dword v72, v73, s[40:43], 0 offen offset:64 sc1
  s_waitcnt vmcnt(0)
  v_cmp_gt_u32 vcc, 128, v72
  s_cbranch_vccnz kv_165
kv_165_ok:
  s_barrier
  s_add_u32 s15, s15, 1
  s_nop 15
  s_nop 15
  s_nop 7
  s_branch top_147
ret_153:
  s_sub_u32 s23, s23, 1
  s_cbranch_scc1 rec_exit
  buffer_load_dwordx4 v[16:19], v2, s[4:7], s16 offen offset:0 sc1
  buffer_load_dwordx4 v[20:23], v2, s[4:7], s16 offen offset:1024 sc1
  buffer_load_dwordx4 v[24:27], v2, s[4:7], s16 offen offset:2048 sc1
  buffer_load_dwordx4 v[28:31], v2, s[4:7], s16 offen offset:3072 sc1
  s_waitcnt vmcnt(3)
  v_max3_u32 v4, v16, v17, v18
  v_max_u32 v4, v4, v19
  v_cmp_eq_u32 vcc, -1, v4
  s_cbranch_vccnz ret_153
  s_branch cont_149
ret_154:
  s_sub_u32 s23, s23, 1
  s_cbranch_scc1 rec_exit
  buffer_load_dwordx4 v[20:23], v2, s[4:7], s16 offen offset:1024 sc1
  buffer_load_dwordx4 v[24:27], v2, s[4:7], s16 offen offset:2048 sc1
  buffer_load_dwordx4 v[28:31], v2, s[4:7], s16 offen offset:3072 sc1
  s_waitcnt vmcnt(2)
  v_max3_u32 v4, v20, v21, v22
  v_max_u32 v4, v4, v23
  v_cmp_eq_u32 vcc, -1, v4
  s_cbranch_vccnz ret_154
  s_branch cont_150
ret_155:
  s_sub_u32 s23, s23, 1
  s_cbranch_scc1 rec_exit
  buffer_load_dwordx4 v[24:27], v2, s[4:7], s16 offen offset:2048 sc1
  buffer_load_dwordx4 v[28:31], v2, s[4:7], s16 offen offset:3072 sc1
  s_waitcnt vmcnt(1)
  v_max3_u32 v4, v24, v25, v26
  v_max_u32 v4, v4, v27
  v_cmp_eq_u32 vcc, -1, v4
  s_cbranch_vccnz ret_155
  s_branch cont_151
ret_156:
  s_sub_u32 s23, s23, 1
  s_cbranch_scc1 rec_exit
  buffer_load_dwordx4 v[28:31], v2, s[4:7], s16 offen offset:3072 sc1
  s_waitcnt vmcnt(0)
  v_max3_u32 v4, v28, v29, v30
  v_max_u32 v4, v4, v31
  v_cmp_eq_u32 vcc, -1, v4
  s_cbranch_vccnz ret_156
  s_branch cont_152
ret_161:
  s_sub_u32 s23, s23, 1
  s_cbranch_scc1 rec_exit
  buffer_load_dwordx4 v[16:19], v2, s[4:7], s35 offen offset:0 sc1
  buffer_load_dwordx4 v[20:23], v2, s[4:7], s35 offen offset:1024 sc1
  buffer_load_dwordx4 v[24:27], v2, s[4:7], s35 offen offset:2048 sc1
  buffer_load_dwordx4 v[28:31], v2, s[4:7], s35 offen offset:3072 sc1
  s_waitcnt vmcnt(3)
  v_max3_u32 v4, v16, v17, v18
  v_max_u32 v4, v4, v19
  v_cmp_eq_u32 vcc, -1, v4
  s_cbranch_vccnz ret_161
  s_branch cont_157
ret_162:
  s_sub_u32 s23, s23, 1
  s_cbranch_scc1 rec_exit
  buffer_load_dwordx4 v[20:23], v2, s[4:7], s35 offen offset:1024 sc1
  buffer_load_dwordx4 v[24:27], v2, s[4:7], s35 offen offset:2048 sc1
  buffer_load_dwordx4 v[28:31], v2, s[4:7], s35 offen offset:3072 sc1
  s_waitcnt vmcnt(2)
  v_max3_u32 v4, v20, v21, v22
  v_max_u32 v4, v4, v23
  v_cmp_eq_u32 vcc, -1, v4
  s_cbranch_vccnz ret_162
  s_branch cont_158
ret_163:
  s_sub_u32 s23, s23, 1
  s_cbranch_scc1 rec_exit
  buffer_load_dwordx4 v[24:27], v2, s[4:7], s35 offen offset:2048 sc1
  buffer_load_dwordx4 v[28:31], v2, s[4:7], s35 offen offset:3072 sc1
  s_waitcnt vmcnt(1)
  v_max3_u32 v4, v24, v25, v26
  v_max_u32 v4, v4, v27
  v_cmp_eq_u32 vcc, -1, v4
  s_cbranch_vccnz ret_163
  s_branch cont_159
ret_164:
  s_sub_u32 s23, s23, 1
  s_cbranch_scc1 rec_exit
  buffer_load_dwordx4 v[28:31], v2, s[4:7], s35 offen offset:3072 sc1
  s_waitcnt vmcnt(0)
  v_max3_u32 v4, v28, v29, v30
  v_max_u32 v4, v4, v31
  v_cmp_eq_u32 vcc, -1, v4
  s_cbranch_vccnz ret_164
  s_branch cont_160
fin_148:
  s_waitcnt vmcnt(0)
  s_barrier
  v_mov_b32 v72, 64
  s_mov_b64 exec, 1
  buffer_store_dword v72, v7, s[4:7], s20 offen sc1
  s_mov_b64 exec, -1
  s_branch rec_exit
rec_exit:
  s_waitcnt vmcnt(0)
  s_endpgm
worker:
  s_sub_u32 s62, s3, 128
  s_lshr_b32 s60, s62, 4
  s_and_b32 s61, s62, 15
  s_lshl_b32 s60, s60, 2
  s_lshr_b32 s60, 1985229328, s60
  s_and_b32 s60, s60, 15
  s_lshl_b32 s62, s60, 4
  s_add_u32 s62, s62, s61
  s_add_u32 s3, s62, 128
  s_mov_b32 s23, 0x40000
  s_mov_b32 s39, 0
  v_mov_b32 v2, 0
  v_mov_b32 v3, 0
  v_mov_b32 v4, 0
  v_mov_b32 v5, 0
  v_mov_b32 v6, 0
  v_mov_b32 v7, 0
  v_mov_b32 v8, 0
  v_mov_b32 v9, 0
  v_mov_b32 v10, 0
  v_mov_b32 v11, 0
  v_mov_b32 v12, 0
  v_mov_b32 v13, 0
  v_mov_b32 v14, 0
  v_mov_b32 v15, 0
  v_mov_b32 v16, 0
  v_mov_b32 v17, 0
  v_mov_b32 v18, 0
  v_mov_b32 v19, 0
  v_mov_b32 v20, 0
  v_mov_b32 v21, 0
  v_mov_b32 v22, 0
  v_mov_b32 v23, 0
  v_mov_b32 v24, 0
  v_mov_b32 v25, 0
  v_mov_b32 v26, 0
  v_mov_b32 v27, 0
  v_mov_b32 v28, 0
  v_mov_b32 v29, 0
  v_mov_b32 v30, 0
  v_mov_b32 v31, 0
  s_mov_b32 s44, s4
  s_mov_b32 s45, s5
  s_mov_b32 s46, 268435456
  s_mov_b32 s47, 0x00020000
  s_mov_b32 s8, s4
  s_mov_b32 s9, s5
  s_mov_b32 s10, 0
  s_mov_b32 s11, s7
  s_mov_b32 s48, s4
  s_mov_b32 s49, s5
  s_mov_b32 s50, 0
  s_mov_b32 s51, s7
  s_mov_b32 s27, 0
  s_mov_b32 s52, 0
  s_mov_b32 s53, 0
  s_mov_b32 s55, 0
  s_mov_b32 s56, 0
  s_mov_b32 s57, 0
  s_mov_b32 s63, 0
  s_mov_b32 s22, 0
  s_mov_b32 s16, 0
  s_load_dwordx2 s[64:65], s[0:1], 40
  s_mov_b32 s66, 8388608
  s_mov_b32 s67, 0x00020000
  s_lshl_b32 s58, s62, 2
  s_add_u32 s58, s58, s14
  s_mul_i32 s58, s58, 16384
  v_lshl_add_u32 v221, v1, 7, s58
  s_waitcnt lgkmcnt(0)
  s_lshl_b32 s19, s61, 1
  s_and_b32 s58, s14, 1
  s_add_u32 s19, s19, s58
  s_lshl_b32 s19, s19, 7
  s_add_u32 s19, s19, 100679680
  s_cmp_lt_u32 s62, 64
  s_cbranch_scc1 do_ln
mini:
  s_lshl_b32 s36, s39, 7
  s_and_b32 s37, s62, 31
  s_lshl_b32 s37, s37, 7
  s_cmp_ge_u32 s62, 96
  s_cbranch_scc1 miniv
  s_load_dwordx2 s[44:45], s[0:1], 0
  s_mov_b32 s46, 4194304
  s_mov_b32 s47, 0x00020000
  s_load_dwordx2 s[48:49], s[0:1], 24
  s_mov_b32 s50, 8388608
  s_mov_b32 s51, 0x00020000
  s_lshl_b32 s52, s36, 11
  s_lshl_b32 s53, s37, 1
  s_lshr_b32 s56, s14, 1
  s_and_b32 s57, s14, 1
  s_lshl_b32 s55, s14, 10
  v_and_b32 v28, 15, v1
  v_lshrrev_b32 v29, 4, v1
  v_lshrrev_b32 v30, 1, v28
  v_xor_b32 v30, v29, v30
  v_lshlrev_b32 v30, 4, v30
  v_lshl_add_u32 v2, v28, 7, v30
  s_mul_i32 s58, s56, 8192
  v_add_u32 v2, s58, v2
  v_xor_b32 v3, 64, v2
  v_bfe_u32 v30, v1, 2, 2
  v_lshl_add_u32 v31, v29, 3, v30
  v_mul_u32_u24 v31, 256, v31
  v_and_b32 v160, 3, v1
  v_lshl_add_u32 v31, v160, 3, v31
  v_add_u32 v31, 65536, v31
  v_and_b32 v160, 1, v29
  v_lshl_add_u32 v30, v160, 2, v30
  s_mul_i32 s58, s57, 4
  v_xor_b32 v160, s58, v30
  v_lshl_add_u32 v4, v160, 5, v31
  s_add_u32 s58, s58, 1
  v_xor_b32 v160, s58, v30
  v_lshl_add_u32 v5, v160, 5, v31
  s_add_u32 s58, s58, 1
  v_xor_b32 v160, s58, v30
  v_lshl_add_u32 v6, v160, 5, v31
  s_add_u32 s58, s58, 1
  v_xor_b32 v160, s58, v30
  v_lshl_add_u32 v7, v160, 5, v31
  s_add_u32 s58, s58, 1
  s_lshl_b32 s58, s57, 2
  v_or_b32 v30, s58, v29
  v_and_b32 v31, 7, v1
  v_xor_b32 v30, v30, v31
  v_lshrrev_b32 v31, 3, v1
  s_lshl_b32 s58, s14, 3
  v_add_u32 v31, s58, v31
  v_bfe_u32 v160, v31, 2, 2
  v_and_b32 v31, 3, v31
  v_lshl_add_u32 v31, v160, 3, v31
  s_lshl_b32 s58, s56, 2
  v_add_u32 v31, s58, v31
  v_mul_u32_u24 v31, 2048, v31
  v_lshl_add_u32 v12, v30, 4, v31
  v_add_u32 v13, 65536, v12
  v_add_u32 v14, 131072, v12
  v_add_u32 v15, 196608, v12
  s_mov_b32 s22, 524288
  s_mul_i32 s58, s14, 4
  v_lshrrev_b32 v30, 4, v1
  v_add_u32 v30, s58, v30
  v_and_b32 v31, 15, v1
  v_add_u32 v160, 0, v30
  v_bfe_u32 v161, v160, 3, 1
  v_and_b32 v162, 3, v160
  v_lshl_add_u32 v161, v161, 2, v162
  v_lshlrev_b32 v161, 1, v161
  v_xor_b32 v161, v161, v31
  v_mul_u32_u24 v160, 8192, v160
  v_lshl_add_u32 v20, v161, 4, v160
  v_add_u32 v160, 16, v30
  v_bfe_u32 v161, v160, 3, 1
  v_and_b32 v162, 3, v160
  v_lshl_add_u32 v161, v161, 2, v162
  v_lshlrev_b32 v161, 1, v161
  v_xor_b32 v161, v161, v31
  v_mul_u32_u24 v160, 8192, v160
  v_lshl_add_u32 v21, v161, 4, v160
  v_add_u32 v160, 32, v30
  v_bfe_u32 v161, v160, 3, 1
  v_and_b32 v162, 3, v160
  v_lshl_add_u32 v161, v161, 2, v162
  v_lshlrev_b32 v161, 1, v161
  v_xor_b32 v161, v161, v31
  v_mul_u32_u24 v160, 8192, v160
  v_lshl_add_u32 v22, v161, 4, v160
  v_add_u32 v160, 48, v30
  v_bfe_u32 v161, v160, 3, 1
  v_and_b32 v162, 3, v160
  v_lshl_add_u32 v161, v161, 2, v162
  v_lshlrev_b32 v161, 1, v161
  v_xor_b32 v161, v161, v31
  v_mul_u32_u24 v160, 8192, v160
  v_lshl_add_u32 v23, v161, 4, v160
  s_waitcnt vmcnt(0) lgkmcnt(0)
  s_barrier
  s_add_u32 m0, s55, 0
  s_nop 0
  buffer_load_dwordx4 v12, s[44:47], s52 offen  lds
  s_add_u32 m0, s55, 65536
  s_nop 0
  buffer_load_dwordx4 v20, s[48:51], s53 offen lds
  s_add_u32 m0, s55, 4096
  s_nop 0
  buffer_load_dwordx4 v13, s[44:47], s52 offen  lds
  s_add_u32 m0, s55, 69632
  s_nop 0
  buffer_load_dwordx4 v21, s[48:51], s53 offen lds
  s_add_u32 m0, s55, 8192
  s_nop 0
  buffer_load_dwordx4 v14, s[44:47], s52 offen  lds
  s_add_u32 m0, s55, 73728
  s_nop 0
  buffer_load_dwordx4 v22, s[48:51], s53 offen lds
  s_add_u32 m0, s55, 12288
  s_nop 0
  buffer_load_dwordx4 v15, s[44:47], s52 offen  lds
  s_add_u32 m0, s55, 77824
  s_nop 0
  buffer_load_dwordx4 v23, s[48:51], s53 offen lds
  s_add_u32 s52, s52, 128
  s_add_u32 s53, s53, s22
  s_add_u32 m0, s55, 16384
  s_nop 0
  buffer_load_dwordx4 v12, s[44:47], s52 offen  lds
  s_add_u32 m0, s55, 81920
  s_nop 0
  buffer_load_dwordx4 v20, s[48:51], s53 offen lds
  s_add_u32 m0, s55, 20480
  s_nop 0
  buffer_load_dwordx4 v13, s[44:47], s52 offen  lds
  s_add_u32 m0, s55, 86016
  s_nop 0
  buffer_load_dwordx4 v21, s[48:51], s53 offen lds
  s_add_u32 m0, s55, 24576
  s_nop 0
  buffer_load_dwordx4 v14, s[44:47], s52 offen  lds
  s_add_u32 m0, s55, 90112
  s_nop 0
  buffer_load_dwordx4 v22, s[48:51], s53 offen lds
  s_add_u32 m0, s55, 28672
  s_nop 0
  buffer_load_dwordx4 v15, s[44:47], s52 offen  lds
  s_add_u32 m0, s55, 94208
  s_nop 0
  buffer_load_dwordx4 v23, s[48:51], s53 offen lds
  s_add_u32 s52, s52, 128
  s_add_u32 s53, s53, s22
  s_add_u32 m0, s55, 32768
  s_nop 0
  buffer_load_dwordx4 v12, s[44:47], s52 offen  lds
  s_add_u32 m0, s55, 98304
  s_nop 0
  buffer_load_dwordx4 v20, s[48:51], s53 offen lds
  s_add_u32 m0, s55, 36864
  s_nop 0
  buffer_load_dwordx4 v13, s[44:47], s52 offen  lds
  s_add_u32 m0, s55, 102400
  s_nop 0
  buffer_load_dwordx4 v21, s[48:51], s53 offen lds
  s_add_u32 m0, s55, 40960
  s_nop 0
  buffer_load_dwordx4 v14, s[44:47], s52 offen  lds
  s_add_u32 m0, s55, 106496
  s_nop 0
  buffer_load_dwordx4 v22, s[48:51], s53 offen lds
  s_add_u32 m0, s55, 45056
  s_nop 0
  buffer_load_dwordx4 v15, s[44:47], s52 offen  lds
  s_add_u32 m0, s55, 110592
  s_nop 0
  buffer_load_dwordx4 v23, s[48:51], s53 offen lds
  s_add_u32 s52, s52, 128
  s_add_u32 s53, s53, s22
  v_accvgpr_write_b32 a0, 0
  v_accvgpr_write_b32 a1, 0
  v_accvgpr_write_b32 a2, 0
  v_accvgpr_write_b32 a3, 0
  v_accvgpr_write_b32 a4, 0
  v_accvgpr_write_b32 a5, 0
  v_accvgpr_write_b32 a6, 0
  v_accvgpr_write_b32 a7, 0
  v_accvgpr_write_b32 a8, 0
  v_accvgpr_write_b32 a9, 0
  v_accvgpr_write_b32 a10, 0
  v_accvgpr_write_b32 a11, 0
  v_accvgpr_write_b32 a12, 0
  v_accvgpr_write_b32 a13, 0
  v_accvgpr_write_b32 a14, 0
  v_accvgpr_write_b32 a15, 0
  v_accvgpr_write_b32 a16, 0
  v_accvgpr_write_b32 a17, 0
  v_accvgpr_write_b32 a18, 0
  v_accvgpr_write_b32 a19, 0
  v_accvgpr_write_b32 a20, 0
  v_accvgpr_write_b32 a21, 0
  v_accvgpr_write_b32 a22, 0
  v_accvgpr_write_b32 a23, 0
  v_accvgpr_write_b32 a24, 0
  v_accvgpr_write_b32 a25, 0
  v_accvgpr_write_b32 a26, 0
  v_accvgpr_write_b32 a27, 0
  v_accvgpr_write_b32 a28, 0
  v_accvgpr_write_b32 a29, 0
  v_accvgpr_write_b32 a30, 0
  v_accvgpr_write_b32 a31, 0
  v_accvgpr_write_b32 a32, 0
  v_accvgpr_write_b32 a33, 0
  v_accvgpr_write_b32 a34, 0
  v_accvgpr_write_b32 a35, 0
  v_accvgpr_write_b32 a36, 0
  v_accvgpr_write_b32 a37, 0
  v_accvgpr_write_b32 a38, 0
  v_accvgpr_write_b32 a39, 0
  v_accvgpr_write_b32 a40, 0
  v_accvgpr_write_b32 a41, 0
  v_accvgpr_write_b32 a42, 0
  v_accvgpr_write_b32 a43, 0
  v_accvgpr_write_b32 a44, 0
  v_accvgpr_write_b32 a45, 0
  v_accvgpr_write_b32 a46, 0
  v_accvgpr_write_b32 a47, 0
  v_accvgpr_write_b32 a48, 0
  v_accvgpr_write_b32 a49, 0
  v_accvgpr_write_b32 a50, 0
  v_accvgpr_write_b32 a51, 0
  v_accvgpr_write_b32 a52, 0
  v_accvgpr_write_b32 a53, 0
  v_accvgpr_write_b32 a54, 0
  v_accvgpr_write_b32 a55, 0
  v_accvgpr_write_b32 a56, 0
  v_accvgpr_write_b32 a57, 0
  v_accvgpr_write_b32 a58, 0
  v_accvgpr_write_b32 a59, 0
  v_accvgpr_write_b32 a60, 0
  v_accvgpr_write_b32 a61, 0
  v_accvgpr_write_b32 a62, 0
  v_accvgpr_write_b32 a63, 0
  s_waitcnt vmcnt(16)
  s_barrier
  ds_read_b128 v[32:35], v2 offset:0
  ds_read_b64_tr_b16 v[64:65], v4 offset:0
  ds_read_b64_tr_b16 v[66:67], v4 offset:1024
  ds_read_b64_tr_b16 v[68:69], v5 offset:0
  ds_read_b64_tr_b16 v[70:71], v5 offset:1024
  ds_read_b128 v[36:39], v2 offset:2048
  ds_read_b64_tr_b16 v[72:73], v6 offset:0
  ds_read_b64_tr_b16 v[74:75], v6 offset:1024
  ds_read_b128 v[40:43], v2 offset:4096
  ds_read_b64_tr_b16 v[76:77], v7 offset:0
  ds_read_b64_tr_b16 v[78:79], v7 offset:1024
  ds_read_b128 v[44:47], v2 offset:6144
  s_mov_b32 s54, 4
gl_166:
  s_waitcnt lgkmcnt(9)
  s_add_u32 m0, s55, 49152
  v_mfma_f32_16x16x32_bf16 a[0:3], v[64:67], v[32:35], a[0:3]
  buffer_load_dwordx4 v12, s[44:47], s52 offen  lds
  s_waitcnt lgkmcnt(7)
  v_mfma_f32_16x16x32_bf16 a[4:7], v[68:71], v[32:35], a[4:7]
  s_waitcnt lgkmcnt(6)
  s_add_u32 m0, s55, 114688
  v_mfma_f32_16x16x32_bf16 a[16:19], v[64:67], v[36:39], a[16:19]
  buffer_load_dwordx4 v20, s[48:51], s53 offen lds
  v_mfma_f32_16x16x32_bf16 a[20:23], v[68:71], v[36:39], a[20:23]
  s_waitcnt lgkmcnt(4)
  v_mfma_f32_16x16x32_bf16 a[8:11], v[72:75], v[32:35], a[8:11]
  s_add_u32 m0, s55, 53248
  v_mfma_f32_16x16x32_bf16 a[24:27], v[72:75], v[36:39], a[24:27]
  buffer_load_dwordx4 v13, s[44:47], s52 offen  lds
  s_waitcnt lgkmcnt(3)
  v_mfma_f32_16x16x32_bf16 a[32:35], v[64:67], v[40:43], a[32:35]
  v_mfma_f32_16x16x32_bf16 a[36:39], v[68:71], v[40:43], a[36:39]
  s_add_u32 m0, s55, 118784
  v_mfma_f32_16x16x32_bf16 a[40:43], v[72:75], v[40:43], a[40:43]
  buffer_load_dwordx4 v21, s[48:51], s53 offen lds
  ds_read_b128 v[96:99], v3 offset:0
  ds_read_b64_tr_b16 v[128:129], v4 offset:8192
  s_waitcnt lgkmcnt(3)
  v_mfma_f32_16x16x32_bf16 a[12:15], v[76:79], v[32:35], a[12:15]
  ds_read_b64_tr_b16 v[130:131], v4 offset:9216
  s_add_u32 m0, s55, 57344
  v_mfma_f32_16x16x32_bf16 a[28:31], v[76:79], v[36:39], a[28:31]
  buffer_load_dwordx4 v14, s[44:47], s52 offen  lds
  ds_read_b64_tr_b16 v[132:133], v5 offset:8192
  ds_read_b64_tr_b16 v[134:135], v5 offset:9216
  v_mfma_f32_16x16x32_bf16 a[44:47], v[76:79], v[40:43], a[44:47]
  ds_read_b128 v[100:103], v3 offset:2048
  s_waitcnt lgkmcnt(6)
  v_mfma_f32_16x16x32_bf16 a[48:51], v[64:67], v[44:47], a[48:51]
  ds_read_b64_tr_b16 v[136:137], v6 offset:8192
  ds_read_b64_tr_b16 v[138:139], v6 offset:9216
  s_add_u32 m0, s55, 122880
  v_mfma_f32_16x16x32_bf16 a[52:55], v[68:71], v[44:47], a[52:55]
  buffer_load_dwordx4 v22, s[48:51], s53 offen lds
  ds_read_b128 v[104:107], v3 offset:4096
  v_mfma_f32_16x16x32_bf16 a[56:59], v[72:75], v[44:47], a[56:59]
  ds_read_b64_tr_b16 v[140:141], v7 offset:8192
  ds_read_b64_tr_b16 v[142:143], v7 offset:9216
  v_mfma_f32_16x16x32_bf16 a[60:63], v[76:79], v[44:47], a[60:63]
  ds_read_b128 v[108:111], v3 offset:6144
  s_waitcnt lgkmcnt(9)
  s_add_u32 m0, s55, 61440
  v_mfma_f32_16x16x32_bf16 a[0:3], v[128:131], v[96:99], a[0:3]
  buffer_load_dwordx4 v15, s[44:47], s52 offen  lds
  s_waitcnt lgkmcnt(7)
  v_mfma_f32_16x16x32_bf16 a[4:7], v[132:135], v[96:99], a[4:7]
  s_waitcnt lgkmcnt(6)
  v_mfma_f32_16x16x32_bf16 a[16:19], v[128:131], v[100:103], a[16:19]
  s_add_u32 m0, s55, 126976
  v_mfma_f32_16x16x32_bf16 a[20:23], v[132:135], v[100:103], a[20:23]
  buffer_load_dwordx4 v23, s[48:51], s53 offen lds
  s_waitcnt lgkmcnt(4)
  v_mfma_f32_16x16x32_bf16 a[8:11], v[136:139], v[96:99], a[8:11]
  v_mfma_f32_16x16x32_bf16 a[24:27], v[136:139], v[100:103], a[24:27]
  s_waitcnt lgkmcnt(3)
  v_mfma_f32_16x16x32_bf16 a[32:35], v[128:131], v[104:107], a[32:35]
  v_mfma_f32_16x16x32_bf16 a[36:39], v[132:135], v[104:107], a[36:39]
  s_waitcnt vmcnt(16) lgkmcnt(0)
  s_barrier
  v_mfma_f32_16x16x32_bf16 a[40:43], v[136:139], v[104:107], a[40:43]
  ds_read_b128 v[32:35], v2 offset:16384
  ds_read_b64_tr_b16 v[64:65], v4 offset:16384
  v_mfma_f32_16x16x32_bf16 a[12:15], v[140:143], v[96:99], a[12:15]
  ds_read_b64_tr_b16 v[66:67], v4 offset:17408
  v_mfma_f32_16x16x32_bf16 a[28:31], v[140:143], v[100:103], a[28:31]
  ds_read_b64_tr_b16 v[68:69], v5 offset:16384
  ds_read_b64_tr_b16 v[70:71], v5 offset:17408
  v_mfma_f32_16x16x32_bf16 a[44:47], v[140:143], v[104:107], a[44:47]
  ds_read_b128 v[36:39], v2 offset:18432
  v_mfma_f32_16x16x32_bf16 a[48:51], v[128:131], v[108:111], a[48:51]
  ds_read_b64_tr_b16 v[72:73], v6 offset:16384
  ds_read_b64_tr_b16 v[74:75], v6 offset:17408
  v_mfma_f32_16x16x32_bf16 a[52:55], v[132:135], v[108:111], a[52:55]
  ds_read_b128 v[40:43], v2 offset:20480
  v_mfma_f32_16x16x32_bf16 a[56:59], v[136:139], v[108:111], a[56:59]
  ds_read_b64_tr_b16 v[76:77], v7 offset:16384
  ds_read_b64_tr_b16 v[78:79], v7 offset:17408
  v_mfma_f32_16x16x32_bf16 a[60:63], v[140:143], v[108:111], a[60:63]
  ds_read_b128 v[44:47], v2 offset:22528
  s_add_u32 s52, s52, 128
  s_add_u32 s53, s53, s22
  s_cmp_eq_u32 s54, 1
  s_cselect_b32 s46, 0, s46
  s_cselect_b32 s50, 0, s50
  s_waitcnt lgkmcnt(9)
  s_add_u32 m0, s55, 0
  v_mfma_f32_16x16x32_bf16 a[0:3], v[64:67], v[32:35], a[0:3]
  buffer_load_dwordx4 v12, s[44:47], s52 offen  lds
  s_waitcnt lgkmcnt(7)
  v_mfma_f32_16x16x32_bf16 a[4:7], v[68:71], v[32:35], a[4:7]
  s_waitcnt lgkmcnt(6)
  s_add_u32 m0, s55, 65536
  v_mfma_f32_16x16x32_bf16 a[16:19], v[64:67], v[36:39], a[16:19]
  buffer_load_dwordx4 v20, s[48:51], s53 offen lds
  v_mfma_f32_16x16x32_bf16 a[20:23], v[68:71], v[36:39], a[20:23]
  s_waitcnt lgkmcnt(4)
  v_mfma_f32_16x16x32_bf16 a[8:11], v[72:75], v[32:35], a[8:11]
  s_add_u32 m0, s55, 4096
  v_mfma_f32_16x16x32_bf16 a[24:27], v[72:75], v[36:39], a[24:27]
  buffer_load_dwordx4 v13, s[44:47], s52 offen  lds
  s_waitcnt lgkmcnt(3)
  v_mfma_f32_16x16x32_bf16 a[32:35], v[64:67], v[40:43], a[32:35]
  v_mfma_f32_16x16x32_bf16 a[36:39], v[68:71], v[40:43], a[36:39]
  s_add_u32 m0, s55, 69632
  v_mfma_f32_16x16x32_bf16 a[40:43], v[72:75], v[40:43], a[40:43]
  buffer_load_dwordx4 v21, s[48:51], s53 offen lds
  ds_read_b128 v[96:99], v3 offset:16384
  ds_read_b64_tr_b16 v[128:129], v4 offset:24576
  s_waitcnt lgkmcnt(3)
  v_mfma_f32_16x16x32_bf16 a[12:15], v[76:79], v[32:35], a[12:15]
  ds_read_b64_tr_b16 v[130:131], v4 offset:25600
  s_add_u32 m0, s55, 8192
  v_mfma_f32_16x16x32_bf16 a[28:31], v[76:79], v[36:39], a[28:31]
  buffer_load_dwordx4 v14, s[44:47], s52 offen  lds
  ds_read_b64_tr_b16 v[132:133], v5 offset:24576
  ds_read_b64_tr_b16 v[134:135], v5 offset:25600
  v_mfma_f32_16x16x32_bf16 a[44:47], v[76:79], v[40:43], a[44:47]
  ds_read_b128 v[100:103], v3 offset:18432
  s_waitcnt lgkmcnt(6)
  v_mfma_f32_16x16x32_bf16 a[48:51], v[64:67], v[44:47], a[48:51]
  ds_read_b64_tr_b16 v[136:137], v6 offset:24576
  ds_read_b64_tr_b16 v[138:139], v6 offset:25600
  s_add_u32 m0, s55, 73728
  v_mfma_f32_16x16x32_bf16 a[52:55], v[68:71], v[44:47], a[52:55]
  buffer_load_dwordx4 v22, s[48:51], s53 offen lds
  ds_read_b128 v[104:107], v3 offset:20480
  v_mfma_f32_16x16x32_bf16 a[56:59], v[72:75], v[44:47], a[56:59]
  ds_read_b64_tr_b16 v[140:141], v7 offset:24576
  ds_read_b64_tr_b16 v[142:143], v7 offset:25600
  v_mfma_f32_16x16x32_bf16 a[60:63], v[76:79], v[44:47], a[60:63]
  ds_read_b128 v[108:111], v3 offset:22528
  s_waitcnt lgkmcnt(9)
  s_add_u32 m0, s55, 12288
  v_mfma_f32_16x16x32_bf16 a[0:3], v[128:131], v[96:99], a[0:3]
  buffer_load_dwordx4 v15, s[44:47], s52 offen  lds
  s_waitcnt lgkmcnt(7)
  v_mfma_f32_16x16x32_bf16 a[4:7], v[132:135], v[96:99], a[4:7]
  s_waitcnt lgkmcnt(6)
  v_mfma_f32_16x16x32_bf16 a[16:19], v[128:131], v[100:103], a[16:19]
  s_add_u32 m0, s55, 77824
  v_mfma_f32_16x16x32_bf16 a[20:23], v[132:135], v[100:103], a[20:23]
  buffer_load_dwordx4 v23, s[48:51], s53 offen lds
  s_waitcnt lgkmcnt(4)
  v_mfma_f32_16x16x32_bf16 a[8:11], v[136:139], v[96:99], a[8:11]
  v_mfma_f32_16x16x32_bf16 a[24:27], v[136:139], v[100:103], a[24:27]
  s_waitcnt lgkmcnt(3)
  v_mfma_f32_16x16x32_bf16 a[32:35], v[128:131], v[104:107], a[32:35]
  v_mfma_f32_16x16x32_bf16 a[36:39], v[132:135], v[104:107], a[36:39]
  s_waitcnt vmcnt(16) lgkmcnt(0)
  s_barrier
  v_mfma_f32_16x16x32_bf16 a[40:43], v[136:139], v[104:107], a[40:43]
  ds_read_b128 v[32:35], v2 offset:32768
  ds_read_b64_tr_b16 v[64:65], v4 offset:32768
  v_mfma_f32_16x16x32_bf16 a[12:15], v[140:143], v[96:99], a[12:15]
  ds_read_b64_tr_b16 v[66:67], v4 offset:33792
  v_mfma_f32_16x16x32_bf16 a[28:31], v[140:143], v[100:103], a[28:31]
  ds_read_b64_tr_b16 v[68:69], v5 offset:32768
  ds_read_b64_tr_b16 v[70:71], v5 offset:33792
  v_mfma_f32_16x16x32_bf16 a[44:47], v[140:143], v[104:107], a[44:47]
  ds_read_b128 v[36:39], v2 offset:34816
  v_mfma_f32_16x16x32_bf16 a[48:51], v[128:131], v[108:111], a[48:51]
  ds_read_b64_tr_b16 v[72:73], v6 offset:32768
  ds_read_b64_tr_b16 v[74:75], v6 offset:33792
  v_mfma_f32_16x16x32_bf16 a[52:55], v[132:135], v[108:111], a[52:55]
  ds_read_b128 v[40:43], v2 offset:36864
  v_mfma_f32_16x16x32_bf16 a[56:59], v[136:139], v[108:111], a[56:59]
  ds_read_b64_tr_b16 v[76:77], v7 offset:32768
  ds_read_b64_tr_b16 v[78:79], v7 offset:33792
  v_mfma_f32_16x16x32_bf16 a[60:63], v[140:143], v[108:111], a[60:63]
  ds_read_b128 v[44:47], v2 offset:38912
  s_add_u32 s52, s52, 128
  s_add_u32 s53, s53, s22
  s_waitcnt lgkmcnt(9)
  s_add_u32 m0, s55, 16384
  v_mfma_f32_16x16x32_bf16 a[0:3], v[64:67], v[32:35], a[0:3]
  buffer_load_dwordx4 v12, s[44:47], s52 offen  lds
  s_waitcnt lgkmcnt(7)
  v_mfma_f32_16x16x32_bf16 a[4:7], v[68:71], v[32:35], a[4:7]
  s_waitcnt lgkmcnt(6)
  s_add_u32 m0, s55, 81920
  v_mfma_f32_16x16x32_bf16 a[16:19], v[64:67], v[36:39], a[16:19]
  buffer_load_dwordx4 v20, s[48:51], s53 offen lds
  v_mfma_f32_16x16x32_bf16 a[20:23], v[68:71], v[36:39], a[20:23]
  s_waitcnt lgkmcnt(4)
  v_mfma_f32_16x16x32_bf16 a[8:11], v[72:75], v[32:35], a[8:11]
  s_add_u32 m0, s55, 20480
  v_mfma_f32_16x16x32_bf16 a[24:27], v[72:75], v[36:39], a[24:27]
  buffer_load_dwordx4 v13, s[44:47], s52 offen  lds
  s_waitcnt lgkmcnt(3)
  v_mfma_f32_16x16x32_bf16 a[32:35], v[64:67], v[40:43], a[32:35]
  v_mfma_f32_16x16x32_bf16 a[36:39], v[68:71], v[40:43], a[36:39]
  s_add_u32 m0, s55, 86016
  v_mfma_f32_16x16x32_bf16 a[40:43], v[72:75], v[40:43], a[40:43]
  buffer_load_dwordx4 v21, s[48:51], s53 offen lds
  ds_read_b128 v[96:99], v3 offset:32768
  ds_read_b64_tr_b16 v[128:129], v4 offset:40960
  s_waitcnt lgkmcnt(3)
  v_mfma_f32_16x16x32_bf16 a[12:15], v[76:79], v[32:35], a[12:15]
  ds_read_b64_tr_b16 v[130:131], v4 offset:41984
  s_add_u32 m0, s55, 24576
  v_mfma_f32_16x16x32_bf16 a[28:31], v[76:79], v[36:39], a[28:31]
  buffer_load_dwordx4 v14, s[44:47], s52 offen  lds
  ds_read_b64_tr_b16 v[132:133], v5 offset:40960
  ds_read_b64_tr_b16 v[134:135], v5 offset:41984
  v_mfma_f32_16x16x32_bf16 a[44:47], v[76:79], v[40:43], a[44:47]
  ds_read_b128 v[100:103], v3 offset:34816
  s_waitcnt lgkmcnt(6)
  v_mfma_f32_16x16x32_bf16 a[48:51], v[64:67], v[44:47], a[48:51]
  ds_read_b64_tr_b16 v[136:137], v6 offset:40960
  ds_read_b64_tr_b16 v[138:139], v6 offset:41984
  s_add_u32 m0, s55, 90112
  v_mfma_f32_16x16x32_bf16 a[52:55], v[68:71], v[44:47], a[52:55]
  buffer_load_dwordx4 v22, s[48:51], s53 offen lds
  ds_read_b128 v[104:107], v3 offset:36864
  v_mfma_f32_16x16x32_bf16 a[56:59], v[72:75], v[44:47], a[56:59]
  ds_read_b64_tr_b16 v[140:141], v7 offset:40960
  ds_read_b64_tr_b16 v[142:143], v7 offset:41984
  v_mfma_f32_16x16x32_bf16 a[60:63], v[76:79], v[44:47], a[60:63]
  ds_read_b128 v[108:111], v3 offset:38912
  s_waitcnt lgkmcnt(9)
  s_add_u32 m0, s55, 28672
  v_mfma_f32_16x16x32_bf16 a[0:3], v[128:131], v[96:99], a[0:3]
  buffer_load_dwordx4 v15, s[44:47], s52 offen  lds
  s_waitcnt lgkmcnt(7)
  v_mfma_f32_16x16x32_bf16 a[4:7], v[132:135], v[96:99], a[4:7]
  s_waitcnt lgkmcnt(6)
  v_mfma_f32_16x16x32_bf16 a[16:19], v[128:131], v[100:103], a[16:19]
  s_add_u32 m0, s55, 94208
  v_mfma_f32_16x16x32_bf16 a[20:23], v[132:135], v[100:103], a[20:23]
  buffer_load_dwordx4 v23, s[48:51], s53 offen lds
  s_waitcnt lgkmcnt(4)
  v_mfma_f32_16x16x32_bf16 a[8:11], v[136:139], v[96:99], a[8:11]
  v_mfma_f32_16x16x32_bf16 a[24:27], v[136:139], v[100:103], a[24:27]
  s_waitcnt lgkmcnt(3)
  v_mfma_f32_16x16x32_bf16 a[32:35], v[128:131], v[104:107], a[32:35]
  v_mfma_f32_16x16x32_bf16 a[36:39], v[132:135], v[104:107], a[36:39]
  s_waitcnt vmcnt(16) lgkmcnt(0)
  s_barrier
  v_mfma_f32_16x16x32_bf16 a[40:43], v[136:139], v[104:107], a[40:43]
  ds_read_b128 v[32:35], v2 offset:49152
  ds_read_b64_tr_b16 v[64:65], v4 offset:49152
  v_mfma_f32_16x16x32_bf16 a[12:15], v[140:143], v[96:99], a[12:15]
  ds_read_b64_tr_b16 v[66:67], v4 offset:50176
  v_mfma_f32_16x16x32_bf16 a[28:31], v[140:143], v[100:103], a[28:31]
  ds_read_b64_tr_b16 v[68:69], v5 offset:49152
  ds_read_b64_tr_b16 v[70:71], v5 offset:50176
  v_mfma_f32_16x16x32_bf16 a[44:47], v[140:143], v[104:107], a[44:47]
  ds_read_b128 v[36:39], v2 offset:51200
  v_mfma_f32_16x16x32_bf16 a[48:51], v[128:131], v[108:111], a[48:51]
  ds_read_b64_tr_b16 v[72:73], v6 offset:49152
  ds_read_b64_tr_b16 v[74:75], v6 offset:50176
  v_mfma_f32_16x16x32_bf16 a[52:55], v[132:135], v[108:111], a[52:55]
  ds_read_b128 v[40:43], v2 offset:53248
  v_mfma_f32_16x16x32_bf16 a[56:59], v[136:139], v[108:111], a[56:59]
  ds_read_b64_tr_b16 v[76:77], v7 offset:49152
  ds_read_b64_tr_b16 v[78:79], v7 offset:50176
  v_mfma_f32_16x16x32_bf16 a[60:63], v[140:143], v[108:111], a[60:63]
  ds_read_b128 v[44:47], v2 offset:55296
  s_add_u32 s52, s52, 128
  s_add_u32 s53, s53, s22
  s_waitcnt lgkmcnt(9)
  s_add_u32 m0, s55, 32768
  v_mfma_f32_16x16x32_bf16 a[0:3], v[64:67], v[32:35], a[0:3]
  buffer_load_dwordx4 v12, s[44:47], s52 offen  lds
  s_waitcnt lgkmcnt(7)
  v_mfma_f32_16x16x32_bf16 a[4:7], v[68:71], v[32:35], a[4:7]
  s_waitcnt lgkmcnt(6)
  s_add_u32 m0, s55, 98304
  v_mfma_f32_16x16x32_bf16 a[16:19], v[64:67], v[36:39], a[16:19]
  buffer_load_dwordx4 v20, s[48:51], s53 offen lds
  v_mfma_f32_16x16x32_bf16 a[20:23], v[68:71], v[36:39], a[20:23]
  s_waitcnt lgkmcnt(4)
  v_mfma_f32_16x16x32_bf16 a[8:11], v[72:75], v[32:35], a[8:11]
  s_add_u32 m0, s55, 36864
  v_mfma_f32_16x16x32_bf16 a[24:27], v[72:75], v[36:39], a[24:27]
  buffer_load_dwordx4 v13, s[44:47], s52 offen  lds
  s_waitcnt lgkmcnt(3)
  v_mfma_f32_16x16x32_bf16 a[32:35], v[64:67], v[40:43], a[32:35]
  v_mfma_f32_16x16x32_bf16 a[36:39], v[68:71], v[40:43], a[36:39]
  s_add_u32 m0, s55, 102400
  v_mfma_f32_16x16x32_bf16 a[40:43], v[72:75], v[40:43], a[40:43]
  buffer_load_dwordx4 v21, s[48:51], s53 offen lds
  ds_read_b128 v[96:99], v3 offset:49152
  ds_read_b64_tr_b16 v[128:129], v4 offset:57344
  s_waitcnt lgkmcnt(3)
  v_mfma_f32_16x16x32_bf16 a[12:15], v[76:79], v[32:35], a[12:15]
  ds_read_b64_tr_b16 v[130:131], v4 offset:58368
  s_add_u32 m0, s55, 40960
  v_mfma_f32_16x16x32_bf16 a[28:31], v[76:79], v[36:39], a[28:31]
  buffer_load_dwordx4 v14, s[44:47], s52 offen  lds
  ds_read_b64_tr_b16 v[132:133], v5 offset:57344
  ds_read_b64_tr_b16 v[134:135], v5 offset:58368
  v_mfma_f32_16x16x32_bf16 a[44:47], v[76:79], v[40:43], a[44:47]
  ds_read_b128 v[100:103], v3 offset:51200
  s_waitcnt lgkmcnt(6)
  v_mfma_f32_16x16x32_bf16 a[48:51], v[64:67], v[44:47], a[48:51]
  ds_read_b64_tr_b16 v[136:137], v6 offset:57344
  ds_read_b64_tr_b16 v[138:139], v6 offset:58368
  s_add_u32 m0, s55, 106496
  v_mfma_f32_16x16x32_bf16 a[52:55], v[68:71], v[44:47], a[52:55]
  buffer_load_dwordx4 v22, s[48:51], s53 offen lds
  ds_read_b128 v[104:107], v3 offset:53248
  v_mfma_f32_16x16x32_bf16 a[56:59], v[72:75], v[44:47], a[56:59]
  ds_read_b64_tr_b16 v[140:141], v7 offset:57344
  ds_read_b64_tr_b16 v[142:143], v7 offset:58368
  v_mfma_f32_16x16x32_bf16 a[60:63], v[76:79], v[44:47], a[60:63]
  ds_read_b128 v[108:111], v3 offset:55296
  s_waitcnt lgkmcnt(9)
  s_add_u32 m0, s55, 45056
  v_mfma_f32_16x16x32_bf16 a[0:3], v[128:131], v[96:99], a[0:3]
  buffer_load_dwordx4 v15, s[44:47], s52 offen  lds
  s_waitcnt lgkmcnt(7)
  v_mfma_f32_16x16x32_bf16 a[4:7], v[132:135], v[96:99], a[4:7]
  s_waitcnt lgkmcnt(6)
  v_mfma_f32_16x16x32_bf16 a[16:19], v[128:131], v[100:103], a[16:19]
  s_add_u32 m0, s55, 110592
  v_mfma_f32_16x16x32_bf16 a[20:23], v[132:135], v[100:103], a[20:23]
  buffer_load_dwordx4 v23, s[48:51], s53 offen lds
  s_waitcnt lgkmcnt(4)
  v_mfma_f32_16x16x32_bf16 a[8:11], v[136:139], v[96:99], a[8:11]
  v_mfma_f32_16x16x32_bf16 a[24:27], v[136:139], v[100:103], a[24:27]
  s_waitcnt lgkmcnt(3)
  v_mfma_f32_16x16x32_bf16 a[32:35], v[128:131], v[104:107], a[32:35]
  v_mfma_f32_16x16x32_bf16 a[36:39], v[132:135], v[104:107], a[36:39]
  s_waitcnt vmcnt(16) lgkmcnt(0)
  s_barrier
  v_mfma_f32_16x16x32_bf16 a[40:43], v[136:139], v[104:107], a[40:43]
  ds_read_b128 v[32:35], v2 offset:0
  ds_read_b64_tr_b16 v[64:65], v4 offset:0
  v_mfma_f32_16x16x32_bf16 a[12:15], v[140:143], v[96:99], a[12:15]
  ds_read_b64_tr_b16 v[66:67], v4 offset:1024
  v_mfma_f32_16x16x32_bf16 a[28:31], v[140:143], v[100:103], a[28:31]
  ds_read_b64_tr_b16 v[68:69], v5 offset:0
  ds_read_b64_tr_b16 v[70:71], v5 offset:1024
  v_mfma_f32_16x16x32_bf16 a[44:47], v[140:143], v[104:107], a[44:47]
  ds_read_b128 v[36:39], v2 offset:2048
  v_mfma_f32_16x16x32_bf16 a[48:51], v[128:131], v[108:111], a[48:51]
  ds_read_b64_tr_b16 v[72:73], v6 offset:0
  ds_read_b64_tr_b16 v[74:75], v6 offset:1024
  v_mfma_f32_16x16x32_bf16 a[52:55], v[132:135], v[108:111], a[52:55]
  ds_read_b128 v[40:43], v2 offset:4096
  v_mfma_f32_16x16x32_bf16 a[56:59], v[136:139], v[108:111], a[56:59]
  ds_read_b64_tr_b16 v[76:77], v7 offset:0
  ds_read_b64_tr_b16 v[78:79], v7 offset:1024
  v_mfma_f32_16x16x32_bf16 a[60:63], v[140:143], v[108:111], a[60:63]
  ds_read_b128 v[44:47], v2 offset:6144
  s_add_u32 s52, s52, 128
  s_add_u32 s53, s53, s22
  s_sub_u32 s54, s54, 1
  s_cmp_lg_u32 s54, 0
  s_cbranch_scc1 gl_166
gl_166_e:
  s_waitcnt lgkmcnt(0)
  s_nop 7
  s_lshl_b32 s63, s36, 13
  s_lshl_b32 s58, s37, 5
  s_add_u32 s63, s63, s58
  s_add_u32 s63, s63, 0
  v_and_b32 v30, 1, v29
  v_lshlrev_b32 v30, 5, v30
  v_lshrrev_b32 v160, 1, v29
  v_lshl_add_u32 v30, v160, 4, v30
  s_mul_i32 s58, s56, 524288
  s_mul_i32 s59, s57, 2048
  s_add_u32 s58, s58, s59
  v_add_u32 v30, v30, v28
  v_lshl_add_u32 v30, v30, 4, s58
  v_accvgpr_read_b32 v32, a0
  v_accvgpr_read_b32 v33, a1
  v_accvgpr_read_b32 v34, a2
  v_accvgpr_read_b32 v35, a3
  v_accvgpr_read_b32 v36, a4
  v_accvgpr_read_b32 v37, a5
  v_accvgpr_read_b32 v38, a6
  v_accvgpr_read_b32 v39, a7
  v_cvt_pk_bf16_f32 v64, v32, v33
  v_cvt_pk_bf16_f32 v65, v34, v35
  v_cvt_pk_bf16_f32 v66, v36, v37
  v_cvt_pk_bf16_f32 v67, v38, v39
  s_nop 0
  v_permlane16_swap_b32 v64, v66
  v_permlane16_swap_b32 v65, v67
  buffer_store_dwordx4 v[64:67], v30, s[4:7], s63 offen offset:0 sc1
  v_accvgpr_read_b32 v40, a8
  v_accvgpr_read_b32 v41, a9
  v_accvgpr_read_b32 v42, a10
  v_accvgpr_read_b32 v43, a11
  v_accvgpr_read_b32 v44, a12
  v_accvgpr_read_b32 v45, a13
  v_accvgpr_read_b32 v46, a14
  v_accvgpr_read_b32 v47, a15
  v_cvt_pk_bf16_f32 v68, v40, v41
  v_cvt_pk_bf16_f32 v69, v42, v43
  v_cvt_pk_bf16_f32 v70, v44, v45
  v_cvt_pk_bf16_f32 v71, v46, v47
  s_nop 0
  v_permlane16_swap_b32 v68, v70
  v_permlane16_swap_b32 v69, v71
  buffer_store_dwordx4 v[68:71], v30, s[4:7], s63 offen offset:1024 sc1
  s_add_u32 s63, s63, 131072
  v_accvgpr_read_b32 v32, a16
  v_accvgpr_read_b32 v33, a17
  v_accvgpr_read_b32 v34, a18
  v_accvgpr_read_b32 v35, a19
  v_accvgpr_read_b32 v36, a20
  v_accvgpr_read_b32 v37, a21
  v_accvgpr_read_b32 v38, a22
  v_accvgpr_read_b32 v39, a23
  v_cvt_pk_bf16_f32 v72, v32, v33
  v_cvt_pk_bf16_f32 v73, v34, v35
  v_cvt_pk_bf16_f32 v74, v36, v37
  v_cvt_pk_bf16_f32 v75, v38, v39
  s_nop 0
  v_permlane16_swap_b32 v72, v74
  v_permlane16_swap_b32 v73, v75
  buffer_store_dwordx4 v[72:75], v30, s[4:7], s63 offen offset:0 sc1
  v_accvgpr_read_b32 v40, a24
  v_accvgpr_read_b32 v41, a25
  v_accvgpr_read_b32 v42, a26
  v_accvgpr_read_b32 v43, a27
  v_accvgpr_read_b32 v44, a28
  v_accvgpr_read_b32 v45, a29
  v_accvgpr_read_b32 v46, a30
  v_accvgpr_read_b32 v47, a31
  v_cvt_pk_bf16_f32 v76, v40, v41
  v_cvt_pk_bf16_f32 v77, v42, v43
  v_cvt_pk_bf16_f32 v78, v44, v45
  v_cvt_pk_bf16_f32 v79, v46, v47
  s_nop 0
  v_permlane16_swap_b32 v76, v78
  v_permlane16_swap_b32 v77, v79
  buffer_store_dwordx4 v[76:79], v30, s[4:7], s63 offen offset:1024 sc1
  s_add_u32 s63, s63, 131072
  v_accvgpr_read_b32 v32, a32
  v_accvgpr_read_b32 v33, a33
  v_accvgpr_read_b32 v34, a34
  v_accvgpr_read_b32 v35, a35
  v_accvgpr_read_b32 v36, a36
  v_accvgpr_read_b32 v37, a37
  v_accvgpr_read_b32 v38, a38
  v_accvgpr_read_b32 v39, a39
  v_cvt_pk_bf16_f32 v80, v32, v33
  v_cvt_pk_bf16_f32 v81, v34, v35
  v_cvt_pk_bf16_f32 v82, v36, v37
  v_cvt_pk_bf16_f32 v83, v38, v39
  s_nop 0
  v_permlane16_swap_b32 v80, v82
  v_permlane16_swap_b32 v81, v83
  buffer_store_dwordx4 v[80:83], v30, s[4:7], s63 offen offset:0 sc1
  v_accvgpr_read_b32 v40, a40
  v_accvgpr_read_b32 v41, a41
  v_accvgpr_read_b32 v42, a42
  v_accvgpr_read_b32 v43, a43
  v_accvgpr_read_b32 v44, a44
  v_accvgpr_read_b32 v45, a45
  v_accvgpr_read_b32 v46, a46
  v_accvgpr_read_b32 v47, a47
  v_cvt_pk_bf16_f32 v84, v40, v41
  v_cvt_pk_bf16_f32 v85, v42, v43
  v_cvt_pk_bf16_f32 v86, v44, v45
  v_cvt_pk_bf16_f32 v87, v46, v47
  s_nop 0
  v_permlane16_swap_b32 v84, v86
  v_permlane16_swap_b32 v85, v87
  buffer_store_dwordx4 v[84:87], v30, s[4:7], s63 offen offset:1024 sc1
  s_add_u32 s63, s63, 131072
  v_accvgpr_read_b32 v32, a48
  v_accvgpr_read_b32 v33, a49
  v_accvgpr_read_b32 v34, a50
  v_accvgpr_read_b32 v35, a51
  v_accvgpr_read_b32 v36, a52
  v_accvgpr_read_b32 v37, a53
  v_accvgpr_read_b32 v38, a54
  v_accvgpr_read_b32 v39, a55
  v_cvt_pk_bf16_f32 v88, v32, v33
  v_cvt_pk_bf16_f32 v89, v34, v35
  v_cvt_pk_bf16_f32 v90, v36, v37
  v_cvt_pk_bf16_f32 v91, v38, v39
  s_nop 0
  v_permlane16_swap_b32 v88, v90
  v_permlane16_swap_b32 v89, v91
  buffer_store_dwordx4 v[88:91], v30, s[4:7], s63 offen offset:0 sc1
  v_accvgpr_read_b32 v40, a56
  v_accvgpr_read_b32 v41, a57
  v_accvgpr_read_b32 v42, a58
  v_accvgpr_read_b32 v43, a59
  v_accvgpr_read_b32 v44, a60
  v_accvgpr_read_b32 v45, a61
  v_accvgpr_read_b32 v46, a62
  v_accvgpr_read_b32 v47, a63
  v_cvt_pk_bf16_f32 v92, v40, v41
  v_cvt_pk_bf16_f32 v93, v42, v43
  v_cvt_pk_bf16_f32 v94, v44, v45
  v_cvt_pk_bf16_f32 v95, v46, v47
  s_nop 0
  v_permlane16_swap_b32 v92, v94
  v_permlane16_swap_b32 v93, v95
  buffer_store_dwordx4 v[92:95], v30, s[4:7], s63 offen offset:1024 sc1
  s_add_u32 s63, s63, 131072
  s_branch minie
miniv:
  s_load_dwordx2 s[44:45], s[0:1], 0
  s_mov_b32 s46, 4194304
  s_mov_b32 s47, 0x00020000
  s_load_dwordx2 s[48:49], s[0:1], 32
  s_mov_b32 s50, 8388608
  s_mov_b32 s51, 0x00020000
  s_lshl_b32 s52, s36, 11
  s_lshl_b32 s53, s37, 1
  s_lshr_b32 s56, s14, 1
  s_and_b32 s57, s14, 1
  s_lshl_b32 s55, s14, 10
  v_and_b32 v28, 15, v1
  v_lshrrev_b32 v29, 4, v1
  v_lshrrev_b32 v30, 1, v28
  v_xor_b32 v30, v29, v30
  v_lshlrev_b32 v30, 4, v30
  v_lshl_add_u32 v2, v28, 7, v30
  s_mul_i32 s58, s56, 8192
  v_add_u32 v2, s58, v2
  v_xor_b32 v3, 64, v2
  v_bfe_u32 v30, v1, 2, 2
  v_lshl_add_u32 v31, v29, 3, v30
  v_mul_u32_u24 v31, 256, v31
  v_and_b32 v160, 3, v1
  v_lshl_add_u32 v31, v160, 3, v31
  v_add_u32 v31, 65536, v31
  v_and_b32 v160, 1, v29
  v_lshl_add_u32 v30, v160, 2, v30
  s_mul_i32 s58, s57, 4
  v_xor_b32 v160, s58, v30
  v_lshl_add_u32 v4, v160, 5, v31
  s_add_u32 s58, s58, 1
  v_xor_b32 v160, s58, v30
  v_lshl_add_u32 v5, v160, 5, v31
  s_add_u32 s58, s58, 1
  v_xor_b32 v160, s58, v30
  v_lshl_add_u32 v6, v160, 5, v31
  s_add_u32 s58, s58, 1
  v_xor_b32 v160, s58, v30
  v_lshl_add_u32 v7, v160, 5, v31
  s_add_u32 s58, s58, 1
  s_lshl_b32 s58, s57, 2
  v_or_b32 v30, s58, v29
  v_and_b32 v31, 7, v1
  v_xor_b32 v30, v30, v31
  v_lshrrev_b32 v31, 3, v1
  s_lshl_b32 s58, s14, 3
  v_add_u32 v31, s58, v31
  v_mul_u32_u24 v31, 2048, v31
  v_lshl_add_u32 v12, v30, 4, v31
  v_add_u32 v13, 65536, v12
  v_add_u32 v14, 131072, v12
  v_add_u32 v15, 196608, v12
  s_mov_b32 s22, 524288
  s_mul_i32 s58, s14, 4
  v_lshrrev_b32 v30, 4, v1
  v_add_u32 v30, s58, v30
  v_and_b32 v31, 15, v1
  v_add_u32 v160, 0, v30
  v_bfe_u32 v161, v160, 3, 1
  v_and_b32 v162, 3, v160
  v_lshl_add_u32 v161, v161, 2, v162
  v_lshlrev_b32 v161, 1, v161
  v_xor_b32 v161, v161, v31
  v_mul_u32_u24 v160, 8192, v160
  v_lshl_add_u32 v20, v161, 4, v160
  v_add_u32 v160, 16, v30
  v_bfe_u32 v161, v160, 3, 1
  v_and_b32 v162, 3, v160
  v_lshl_add_u32 v161, v161, 2, v162
  v_lshlrev_b32 v161, 1, v161
  v_xor_b32 v161, v161, v31
  v_mul_u32_u24 v160, 8192, v160
  v_lshl_add_u32 v21, v161, 4, v160
  v_add_u32 v160, 32, v30
  v_bfe_u32 v161, v160, 3, 1
  v_and_b32 v162, 3, v160
  v_lshl_add_u32 v161, v161, 2, v162
  v_lshlrev_b32 v161, 1, v161
  v_xor_b32 v161, v161, v31
  v_mul_u32_u24 v160, 8192, v160
  v_lshl_add_u32 v22, v161, 4, v160
  v_add_u32 v160, 48, v30
  v_bfe_u32 v161, v160, 3, 1
  v_and_b32 v162, 3, v160
  v_lshl_add_u32 v161, v161, 2, v162
  v_lshlrev_b32 v161, 1, v161
  v_xor_b32 v161, v161, v31
  v_mul_u32_u24 v160, 8192, v160
  v_lshl_add_u32 v23, v161, 4, v160
  s_waitcnt vmcnt(0) lgkmcnt(0)
  s_barrier
  s_add_u32 m0, s55, 0
  s_nop 0
  buffer_load_dwordx4 v12, s[44:47], s52 offen  lds
  s_add_u32 m0, s55, 65536
  s_nop 0
  buffer_load_dwordx4 v20, s[48:51], s53 offen lds
  s_add_u32 m0, s55, 4096
  s_nop 0
  buffer_load_dwordx4 v13, s[44:47], s52 offen  lds
  s_add_u32 m0, s55, 69632
  s_nop 0
  buffer_load_dwordx4 v21, s[48:51], s53 offen lds
  s_add_u32 m0, s55, 8192
  s_nop 0
  buffer_load_dwordx4 v14, s[44:47], s52 offen  lds
  s_add_u32 m0, s55, 73728
  s_nop 0
  buffer_load_dwordx4 v22, s[48:51], s53 offen lds
  s_add_u32 m0, s55, 12288
  s_nop 0
  buffer_load_dwordx4 v15, s[44:47], s52 offen  lds
  s_add_u32 m0, s55, 77824
  s_nop 0
  buffer_load_dwordx4 v23, s[48:51], s53 offen lds
  s_add_u32 s52, s52, 128
  s_add_u32 s53, s53, s22
  s_add_u32 m0, s55, 16384
  s_nop 0
  buffer_load_dwordx4 v12, s[44:47], s52 offen  lds
  s_add_u32 m0, s55, 81920
  s_nop 0
  buffer_load_dwordx4 v20, s[48:51], s53 offen lds
  s_add_u32 m0, s55, 20480
  s_nop 0
  buffer_load_dwordx4 v13, s[44:47], s52 offen  lds
  s_add_u32 m0, s55, 86016
  s_nop 0
  buffer_load_dwordx4 v21, s[48:51], s53 offen lds
  s_add_u32 m0, s55, 24576
  s_nop 0
  buffer_load_dwordx4 v14, s[44:47], s52 offen  lds
  s_add_u32 m0, s55, 90112
  s_nop 0
  buffer_load_dwordx4 v22, s[48:51], s53 offen lds
  s_add_u32 m0, s55, 28672
  s_nop 0
  buffer_load_dwordx4 v15, s[44:47], s52 offen  lds
  s_add_u32 m0, s55, 94208
  s_nop 0
  buffer_load_dwordx4 v23, s[48:51], s53 offen lds
  s_add_u32 s52, s52, 128
  s_add_u32 s53, s53, s22
  s_add_u32 m0, s55, 32768
  s_nop 0
  buffer_load_dwordx4 v12, s[44:47], s52 offen  lds
  s_add_u32 m0, s55, 98304
  s_nop 0
  buffer_load_dwordx4 v20, s[48:51], s53 offen lds
  s_add_u32 m0, s55, 36864
  s_nop 0
  buffer_load_dwordx4 v13, s[44:47], s52 offen  lds
  s_add_u32 m0, s55, 102400
  s_nop 0
  buffer_load_dwordx4 v21, s[48:51], s53 offen lds
  s_add_u32 m0, s55, 40960
  s_nop 0
  buffer_load_dwordx4 v14, s[44:47], s52 offen  lds
  s_add_u32 m0, s55, 106496
  s_nop 0
  buffer_load_dwordx4 v22, s[48:51], s53 offen lds
  s_add_u32 m0, s55, 45056
  s_nop 0
  buffer_load_dwordx4 v15, s[44:47], s52 offen  lds
  s_add_u32 m0, s55, 110592
  s_nop 0
  buffer_load_dwordx4 v23, s[48:51], s53 offen lds
  s_add_u32 s52, s52, 128
  s_add_u32 s53, s53, s22
  v_accvgpr_write_b32 a0, 0
  v_accvgpr_write_b32 a1, 0
  v_accvgpr_write_b32 a2, 0
  v_accvgpr_write_b32 a3, 0
  v_accvgpr_write_b32 a4, 0
  v_accvgpr_write_b32 a5, 0
  v_accvgpr_write_b32 a6, 0
  v_accvgpr_write_b32 a7, 0
  v_accvgpr_write_b32 a8, 0
  v_accvgpr_write_b32 a9, 0
  v_accvgpr_write_b32 a10, 0
  v_accvgpr_write_b32 a11, 0
  v_accvgpr_write_b32 a12, 0
  v_accvgpr_write_b32 a13, 0
  v_accvgpr_write_b32 a14, 0
  v_accvgpr_write_b32 a15, 0
  v_accvgpr_write_b32 a16, 0
  v_accvgpr_write_b32 a17, 0
  v_accvgpr_write_b32 a18, 0
  v_accvgpr_write_b32 a19, 0
  v_accvgpr_write_b32 a20, 0
  v_accvgpr_write_b32 a21, 0
  v_accvgpr_write_b32 a22, 0
  v_accvgpr_write_b32 a23, 0
  v_accvgpr_write_b32 a24, 0
  v_accvgpr_write_b32 a25, 0
  v_accvgpr_write_b32 a26, 0
  v_accvgpr_write_b32 a27, 0
  v_accvgpr_write_b32 a28, 0
  v_accvgpr_write_b32 a29, 0
  v_accvgpr_write_b32 a30, 0
  v_accvgpr_write_b32 a31, 0
  v_accvgpr_write_b32 a32, 0
  v_accvgpr_write_b32 a33, 0
  v_accvgpr_write_b32 a34, 0
  v_accvgpr_write_b32 a35, 0
  v_accvgpr_write_b32 a36, 0
  v_accvgpr_write_b32 a37, 0
  v_accvgpr_write_b32 a38, 0
  v_accvgpr_write_b32 a39, 0
  v_accvgpr_write_b32 a40, 0
  v_accvgpr_write_b32 a41, 0
  v_accvgpr_write_b32 a42, 0
  v_accvgpr_write_b32 a43, 0
  v_accvgpr_write_b32 a44, 0
  v_accvgpr_write_b32 a45, 0
  v_accvgpr_write_b32 a46, 0
  v_accvgpr_write_b32 a47, 0
  v_accvgpr_write_b32 a48, 0
  v_accvgpr_write_b32 a49, 0
  v_accvgpr_write_b32 a50, 0
  v_accvgpr_write_b32 a51, 0
  v_accvgpr_write_b32 a52, 0
  v_accvgpr_write_b32 a53, 0
  v_accvgpr_write_b32 a54, 0
  v_accvgpr_write_b32 a55, 0
  v_accvgpr_write_b32 a56, 0
  v_accvgpr_write_b32 a57, 0
  v_accvgpr_write_b32 a58, 0
  v_accvgpr_write_b32 a59, 0
  v_accvgpr_write_b32 a60, 0
  v_accvgpr_write_b32 a61, 0
  v_accvgpr_write_b32 a62, 0
  v_accvgpr_write_b32 a63, 0
  s_waitcnt vmcnt(16)
  s_barrier
  ds_read_b128 v[32:35], v2 offset:0
  ds_read_b64_tr_b16 v[64:65], v4 offset:0
  ds_read_b64_tr_b16 v[66:67], v4 offset:1024
  ds_read_b64_tr_b16 v[68:69], v5 offset:0
  ds_read_b64_tr_b16 v[70:71], v5 offset:1024
  ds_read_b128 v[36:39], v2 offset:2048
  ds_read_b64_tr_b16 v[72:73], v6 offset:0
  ds_read_b64_tr_b16 v[74:75], v6 offset:1024
  ds_read_b128 v[40:43], v2 offset:4096
  ds_read_b64_tr_b16 v[76:77], v7 offset:0
  ds_read_b64_tr_b16 v[78:79], v7 offset:1024
  ds_read_b128 v[44:47], v2 offset:6144
  s_mov_b32 s54, 4
gl_167:
  s_waitcnt lgkmcnt(9)
  s_add_u32 m0, s55, 49152
  v_mfma_f32_16x16x32_bf16 a[0:3], v[32:35], v[64:67], a[0:3]
  buffer_load_dwordx4 v12, s[44:47], s52 offen  lds
  s_waitcnt lgkmcnt(7)
  v_mfma_f32_16x16x32_bf16 a[4:7], v[32:35], v[68:71], a[4:7]
  s_waitcnt lgkmcnt(6)
  s_add_u32 m0, s55, 114688
  v_mfma_f32_16x16x32_bf16 a[16:19], v[36:39], v[64:67], a[16:19]
  buffer_load_dwordx4 v20, s[48:51], s53 offen lds
  v_mfma_f32_16x16x32_bf16 a[20:23], v[36:39], v[68:71], a[20:23]
  s_waitcnt lgkmcnt(4)
  v_mfma_f32_16x16x32_bf16 a[8:11], v[32:35], v[72:75], a[8:11]
  s_add_u32 m0, s55, 53248
  v_mfma_f32_16x16x32_bf16 a[24:27], v[36:39], v[72:75], a[24:27]
  buffer_load_dwordx4 v13, s[44:47], s52 offen  lds
  s_waitcnt lgkmcnt(3)
  v_mfma_f32_16x16x32_bf16 a[32:35], v[40:43], v[64:67], a[32:35]
  v_mfma_f32_16x16x32_bf16 a[36:39], v[40:43], v[68:71], a[36:39]
  s_add_u32 m0, s55, 118784
  v_mfma_f32_16x16x32_bf16 a[40:43], v[40:43], v[72:75], a[40:43]
  buffer_load_dwordx4 v21, s[48:51], s53 offen lds
  ds_read_b128 v[96:99], v3 offset:0
  ds_read_b64_tr_b16 v[128:129], v4 offset:8192
  s_waitcnt lgkmcnt(3)
  v_mfma_f32_16x16x32_bf16 a[12:15], v[32:35], v[76:79], a[12:15]
  ds_read_b64_tr_b16 v[130:131], v4 offset:9216
  s_add_u32 m0, s55, 57344
  v_mfma_f32_16x16x32_bf16 a[28:31], v[36:39], v[76:79], a[28:31]
  buffer_load_dwordx4 v14, s[44:47], s52 offen  lds
  ds_read_b64_tr_b16 v[132:133], v5 offset:8192
  ds_read_b64_tr_b16 v[134:135], v5 offset:9216
  v_mfma_f32_16x16x32_bf16 a[44:47], v[40:43], v[76:79], a[44:47]
  ds_read_b128 v[100:103], v3 offset:2048
  s_waitcnt lgkmcnt(6)
  v_mfma_f32_16x16x32_bf16 a[48:51], v[44:47], v[64:67], a[48:51]
  ds_read_b64_tr_b16 v[136:137], v6 offset:8192
  ds_read_b64_tr_b16 v[138:139], v6 offset:9216
  s_add_u32 m0, s55, 122880
  v_mfma_f32_16x16x32_bf16 a[52:55], v[44:47], v[68:71], a[52:55]
  buffer_load_dwordx4 v22, s[48:51], s53 offen lds
  ds_read_b128 v[104:107], v3 offset:4096
  v_mfma_f32_16x16x32_bf16 a[56:59], v[44:47], v[72:75], a[56:59]
  ds_read_b64_tr_b16 v[140:141], v7 offset:8192
  ds_read_b64_tr_b16 v[142:143], v7 offset:9216
  v_mfma_f32_16x16x32_bf16 a[60:63], v[44:47], v[76:79], a[60:63]
  ds_read_b128 v[108:111], v3 offset:6144
  s_waitcnt lgkmcnt(9)
  s_add_u32 m0, s55, 61440
  v_mfma_f32_16x16x32_bf16 a[0:3], v[96:99], v[128:131], a[0:3]
  buffer_load_dwordx4 v15, s[44:47], s52 offen  lds
  s_waitcnt lgkmcnt(7)
  v_mfma_f32_16x16x32_bf16 a[4:7], v[96:99], v[132:135], a[4:7]
  s_waitcnt lgkmcnt(6)
  v_mfma_f32_16x16x32_bf16 a[16:19], v[100:103], v[128:131], a[16:19]
  s_add_u32 m0, s55, 126976
  v_mfma_f32_16x16x32_bf16 a[20:23], v[100:103], v[132:135], a[20:23]
  buffer_load_dwordx4 v23, s[48:51], s53 offen lds
  s_waitcnt lgkmcnt(4)
  v_mfma_f32_16x16x32_bf16 a[8:11], v[96:99], v[136:139], a[8:11]
  v_mfma_f32_16x16x32_bf16 a[24:27], v[100:103], v[136:139], a[24:27]
  s_waitcnt lgkmcnt(3)
  v_mfma_f32_16x16x32_bf16 a[32:35], v[104:107], v[128:131], a[32:35]
  v_mfma_f32_16x16x32_bf16 a[36:39], v[104:107], v[132:135], a[36:39]
  s_waitcnt vmcnt(16) lgkmcnt(0)
  s_barrier
  v_mfma_f32_16x16x32_bf16 a[40:43], v[104:107], v[136:139], a[40:43]
  ds_read_b128 v[32:35], v2 offset:16384
  ds_read_b64_tr_b16 v[64:65], v4 offset:16384
  v_mfma_f32_16x16x32_bf16 a[12:15], v[96:99], v[140:143], a[12:15]
  ds_read_b64_tr_b16 v[66:67], v4 offset:17408
  v_mfma_f32_16x16x32_bf16 a[28:31], v[100:103], v[140:143], a[28:31]
  ds_read_b64_tr_b16 v[68:69], v5 offset:16384
  ds_read_b64_tr_b16 v[70:71], v5 offset:17408
  v_mfma_f32_16x16x32_bf16 a[44:47], v[104:107], v[140:143], a[44:47]
  ds_read_b128 v[36:39], v2 offset:18432
  v_mfma_f32_16x16x32_bf16 a[48:51], v[108:111], v[128:131], a[48:51]
  ds_read_b64_tr_b16 v[72:73], v6 offset:16384
  ds_read_b64_tr_b16 v[74:75], v6 offset:17408
  v_mfma_f32_16x16x32_bf16 a[52:55], v[108:111], v[132:135], a[52:55]
  ds_read_b128 v[40:43], v2 offset:20480
  v_mfma_f32_16x16x32_bf16 a[56:59], v[108:111], v[136:139], a[56:59]
  ds_read_b64_tr_b16 v[76:77], v7 offset:16384
  ds_read_b64_tr_b16 v[78:79], v7 offset:17408
  v_mfma_f32_16x16x32_bf16 a[60:63], v[108:111], v[140:143], a[60:63]
  ds_read_b128 v[44:47], v2 offset:22528
  s_add_u32 s52, s52, 128
  s_add_u32 s53, s53, s22
  s_cmp_eq_u32 s54, 1
  s_cselect_b32 s46, 0, s46
  s_cselect_b32 s50, 0, s50
  s_waitcnt lgkmcnt(9)
  s_add_u32 m0, s55, 0
  v_mfma_f32_16x16x32_bf16 a[0:3], v[32:35], v[64:67], a[0:3]
  buffer_load_dwordx4 v12, s[44:47], s52 offen  lds
  s_waitcnt lgkmcnt(7)
  v_mfma_f32_16x16x32_bf16 a[4:7], v[32:35], v[68:71], a[4:7]
  s_waitcnt lgkmcnt(6)
  s_add_u32 m0, s55, 65536
  v_mfma_f32_16x16x32_bf16 a[16:19], v[36:39], v[64:67], a[16:19]
  buffer_load_dwordx4 v20, s[48:51], s53 offen lds
  v_mfma_f32_16x16x32_bf16 a[20:23], v[36:39], v[68:71], a[20:23]
  s_waitcnt lgkmcnt(4)
  v_mfma_f32_16x16x32_bf16 a[8:11], v[32:35], v[72:75], a[8:11]
  s_add_u32 m0, s55, 4096
  v_mfma_f32_16x16x32_bf16 a[24:27], v[36:39], v[72:75], a[24:27]
  buffer_load_dwordx4 v13, s[44:47], s52 offen  lds
  s_waitcnt lgkmcnt(3)
  v_mfma_f32_16x16x32_bf16 a[32:35], v[40:43], v[64:67], a[32:35]
  v_mfma_f32_16x16x32_bf16 a[36:39], v[40:43], v[68:71], a[36:39]
  s_add_u32 m0, s55, 69632
  v_mfma_f32_16x16x32_bf16 a[40:43], v[40:43], v[72:75], a[40:43]
  buffer_load_dwordx4 v21, s[48:51], s53 offen lds
  ds_read_b128 v[96:99], v3 offset:16384
  ds_read_b64_tr_b16 v[128:129], v4 offset:24576
  s_waitcnt lgkmcnt(3)
  v_mfma_f32_16x16x32_bf16 a[12:15], v[32:35], v[76:79], a[12:15]
  ds_read_b64_tr_b16 v[130:131], v4 offset:25600
  s_add_u32 m0, s55, 8192
  v_mfma_f32_16x16x32_bf16 a[28:31], v[36:39], v[76:79], a[28:31]
  buffer_load_dwordx4 v14, s[44:47], s52 offen  lds
  ds_read_b64_tr_b16 v[132:133], v5 offset:24576
  ds_read_b64_tr_b16 v[134:135], v5 offset:25600
  v_mfma_f32_16x16x32_bf16 a[44:47], v[40:43], v[76:79], a[44:47]
  ds_read_b128 v[100:103], v3 offset:18432
  s_waitcnt lgkmcnt(6)
  v_mfma_f32_16x16x32_bf16 a[48:51], v[44:47], v[64:67], a[48:51]
  ds_read_b64_tr_b16 v[136:137], v6 offset:24576
  ds_read_b64_tr_b16 v[138:139], v6 offset:25600
  s_add_u32 m0, s55, 73728
  v_mfma_f32_16x16x32_bf16 a[52:55], v[44:47], v[68:71], a[52:55]
  buffer_load_dwordx4 v22, s[48:51], s53 offen lds
  ds_read_b128 v[104:107], v3 offset:20480
  v_mfma_f32_16x16x32_bf16 a[56:59], v[44:47], v[72:75], a[56:59]
  ds_read_b64_tr_b16 v[140:141], v7 offset:24576
  ds_read_b64_tr_b16 v[142:143], v7 offset:25600
  v_mfma_f32_16x16x32_bf16 a[60:63], v[44:47], v[76:79], a[60:63]
  ds_read_b128 v[108:111], v3 offset:22528
  s_waitcnt lgkmcnt(9)
  s_add_u32 m0, s55, 12288
  v_mfma_f32_16x16x32_bf16 a[0:3], v[96:99], v[128:131], a[0:3]
  buffer_load_dwordx4 v15, s[44:47], s52 offen  lds
  s_waitcnt lgkmcnt(7)
  v_mfma_f32_16x16x32_bf16 a[4:7], v[96:99], v[132:135], a[4:7]
  s_waitcnt lgkmcnt(6)
  v_mfma_f32_16x16x32_bf16 a[16:19], v[100:103], v[128:131], a[16:19]
  s_add_u32 m0, s55, 77824
  v_mfma_f32_16x16x32_bf16 a[20:23], v[100:103], v[132:135], a[20:23]
  buffer_load_dwordx4 v23, s[48:51], s53 offen lds
  s_waitcnt lgkmcnt(4)
  v_mfma_f32_16x16x32_bf16 a[8:11], v[96:99], v[136:139], a[8:11]
  v_mfma_f32_16x16x32_bf16 a[24:27], v[100:103], v[136:139], a[24:27]
  s_waitcnt lgkmcnt(3)
  v_mfma_f32_16x16x32_bf16 a[32:35], v[104:107], v[128:131], a[32:35]
  v_mfma_f32_16x16x32_bf16 a[36:39], v[104:107], v[132:135], a[36:39]
  s_waitcnt vmcnt(16) lgkmcnt(0)
  s_barrier
  v_mfma_f32_16x16x32_bf16 a[40:43], v[104:107], v[136:139], a[40:43]
  ds_read_b128 v[32:35], v2 offset:32768
  ds_read_b64_tr_b16 v[64:65], v4 offset:32768
  v_mfma_f32_16x16x32_bf16 a[12:15], v[96:99], v[140:143], a[12:15]
  ds_read_b64_tr_b16 v[66:67], v4 offset:33792
  v_mfma_f32_16x16x32_bf16 a[28:31], v[100:103], v[140:143], a[28:31]
  ds_read_b64_tr_b16 v[68:69], v5 offset:32768
  ds_read_b64_tr_b16 v[70:71], v5 offset:33792
  v_mfma_f32_16x16x32_bf16 a[44:47], v[104:107], v[140:143], a[44:47]
  ds_read_b128 v[36:39], v2 offset:34816
  v_mfma_f32_16x16x32_bf16 a[48:51], v[108:111], v[128:131], a[48:51]
  ds_read_b64_tr_b16 v[72:73], v6 offset:32768
  ds_read_b64_tr_b16 v[74:75], v6 offset:33792
  v_mfma_f32_16x16x32_bf16 a[52:55], v[108:111], v[132:135], a[52:55]
  ds_read_b128 v[40:43], v2 offset:36864
  v_mfma_f32_16x16x32_bf16 a[56:59], v[108:111], v[136:139], a[56:59]
  ds_read_b64_tr_b16 v[76:77], v7 offset:32768
  ds_read_b64_tr_b16 v[78:79], v7 offset:33792
  v_mfma_f32_16x16x32_bf16 a[60:63], v[108:111], v[140:143], a[60:63]
  ds_read_b128 v[44:47], v2 offset:38912
  s_add_u32 s52, s52, 128
  s_add_u32 s53, s53, s22
  s_waitcnt lgkmcnt(9)
  s_add_u32 m0, s55, 16384
  v_mfma_f32_16x16x32_bf16 a[0:3], v[32:35], v[64:67], a[0:3]
  buffer_load_dwordx4 v12, s[44:47], s52 offen  lds
  s_waitcnt lgkmcnt(7)
  v_mfma_f32_16x16x32_bf16 a[4:7], v[32:35], v[68:71], a[4:7]
  s_waitcnt lgkmcnt(6)
  s_add_u32 m0, s55, 81920
  v_mfma_f32_16x16x32_bf16 a[16:19], v[36:39], v[64:67], a[16:19]
  buffer_load_dwordx4 v20, s[48:51], s53 offen lds
  v_mfma_f32_16x16x32_bf16 a[20:23], v[36:39], v[68:71], a[20:23]
  s_waitcnt lgkmcnt(4)
  v_mfma_f32_16x16x32_bf16 a[8:11], v[32:35], v[72:75], a[8:11]
  s_add_u32 m0, s55, 20480
  v_mfma_f32_16x16x32_bf16 a[24:27], v[36:39], v[72:75], a[24:27]
  buffer_load_dwordx4 v13, s[44:47], s52 offen  lds
  s_waitcnt lgkmcnt(3)
  v_mfma_f32_16x16x32_bf16 a[32:35], v[40:43], v[64:67], a[32:35]
  v_mfma_f32_16x16x32_bf16 a[36:39], v[40:43], v[68:71], a[36:39]
  s_add_u32 m0, s55, 86016
  v_mfma_f32_16x16x32_bf16 a[40:43], v[40:43], v[72:75], a[40:43]
  buffer_load_dwordx4 v21, s[48:51], s53 offen lds
  ds_read_b128 v[96:99], v3 offset:32768
  ds_read_b64_tr_b16 v[128:129], v4 offset:40960
  s_waitcnt lgkmcnt(3)
  v_mfma_f32_16x16x32_bf16 a[12:15], v[32:35], v[76:79], a[12:15]
  ds_read_b64_tr_b16 v[130:131], v4 offset:41984
  s_add_u32 m0, s55, 24576
  v_mfma_f32_16x16x32_bf16 a[28:31], v[36:39], v[76:79], a[28:31]
  buffer_load_dwordx4 v14, s[44:47], s52 offen  lds
  ds_read_b64_tr_b16 v[132:133], v5 offset:40960
  ds_read_b64_tr_b16 v[134:135], v5 offset:41984
  v_mfma_f32_16x16x32_bf16 a[44:47], v[40:43], v[76:79], a[44:47]
  ds_read_b128 v[100:103], v3 offset:34816
  s_waitcnt lgkmcnt(6)
  v_mfma_f32_16x16x32_bf16 a[48:51], v[44:47], v[64:67], a[48:51]
  ds_read_b64_tr_b16 v[136:137], v6 offset:40960
  ds_read_b64_tr_b16 v[138:139], v6 offset:41984
  s_add_u32 m0, s55, 90112
  v_mfma_f32_16x16x32_bf16 a[52:55], v[44:47], v[68:71], a[52:55]
  buffer_load_dwordx4 v22, s[48:51], s53 offen lds
  ds_read_b128 v[104:107], v3 offset:36864
  v_mfma_f32_16x16x32_bf16 a[56:59], v[44:47], v[72:75], a[56:59]
  ds_read_b64_tr_b16 v[140:141], v7 offset:40960
  ds_read_b64_tr_b16 v[142:143], v7 offset:41984
  v_mfma_f32_16x16x32_bf16 a[60:63], v[44:47], v[76:79], a[60:63]
  ds_read_b128 v[108:111], v3 offset:38912
  s_waitcnt lgkmcnt(9)
  s_add_u32 m0, s55, 28672
  v_mfma_f32_16x16x32_bf16 a[0:3], v[96:99], v[128:131], a[0:3]
  buffer_load_dwordx4 v15, s[44:47], s52 offen  lds
  s_waitcnt lgkmcnt(7)
  v_mfma_f32_16x16x32_bf16 a[4:7], v[96:99], v[132:135], a[4:7]
  s_waitcnt lgkmcnt(6)
  v_mfma_f32_16x16x32_bf16 a[16:19], v[100:103], v[128:131], a[16:19]
  s_add_u32 m0, s55, 94208
  v_mfma_f32_16x16x32_bf16 a[20:23], v[100:103], v[132:135], a[20:23]
  buffer_load_dwordx4 v23, s[48:51], s53 offen lds
  s_waitcnt lgkmcnt(4)
  v_mfma_f32_16x16x32_bf16 a[8:11], v[96:99], v[136:139], a[8:11]
  v_mfma_f32_16x16x32_bf16 a[24:27], v[100:103], v[136:139], a[24:27]
  s_waitcnt lgkmcnt(3)
  v_mfma_f32_16x16x32_bf16 a[32:35], v[104:107], v[128:131], a[32:35]
  v_mfma_f32_16x16x32_bf16 a[36:39], v[104:107], v[132:135], a[36:39]
  s_waitcnt vmcnt(16) lgkmcnt(0)
  s_barrier
  v_mfma_f32_16x16x32_bf16 a[40:43], v[104:107], v[136:139], a[40:43]
  ds_read_b128 v[32:35], v2 offset:49152
  ds_read_b64_tr_b16 v[64:65], v4 offset:49152
  v_mfma_f32_16x16x32_bf16 a[12:15], v[96:99], v[140:143], a[12:15]
  ds_read_b64_tr_b16 v[66:67], v4 offset:50176
  v_mfma_f32_16x16x32_bf16 a[28:31], v[100:103], v[140:143], a[28:31]
  ds_read_b64_tr_b16 v[68:69], v5 offset:49152
  ds_read_b64_tr_b16 v[70:71], v5 offset:50176
  v_mfma_f32_16x16x32_bf16 a[44:47], v[104:107], v[140:143], a[44:47]
  ds_read_b128 v[36:39], v2 offset:51200
  v_mfma_f32_16x16x32_bf16 a[48:51], v[108:111], v[128:131], a[48:51]
  ds_read_b64_tr_b16 v[72:73], v6 offset:49152
  ds_read_b64_tr_b16 v[74:75], v6 offset:50176
  v_mfma_f32_16x16x32_bf16 a[52:55], v[108:111], v[132:135], a[52:55]
  ds_read_b128 v[40:43], v2 offset:53248
  v_mfma_f32_16x16x32_bf16 a[56:59], v[108:111], v[136:139], a[56:59]
  ds_read_b64_tr_b16 v[76:77], v7 offset:49152
  ds_read_b64_tr_b16 v[78:79], v7 offset:50176
  v_mfma_f32_16x16x32_bf16 a[60:63], v[108:111], v[140:143], a[60:63]
  ds_read_b128 v[44:47], v2 offset:55296
  s_add_u32 s52, s52, 128
  s_add_u32 s53, s53, s22
  s_waitcnt lgkmcnt(9)
  s_add_u32 m0, s55, 32768
  v_mfma_f32_16x16x32_bf16 a[0:3], v[32:35], v[64:67], a[0:3]
  buffer_load_dwordx4 v12, s[44:47], s52 offen  lds
  s_waitcnt lgkmcnt(7)
  v_mfma_f32_16x16x32_bf16 a[4:7], v[32:35], v[68:71], a[4:7]
  s_waitcnt lgkmcnt(6)
  s_add_u32 m0, s55, 98304
  v_mfma_f32_16x16x32_bf16 a[16:19], v[36:39], v[64:67], a[16:19]
  buffer_load_dwordx4 v20, s[48:51], s53 offen lds
  v_mfma_f32_16x16x32_bf16 a[20:23], v[36:39], v[68:71], a[20:23]
  s_waitcnt lgkmcnt(4)
  v_mfma_f32_16x16x32_bf16 a[8:11], v[32:35], v[72:75], a[8:11]
  s_add_u32 m0, s55, 36864
  v_mfma_f32_16x16x32_bf16 a[24:27], v[36:39], v[72:75], a[24:27]
  buffer_load_dwordx4 v13, s[44:47], s52 offen  lds
  s_waitcnt lgkmcnt(3)
  v_mfma_f32_16x16x32_bf16 a[32:35], v[40:43], v[64:67], a[32:35]
  v_mfma_f32_16x16x32_bf16 a[36:39], v[40:43], v[68:71], a[36:39]
  s_add_u32 m0, s55, 102400
  v_mfma_f32_16x16x32_bf16 a[40:43], v[40:43], v[72:75], a[40:43]
  buffer_load_dwordx4 v21, s[48:51], s53 offen lds
  ds_read_b128 v[96:99], v3 offset:49152
  ds_read_b64_tr_b16 v[128:129], v4 offset:57344
  s_waitcnt lgkmcnt(3)
  v_mfma_f32_16x16x32_bf16 a[12:15], v[32:35], v[76:79], a[12:15]
  ds_read_b64_tr_b16 v[130:131], v4 offset:58368
  s_add_u32 m0, s55, 40960
  v_mfma_f32_16x16x32_bf16 a[28:31], v[36:39], v[76:79], a[28:31]
  buffer_load_dwordx4 v14, s[44:47], s52 offen  lds
  ds_read_b64_tr_b16 v[132:133], v5 offset:57344
  ds_read_b64_tr_b16 v[134:135], v5 offset:58368
  v_mfma_f32_16x16x32_bf16 a[44:47], v[40:43], v[76:79], a[44:47]
  ds_read_b128 v[100:103], v3 offset:51200
  s_waitcnt lgkmcnt(6)
  v_mfma_f32_16x16x32_bf16 a[48:51], v[44:47], v[64:67], a[48:51]
  ds_read_b64_tr_b16 v[136:137], v6 offset:57344
  ds_read_b64_tr_b16 v[138:139], v6 offset:58368
  s_add_u32 m0, s55, 106496
  v_mfma_f32_16x16x32_bf16 a[52:55], v[44:47], v[68:71], a[52:55]
  buffer_load_dwordx4 v22, s[48:51], s53 offen lds
  ds_read_b128 v[104:107], v3 offset:53248
  v_mfma_f32_16x16x32_bf16 a[56:59], v[44:47], v[72:75], a[56:59]
  ds_read_b64_tr_b16 v[140:141], v7 offset:57344
  ds_read_b64_tr_b16 v[142:143], v7 offset:58368
  v_mfma_f32_16x16x32_bf16 a[60:63], v[44:47], v[76:79], a[60:63]
  ds_read_b128 v[108:111], v3 offset:55296
  s_waitcnt lgkmcnt(9)
  s_add_u32 m0, s55, 45056
  v_mfma_f32_16x16x32_bf16 a[0:3], v[96:99], v[128:131], a[0:3]
  buffer_load_dwordx4 v15, s[44:47], s52 offen  lds
  s_waitcnt lgkmcnt(7)
  v_mfma_f32_16x16x32_bf16 a[4:7], v[96:99], v[132:135], a[4:7]
  s_waitcnt lgkmcnt(6)
  v_mfma_f32_16x16x32_bf16 a[16:19], v[100:103], v[128:131], a[16:19]
  s_add_u32 m0, s55, 110592
  v_mfma_f32_16x16x32_bf16 a[20:23], v[100:103], v[132:135], a[20:23]
  buffer_load_dwordx4 v23, s[48:51], s53 offen lds
  s_waitcnt lgkmcnt(4)
  v_mfma_f32_16x16x32_bf16 a[8:11], v[96:99], v[136:139], a[8:11]
  v_mfma_f32_16x16x32_bf16 a[24:27], v[100:103], v[136:139], a[24:27]
  s_waitcnt lgkmcnt(3)
  v_mfma_f32_16x16x32_bf16 a[32:35], v[104:107], v[128:131], a[32:35]
  v_mfma_f32_16x16x32_bf16 a[36:39], v[104:107], v[132:135], a[36:39]
  s_waitcnt vmcnt(16) lgkmcnt(0)
  s_barrier
  v_mfma_f32_16x16x32_bf16 a[40:43], v[104:107], v[136:139], a[40:43]
  ds_read_b128 v[32:35], v2 offset:0
  ds_read_b64_tr_b16 v[64:65], v4 offset:0
  v_mfma_f32_16x16x32_bf16 a[12:15], v[96:99], v[140:143], a[12:15]
  ds_read_b64_tr_b16 v[66:67], v4 offset:1024
  v_mfma_f32_16x16x32_bf16 a[28:31], v[100:103], v[140:143], a[28:31]
  ds_read_b64_tr_b16 v[68:69], v5 offset:0
  ds_read_b64_tr_b16 v[70:71], v5 offset:1024
  v_mfma_f32_16x16x32_bf16 a[44:47], v[104:107], v[140:143], a[44:47]
  ds_read_b128 v[36:39], v2 offset:2048
  v_mfma_f32_16x16x32_bf16 a[48:51], v[108:111], v[128:131], a[48:51]
  ds_read_b64_tr_b16 v[72:73], v6 offset:0
  ds_read_b64_tr_b16 v[74:75], v6 offset:1024
  v_mfma_f32_16x16x32_bf16 a[52:55], v[108:111], v[132:135], a[52:55]
  ds_read_b128 v[40:43], v2 offset:4096
  v_mfma_f32_16x16x32_bf16 a[56:59], v[108:111], v[136:139], a[56:59]
  ds_read_b64_tr_b16 v[76:77], v7 offset:0
  ds_read_b64_tr_b16 v[78:79], v7 offset:1024
  v_mfma_f32_16x16x32_bf16 a[60:63], v[108:111], v[140:143], a[60:63]
  ds_read_b128 v[44:47], v2 offset:6144
  s_add_u32 s52, s52, 128
  s_add_u32 s53, s53, s22
  s_sub_u32 s54, s54, 1
  s_cmp_lg_u32 s54, 0
  s_cbranch_scc1 gl_167
gl_167_e:
  s_waitcnt lgkmcnt(0)
  s_nop 7
  s_lshl_b32 s63, s36, 13
  s_lshl_b32 s58, s37, 6
  s_add_u32 s63, s63, s58
  s_add_u32 s63, s63, 16777216
  v_and_b32 v30, 1, v29
  v_lshlrev_b32 v30, 5, v30
  v_lshrrev_b32 v160, 1, v29
  v_lshl_add_u32 v30, v160, 4, v30
  s_mul_i32 s58, s56, 524288
  s_mul_i32 s59, s57, 4096
  s_add_u32 s58, s58, s59
  v_add_u32 v30, v28, v30
  v_lshl_add_u32 v30, v30, 4, s58
  v_add_u32 v31, 4096, v30
  v_accvgpr_read_b32 v32, a0
  v_accvgpr_read_b32 v33, a1
  v_accvgpr_read_b32 v34, a2
  v_accvgpr_read_b32 v35, a3
  v_accvgpr_read_b32 v36, a16
  v_accvgpr_read_b32 v37, a17
  v_accvgpr_read_b32 v38, a18
  v_accvgpr_read_b32 v39, a19
  v_cvt_pk_bf16_f32 v64, v32, v33
  v_cvt_pk_bf16_f32 v65, v34, v35
  v_cvt_pk_bf16_f32 v66, v36, v37
  v_cvt_pk_bf16_f32 v67, v38, v39
  s_nop 0
  v_permlane16_swap_b32 v64, v66
  v_permlane16_swap_b32 v65, v67
  buffer_store_dwordx4 v[64:67], v30, s[4:7], s63 offen offset:0 sc1
  v_accvgpr_read_b32 v40, a4
  v_accvgpr_read_b32 v41, a5
  v_accvgpr_read_b32 v42, a6
  v_accvgpr_read_b32 v43, a7
  v_accvgpr_read_b32 v44, a20
  v_accvgpr_read_b32 v45, a21
  v_accvgpr_read_b32 v46, a22
  v_accvgpr_read_b32 v47, a23
  v_cvt_pk_bf16_f32 v68, v40, v41
  v_cvt_pk_bf16_f32 v69, v42, v43
  v_cvt_pk_bf16_f32 v70, v44, v45
  v_cvt_pk_bf16_f32 v71, v46, v47
  s_nop 0
  v_permlane16_swap_b32 v68, v70
  v_permlane16_swap_b32 v69, v71
  buffer_store_dwordx4 v[68:71], v30, s[4:7], s63 offen offset:1024 sc1
  v_accvgpr_read_b32 v32, a8
  v_accvgpr_read_b32 v33, a9
  v_accvgpr_read_b32 v34, a10
  v_accvgpr_read_b32 v35, a11
  v_accvgpr_read_b32 v36, a24
  v_accvgpr_read_b32 v37, a25
  v_accvgpr_read_b32 v38, a26
  v_accvgpr_read_b32 v39, a27
  v_cvt_pk_bf16_f32 v72, v32, v33
  v_cvt_pk_bf16_f32 v73, v34, v35
  v_cvt_pk_bf16_f32 v74, v36, v37
  v_cvt_pk_bf16_f32 v75, v38, v39
  s_nop 0
  v_permlane16_swap_b32 v72, v74
  v_permlane16_swap_b32 v73, v75
  buffer_store_dwordx4 v[72:75], v30, s[4:7], s63 offen offset:2048 sc1
  v_accvgpr_read_b32 v40, a12
  v_accvgpr_read_b32 v41, a13
  v_accvgpr_read_b32 v42, a14
  v_accvgpr_read_b32 v43, a15
  v_accvgpr_read_b32 v44, a28
  v_accvgpr_read_b32 v45, a29
  v_accvgpr_read_b32 v46, a30
  v_accvgpr_read_b32 v47, a31
  v_cvt_pk_bf16_f32 v76, v40, v41
  v_cvt_pk_bf16_f32 v77, v42, v43
  v_cvt_pk_bf16_f32 v78, v44, v45
  v_cvt_pk_bf16_f32 v79, v46, v47
  s_nop 0
  v_permlane16_swap_b32 v76, v78
  v_permlane16_swap_b32 v77, v79
  buffer_store_dwordx4 v[76:79], v30, s[4:7], s63 offen offset:3072 sc1
  s_add_u32 s63, s63, 262144
  v_accvgpr_read_b32 v32, a32
  v_accvgpr_read_b32 v33, a33
  v_accvgpr_read_b32 v34, a34
  v_accvgpr_read_b32 v35, a35
  v_accvgpr_read_b32 v36, a48
  v_accvgpr_read_b32 v37, a49
  v_accvgpr_read_b32 v38, a50
  v_accvgpr_read_b32 v39, a51
  v_cvt_pk_bf16_f32 v80, v32, v33
  v_cvt_pk_bf16_f32 v81, v34, v35
  v_cvt_pk_bf16_f32 v82, v36, v37
  v_cvt_pk_bf16_f32 v83, v38, v39
  s_nop 0
  v_permlane16_swap_b32 v80, v82
  v_permlane16_swap_b32 v81, v83
  buffer_store_dwordx4 v[80:83], v30, s[4:7], s63 offen offset:0 sc1
  v_accvgpr_read_b32 v40, a36
  v_accvgpr_read_b32 v41, a37
  v_accvgpr_read_b32 v42, a38
  v_accvgpr_read_b32 v43, a39
  v_accvgpr_read_b32 v44, a52
  v_accvgpr_read_b32 v45, a53
  v_accvgpr_read_b32 v46, a54
  v_accvgpr_read_b32 v47, a55
  v_cvt_pk_bf16_f32 v84, v40, v41
  v_cvt_pk_bf16_f32 v85, v42, v43
  v_cvt_pk_bf16_f32 v86, v44, v45
  v_cvt_pk_bf16_f32 v87, v46, v47
  s_nop 0
  v_permlane16_swap_b32 v84, v86
  v_permlane16_swap_b32 v85, v87
  buffer_store_dwordx4 v[84:87], v30, s[4:7], s63 offen offset:1024 sc1
  v_accvgpr_read_b32 v32, a40
  v_accvgpr_read_b32 v33, a41
  v_accvgpr_read_b32 v34, a42
  v_accvgpr_read_b32 v35, a43
  v_accvgpr_read_b32 v36, a56
  v_accvgpr_read_b32 v37, a57
  v_accvgpr_read_b32 v38, a58
  v_accvgpr_read_b32 v39, a59
  v_cvt_pk_bf16_f32 v88, v32, v33
  v_cvt_pk_bf16_f32 v89, v34, v35
  v_cvt_pk_bf16_f32 v90, v36, v37
  v_cvt_pk_bf16_f32 v91, v38, v39
  s_nop 0
  v_permlane16_swap_b32 v88, v90
  v_permlane16_swap_b32 v89, v91
  buffer_store_dwordx4 v[88:91], v30, s[4:7], s63 offen offset:2048 sc1
  v_accvgpr_read_b32 v40, a44
  v_accvgpr_read_b32 v41, a45
  v_accvgpr_read_b32 v42, a46
  v_accvgpr_read_b32 v43, a47
  v_accvgpr_read_b32 v44, a60
  v_accvgpr_read_b32 v45, a61
  v_accvgpr_read_b32 v46, a62
  v_accvgpr_read_b32 v47, a63
  v_cvt_pk_bf16_f32 v92, v40, v41
  v_cvt_pk_bf16_f32 v93, v42, v43
  v_cvt_pk_bf16_f32 v94, v44, v45
  v_cvt_pk_bf16_f32 v95, v46, v47
  s_nop 0
  v_permlane16_swap_b32 v92, v94
  v_permlane16_swap_b32 v93, v95
  buffer_store_dwordx4 v[92:95], v30, s[4:7], s63 offen offset:3072 sc1
  s_add_u32 s63, s63, 262144
minie:
  s_waitcnt vmcnt(0)
  s_barrier
  s_cmp_lg_u32 s14, 0
  s_cbranch_scc1 sg_168
  s_lshl_b32 s58, s39, 2
  v_mov_b32 v160, 2
  v_mov_b32 v161, s58
  s_mov_b64 exec, 1
  buffer_atomic_add v160, v161, s[40:43], 0 offen offset:60 sc1
  s_mov_b64 exec, -1
sg_168:
  s_add_u32 s39, s39, 1
  s_cmp_lt_u32 s39, 2
  s_cbranch_scc1 mini
  s_branch mini_done
do_ln:
  s_bitcmp1_b32 s62, 4
  s_cbranch_scc0 mini_done
  s_lshr_b32 s39, s62, 5
  s_lshl_b32 s39, s39, 4
  s_add_u32 s39, s39, s61
  s_load_dwordx2 s[44:45], s[0:1], 0
  s_mov_b32 s46, 4194304
  s_mov_b32 s47, 0x00020000
  s_load_dwordx2 s[8:9], s[0:1], 96
  s_mov_b32 s10, 2048
  s_mov_b32 s11, 0x00020000
  s_lshl_b32 s30, s39, 4
  s_lshl_b32 s31, s14, 2
  s_add_u32 s30, s30, s31
  s_lshl_b32 s31, s30, 11
  v_lshlrev_b32 v2, 4, v1
  v_add_u32 v3, 4096, v2
  s_waitcnt lgkmcnt(0)
  s_add_u32 s58, s31, 0
  buffer_load_dwordx4 a[0:3], v2, s[44:47], s58 offen offset:0
  buffer_load_dwordx4 a[4:7], v2, s[44:47], s58 offen offset:1024
  buffer_load_dwordx4 a[8:11], v2, s[44:47], s58 offen offset:2048
  buffer_load_dwordx4 a[12:15], v2, s[44:47], s58 offen offset:3072
  buffer_load_dwordx4 a[16:19], v3, s[44:47], s58 offen offset:0
  buffer_load_dwordx4 a[20:23], v3, s[44:47], s58 offen offset:1024
  buffer_load_dwordx4 a[24:27], v3, s[44:47], s58 offen offset:2048
  buffer_load_dwordx4 a[28:31], v3, s[44:47], s58 offen offset:3072
  s_add_u32 s58, s31, 1048576
  buffer_load_dwordx4 a[32:35], v2, s[44:47], s58 offen offset:0
  buffer_load_dwordx4 a[36:39], v2, s[44:47], s58 offen offset:1024
  buffer_load_dwordx4 a[40:43], v2, s[44:47], s58 offen offset:2048
  buffer_load_dwordx4 a[44:47], v2, s[44:47], s58 offen offset:3072
  buffer_load_dwordx4 a[48:51], v3, s[44:47], s58 offen offset:0
  buffer_load_dwordx4 a[52:55], v3, s[44:47], s58 offen offset:1024
  buffer_load_dwordx4 a[56:59], v3, s[44:47], s58 offen offset:2048
  buffer_load_dwordx4 a[60:63], v3, s[44:47], s58 offen offset:3072
  s_add_u32 s58, s31, 2097152
  buffer_load_dwordx4 a[64:67], v2, s[44:47], s58 offen offset:0
  buffer_load_dwordx4 a[68:71], v2, s[44:47], s58 offen offset:1024
  buffer_load_dwordx4 a[72:75], v2, s[44:47], s58 offen offset:2048
  buffer_load_dwordx4 a[76:79], v2, s[44:47], s58 offen offset:3072
  buffer_load_dwordx4 a[80:83], v3, s[44:47], s58 offen offset:0
  buffer_load_dwordx4 a[84:87], v3, s[44:47], s58 offen offset:1024
  buffer_load_dwordx4 a[88:91], v3, s[44:47], s58 offen offset:2048
  buffer_load_dwordx4 a[92:95], v3, s[44:47], s58 offen offset:3072
  s_add_u32 s58, s31, 3145728
  buffer_load_dwordx4 a[96:99], v2, s[44:47], s58 offen offset:0
  buffer_load_dwordx4 a[100:103], v2, s[44:47], s58 offen offset:1024
  buffer_load_dwordx4 a[104:107], v2, s[44:47], s58 offen offset:2048
  buffer_load_dwordx4 a[108:111], v2, s[44:47], s58 offen offset:3072
  buffer_load_dwordx4 a[112:115], v3, s[44:47], s58 offen offset:0
  buffer_load_dwordx4 a[116:119], v3, s[44:47], s58 offen offset:1024
  buffer_load_dwordx4 a[120:123], v3, s[44:47], s58 offen offset:2048
  buffer_load_dwordx4 a[124:127], v3, s[44:47], s58 offen offset:3072
  buffer_load_dwordx4 v[64:67], v2, s[8:11], 0 offen offset:0
  buffer_load_dwordx4 v[68:71], v2, s[8:11], 0 offen offset:1024
  s_add_u32 s31, s31, 83886080
  s_lshl_b32 s30, s30, 2
  s_add_u32 s30, s30, 100663296
  s_waitcnt vmcnt(0)
  v_lshlrev_b32 v72, 16, v64
  v_and_b32 v73, 0xffff0000, v64
  v_lshlrev_b32 v74, 16, v65
  v_and_b32 v75, 0xffff0000, v65
  v_lshlrev_b32 v76, 16, v66
  v_and_b32 v77, 0xffff0000, v66
  v_lshlrev_b32 v78, 16, v67
  v_and_b32 v79, 0xffff0000, v67
  v_lshlrev_b32 v80, 16, v68
  v_and_b32 v81, 0xffff0000, v68
  v_lshlrev_b32 v82, 16, v69
  v_and_b32 v83, 0xffff0000, v69
  v_lshlrev_b32 v84, 16, v70
  v_and_b32 v85, 0xffff0000, v70
  v_lshlrev_b32 v86, 16, v71
  v_and_b32 v87, 0xffff0000, v71
  s_load_dwordx2 s[64:65], s[0:1], 64
  s_mov_b32 s66, 7340032
  s_mov_b32 s67, 0x00020000
  s_lshl_b32 s58, s39, 2
  s_add_u32 s58, s58, s14
  s_mul_i32 s58, s58, 57344
  v_lshl_add_u32 v221, v1, 7, s58
  s_waitcnt lgkmcnt(0)
  buffer_load_dword v220, v221, s[64:67], 0 offen
  v_add_u32 v221, 8192, v221
  buffer_load_dword v220, v221, s[64:67], 0 offen
  v_add_u32 v221, 8192, v221
  buffer_load_dword v220, v221, s[64:67], 0 offen
  v_add_u32 v221, 8192, v221
  buffer_load_dword v220, v221, s[64:67], 0 offen
  v_add_u32 v221, 8192, v221
  buffer_load_dword v220, v221, s[64:67], 0 offen
  v_add_u32 v221, 8192, v221
  buffer_load_dword v220, v221, s[64:67], 0 offen
  v_add_u32 v221, 8192, v221
  buffer_load_dword v220, v221, s[64:67], 0 offen
  v_add_u32 v221, 8192, v221
  s_load_dwordx2 s[64:65], s[0:1], 80
  s_mov_b32 s66, 7340032
  s_mov_b32 s67, 0x00020000
  s_lshl_b32 s58, s39, 2
  s_add_u32 s58, s58, s14
  s_mul_i32 s58, s58, 57344
  v_lshl_add_u32 v221, v1, 7, s58
  s_waitcnt lgkmcnt(0)
  s_mov_b32 s16, 7
ln_top:
  v_accvgpr_read_b32 v184, a0
  v_accvgpr_read_b32 v185, a1
  v_accvgpr_read_b32 v186, a2
  v_accvgpr_read_b32 v187, a3
  v_accvgpr_read_b32 v188, a4
  v_accvgpr_read_b32 v189, a5
  v_accvgpr_read_b32 v190, a6
  v_accvgpr_read_b32 v191, a7
  v_accvgpr_read_b32 v192, a8
  v_accvgpr_read_b32 v193, a9
  v_accvgpr_read_b32 v194, a10
  v_accvgpr_read_b32 v195, a11
  v_accvgpr_read_b32 v196, a12
  v_accvgpr_read_b32 v197, a13
  v_accvgpr_read_b32 v198, a14
  v_accvgpr_read_b32 v199, a15
  v_accvgpr_read_b32 v200, a16
  v_accvgpr_read_b32 v201, a17
  v_accvgpr_read_b32 v202, a18
  v_accvgpr_read_b32 v203, a19
  v_accvgpr_read_b32 v204, a20
  v_accvgpr_read_b32 v205, a21
  v_accvgpr_read_b32 v206, a22
  v_accvgpr_read_b32 v207, a23
  v_accvgpr_read_b32 v208, a24
  v_accvgpr_read_b32 v209, a25
  v_accvgpr_read_b32 v210, a26
  v_accvgpr_read_b32 v211, a27
  v_accvgpr_read_b32 v212, a28
  v_accvgpr_read_b32 v213, a29
  v_accvgpr_read_b32 v214, a30
  v_accvgpr_read_b32 v215, a31
  v_accvgpr_mov_b32 a0, a32
  v_accvgpr_mov_b32 a1, a33
  v_accvgpr_mov_b32 a2, a34
  v_accvgpr_mov_b32 a3, a35
  v_accvgpr_mov_b32 a4, a36
  v_accvgpr_mov_b32 a5, a37
  v_accvgpr_mov_b32 a6, a38
  v_accvgpr_mov_b32 a7, a39
  v_accvgpr_mov_b32 a8, a40
  v_accvgpr_mov_b32 a9, a41
  v_accvgpr_mov_b32 a10, a42
  v_accvgpr_mov_b32 a11, a43
  v_accvgpr_mov_b32 a12, a44
  v_accvgpr_mov_b32 a13, a45
  v_accvgpr_mov_b32 a14, a46
  v_accvgpr_mov_b32 a15, a47
  v_accvgpr_mov_b32 a16, a48
  v_accvgpr_mov_b32 a17, a49
  v_accvgpr_mov_b32 a18, a50
  v_accvgpr_mov_b32 a19, a51
  v_accvgpr_mov_b32 a20, a52
  v_accvgpr_mov_b32 a21, a53
  v_accvgpr_mov_b32 a22, a54
  v_accvgpr_mov_b32 a23, a55
  v_accvgpr_mov_b32 a24, a56
  v_accvgpr_mov_b32 a25, a57
  v_accvgpr_mov_b32 a26, a58
  v_accvgpr_mov_b32 a27, a59
  v_accvgpr_mov_b32 a28, a60
  v_accvgpr_mov_b32 a29, a61
  v_accvgpr_mov_b32 a30, a62
  v_accvgpr_mov_b32 a31, a63
  v_accvgpr_mov_b32 a32, a64
  v_accvgpr_mov_b32 a33, a65
  v_accvgpr_mov_b32 a34, a66
  v_accvgpr_mov_b32 a35, a67
  v_accvgpr_mov_b32 a36, a68
  v_accvgpr_mov_b32 a37, a69
  v_accvgpr_mov_b32 a38, a70
  v_accvgpr_mov_b32 a39, a71
  v_accvgpr_mov_b32 a40, a72
  v_accvgpr_mov_b32 a41, a73
  v_accvgpr_mov_b32 a42, a74
  v_accvgpr_mov_b32 a43, a75
  v_accvgpr_mov_b32 a44, a76
  v_accvgpr_mov_b32 a45, a77
  v_accvgpr_mov_b32 a46, a78
  v_accvgpr_mov_b32 a47, a79
  v_accvgpr_mov_b32 a48, a80
  v_accvgpr_mov_b32 a49, a81
  v_accvgpr_mov_b32 a50, a82
  v_accvgpr_mov_b32 a51, a83
  v_accvgpr_mov_b32 a52, a84
  v_accvgpr_mov_b32 a53, a85
  v_accvgpr_mov_b32 a54, a86
  v_accvgpr_mov_b32 a55, a87
  v_accvgpr_mov_b32 a56, a88
  v_accvgpr_mov_b32 a57, a89
  v_accvgpr_mov_b32 a58, a90
  v_accvgpr_mov_b32 a59, a91
  v_accvgpr_mov_b32 a60, a92
  v_accvgpr_mov_b32 a61, a93
  v_accvgpr_mov_b32 a62, a94
  v_accvgpr_mov_b32 a63, a95
  v_accvgpr_mov_b32 a64, a96
  v_accvgpr_mov_b32 a65, a97
  v_accvgpr_mov_b32 a66, a98
  v_accvgpr_mov_b32 a67, a99
  v_accvgpr_mov_b32 a68, a100
  v_accvgpr_mov_b32 a69, a101
  v_accvgpr_mov_b32 a70, a102
  v_accvgpr_mov_b32 a71, a103
  v_accvgpr_mov_b32 a72, a104
  v_accvgpr_mov_b32 a73, a105
  v_accvgpr_mov_b32 a74, a106
  v_accvgpr_mov_b32 a75, a107
  v_accvgpr_mov_b32 a76, a108
  v_accvgpr_mov_b32 a77, a109
  v_accvgpr_mov_b32 a78, a110
  v_accvgpr_mov_b32 a79, a111
  v_accvgpr_mov_b32 a80, a112
  v_accvgpr_mov_b32 a81, a113
  v_accvgpr_mov_b32 a82, a114
  v_accvgpr_mov_b32 a83, a115
  v_accvgpr_mov_b32 a84, a116
  v_accvgpr_mov_b32 a85, a117
  v_accvgpr_mov_b32 a86, a118
  v_accvgpr_mov_b32 a87, a119
  v_accvgpr_mov_b32 a88, a120
  v_accvgpr_mov_b32 a89, a121
  v_accvgpr_mov_b32 a90, a122
  v_accvgpr_mov_b32 a91, a123
  v_accvgpr_mov_b32 a92, a124
  v_accvgpr_mov_b32 a93, a125
  v_accvgpr_mov_b32 a94, a126
  v_accvgpr_mov_b32 a95, a127
  v_lshlrev_b32 v96, 16, v184
  v_and_b32 v97, 0xffff0000, v184
  v_lshlrev_b32 v98, 16, v185
  v_and_b32 v99, 0xffff0000, v185
  v_lshlrev_b32 v100, 16, v186
  v_and_b32 v101, 0xffff0000, v186
  v_lshlrev_b32 v102, 16, v187
  v_and_b32 v103, 0xffff0000, v187
  v_lshlrev_b32 v104, 16, v188
  v_and_b32 v105, 0xffff0000, v188
  v_lshlrev_b32 v106, 16, v189
  v_and_b32 v107, 0xffff0000, v189
  v_lshlrev_b32 v108, 16, v190
  v_and_b32 v109, 0xffff0000, v190
  v_lshlrev_b32 v110, 16, v191
  v_and_b32 v111, 0xffff0000, v191
  v_add_f32 v160, v96, v97
  v_mul_f32 v164, v96, v72
  v_fmac_f32 v164, v97, v73
  v_add_f32 v160, v160, v98
  v_fmac_f32 v164, v98, v74
  v_add_f32 v160, v160, v99
  v_fmac_f32 v164, v99, v75
  v_add_f32 v160, v160, v100
  v_fmac_f32 v164, v100, v76
  v_add_f32 v160, v160, v101
  v_fmac_f32 v164, v101, v77
  v_add_f32 v160, v160, v102
  v_fmac_f32 v164, v102, v78
  v_add_f32 v160, v160, v103
  v_fmac_f32 v164, v103, v79
  v_add_f32 v160, v160, v104
  v_fmac_f32 v164, v104, v80
  v_add_f32 v160, v160, v105
  v_fmac_f32 v164, v105, v81
  v_add_f32 v160, v160, v106
  v_fmac_f32 v164, v106, v82
  v_add_f32 v160, v160, v107
  v_fmac_f32 v164, v107, v83
  v_add_f32 v160, v160, v108
  v_fmac_f32 v164, v108, v84
  v_add_f32 v160, v160, v109
  v_fmac_f32 v164, v109, v85
  v_add_f32 v160, v160, v110
  v_fmac_f32 v164, v110, v86
  v_add_f32 v160, v160, v111
  v_fmac_f32 v164, v111, v87
  v_lshlrev_b32 v112, 16, v192
  v_and_b32 v113, 0xffff0000, v192
  v_lshlrev_b32 v114, 16, v193
  v_and_b32 v115, 0xffff0000, v193
  v_lshlrev_b32 v116, 16, v194
  v_and_b32 v117, 0xffff0000, v194
  v_lshlrev_b32 v118, 16, v195
  v_and_b32 v119, 0xffff0000, v195
  v_lshlrev_b32 v120, 16, v196
  v_and_b32 v121, 0xffff0000, v196
  v_lshlrev_b32 v122, 16, v197
  v_and_b32 v123, 0xffff0000, v197
  v_lshlrev_b32 v124, 16, v198
  v_and_b32 v125, 0xffff0000, v198
  v_lshlrev_b32 v126, 16, v199
  v_and_b32 v127, 0xffff0000, v199
  v_add_f32 v161, v112, v113
  v_mul_f32 v165, v112, v72
  v_fmac_f32 v165, v113, v73
  v_add_f32 v161, v161, v114
  v_fmac_f32 v165, v114, v74
  v_add_f32 v161, v161, v115
  v_fmac_f32 v165, v115, v75
  v_add_f32 v161, v161, v116
  v_fmac_f32 v165, v116, v76
  v_add_f32 v161, v161, v117
  v_fmac_f32 v165, v117, v77
  v_add_f32 v161, v161, v118
  v_fmac_f32 v165, v118, v78
  v_add_f32 v161, v161, v119
  v_fmac_f32 v165, v119, v79
  v_add_f32 v161, v161, v120
  v_fmac_f32 v165, v120, v80
  v_add_f32 v161, v161, v121
  v_fmac_f32 v165, v121, v81
  v_add_f32 v161, v161, v122
  v_fmac_f32 v165, v122, v82
  v_add_f32 v161, v161, v123
  v_fmac_f32 v165, v123, v83
  v_add_f32 v161, v161, v124
  v_fmac_f32 v165, v124, v84
  v_add_f32 v161, v161, v125
  v_fmac_f32 v165, v125, v85
  v_add_f32 v161, v161, v126
  v_fmac_f32 v165, v126, v86
  v_add_f32 v161, v161, v127
  v_fmac_f32 v165, v127, v87
  v_lshlrev_b32 v128, 16, v200
  v_and_b32 v129, 0xffff0000, v200
  v_lshlrev_b32 v130, 16, v201
  v_and_b32 v131, 0xffff0000, v201
  v_lshlrev_b32 v132, 16, v202
  v_and_b32 v133, 0xffff0000, v202
  v_lshlrev_b32 v134, 16, v203
  v_and_b32 v135, 0xffff0000, v203
  v_lshlrev_b32 v136, 16, v204
  v_and_b32 v137, 0xffff0000, v204
  v_lshlrev_b32 v138, 16, v205
  v_and_b32 v139, 0xffff0000, v205
  v_lshlrev_b32 v140, 16, v206
  v_and_b32 v141, 0xffff0000, v206
  v_lshlrev_b32 v142, 16, v207
  v_and_b32 v143, 0xffff0000, v207
  v_add_f32 v162, v128, v129
  v_mul_f32 v166, v128, v72
  v_fmac_f32 v166, v129, v73
  v_add_f32 v162, v162, v130
  v_fmac_f32 v166, v130, v74
  v_add_f32 v162, v162, v131
  v_fmac_f32 v166, v131, v75
  v_add_f32 v162, v162, v132
  v_fmac_f32 v166, v132, v76
  v_add_f32 v162, v162, v133
  v_fmac_f32 v166, v133, v77
  v_add_f32 v162, v162, v134
  v_fmac_f32 v166, v134, v78
  v_add_f32 v162, v162, v135
  v_fmac_f32 v166, v135, v79
  v_add_f32 v162, v162, v136
  v_fmac_f32 v166, v136, v80
  v_add_f32 v162, v162, v137
  v_fmac_f32 v166, v137, v81
  v_add_f32 v162, v162, v138
  v_fmac_f32 v166, v138, v82
  v_add_f32 v162, v162, v139
  v_fmac_f32 v166, v139, v83
  v_add_f32 v162, v162, v140
  v_fmac_f32 v166, v140, v84
  v_add_f32 v162, v162, v141
  v_fmac_f32 v166, v141, v85
  v_add_f32 v162, v162, v142
  v_fmac_f32 v166, v142, v86
  v_add_f32 v162, v162, v143
  v_fmac_f32 v166, v143, v87
  v_lshlrev_b32 v144, 16, v208
  v_and_b32 v145, 0xffff0000, v208
  v_lshlrev_b32 v146, 16, v209
  v_and_b32 v147, 0xffff0000, v209
  v_lshlrev_b32 v148, 16, v210
  v_and_b32 v149, 0xffff0000, v210
  v_lshlrev_b32 v150, 16, v211
  v_and_b32 v151, 0xffff0000, v211
  v_lshlrev_b32 v152, 16, v212
  v_and_b32 v153, 0xffff0000, v212
  v_lshlrev_b32 v154, 16, v213
  v_and_b32 v155, 0xffff0000, v213
  v_lshlrev_b32 v156, 16, v214
  v_and_b32 v157, 0xffff0000, v214
  v_lshlrev_b32 v158, 16, v215
  v_and_b32 v159, 0xffff0000, v215
  v_add_f32 v163, v144, v145
  v_mul_f32 v167, v144, v72
  v_fmac_f32 v167, v145, v73
  v_add_f32 v163, v163, v146
  v_fmac_f32 v167, v146, v74
  v_add_f32 v163, v163, v147
  v_fmac_f32 v167, v147, v75
  v_add_f32 v163, v163, v148
  v_fmac_f32 v167, v148, v76
  v_add_f32 v163, v163, v149
  v_fmac_f32 v167, v149, v77
  v_add_f32 v163, v163, v150
  v_fmac_f32 v167, v150, v78
  v_add_f32 v163, v163, v151
  v_fmac_f32 v167, v151, v79
  v_add_f32 v163, v163, v152
  v_fmac_f32 v167, v152, v80
  v_add_f32 v163, v163, v153
  v_fmac_f32 v167, v153, v81
  v_add_f32 v163, v163, v154
  v_fmac_f32 v167, v154, v82
  v_add_f32 v163, v163, v155
  v_fmac_f32 v167, v155, v83
  v_add_f32 v163, v163, v156
  v_fmac_f32 v167, v156, v84
  v_add_f32 v163, v163, v157
  v_fmac_f32 v167, v157, v85
  v_add_f32 v163, v163, v158
  v_fmac_f32 v167, v158, v86
  v_add_f32 v163, v163, v159
  v_fmac_f32 v167, v159, v87
  s_nop 1
  v_add_f32_dpp v160, v160, v160 row_ror:8 row_mask:0xf bank_mask:0xf
  v_add_f32_dpp v161, v161, v161 row_ror:8 row_mask:0xf bank_mask:0xf
  v_add_f32_dpp v162, v162, v162 row_ror:8 row_mask:0xf bank_mask:0xf
  v_add_f32_dpp v163, v163, v163 row_ror:8 row_mask:0xf bank_mask:0xf
  v_add_f32_dpp v164, v164, v164 row_ror:8 row_mask:0xf bank_mask:0xf
  v_add_f32_dpp v165, v165, v165 row_ror:8 row_mask:0xf bank_mask:0xf
  v_add_f32_dpp v166, v166, v166 row_ror:8 row_mask:0xf bank_mask:0xf
  v_add_f32_dpp v167, v167, v167 row_ror:8 row_mask:0xf bank_mask:0xf
  v_add_f32_dpp v160, v160, v160 row_ror:4 row_mask:0xf bank_mask:0xf
  v_add_f32_dpp v161, v161, v161 row_ror:4 row_mask:0xf bank_mask:0xf
  v_add_f32_dpp v162, v162, v162 row_ror:4 row_mask:0xf bank_mask:0xf
  v_add_f32_dpp v163, v163, v163 row_ror:4 row_mask:0xf bank_mask:0xf
  v_add_f32_dpp v164, v164, v164 row_ror:4 row_mask:0xf bank_mask:0xf
  v_add_f32_dpp v165, v165, v165 row_ror:4 row_mask:0xf bank_mask:0xf
  v_add_f32_dpp v166, v166, v166 row_ror:4 row_mask:0xf bank_mask:0xf
  v_add_f32_dpp v167, v167, v167 row_ror:4 row_mask:0xf bank_mask:0xf
  v_add_f32_dpp v160, v160, v160 row_ror:2 row_mask:0xf bank_mask:0xf
  v_add_f32_dpp v161, v161, v161 row_ror:2 row_mask:0xf bank_mask:0xf
  v_add_f32_dpp v162, v162, v162 row_ror:2 row_mask:0xf bank_mask:0xf
  v_add_f32_dpp v163, v163, v163 row_ror:2 row_mask:0xf bank_mask:0xf
  v_add_f32_dpp v164, v164, v164 row_ror:2 row_mask:0xf bank_mask:0xf
  v_add_f32_dpp v165, v165, v165 row_ror:2 row_mask:0xf bank_mask:0xf
  v_add_f32_dpp v166, v166, v166 row_ror:2 row_mask:0xf bank_mask:0xf
  v_add_f32_dpp v167, v167, v167 row_ror:2 row_mask:0xf bank_mask:0xf
  v_add_f32_dpp v160, v160, v160 row_ror:1 row_mask:0xf bank_mask:0xf
  v_add_f32_dpp v161, v161, v161 row_ror:1 row_mask:0xf bank_mask:0xf
  v_add_f32_dpp v162, v162, v162 row_ror:1 row_mask:0xf bank_mask:0xf
  v_add_f32_dpp v163, v163, v163 row_ror:1 row_mask:0xf bank_mask:0xf
  v_add_f32_dpp v164, v164, v164 row_ror:1 row_mask:0xf bank_mask:0xf
  v_add_f32_dpp v165, v165, v165 row_ror:1 row_mask:0xf bank_mask:0xf
  v_add_f32_dpp v166, v166, v166 row_ror:1 row_mask:0xf bank_mask:0xf
  v_add_f32_dpp v167, v167, v167 row_ror:1 row_mask:0xf bank_mask:0xf
  v_mov_b32 v176, v160
  v_mov_b32 v177, v161
  v_mov_b32 v178, v162
  v_mov_b32 v179, v163
  v_mov_b32 v180, v164
  v_mov_b32 v181, v165
  v_mov_b32 v182, v166
  v_mov_b32 v183, v167
  v_permlane16_swap_b32 v160, v176
  v_permlane16_swap_b32 v161, v177
  v_permlane16_swap_b32 v162, v178
  v_permlane16_swap_b32 v163, v179
  v_permlane16_swap_b32 v164, v180
  v_permlane16_swap_b32 v165, v181
  v_permlane16_swap_b32 v166, v182
  v_permlane16_swap_b32 v167, v183
  v_add_f32 v160, v160, v176
  v_add_f32 v161, v161, v177
  v_add_f32 v162, v162, v178
  v_add_f32 v163, v163, v179
  v_add_f32 v164, v164, v180
  v_add_f32 v165, v165, v181
  v_add_f32 v166, v166, v182
  v_add_f32 v167, v167, v183
  v_mov_b32 v176, v160
  v_mov_b32 v177, v161
  v_mov_b32 v178, v162
  v_mov_b32 v179, v163
  v_mov_b32 v180, v164
  v_mov_b32 v181, v165
  v_mov_b32 v182, v166
  v_mov_b32 v183, v167
  v_permlane32_swap_b32 v160, v176
  v_permlane32_swap_b32 v161, v177
  v_permlane32_swap_b32 v162, v178
  v_permlane32_swap_b32 v163, v179
  v_permlane32_swap_b32 v164, v180
  v_permlane32_swap_b32 v165, v181
  v_permlane32_swap_b32 v166, v182
  v_permlane32_swap_b32 v167, v183
  v_add_f32 v160, v160, v176
  v_add_f32 v161, v161, v177
  v_add_f32 v162, v162, v178
  v_add_f32 v163, v163, v179
  v_add_f32 v164, v164, v180
  v_add_f32 v165, v165, v181
  v_add_f32 v166, v166, v182
  v_add_f32 v167, v167, v183
  v_mul_f32 v160, 0x3a800000, v160
  v_sub_f32 v96, v96, v160
  v_mul_f32 v168, v96, v96
  v_sub_f32 v97, v97, v160
  v_fmac_f32 v168, v97, v97
  v_sub_f32 v98, v98, v160
  v_fmac_f32 v168, v98, v98
  v_sub_f32 v99, v99, v160
  v_fmac_f32 v168, v99, v99
  v_sub_f32 v100, v100, v160
  v_fmac_f32 v168, v100, v100
  v_sub_f32 v101, v101, v160
  v_fmac_f32 v168, v101, v101
  v_sub_f32 v102, v102, v160
  v_fmac_f32 v168, v102, v102
  v_sub_f32 v103, v103, v160
  v_fmac_f32 v168, v103, v103
  v_sub_f32 v104, v104, v160
  v_fmac_f32 v168, v104, v104
  v_sub_f32 v105, v105, v160
  v_fmac_f32 v168, v105, v105
  v_sub_f32 v106, v106, v160
  v_fmac_f32 v168, v106, v106
  v_sub_f32 v107, v107, v160
  v_fmac_f32 v168, v107, v107
  v_sub_f32 v108, v108, v160
  v_fmac_f32 v168, v108, v108
  v_sub_f32 v109, v109, v160
  v_fmac_f32 v168, v109, v109
  v_sub_f32 v110, v110, v160
  v_fmac_f32 v168, v110, v110
  v_sub_f32 v111, v111, v160
  v_fmac_f32 v168, v111, v111
  v_mul_f32 v161, 0x3a800000, v161
  v_sub_f32 v112, v112, v161
  v_mul_f32 v169, v112, v112
  v_sub_f32 v113, v113, v161
  v_fmac_f32 v169, v113, v113
  v_sub_f32 v114, v114, v161
  v_fmac_f32 v169, v114, v114
  v_sub_f32 v115, v115, v161
  v_fmac_f32 v169, v115, v115
  v_sub_f32 v116, v116, v161
  v_fmac_f32 v169, v116, v116
  v_sub_f32 v117, v117, v161
  v_fmac_f32 v169, v117, v117
  v_sub_f32 v118, v118, v161
  v_fmac_f32 v169, v118, v118
  v_sub_f32 v119, v119, v161
  v_fmac_f32 v169, v119, v119
  v_sub_f32 v120, v120, v161
  v_fmac_f32 v169, v120, v120
  v_sub_f32 v121, v121, v161
  v_fmac_f32 v169, v121, v121
  v_sub_f32 v122, v122, v161
  v_fmac_f32 v169, v122, v122
  v_sub_f32 v123, v123, v161
  v_fmac_f32 v169, v123, v123
  v_sub_f32 v124, v124, v161
  v_fmac_f32 v169, v124, v124
  v_sub_f32 v125, v125, v161
  v_fmac_f32 v169, v125, v125
  v_sub_f32 v126, v126, v161
  v_fmac_f32 v169, v126, v126
  v_sub_f32 v127, v127, v161
  v_fmac_f32 v169, v127, v127
  v_mul_f32 v162, 0x3a800000, v162
  v_sub_f32 v128, v128, v162
  v_mul_f32 v170, v128, v128
  v_sub_f32 v129, v129, v162
  v_fmac_f32 v170, v129, v129
  v_sub_f32 v130, v130, v162
  v_fmac_f32 v170, v130, v130
  v_sub_f32 v131, v131, v162
  v_fmac_f32 v170, v131, v131
  v_sub_f32 v132, v132, v162
  v_fmac_f32 v170, v132, v132
  v_sub_f32 v133, v133, v162
  v_fmac_f32 v170, v133, v133
  v_sub_f32 v134, v134, v162
  v_fmac_f32 v170, v134, v134
  v_sub_f32 v135, v135, v162
  v_fmac_f32 v170, v135, v135
  v_sub_f32 v136, v136, v162
  v_fmac_f32 v170, v136, v136
  v_sub_f32 v137, v137, v162
  v_fmac_f32 v170, v137, v137
  v_sub_f32 v138, v138, v162
  v_fmac_f32 v170, v138, v138
  v_sub_f32 v139, v139, v162
  v_fmac_f32 v170, v139, v139
  v_sub_f32 v140, v140, v162
  v_fmac_f32 v170, v140, v140
  v_sub_f32 v141, v141, v162
  v_fmac_f32 v170, v141, v141
  v_sub_f32 v142, v142, v162
  v_fmac_f32 v170, v142, v142
  v_sub_f32 v143, v143, v162
  v_fmac_f32 v170, v143, v143
  v_mul_f32 v163, 0x3a800000, v163
  v_sub_f32 v144, v144, v163
  v_mul_f32 v171, v144, v144
  v_sub_f32 v145, v145, v163
  v_fmac_f32 v171, v145, v145
  v_sub_f32 v146, v146, v163
  v_fmac_f32 v171, v146, v146
  v_sub_f32 v147, v147, v163
  v_fmac_f32 v171, v147, v147
  v_sub_f32 v148, v148, v163
  v_fmac_f32 v171, v148, v148
  v_sub_f32 v149, v149, v163
  v_fmac_f32 v171, v149, v149
  v_sub_f32 v150, v150, v163
  v_fmac_f32 v171, v150, v150
  v_sub_f32 v151, v151, v163
  v_fmac_f32 v171, v151, v151
  v_sub_f32 v152, v152, v163
  v_fmac_f32 v171, v152, v152
  v_sub_f32 v153, v153, v163
  v_fmac_f32 v171, v153, v153
  v_sub_f32 v154, v154, v163
  v_fmac_f32 v171, v154, v154
  v_sub_f32 v155, v155, v163
  v_fmac_f32 v171, v155, v155
  v_sub_f32 v156, v156, v163
  v_fmac_f32 v171, v156, v156
  v_sub_f32 v157, v157, v163
  v_fmac_f32 v171, v157, v157
  v_sub_f32 v158, v158, v163
  v_fmac_f32 v171, v158, v158
  v_sub_f32 v159, v159, v163
  v_fmac_f32 v171, v159, v159
  s_nop 1
  v_add_f32_dpp v168, v168, v168 row_ror:8 row_mask:0xf bank_mask:0xf
  v_add_f32_dpp v169, v169, v169 row_ror:8 row_mask:0xf bank_mask:0xf
  v_add_f32_dpp v170, v170, v170 row_ror:8 row_mask:0xf bank_mask:0xf
  v_add_f32_dpp v171, v171, v171 row_ror:8 row_mask:0xf bank_mask:0xf
  v_add_f32_dpp v168, v168, v168 row_ror:4 row_mask:0xf bank_mask:0xf
  v_add_f32_dpp v169, v169, v169 row_ror:4 row_mask:0xf bank_mask:0xf
  v_add_f32_dpp v170, v170, v170 row_ror:4 row_mask:0xf bank_mask:0xf
  v_add_f32_dpp v171, v171, v171 row_ror:4 row_mask:0xf bank_mask:0xf
  v_add_f32_dpp v168, v168, v168 row_ror:2 row_mask:0xf bank_mask:0xf
  v_add_f32_dpp v169, v169, v169 row_ror:2 row_mask:0xf bank_mask:0xf
  v_add_f32_dpp v170, v170, v170 row_ror:2 row_mask:0xf bank_mask:0xf
  v_add_f32_dpp v171, v171, v171 row_ror:2 row_mask:0xf bank_mask:0xf
  v_add_f32_dpp v168, v168, v168 row_ror:1 row_mask:0xf bank_mask:0xf
  v_add_f32_dpp v169, v169, v169 row_ror:1 row_mask:0xf bank_mask:0xf
  v_add_f32_dpp v170, v170, v170 row_ror:1 row_mask:0xf bank_mask:0xf
  v_add_f32_dpp v171, v171, v171 row_ror:1 row_mask:0xf bank_mask:0xf
  v_mov_b32 v176, v168
  v_mov_b32 v177, v169
  v_mov_b32 v178, v170
  v_mov_b32 v179, v171
  v_permlane16_swap_b32 v168, v176
  v_permlane16_swap_b32 v169, v177
  v_permlane16_swap_b32 v170, v178
  v_permlane16_swap_b32 v171, v179
  v_add_f32 v168, v168, v176
  v_add_f32 v169, v169, v177
  v_add_f32 v170, v170, v178
  v_add_f32 v171, v171, v179
  v_mov_b32 v176, v168
  v_mov_b32 v177, v169
  v_mov_b32 v178, v170
  v_mov_b32 v179, v171
  v_permlane32_swap_b32 v168, v176
  v_permlane32_swap_b32 v169, v177
  v_permlane32_swap_b32 v170, v178
  v_permlane32_swap_b32 v171, v179
  v_add_f32 v168, v168, v176
  v_add_f32 v169, v169, v177
  v_add_f32 v170, v170, v178
  v_add_f32 v171, v171, v179
  v_mov_b32 v176, 0x3727c5ac
  v_fmamk_f32 v168, v168, 0x3a800000, v176
  v_mul_f32 v164, 0xbfb8aa3b, v164
  v_fmamk_f32 v169, v169, 0x3a800000, v176
  v_mul_f32 v165, 0xbfb8aa3b, v165
  v_fmamk_f32 v170, v170, 0x3a800000, v176
  v_mul_f32 v166, 0xbfb8aa3b, v166
  v_fmamk_f32 v171, v171, 0x3a800000, v176
  v_mul_f32 v167, 0xbfb8aa3b, v167
  v_rsq_f32 v168, v168
  v_exp_f32 v164, v164
  v_rsq_f32 v169, v169
  v_exp_f32 v165, v165
  v_rsq_f32 v170, v170
  v_exp_f32 v166, v166
  v_rsq_f32 v171, v171
  v_exp_f32 v167, v167
  s_nop 0
  v_add_f32 v164, 1.0, v164
  v_add_f32 v165, 1.0, v165
  v_add_f32 v166, 1.0, v166
  v_add_f32 v167, 1.0, v167
  v_rcp_f32 v164, v164
  v_rcp_f32 v165, v165
  v_rcp_f32 v166, v166
  v_rcp_f32 v167, v167
  v_mul_f32 v96, v96, v168
  v_mul_f32 v97, v97, v168
  v_mul_f32 v98, v98, v168
  v_mul_f32 v99, v99, v168
  v_mul_f32 v100, v100, v168
  v_mul_f32 v101, v101, v168
  v_mul_f32 v102, v102, v168
  v_mul_f32 v103, v103, v168
  v_mul_f32 v104, v104, v168
  v_mul_f32 v105, v105, v168
  v_mul_f32 v106, v106, v168
  v_mul_f32 v107, v107, v168
  v_mul_f32 v108, v108, v168
  v_mul_f32 v109, v109, v168
  v_mul_f32 v110, v110, v168
  v_mul_f32 v111, v111, v168
  v_cvt_pk_bf16_f32 v32, v96, v97
  v_cvt_pk_bf16_f32 v33, v98, v99
  v_cvt_pk_bf16_f32 v34, v100, v101
  v_cvt_pk_bf16_f32 v35, v102, v103
  v_cvt_pk_bf16_f32 v36, v104, v105
  v_cvt_pk_bf16_f32 v37, v106, v107
  v_cvt_pk_bf16_f32 v38, v108, v109
  v_cvt_pk_bf16_f32 v39, v110, v111
  buffer_store_dwordx4 v[32:35], v2, s[4:7], s31 offen offset:0 sc1
  buffer_store_dwordx4 v[36:39], v2, s[4:7], s31 offen offset:1024 sc1
  v_mul_f32 v112, v112, v169
  v_mul_f32 v113, v113, v169
  v_mul_f32 v114, v114, v169
  v_mul_f32 v115, v115, v169
  v_mul_f32 v116, v116, v169
  v_mul_f32 v117, v117, v169
  v_mul_f32 v118, v118, v169
  v_mul_f32 v119, v119, v169
  v_mul_f32 v120, v120, v169
  v_mul_f32 v121, v121, v169
  v_mul_f32 v122, v122, v169
  v_mul_f32 v123, v123, v169
  v_mul_f32 v124, v124, v169
  v_mul_f32 v125, v125, v169
  v_mul_f32 v126, v126, v169
  v_mul_f32 v127, v127, v169
  v_cvt_pk_bf16_f32 v40, v112, v113
  v_cvt_pk_bf16_f32 v41, v114, v115
  v_cvt_pk_bf16_f32 v42, v116, v117
  v_cvt_pk_bf16_f32 v43, v118, v119
  v_cvt_pk_bf16_f32 v44, v120, v121
  v_cvt_pk_bf16_f32 v45, v122, v123
  v_cvt_pk_bf16_f32 v46, v124, v125
  v_cvt_pk_bf16_f32 v47, v126, v127
  buffer_store_dwordx4 v[40:43], v2, s[4:7], s31 offen offset:2048 sc1
  buffer_store_dwordx4 v[44:47], v2, s[4:7], s31 offen offset:3072 sc1
  v_mul_f32 v128, v128, v170
  v_mul_f32 v129, v129, v170
  v_mul_f32 v130, v130, v170
  v_mul_f32 v131, v131, v170
  v_mul_f32 v132, v132, v170
  v_mul_f32 v133, v133, v170
  v_mul_f32 v134, v134, v170
  v_mul_f32 v135, v135, v170
  v_mul_f32 v136, v136, v170
  v_mul_f32 v137, v137, v170
  v_mul_f32 v138, v138, v170
  v_mul_f32 v139, v139, v170
  v_mul_f32 v140, v140, v170
  v_mul_f32 v141, v141, v170
  v_mul_f32 v142, v142, v170
  v_mul_f32 v143, v143, v170
  v_cvt_pk_bf16_f32 v48, v128, v129
  v_cvt_pk_bf16_f32 v49, v130, v131
  v_cvt_pk_bf16_f32 v50, v132, v133
  v_cvt_pk_bf16_f32 v51, v134, v135
  v_cvt_pk_bf16_f32 v52, v136, v137
  v_cvt_pk_bf16_f32 v53, v138, v139
  v_cvt_pk_bf16_f32 v54, v140, v141
  v_cvt_pk_bf16_f32 v55, v142, v143
  buffer_store_dwordx4 v[48:51], v3, s[4:7], s31 offen offset:0 sc1
  buffer_store_dwordx4 v[52:55], v3, s[4:7], s31 offen offset:1024 sc1
  v_mul_f32 v144, v144, v171
  v_mul_f32 v145, v145, v171
  v_mul_f32 v146, v146, v171
  v_mul_f32 v147, v147, v171
  v_mul_f32 v148, v148, v171
  v_mul_f32 v149, v149, v171
  v_mul_f32 v150, v150, v171
  v_mul_f32 v151, v151, v171
  v_mul_f32 v152, v152, v171
  v_mul_f32 v153, v153, v171
  v_mul_f32 v154, v154, v171
  v_mul_f32 v155, v155, v171
  v_mul_f32 v156, v156, v171
  v_mul_f32 v157, v157, v171
  v_mul_f32 v158, v158, v171
  v_mul_f32 v159, v159, v171
  v_cvt_pk_bf16_f32 v56, v144, v145
  v_cvt_pk_bf16_f32 v57, v146, v147
  v_cvt_pk_bf16_f32 v58, v148, v149
  v_cvt_pk_bf16_f32 v59, v150, v151
  v_cvt_pk_bf16_f32 v60, v152, v153
  v_cvt_pk_bf16_f32 v61, v154, v155
  v_cvt_pk_bf16_f32 v62, v156, v157
  v_cvt_pk_bf16_f32 v63, v158, v159
  buffer_store_dwordx4 v[56:59], v3, s[4:7], s31 offen offset:2048 sc1
  buffer_store_dwordx4 v[60:63], v3, s[4:7], s31 offen offset:3072 sc1
  s_mov_b64 exec, 1
  buffer_store_dwordx4 v[164:167], v2, s[4:7], s30 offen sc1
  s_mov_b64 exec, -1
  s_add_u32 s31, s31, 1048576
  s_add_u32 s30, s30, 2048
  s_add_u32 s39, s39, 32
  s_cmp_lt_u32 s39, 128
  s_cbranch_scc1 ln_top
  s_waitcnt vmcnt(0)
  s_barrier
  s_cmp_lg_u32 s14, 0
  s_cbranch_scc1 sg_169
  s_lshl_b32 s58, 0, 2
  v_mov_b32 v160, 4
  v_mov_b32 v161, s58
  s_mov_b64 exec, 1
  buffer_atomic_add v160, v161, s[40:43], 0 offen offset:96 sc1
  s_mov_b64 exec, -1
sg_169:
mini_done:
  v_mov_b32 v171, v221
  s_mov_b32 s24, 370479889
  s_mov_b32 s25, 28755
  s_cmp_eq_u32 s60, 0
  s_cbranch_scc1 tab_ok
  s_mov_b32 s24, 1094063122
  s_mov_b32 s25, 25697
  s_cmp_eq_u32 s60, 1
  s_cbranch_scc1 tab_ok
  s_mov_b32 s24, 639968033
  s_mov_b32 s25, 18243
  s_cmp_eq_u32 s60, 2
  s_cbranch_scc1 tab_ok
  s_mov_b32 s24, 658514978
  s_mov_b32 s25, 25925
  s_cmp_eq_u32 s60, 3
  s_cbranch_scc1 tab_ok
  s_mov_b32 s24, 1667256368
  s_mov_b32 s25, 0
  s_cmp_eq_u32 s60, 4
  s_cbranch_scc1 tab_ok
  s_mov_b32 s24, 1645695281
  s_mov_b32 s25, 114
  s_cmp_eq_u32 s60, 5
  s_cbranch_scc1 tab_ok
  s_mov_b32 s24, 1179792434
  s_mov_b32 s25, 119
  s_cmp_eq_u32 s60, 6
  s_cbranch_scc1 tab_ok
  s_mov_b32 s24, 1145189683
  s_mov_b32 s25, 117
tab_ok:
  s_mov_b32 s26, 0
  s_mov_b32 s38, 0
  s_mov_b32 s15, 100794376
next_task:
  s_bfe_u32 s28, s24, 0x40004
  s_and_b32 s29, s24, 15
  s_lshr_b64 s[24:25], s[24:25], 8
  s_cmp_lg_u32 s28, 1
  s_cbranch_scc1 pro_1
  s_load_dwordx2 s[44:45], s[0:1], 0
  s_mov_b32 s46, 4194304
  s_mov_b32 s47, 0x00020000
  s_load_dwordx2 s[48:49], s[0:1], 24
  s_mov_b32 s50, 8388608
  s_mov_b32 s51, 0x00020000
  s_lshl_b32 s52, s29, 19
  s_lshl_b32 s53, s61, 9
  s_lshr_b32 s56, s14, 1
  s_and_b32 s57, s14, 1
  s_lshl_b32 s55, s14, 10
  v_and_b32 v28, 15, v1
  v_lshrrev_b32 v29, 4, v1
  v_lshrrev_b32 v30, 1, v28
  v_xor_b32 v30, v29, v30
  v_lshlrev_b32 v30, 4, v30
  v_lshl_add_u32 v2, v28, 7, v30
  s_mul_i32 s58, s56, 16384
  v_add_u32 v2, s58, v2
  v_xor_b32 v3, 64, v2
  v_bfe_u32 v30, v1, 2, 2
  v_lshl_add_u32 v31, v29, 3, v30
  v_mul_u32_u24 v31, 512, v31
  v_and_b32 v160, 3, v1
  v_lshl_add_u32 v31, v160, 3, v31
  v_add_u32 v31, 65536, v31
  v_and_b32 v160, 1, v29
  v_lshl_add_u32 v30, v160, 2, v30
  s_mul_i32 s58, s57, 8
  v_xor_b32 v160, s58, v30
  v_lshl_add_u32 v4, v160, 5, v31
  s_add_u32 s58, s58, 1
  v_xor_b32 v160, s58, v30
  v_lshl_add_u32 v5, v160, 5, v31
  s_add_u32 s58, s58, 1
  v_xor_b32 v160, s58, v30
  v_lshl_add_u32 v6, v160, 5, v31
  s_add_u32 s58, s58, 1
  v_xor_b32 v160, s58, v30
  v_lshl_add_u32 v7, v160, 5, v31
  s_add_u32 s58, s58, 1
  v_xor_b32 v160, s58, v30
  v_lshl_add_u32 v8, v160, 5, v31
  s_add_u32 s58, s58, 1
  v_xor_b32 v160, s58, v30
  v_lshl_add_u32 v9, v160, 5, v31
  s_add_u32 s58, s58, 1
  v_xor_b32 v160, s58, v30
  v_lshl_add_u32 v10, v160, 5, v31
  s_add_u32 s58, s58, 1
  v_xor_b32 v160, s58, v30
  v_lshl_add_u32 v11, v160, 5, v31
  s_add_u32 s58, s58, 1
  s_lshl_b32 s58, s57, 2
  v_or_b32 v30, s58, v29
  v_and_b32 v31, 7, v1
  v_xor_b32 v30, v30, v31
  v_lshrrev_b32 v31, 3, v1
  s_lshl_b32 s58, s14, 3
  v_add_u32 v31, s58, v31
  v_bfe_u32 v160, v31, 2, 2
  v_and_b32 v31, 3, v31
  v_lshl_add_u32 v31, v160, 3, v31
  s_lshl_b32 s58, s56, 2
  v_add_u32 v31, s58, v31
  v_mul_u32_u24 v31, 2048, v31
  v_lshl_add_u32 v12, v30, 4, v31
  v_add_u32 v13, 65536, v12
  v_add_u32 v14, 131072, v12
  v_add_u32 v15, 196608, v12
  v_add_u32 v16, 262144, v12
  v_add_u32 v17, 327680, v12
  v_add_u32 v18, 393216, v12
  v_add_u32 v19, 458752, v12
  s_mov_b32 s22, 524288
  s_mul_i32 s58, s14, 2
  v_lshrrev_b32 v30, 5, v1
  v_add_u32 v30, s58, v30
  v_and_b32 v31, 31, v1
  v_add_u32 v160, 0, v30
  v_bfe_u32 v161, v160, 3, 1
  v_and_b32 v162, 3, v160
  v_lshl_add_u32 v161, v161, 2, v162
  v_lshlrev_b32 v161, 1, v161
  v_xor_b32 v161, v161, v31
  v_mul_u32_u24 v160, 8192, v160
  v_lshl_add_u32 v20, v161, 4, v160
  v_add_u32 v160, 8, v30
  v_bfe_u32 v161, v160, 3, 1
  v_and_b32 v162, 3, v160
  v_lshl_add_u32 v161, v161, 2, v162
  v_lshlrev_b32 v161, 1, v161
  v_xor_b32 v161, v161, v31
  v_mul_u32_u24 v160, 8192, v160
  v_lshl_add_u32 v21, v161, 4, v160
  v_add_u32 v160, 16, v30
  v_bfe_u32 v161, v160, 3, 1
  v_and_b32 v162, 3, v160
  v_lshl_add_u32 v161, v161, 2, v162
  v_lshlrev_b32 v161, 1, v161
  v_xor_b32 v161, v161, v31
  v_mul_u32_u24 v160, 8192, v160
  v_lshl_add_u32 v22, v161, 4, v160
  v_add_u32 v160, 24, v30
  v_bfe_u32 v161, v160, 3, 1
  v_and_b32 v162, 3, v160
  v_lshl_add_u32 v161, v161, 2, v162
  v_lshlrev_b32 v161, 1, v161
  v_xor_b32 v161, v161, v31
  v_mul_u32_u24 v160, 8192, v160
  v_lshl_add_u32 v23, v161, 4, v160
  v_add_u32 v160, 32, v30
  v_bfe_u32 v161, v160, 3, 1
  v_and_b32 v162, 3, v160
  v_lshl_add_u32 v161, v161, 2, v162
  v_lshlrev_b32 v161, 1, v161
  v_xor_b32 v161, v161, v31
  v_mul_u32_u24 v160, 8192, v160
  v_lshl_add_u32 v24, v161, 4, v160
  v_add_u32 v160, 40, v30
  v_bfe_u32 v161, v160, 3, 1
  v_and_b32 v162, 3, v160
  v_lshl_add_u32 v161, v161, 2, v162
  v_lshlrev_b32 v161, 1, v161
  v_xor_b32 v161, v161, v31
  v_mul_u32_u24 v160, 8192, v160
  v_lshl_add_u32 v25, v161, 4, v160
  v_add_u32 v160, 48, v30
  v_bfe_u32 v161, v160, 3, 1
  v_and_b32 v162, 3, v160
  v_lshl_add_u32 v161, v161, 2, v162
  v_lshlrev_b32 v161, 1, v161
  v_xor_b32 v161, v161, v31
  v_mul_u32_u24 v160, 8192, v160
  v_lshl_add_u32 v26, v161, 4, v160
  v_add_u32 v160, 56, v30
  v_bfe_u32 v161, v160, 3, 1
  v_and_b32 v162, 3, v160
  v_lshl_add_u32 v161, v161, 2, v162
  v_lshlrev_b32 v161, 1, v161
  v_xor_b32 v161, v161, v31
  v_mul_u32_u24 v160, 8192, v160
  v_lshl_add_u32 v27, v161, 4, v160
  s_waitcnt vmcnt(0) lgkmcnt(0)
  s_barrier
  s_branch epi_0
pro_1:
  s_cmp_lg_u32 s28, 2
  s_cbranch_scc1 pro_2
  s_load_dwordx2 s[44:45], s[0:1], 0
  s_mov_b32 s46, 4194304
  s_mov_b32 s47, 0x00020000
  s_load_dwordx2 s[48:49], s[0:1], 32
  s_mov_b32 s50, 8388608
  s_mov_b32 s51, 0x00020000
  s_lshl_b32 s52, s29, 19
  s_lshl_b32 s53, s61, 9
  s_lshr_b32 s56, s14, 1
  s_and_b32 s57, s14, 1
  s_lshl_b32 s55, s14, 10
  v_and_b32 v28, 15, v1
  v_lshrrev_b32 v29, 4, v1
  v_lshrrev_b32 v30, 1, v28
  v_xor_b32 v30, v29, v30
  v_lshlrev_b32 v30, 4, v30
  v_lshl_add_u32 v2, v28, 7, v30
  s_mul_i32 s58, s56, 16384
  v_add_u32 v2, s58, v2
  v_xor_b32 v3, 64, v2
  v_bfe_u32 v30, v1, 2, 2
  v_lshl_add_u32 v31, v29, 3, v30
  v_mul_u32_u24 v31, 512, v31
  v_and_b32 v160, 3, v1
  v_lshl_add_u32 v31, v160, 3, v31
  v_add_u32 v31, 65536, v31
  v_and_b32 v160, 1, v29
  v_lshl_add_u32 v30, v160, 2, v30
  s_mul_i32 s58, s57, 8
  v_xor_b32 v160, s58, v30
  v_lshl_add_u32 v4, v160, 5, v31
  s_add_u32 s58, s58, 1
  v_xor_b32 v160, s58, v30
  v_lshl_add_u32 v5, v160, 5, v31
  s_add_u32 s58, s58, 1
  v_xor_b32 v160, s58, v30
  v_lshl_add_u32 v6, v160, 5, v31
  s_add_u32 s58, s58, 1
  v_xor_b32 v160, s58, v30
  v_lshl_add_u32 v7, v160, 5, v31
  s_add_u32 s58, s58, 1
  v_xor_b32 v160, s58, v30
  v_lshl_add_u32 v8, v160, 5, v31
  s_add_u32 s58, s58, 1
  v_xor_b32 v160, s58, v30
  v_lshl_add_u32 v9, v160, 5, v31
  s_add_u32 s58, s58, 1
  v_xor_b32 v160, s58, v30
  v_lshl_add_u32 v10, v160, 5, v31
  s_add_u32 s58, s58, 1
  v_xor_b32 v160, s58, v30
  v_lshl_add_u32 v11, v160, 5, v31
  s_add_u32 s58, s58, 1
  s_lshl_b32 s58, s57, 2
  v_or_b32 v30, s58, v29
  v_and_b32 v31, 7, v1
  v_xor_b32 v30, v30, v31
  v_lshrrev_b32 v31, 3, v1
  s_lshl_b32 s58, s14, 3
  v_add_u32 v31, s58, v31
  v_mul_u32_u24 v31, 2048, v31
  v_lshl_add_u32 v12, v30, 4, v31
  v_add_u32 v13, 65536, v12
  v_add_u32 v14, 131072, v12
  v_add_u32 v15, 196608, v12
  v_add_u32 v16, 262144, v12
  v_add_u32 v17, 327680, v12
  v_add_u32 v18, 393216, v12
  v_add_u32 v19, 458752, v12
  s_mov_b32 s22, 524288
  s_mul_i32 s58, s14, 2
  v_lshrrev_b32 v30, 5, v1
  v_add_u32 v30, s58, v30
  v_and_b32 v31, 31, v1
  v_add_u32 v160, 0, v30
  v_bfe_u32 v161, v160, 3, 1
  v_and_b32 v162, 3, v160
  v_lshl_add_u32 v161, v161, 2, v162
  v_lshlrev_b32 v161, 1, v161
  v_xor_b32 v161, v161, v31
  v_mul_u32_u24 v160, 8192, v160
  v_lshl_add_u32 v20, v161, 4, v160
  v_add_u32 v160, 8, v30
  v_bfe_u32 v161, v160, 3, 1
  v_and_b32 v162, 3, v160
  v_lshl_add_u32 v161, v161, 2, v162
  v_lshlrev_b32 v161, 1, v161
  v_xor_b32 v161, v161, v31
  v_mul_u32_u24 v160, 8192, v160
  v_lshl_add_u32 v21, v161, 4, v160
  v_add_u32 v160, 16, v30
  v_bfe_u32 v161, v160, 3, 1
  v_and_b32 v162, 3, v160
  v_lshl_add_u32 v161, v161, 2, v162
  v_lshlrev_b32 v161, 1, v161
  v_xor_b32 v161, v161, v31
  v_mul_u32_u24 v160, 8192, v160
  v_lshl_add_u32 v22, v161, 4, v160
  v_add_u32 v160, 24, v30
  v_bfe_u32 v161, v160, 3, 1
  v_and_b32 v162, 3, v160
  v_lshl_add_u32 v161, v161, 2, v162
  v_lshlrev_b32 v161, 1, v161
  v_xor_b32 v161, v161, v31
  v_mul_u32_u24 v160, 8192, v160
  v_lshl_add_u32 v23, v161, 4, v160
  v_add_u32 v160, 32, v30
  v_bfe_u32 v161, v160, 3, 1
  v_and_b32 v162, 3, v160
  v_lshl_add_u32 v161, v161, 2, v162
  v_lshlrev_b32 v161, 1, v161
  v_xor_b32 v161, v161, v31
  v_mul_u32_u24 v160, 8192, v160
  v_lshl_add_u32 v24, v161, 4, v160
  v_add_u32 v160, 40, v30
  v_bfe_u32 v161, v160, 3, 1
  v_and_b32 v162, 3, v160
  v_lshl_add_u32 v161, v161, 2, v162
  v_lshlrev_b32 v161, 1, v161
  v_xor_b32 v161, v161, v31
  v_mul_u32_u24 v160, 8192, v160
  v_lshl_add_u32 v25, v161, 4, v160
  v_add_u32 v160, 48, v30
  v_bfe_u32 v161, v160, 3, 1
  v_and_b32 v162, 3, v160
  v_lshl_add_u32 v161, v161, 2, v162
  v_lshlrev_b32 v161, 1, v161
  v_xor_b32 v161, v161, v31
  v_mul_u32_u24 v160, 8192, v160
  v_lshl_add_u32 v26, v161, 4, v160
  v_add_u32 v160, 56, v30
  v_bfe_u32 v161, v160, 3, 1
  v_and_b32 v162, 3, v160
  v_lshl_add_u32 v161, v161, 2, v162
  v_lshlrev_b32 v161, 1, v161
  v_xor_b32 v161, v161, v31
  v_mul_u32_u24 v160, 8192, v160
  v_lshl_add_u32 v27, v161, 4, v160
  s_waitcnt vmcnt(0) lgkmcnt(0)
  s_barrier
  s_branch epi_0
pro_2:
  s_cmp_lg_u32 s28, 3
  s_cbranch_scc1 pro_3
  s_cmp_lg_u32 s14, 0
  s_cbranch_scc1 we_171
  s_lshl_b32 s58, 0, 2
  v_mov_b32 v161, s58
wt_170:
  s_sub_u32 s23, s23, 1
  s_cbranch_scc1 rec_exit
  buffer_load_dword v160, v161, s[40:43], 0 offen offset:96 sc1
  s_waitcnt vmcnt(0)
  v_cmp_gt_u32 vcc, 128, v160
  s_cbranch_vccz wt_170_ok
  s_sleep 8
  s_branch wt_170
wt_170_ok:
we_171:
  s_barrier
  s_mov_b32 s44, s4
  s_mov_b32 s45, s5
  s_mov_b32 s46, 268435456
  s_mov_b32 s47, 0x00020000
  s_load_dwordx2 s[48:49], s[0:1], 64
  s_mov_b32 s50, 7340032
  s_mov_b32 s51, 0x00020000
  s_lshl_b32 s37, s29, 4
  s_add_u32 s37, s37, s61
  s_mul_i32 s36, s37, 4682
  s_lshr_b32 s36, s36, 16
  s_mul_i32 s58, s36, 14
  s_sub_u32 s37, s37, s58
  s_lshl_b32 s37, s37, 9
  s_lshl_b32 s52, s36, 19
  s_add_u32 s52, s52, 83886080
  s_mov_b32 s53, s37
  s_lshr_b32 s56, s14, 1
  s_and_b32 s57, s14, 1
  s_lshl_b32 s55, s14, 10
  v_and_b32 v28, 15, v1
  v_lshrrev_b32 v29, 4, v1
  v_lshrrev_b32 v30, 1, v28
  v_xor_b32 v30, v29, v30
  v_lshlrev_b32 v30, 4, v30
  v_lshl_add_u32 v2, v28, 7, v30
  s_mul_i32 s58, s56, 16384
  v_add_u32 v2, s58, v2
  v_xor_b32 v3, 64, v2
  v_bfe_u32 v30, v1, 2, 2
  v_lshl_add_u32 v31, v29, 3, v30
  v_mul_u32_u24 v31, 512, v31
  v_and_b32 v160, 3, v1
  v_lshl_add_u32 v31, v160, 3, v31
  v_add_u32 v31, 65536, v31
  v_and_b32 v160, 1, v29
  v_lshl_add_u32 v30, v160, 2, v30
  s_mul_i32 s58, s57, 8
  v_xor_b32 v160, s58, v30
  v_lshl_add_u32 v4, v160, 5, v31
  s_add_u32 s58, s58, 1
  v_xor_b32 v160, s58, v30
  v_lshl_add_u32 v5, v160, 5, v31
  s_add_u32 s58, s58, 1
  v_xor_b32 v160, s58, v30
  v_lshl_add_u32 v6, v160, 5, v31
  s_add_u32 s58, s58, 1
  v_xor_b32 v160, s58, v30
  v_lshl_add_u32 v7, v160, 5, v31
  s_add_u32 s58, s58, 1
  v_xor_b32 v160, s58, v30
  v_lshl_add_u32 v8, v160, 5, v31
  s_add_u32 s58, s58, 1
  v_xor_b32 v160, s58, v30
  v_lshl_add_u32 v9, v160, 5, v31
  s_add_u32 s58, s58, 1
  v_xor_b32 v160, s58, v30
  v_lshl_add_u32 v10, v160, 5, v31
  s_add_u32 s58, s58, 1
  v_xor_b32 v160, s58, v30
  v_lshl_add_u32 v11, v160, 5, v31
  s_add_u32 s58, s58, 1
  s_lshl_b32 s58, s57, 2
  v_or_b32 v30, s58, v29
  v_and_b32 v31, 7, v1
  v_xor_b32 v30, v30, v31
  v_lshrrev_b32 v31, 3, v1
  s_lshl_b32 s58, s14, 3
  v_add_u32 v31, s58, v31
  v_mul_u32_u24 v31, 2048, v31
  v_lshl_add_u32 v12, v30, 4, v31
  v_add_u32 v13, 65536, v12
  v_add_u32 v14, 131072, v12
  v_add_u32 v15, 196608, v12
  v_add_u32 v16, 262144, v12
  v_add_u32 v17, 327680, v12
  v_add_u32 v18, 393216, v12
  v_add_u32 v19, 458752, v12
  s_mov_b32 s22, 458752
  s_mul_i32 s58, s14, 2
  v_lshrrev_b32 v30, 5, v1
  v_add_u32 v30, s58, v30
  v_and_b32 v31, 31, v1
  v_add_u32 v160, 0, v30
  v_bfe_u32 v161, v160, 3, 1
  v_and_b32 v162, 3, v160
  v_lshl_add_u32 v161, v161, 2, v162
  v_lshlrev_b32 v161, 1, v161
  v_xor_b32 v161, v161, v31
  v_mul_u32_u24 v160, 7168, v160
  v_lshl_add_u32 v20, v161, 4, v160
  v_add_u32 v160, 8, v30
  v_bfe_u32 v161, v160, 3, 1
  v_and_b32 v162, 3, v160
  v_lshl_add_u32 v161, v161, 2, v162
  v_lshlrev_b32 v161, 1, v161
  v_xor_b32 v161, v161, v31
  v_mul_u32_u24 v160, 7168, v160
  v_lshl_add_u32 v21, v161, 4, v160
  v_add_u32 v160, 16, v30
  v_bfe_u32 v161, v160, 3, 1
  v_and_b32 v162, 3, v160
  v_lshl_add_u32 v161, v161, 2, v162
  v_lshlrev_b32 v161, 1, v161
  v_xor_b32 v161, v161, v31
  v_mul_u32_u24 v160, 7168, v160
  v_lshl_add_u32 v22, v161, 4, v160
  v_add_u32 v160, 24, v30
  v_bfe_u32 v161, v160, 3, 1
  v_and_b32 v162, 3, v160
  v_lshl_add_u32 v161, v161, 2, v162
  v_lshlrev_b32 v161, 1, v161
  v_xor_b32 v161, v161, v31
  v_mul_u32_u24 v160, 7168, v160
  v_lshl_add_u32 v23, v161, 4, v160
  v_add_u32 v160, 32, v30
  v_bfe_u32 v161, v160, 3, 1
  v_and_b32 v162, 3, v160
  v_lshl_add_u32 v161, v161, 2, v162
  v_lshlrev_b32 v161, 1, v161
  v_xor_b32 v161, v161, v31
  v_mul_u32_u24 v160, 7168, v160
  v_lshl_add_u32 v24, v161, 4, v160
  v_add_u32 v160, 40, v30
  v_bfe_u32 v161, v160, 3, 1
  v_and_b32 v162, 3, v160
  v_lshl_add_u32 v161, v161, 2, v162
  v_lshlrev_b32 v161, 1, v161
  v_xor_b32 v161, v161, v31
  v_mul_u32_u24 v160, 7168, v160
  v_lshl_add_u32 v25, v161, 4, v160
  v_add_u32 v160, 48, v30
  v_bfe_u32 v161, v160, 3, 1
  v_and_b32 v162, 3, v160
  v_lshl_add_u32 v161, v161, 2, v162
  v_lshlrev_b32 v161, 1, v161
  v_xor_b32 v161, v161, v31
  v_mul_u32_u24 v160, 7168, v160
  v_lshl_add_u32 v26, v161, 4, v160
  v_add_u32 v160, 56, v30
  v_bfe_u32 v161, v160, 3, 1
  v_and_b32 v162, 3, v160
  v_lshl_add_u32 v161, v161, 2, v162
  v_lshlrev_b32 v161, 1, v161
  v_xor_b32 v161, v161, v31
  v_mul_u32_u24 v160, 7168, v160
  v_lshl_add_u32 v27, v161, 4, v160
  s_waitcnt vmcnt(0) lgkmcnt(0)
  s_barrier
  s_load_dwordx2 s[8:9], s[0:1], 72
  s_mov_b32 s10, 7168
  s_mov_b32 s11, 0x00020000
  s_mul_i32 s58, s57, 256
  s_add_u32 s58, s58, s37
  v_lshlrev_b32 v160, 3, v29
  s_waitcnt lgkmcnt(0)
  buffer_load_dwordx2 v[176:177], v160, s[8:11], s58 offen offset:0
  buffer_load_dwordx2 v[178:179], v160, s[8:11], s58 offen offset:32
  buffer_load_dwordx2 v[180:181], v160, s[8:11], s58 offen offset:64
  buffer_load_dwordx2 v[182:183], v160, s[8:11], s58 offen offset:96
  buffer_load_dwordx2 v[184:185], v160, s[8:11], s58 offen offset:128
  buffer_load_dwordx2 v[186:187], v160, s[8:11], s58 offen offset:160
  buffer_load_dwordx2 v[188:189], v160, s[8:11], s58 offen offset:192
  buffer_load_dwordx2 v[190:191], v160, s[8:11], s58 offen offset:224
  s_branch epi_0
pro_3:
  s_cmp_lg_u32 s28, 4
  s_cbranch_scc1 pro_4
  s_load_dwordx2 s[44:45], s[0:1], 0
  s_mov_b32 s46, 4194304
  s_mov_b32 s47, 0x00020000
  s_load_dwordx2 s[48:49], s[0:1], 16
  s_mov_b32 s50, 8388608
  s_mov_b32 s51, 0x00020000
  s_lshl_b32 s52, s29, 19
  s_lshl_b32 s53, s61, 9
  s_lshr_b32 s56, s14, 1
  s_and_b32 s57, s14, 1
  s_lshl_b32 s55, s14, 10
  v_and_b32 v28, 15, v1
  v_lshrrev_b32 v29, 4, v1
  v_lshrrev_b32 v30, 1, v28
  v_xor_b32 v30, v29, v30
  v_lshlrev_b32 v30, 4, v30
  v_lshl_add_u32 v2, v28, 7, v30
  s_mul_i32 s58, s56, 16384
  v_add_u32 v2, s58, v2
  v_xor_b32 v3, 64, v2
  v_bfe_u32 v30, v1, 2, 2
  v_lshl_add_u32 v31, v29, 3, v30
  v_mul_u32_u24 v31, 512, v31
  v_and_b32 v160, 3, v1
  v_lshl_add_u32 v31, v160, 3, v31
  v_add_u32 v31, 65536, v31
  v_and_b32 v160, 1, v29
  v_lshl_add_u32 v30, v160, 2, v30
  s_mul_i32 s58, s57, 8
  v_xor_b32 v160, s58, v30
  v_lshl_add_u32 v4, v160, 5, v31
  s_add_u32 s58, s58, 1
  v_xor_b32 v160, s58, v30
  v_lshl_add_u32 v5, v160, 5, v31
  s_add_u32 s58, s58, 1
  v_xor_b32 v160, s58, v30
  v_lshl_add_u32 v6, v160, 5, v31
  s_add_u32 s58, s58, 1
  v_xor_b32 v160, s58, v30
  v_lshl_add_u32 v7, v160, 5, v31
  s_add_u32 s58, s58, 1
  v_xor_b32 v160, s58, v30
  v_lshl_add_u32 v8, v160, 5, v31
  s_add_u32 s58, s58, 1
  v_xor_b32 v160, s58, v30
  v_lshl_add_u32 v9, v160, 5, v31
  s_add_u32 s58, s58, 1
  v_xor_b32 v160, s58, v30
  v_lshl_add_u32 v10, v160, 5, v31
  s_add_u32 s58, s58, 1
  v_xor_b32 v160, s58, v30
  v_lshl_add_u32 v11, v160, 5, v31
  s_add_u32 s58, s58, 1
  s_lshl_b32 s58, s57, 2
  v_or_b32 v30, s58, v29
  v_and_b32 v31, 7, v1
  v_xor_b32 v30, v30, v31
  v_lshrrev_b32 v31, 3, v1
  s_lshl_b32 s58, s14, 3
  v_add_u32 v31, s58, v31
  v_mul_u32_u24 v31, 2048, v31
  v_lshl_add_u32 v12, v30, 4, v31
  v_add_u32 v13, 131072, v12
  v_add_u32 v14, 262144, v12
  v_add_u32 v15, 393216, v12
  v_add_u32 v16, 65536, v12
  v_add_u32 v17, 196608, v12
  v_add_u32 v18, 327680, v12
  v_add_u32 v19, 458752, v12
  s_mov_b32 s22, 524288
  s_mul_i32 s58, s14, 2
  v_lshrrev_b32 v30, 5, v1
  v_add_u32 v30, s58, v30
  v_and_b32 v31, 31, v1
  v_add_u32 v160, 0, v30
  v_bfe_u32 v161, v160, 3, 1
  v_and_b32 v162, 3, v160
  v_lshl_add_u32 v161, v161, 2, v162
  v_lshlrev_b32 v161, 1, v161
  v_xor_b32 v161, v161, v31
  v_mul_u32_u24 v160, 8192, v160
  v_lshl_add_u32 v20, v161, 4, v160
  v_add_u32 v160, 8, v30
  v_bfe_u32 v161, v160, 3, 1
  v_and_b32 v162, 3, v160
  v_lshl_add_u32 v161, v161, 2, v162
  v_lshlrev_b32 v161, 1, v161
  v_xor_b32 v161, v161, v31
  v_mul_u32_u24 v160, 8192, v160
  v_lshl_add_u32 v21, v161, 4, v160
  v_add_u32 v160, 16, v30
  v_bfe_u32 v161, v160, 3, 1
  v_and_b32 v162, 3, v160
  v_lshl_add_u32 v161, v161, 2, v162
  v_lshlrev_b32 v161, 1, v161
  v_xor_b32 v161, v161, v31
  v_mul_u32_u24 v160, 8192, v160
  v_lshl_add_u32 v22, v161, 4, v160
  v_add_u32 v160, 24, v30
  v_bfe_u32 v161, v160, 3, 1
  v_and_b32 v162, 3, v160
  v_lshl_add_u32 v161, v161, 2, v162
  v_lshlrev_b32 v161, 1, v161
  v_xor_b32 v161, v161, v31
  v_mul_u32_u24 v160, 8192, v160
  v_lshl_add_u32 v23, v161, 4, v160
  v_add_u32 v160, 32, v30
  v_bfe_u32 v161, v160, 3, 1
  v_and_b32 v162, 3, v160
  v_lshl_add_u32 v161, v161, 2, v162
  v_lshlrev_b32 v161, 1, v161
  v_xor_b32 v161, v161, v31
  v_mul_u32_u24 v160, 8192, v160
  v_lshl_add_u32 v24, v161, 4, v160
  v_add_u32 v160, 40, v30
  v_bfe_u32 v161, v160, 3, 1
  v_and_b32 v162, 3, v160
  v_lshl_add_u32 v161, v161, 2, v162
  v_lshlrev_b32 v161, 1, v161
  v_xor_b32 v161, v161, v31
  v_mul_u32_u24 v160, 8192, v160
  v_lshl_add_u32 v25, v161, 4, v160
  v_add_u32 v160, 48, v30
  v_bfe_u32 v161, v160, 3, 1
  v_and_b32 v162, 3, v160
  v_lshl_add_u32 v161, v161, 2, v162
  v_lshlrev_b32 v161, 1, v161
  v_xor_b32 v161, v161, v31
  v_mul_u32_u24 v160, 8192, v160
  v_lshl_add_u32 v26, v161, 4, v160
  v_add_u32 v160, 56, v30
  v_bfe_u32 v161, v160, 3, 1
  v_and_b32 v162, 3, v160
  v_lshl_add_u32 v161, v161, 2, v162
  v_lshlrev_b32 v161, 1, v161
  v_xor_b32 v161, v161, v31
  v_mul_u32_u24 v160, 8192, v160
  v_lshl_add_u32 v27, v161, 4, v160
  s_waitcnt vmcnt(0) lgkmcnt(0)
  s_barrier
  s_branch epi_0
pro_4:
epi_0:
  s_cmp_lg_u32 s26, 0
  s_cbranch_scc1 epi_1
  s_add_u32 m0, s55, 0
  s_nop 0
  buffer_load_dwordx4 v12, s[44:47], s52 offen  lds
  s_add_u32 m0, s55, 65536
  s_nop 0
  buffer_load_dwordx4 v20, s[48:51], s53 offen lds
  s_add_u32 m0, s55, 4096
  s_nop 0
  buffer_load_dwordx4 v13, s[44:47], s52 offen  lds
  s_add_u32 m0, s55, 69632
  s_nop 0
  buffer_load_dwordx4 v21, s[48:51], s53 offen lds
  s_add_u32 m0, s55, 8192
  s_nop 0
  buffer_load_dwordx4 v14, s[44:47], s52 offen  lds
  s_add_u32 m0, s55, 73728
  s_nop 0
  buffer_load_dwordx4 v22, s[48:51], s53 offen lds
  s_add_u32 m0, s55, 12288
  s_nop 0
  buffer_load_dwordx4 v15, s[44:47], s52 offen  lds
  s_add_u32 m0, s55, 77824
  s_nop 0
  buffer_load_dwordx4 v23, s[48:51], s53 offen lds
  s_add_u32 m0, s55, 16384
  s_nop 0
  buffer_load_dwordx4 v16, s[44:47], s52 offen  lds
  s_add_u32 m0, s55, 81920
  s_nop 0
  buffer_load_dwordx4 v24, s[48:51], s53 offen lds
  s_add_u32 m0, s55, 20480
  s_nop 0
  buffer_load_dwordx4 v17, s[44:47], s52 offen  lds
  s_add_u32 m0, s55, 86016
  s_nop 0
  buffer_load_dwordx4 v25, s[48:51], s53 offen lds
  s_add_u32 m0, s55, 24576
  s_nop 0
  buffer_load_dwordx4 v18, s[44:47], s52 offen  lds
  s_add_u32 m0, s55, 90112
  s_nop 0
  buffer_load_dwordx4 v26, s[48:51], s53 offen lds
  s_add_u32 m0, s55, 28672
  s_nop 0
  buffer_load_dwordx4 v19, s[44:47], s52 offen  lds
  s_add_u32 m0, s55, 94208
  s_nop 0
  buffer_load_dwordx4 v27, s[48:51], s53 offen lds
  s_add_u32 s52, s52, 128
  s_add_u32 s53, s53, s22
  s_add_u32 m0, s55, 32768
  s_nop 0
  buffer_load_dwordx4 v12, s[44:47], s52 offen  lds
  s_add_u32 m0, s55, 98304
  s_nop 0
  buffer_load_dwordx4 v20, s[48:51], s53 offen lds
  s_add_u32 m0, s55, 36864
  s_nop 0
  buffer_load_dwordx4 v13, s[44:47], s52 offen  lds
  s_add_u32 m0, s55, 102400
  s_nop 0
  buffer_load_dwordx4 v21, s[48:51], s53 offen lds
  s_add_u32 m0, s55, 40960
  s_nop 0
  buffer_load_dwordx4 v14, s[44:47], s52 offen  lds
  s_add_u32 m0, s55, 106496
  s_nop 0
  buffer_load_dwordx4 v22, s[48:51], s53 offen lds
  s_add_u32 m0, s55, 45056
  s_nop 0
  buffer_load_dwordx4 v15, s[44:47], s52 offen  lds
  s_add_u32 m0, s55, 110592
  s_nop 0
  buffer_load_dwordx4 v23, s[48:51], s53 offen lds
  s_add_u32 m0, s55, 49152
  s_nop 0
  buffer_load_dwordx4 v16, s[44:47], s52 offen  lds
  s_add_u32 m0, s55, 114688
  s_nop 0
  buffer_load_dwordx4 v24, s[48:51], s53 offen lds
  s_add_u32 m0, s55, 53248
  s_nop 0
  buffer_load_dwordx4 v17, s[44:47], s52 offen  lds
  s_add_u32 m0, s55, 118784
  s_nop 0
  buffer_load_dwordx4 v25, s[48:51], s53 offen lds
  s_waitcnt vmcnt(12)
  s_branch run
epi_1:
  s_cmp_lg_u32 s26, 1
  s_cbranch_scc1 epi_2
  s_lshl_b32 s63, s27, 21
  s_lshl_b32 s58, s61, 13
  s_add_u32 s63, s63, s58
  s_add_u32 s63, s63, 0
  v_and_b32 v30, 1, v29
  v_lshlrev_b32 v30, 5, v30
  v_lshrrev_b32 v160, 1, v29
  v_lshl_add_u32 v30, v160, 4, v30
  s_mul_i32 s58, s56, 1048576
  s_mul_i32 s59, s57, 4096
  s_add_u32 s58, s58, s59
  v_add_u32 v30, v30, v28
  v_lshl_add_u32 v30, v30, 4, s58
  v_accvgpr_read_b32 v32, a0
  v_accvgpr_read_b32 v33, a1
  v_accvgpr_read_b32 v34, a2
  v_accvgpr_read_b32 v35, a3
  v_accvgpr_read_b32 v36, a4
  v_accvgpr_read_b32 v37, a5
  v_accvgpr_read_b32 v38, a6
  v_accvgpr_read_b32 v39, a7
  s_add_u32 m0, s55, 0
  s_nop 0
  buffer_load_dwordx4 v12, s[44:47], s52 offen  lds
  v_cvt_pk_bf16_f32 v64, v32, v33
  v_cvt_pk_bf16_f32 v65, v34, v35
  v_cvt_pk_bf16_f32 v66, v36, v37
  v_cvt_pk_bf16_f32 v67, v38, v39
  s_nop 0
  v_permlane16_swap_b32 v64, v66
  v_permlane16_swap_b32 v65, v67
  buffer_store_dwordx4 v[64:67], v30, s[4:7], s63 offen offset:0 sc1
  v_accvgpr_read_b32 v40, a8
  v_accvgpr_read_b32 v41, a9
  v_accvgpr_read_b32 v42, a10
  v_accvgpr_read_b32 v43, a11
  v_accvgpr_read_b32 v44, a12
  v_accvgpr_read_b32 v45, a13
  v_accvgpr_read_b32 v46, a14
  v_accvgpr_read_b32 v47, a15
  s_add_u32 m0, s55, 65536
  s_nop 0
  buffer_load_dwordx4 v20, s[48:51], s53 offen lds
  v_cvt_pk_bf16_f32 v68, v40, v41
  v_cvt_pk_bf16_f32 v69, v42, v43
  v_cvt_pk_bf16_f32 v70, v44, v45
  v_cvt_pk_bf16_f32 v71, v46, v47
  s_nop 0
  v_permlane16_swap_b32 v68, v70
  v_permlane16_swap_b32 v69, v71
  buffer_store_dwordx4 v[68:71], v30, s[4:7], s63 offen offset:1024 sc1
  v_accvgpr_read_b32 v32, a16
  v_accvgpr_read_b32 v33, a17
  v_accvgpr_read_b32 v34, a18
  v_accvgpr_read_b32 v35, a19
  v_accvgpr_read_b32 v36, a20
  v_accvgpr_read_b32 v37, a21
  v_accvgpr_read_b32 v38, a22
  v_accvgpr_read_b32 v39, a23
  s_add_u32 m0, s55, 4096
  s_nop 0
  buffer_load_dwordx4 v13, s[44:47], s52 offen  lds
  v_cvt_pk_bf16_f32 v72, v32, v33
  v_cvt_pk_bf16_f32 v73, v34, v35
  v_cvt_pk_bf16_f32 v74, v36, v37
  v_cvt_pk_bf16_f32 v75, v38, v39
  s_nop 0
  v_permlane16_swap_b32 v72, v74
  v_permlane16_swap_b32 v73, v75
  buffer_store_dwordx4 v[72:75], v30, s[4:7], s63 offen offset:2048 sc1
  v_accvgpr_read_b32 v40, a24
  v_accvgpr_read_b32 v41, a25
  v_accvgpr_read_b32 v42, a26
  v_accvgpr_read_b32 v43, a27
  v_accvgpr_read_b32 v44, a28
  v_accvgpr_read_b32 v45, a29
  v_accvgpr_read_b32 v46, a30
  v_accvgpr_read_b32 v47, a31
  s_add_u32 m0, s55, 69632
  s_nop 0
  buffer_load_dwordx4 v21, s[48:51], s53 offen lds
  v_cvt_pk_bf16_f32 v76, v40, v41
  v_cvt_pk_bf16_f32 v77, v42, v43
  v_cvt_pk_bf16_f32 v78, v44, v45
  v_cvt_pk_bf16_f32 v79, v46, v47
  s_nop 0
  v_permlane16_swap_b32 v76, v78
  v_permlane16_swap_b32 v77, v79
  buffer_store_dwordx4 v[76:79], v30, s[4:7], s63 offen offset:3072 sc1
  s_add_u32 s63, s63, 131072
  v_accvgpr_read_b32 v32, a32
  v_accvgpr_read_b32 v33, a33
  v_accvgpr_read_b32 v34, a34
  v_accvgpr_read_b32 v35, a35
  v_accvgpr_read_b32 v36, a36
  v_accvgpr_read_b32 v37, a37
  v_accvgpr_read_b32 v38, a38
  v_accvgpr_read_b32 v39, a39
  s_add_u32 m0, s55, 8192
  s_nop 0
  buffer_load_dwordx4 v14, s[44:47], s52 offen  lds
  v_cvt_pk_bf16_f32 v80, v32, v33
  v_cvt_pk_bf16_f32 v81, v34, v35
  v_cvt_pk_bf16_f32 v82, v36, v37
  v_cvt_pk_bf16_f32 v83, v38, v39
  s_nop 0
  v_permlane16_swap_b32 v80, v82
  v_permlane16_swap_b32 v81, v83
  buffer_store_dwordx4 v[80:83], v30, s[4:7], s63 offen offset:0 sc1
  v_accvgpr_read_b32 v40, a40
  v_accvgpr_read_b32 v41, a41
  v_accvgpr_read_b32 v42, a42
  v_accvgpr_read_b32 v43, a43
  v_accvgpr_read_b32 v44, a44
  v_accvgpr_read_b32 v45, a45
  v_accvgpr_read_b32 v46, a46
  v_accvgpr_read_b32 v47, a47
  s_add_u32 m0, s55, 73728
  s_nop 0
  buffer_load_dwordx4 v22, s[48:51], s53 offen lds
  v_cvt_pk_bf16_f32 v84, v40, v41
  v_cvt_pk_bf16_f32 v85, v42, v43
  v_cvt_pk_bf16_f32 v86, v44, v45
  v_cvt_pk_bf16_f32 v87, v46, v47
  s_nop 0
  v_permlane16_swap_b32 v84, v86
  v_permlane16_swap_b32 v85, v87
  buffer_store_dwordx4 v[84:87], v30, s[4:7], s63 offen offset:1024 sc1
  v_accvgpr_read_b32 v32, a48
  v_accvgpr_read_b32 v33, a49
  v_accvgpr_read_b32 v34, a50
  v_accvgpr_read_b32 v35, a51
  v_accvgpr_read_b32 v36, a52
  v_accvgpr_read_b32 v37, a53
  v_accvgpr_read_b32 v38, a54
  v_accvgpr_read_b32 v39, a55
  s_add_u32 m0, s55, 12288
  s_nop 0
  buffer_load_dwordx4 v15, s[44:47], s52 offen  lds
  v_cvt_pk_bf16_f32 v88, v32, v33
  v_cvt_pk_bf16_f32 v89, v34, v35
  v_cvt_pk_bf16_f32 v90, v36, v37
  v_cvt_pk_bf16_f32 v91, v38, v39
  s_nop 0
  v_permlane16_swap_b32 v88, v90
  v_permlane16_swap_b32 v89, v91
  buffer_store_dwordx4 v[88:91], v30, s[4:7], s63 offen offset:2048 sc1
  v_accvgpr_read_b32 v40, a56
  v_accvgpr_read_b32 v41, a57
  v_accvgpr_read_b32 v42, a58
  v_accvgpr_read_b32 v43, a59
  v_accvgpr_read_b32 v44, a60
  v_accvgpr_read_b32 v45, a61
  v_accvgpr_read_b32 v46, a62
  v_accvgpr_read_b32 v47, a63
  s_add_u32 m0, s55, 77824
  s_nop 0
  buffer_load_dwordx4 v23, s[48:51], s53 offen lds
  v_cvt_pk_bf16_f32 v92, v40, v41
  v_cvt_pk_bf16_f32 v93, v42, v43
  v_cvt_pk_bf16_f32 v94, v44, v45
  v_cvt_pk_bf16_f32 v95, v46, v47
  s_nop 0
  v_permlane16_swap_b32 v92, v94
  v_permlane16_swap_b32 v93, v95
  buffer_store_dwordx4 v[92:95], v30, s[4:7], s63 offen offset:3072 sc1
  s_add_u32 s63, s63, 131072
  v_accvgpr_read_b32 v32, a64
  v_accvgpr_read_b32 v33, a65
  v_accvgpr_read_b32 v34, a66
  v_accvgpr_read_b32 v35, a67
  v_accvgpr_read_b32 v36, a68
  v_accvgpr_read_b32 v37, a69
  v_accvgpr_read_b32 v38, a70
  v_accvgpr_read_b32 v39, a71
  s_add_u32 m0, s55, 16384
  s_nop 0
  buffer_load_dwordx4 v16, s[44:47], s52 offen  lds
  v_cvt_pk_bf16_f32 v64, v32, v33
  v_cvt_pk_bf16_f32 v65, v34, v35
  v_cvt_pk_bf16_f32 v66, v36, v37
  v_cvt_pk_bf16_f32 v67, v38, v39
  s_nop 0
  v_permlane16_swap_b32 v64, v66
  v_permlane16_swap_b32 v65, v67
  buffer_store_dwordx4 v[64:67], v30, s[4:7], s63 offen offset:0 sc1
  v_accvgpr_read_b32 v40, a72
  v_accvgpr_read_b32 v41, a73
  v_accvgpr_read_b32 v42, a74
  v_accvgpr_read_b32 v43, a75
  v_accvgpr_read_b32 v44, a76
  v_accvgpr_read_b32 v45, a77
  v_accvgpr_read_b32 v46, a78
  v_accvgpr_read_b32 v47, a79
  s_add_u32 m0, s55, 81920
  s_nop 0
  buffer_load_dwordx4 v24, s[48:51], s53 offen lds
  v_cvt_pk_bf16_f32 v68, v40, v41
  v_cvt_pk_bf16_f32 v69, v42, v43
  v_cvt_pk_bf16_f32 v70, v44, v45
  v_cvt_pk_bf16_f32 v71, v46, v47
  s_nop 0
  v_permlane16_swap_b32 v68, v70
  v_permlane16_swap_b32 v69, v71
  buffer_store_dwordx4 v[68:71], v30, s[4:7], s63 offen offset:1024 sc1
  v_accvgpr_read_b32 v32, a80
  v_accvgpr_read_b32 v33, a81
  v_accvgpr_read_b32 v34, a82
  v_accvgpr_read_b32 v35, a83
  v_accvgpr_read_b32 v36, a84
  v_accvgpr_read_b32 v37, a85
  v_accvgpr_read_b32 v38, a86
  v_accvgpr_read_b32 v39, a87
  s_add_u32 m0, s55, 20480
  s_nop 0
  buffer_load_dwordx4 v17, s[44:47], s52 offen  lds
  v_cvt_pk_bf16_f32 v72, v32, v33
  v_cvt_pk_bf16_f32 v73, v34, v35
  v_cvt_pk_bf16_f32 v74, v36, v37
  v_cvt_pk_bf16_f32 v75, v38, v39
  s_nop 0
  v_permlane16_swap_b32 v72, v74
  v_permlane16_swap_b32 v73, v75
  buffer_store_dwordx4 v[72:75], v30, s[4:7], s63 offen offset:2048 sc1
  v_accvgpr_read_b32 v40, a88
  v_accvgpr_read_b32 v41, a89
  v_accvgpr_read_b32 v42, a90
  v_accvgpr_read_b32 v43, a91
  v_accvgpr_read_b32 v44, a92
  v_accvgpr_read_b32 v45, a93
  v_accvgpr_read_b32 v46, a94
  v_accvgpr_read_b32 v47, a95
  s_add_u32 m0, s55, 86016
  s_nop 0
  buffer_load_dwordx4 v25, s[48:51], s53 offen lds
  v_cvt_pk_bf16_f32 v76, v40, v41
  v_cvt_pk_bf16_f32 v77, v42, v43
  v_cvt_pk_bf16_f32 v78, v44, v45
  v_cvt_pk_bf16_f32 v79, v46, v47
  s_nop 0
  v_permlane16_swap_b32 v76, v78
  v_permlane16_swap_b32 v77, v79
  buffer_store_dwordx4 v[76:79], v30, s[4:7], s63 offen offset:3072 sc1
  s_add_u32 s63, s63, 131072
  v_accvgpr_read_b32 v32, a96
  v_accvgpr_read_b32 v33, a97
  v_accvgpr_read_b32 v34, a98
  v_accvgpr_read_b32 v35, a99
  v_accvgpr_read_b32 v36, a100
  v_accvgpr_read_b32 v37, a101
  v_accvgpr_read_b32 v38, a102
  v_accvgpr_read_b32 v39, a103
  s_add_u32 m0, s55, 24576
  s_nop 0
  buffer_load_dwordx4 v18, s[44:47], s52 offen  lds
  v_cvt_pk_bf16_f32 v80, v32, v33
  v_cvt_pk_bf16_f32 v81, v34, v35
  v_cvt_pk_bf16_f32 v82, v36, v37
  v_cvt_pk_bf16_f32 v83, v38, v39
  s_nop 0
  v_permlane16_swap_b32 v80, v82
  v_permlane16_swap_b32 v81, v83
  buffer_store_dwordx4 v[80:83], v30, s[4:7], s63 offen offset:0 sc1
  v_accvgpr_read_b32 v40, a104
  v_accvgpr_read_b32 v41, a105
  v_accvgpr_read_b32 v42, a106
  v_accvgpr_read_b32 v43, a107
  v_accvgpr_read_b32 v44, a108
  v_accvgpr_read_b32 v45, a109
  v_accvgpr_read_b32 v46, a110
  v_accvgpr_read_b32 v47, a111
  s_add_u32 m0, s55, 90112
  s_nop 0
  buffer_load_dwordx4 v26, s[48:51], s53 offen lds
  v_cvt_pk_bf16_f32 v84, v40, v41
  v_cvt_pk_bf16_f32 v85, v42, v43
  v_cvt_pk_bf16_f32 v86, v44, v45
  v_cvt_pk_bf16_f32 v87, v46, v47
  s_nop 0
  v_permlane16_swap_b32 v84, v86
  v_permlane16_swap_b32 v85, v87
  buffer_store_dwordx4 v[84:87], v30, s[4:7], s63 offen offset:1024 sc1
  v_accvgpr_read_b32 v32, a112
  v_accvgpr_read_b32 v33, a113
  v_accvgpr_read_b32 v34, a114
  v_accvgpr_read_b32 v35, a115
  v_accvgpr_read_b32 v36, a116
  v_accvgpr_read_b32 v37, a117
  v_accvgpr_read_b32 v38, a118
  v_accvgpr_read_b32 v39, a119
  s_add_u32 m0, s55, 28672
  s_nop 0
  buffer_load_dwordx4 v19, s[44:47], s52 offen  lds
  v_cvt_pk_bf16_f32 v88, v32, v33
  v_cvt_pk_bf16_f32 v89, v34, v35
  v_cvt_pk_bf16_f32 v90, v36, v37
  v_cvt_pk_bf16_f32 v91, v38, v39
  s_nop 0
  v_permlane16_swap_b32 v88, v90
  v_permlane16_swap_b32 v89, v91
  buffer_store_dwordx4 v[88:91], v30, s[4:7], s63 offen offset:2048 sc1
  v_accvgpr_read_b32 v40, a120
  v_accvgpr_read_b32 v41, a121
  v_accvgpr_read_b32 v42, a122
  v_accvgpr_read_b32 v43, a123
  v_accvgpr_read_b32 v44, a124
  v_accvgpr_read_b32 v45, a125
  v_accvgpr_read_b32 v46, a126
  v_accvgpr_read_b32 v47, a127
  s_add_u32 m0, s55, 94208
  s_nop 0
  buffer_load_dwordx4 v27, s[48:51], s53 offen lds
  s_add_u32 s52, s52, 128
  s_add_u32 s53, s53, s22
  v_cvt_pk_bf16_f32 v92, v40, v41
  v_cvt_pk_bf16_f32 v93, v42, v43
  v_cvt_pk_bf16_f32 v94, v44, v45
  v_cvt_pk_bf16_f32 v95, v46, v47
  s_nop 0
  v_permlane16_swap_b32 v92, v94
  v_permlane16_swap_b32 v93, v95
  buffer_store_dwordx4 v[92:95], v30, s[4:7], s63 offen offset:3072 sc1
  s_add_u32 s63, s63, 131072
  v_accvgpr_read_b32 v32, a128
  v_accvgpr_read_b32 v33, a129
  v_accvgpr_read_b32 v34, a130
  v_accvgpr_read_b32 v35, a131
  v_accvgpr_read_b32 v36, a132
  v_accvgpr_read_b32 v37, a133
  v_accvgpr_read_b32 v38, a134
  v_accvgpr_read_b32 v39, a135
  s_add_u32 m0, s55, 32768
  s_nop 0
  buffer_load_dwordx4 v12, s[44:47], s52 offen  lds
  v_cvt_pk_bf16_f32 v64, v32, v33
  v_cvt_pk_bf16_f32 v65, v34, v35
  v_cvt_pk_bf16_f32 v66, v36, v37
  v_cvt_pk_bf16_f32 v67, v38, v39
  s_nop 0
  v_permlane16_swap_b32 v64, v66
  v_permlane16_swap_b32 v65, v67
  buffer_store_dwordx4 v[64:67], v30, s[4:7], s63 offen offset:0 sc1
  v_accvgpr_read_b32 v40, a136
  v_accvgpr_read_b32 v41, a137
  v_accvgpr_read_b32 v42, a138
  v_accvgpr_read_b32 v43, a139
  v_accvgpr_read_b32 v44, a140
  v_accvgpr_read_b32 v45, a141
  v_accvgpr_read_b32 v46, a142
  v_accvgpr_read_b32 v47, a143
  s_add_u32 m0, s55, 98304
  s_nop 0
  buffer_load_dwordx4 v20, s[48:51], s53 offen lds
  v_cvt_pk_bf16_f32 v68, v40, v41
  v_cvt_pk_bf16_f32 v69, v42, v43
  v_cvt_pk_bf16_f32 v70, v44, v45
  v_cvt_pk_bf16_f32 v71, v46, v47
  s_nop 0
  v_permlane16_swap_b32 v68, v70
  v_permlane16_swap_b32 v69, v71
  buffer_store_dwordx4 v[68:71], v30, s[4:7], s63 offen offset:1024 sc1
  v_accvgpr_read_b32 v32, a144
  v_accvgpr_read_b32 v33, a145
  v_accvgpr_read_b32 v34, a146
  v_accvgpr_read_b32 v35, a147
  v_accvgpr_read_b32 v36, a148
  v_accvgpr_read_b32 v37, a149
  v_accvgpr_read_b32 v38, a150
  v_accvgpr_read_b32 v39, a151
  s_add_u32 m0, s55, 36864
  s_nop 0
  buffer_load_dwordx4 v13, s[44:47], s52 offen  lds
  v_cvt_pk_bf16_f32 v72, v32, v33
  v_cvt_pk_bf16_f32 v73, v34, v35
  v_cvt_pk_bf16_f32 v74, v36, v37
  v_cvt_pk_bf16_f32 v75, v38, v39
  s_nop 0
  v_permlane16_swap_b32 v72, v74
  v_permlane16_swap_b32 v73, v75
  buffer_store_dwordx4 v[72:75], v30, s[4:7], s63 offen offset:2048 sc1
  v_accvgpr_read_b32 v40, a152
  v_accvgpr_read_b32 v41, a153
  v_accvgpr_read_b32 v42, a154
  v_accvgpr_read_b32 v43, a155
  v_accvgpr_read_b32 v44, a156
  v_accvgpr_read_b32 v45, a157
  v_accvgpr_read_b32 v46, a158
  v_accvgpr_read_b32 v47, a159
  s_add_u32 m0, s55, 102400
  s_nop 0
  buffer_load_dwordx4 v21, s[48:51], s53 offen lds
  v_cvt_pk_bf16_f32 v76, v40, v41
  v_cvt_pk_bf16_f32 v77, v42, v43
  v_cvt_pk_bf16_f32 v78, v44, v45
  v_cvt_pk_bf16_f32 v79, v46, v47
  s_nop 0
  v_permlane16_swap_b32 v76, v78
  v_permlane16_swap_b32 v77, v79
  buffer_store_dwordx4 v[76:79], v30, s[4:7], s63 offen offset:3072 sc1
  s_add_u32 s63, s63, 131072
  v_accvgpr_read_b32 v32, a160
  v_accvgpr_read_b32 v33, a161
  v_accvgpr_read_b32 v34, a162
  v_accvgpr_read_b32 v35, a163
  v_accvgpr_read_b32 v36, a164
  v_accvgpr_read_b32 v37, a165
  v_accvgpr_read_b32 v38, a166
  v_accvgpr_read_b32 v39, a167
  s_add_u32 m0, s55, 40960
  s_nop 0
  buffer_load_dwordx4 v14, s[44:47], s52 offen  lds
  v_cvt_pk_bf16_f32 v80, v32, v33
  v_cvt_pk_bf16_f32 v81, v34, v35
  v_cvt_pk_bf16_f32 v82, v36, v37
  v_cvt_pk_bf16_f32 v83, v38, v39
  s_nop 0
  v_permlane16_swap_b32 v80, v82
  v_permlane16_swap_b32 v81, v83
  buffer_store_dwordx4 v[80:83], v30, s[4:7], s63 offen offset:0 sc1
  v_accvgpr_read_b32 v40, a168
  v_accvgpr_read_b32 v41, a169
  v_accvgpr_read_b32 v42, a170
  v_accvgpr_read_b32 v43, a171
  v_accvgpr_read_b32 v44, a172
  v_accvgpr_read_b32 v45, a173
  v_accvgpr_read_b32 v46, a174
  v_accvgpr_read_b32 v47, a175
  s_add_u32 m0, s55, 106496
  s_nop 0
  buffer_load_dwordx4 v22, s[48:51], s53 offen lds
  v_cvt_pk_bf16_f32 v84, v40, v41
  v_cvt_pk_bf16_f32 v85, v42, v43
  v_cvt_pk_bf16_f32 v86, v44, v45
  v_cvt_pk_bf16_f32 v87, v46, v47
  s_nop 0
  v_permlane16_swap_b32 v84, v86
  v_permlane16_swap_b32 v85, v87
  buffer_store_dwordx4 v[84:87], v30, s[4:7], s63 offen offset:1024 sc1
  v_accvgpr_read_b32 v32, a176
  v_accvgpr_read_b32 v33, a177
  v_accvgpr_read_b32 v34, a178
  v_accvgpr_read_b32 v35, a179
  v_accvgpr_read_b32 v36, a180
  v_accvgpr_read_b32 v37, a181
  v_accvgpr_read_b32 v38, a182
  v_accvgpr_read_b32 v39, a183
  s_add_u32 m0, s55, 45056
  s_nop 0
  buffer_load_dwordx4 v15, s[44:47], s52 offen  lds
  v_cvt_pk_bf16_f32 v88, v32, v33
  v_cvt_pk_bf16_f32 v89, v34, v35
  v_cvt_pk_bf16_f32 v90, v36, v37
  v_cvt_pk_bf16_f32 v91, v38, v39
  s_nop 0
  v_permlane16_swap_b32 v88, v90
  v_permlane16_swap_b32 v89, v91
  buffer_store_dwordx4 v[88:91], v30, s[4:7], s63 offen offset:2048 sc1
  v_accvgpr_read_b32 v40, a184
  v_accvgpr_read_b32 v41, a185
  v_accvgpr_read_b32 v42, a186
  v_accvgpr_read_b32 v43, a187
  v_accvgpr_read_b32 v44, a188
  v_accvgpr_read_b32 v45, a189
  v_accvgpr_read_b32 v46, a190
  v_accvgpr_read_b32 v47, a191
  s_add_u32 m0, s55, 110592
  s_nop 0
  buffer_load_dwordx4 v23, s[48:51], s53 offen lds
  v_cvt_pk_bf16_f32 v92, v40, v41
  v_cvt_pk_bf16_f32 v93, v42, v43
  v_cvt_pk_bf16_f32 v94, v44, v45
  v_cvt_pk_bf16_f32 v95, v46, v47
  s_nop 0
  v_permlane16_swap_b32 v92, v94
  v_permlane16_swap_b32 v93, v95
  buffer_store_dwordx4 v[92:95], v30, s[4:7], s63 offen offset:3072 sc1
  s_add_u32 s63, s63, 131072
  v_accvgpr_read_b32 v32, a192
  v_accvgpr_read_b32 v33, a193
  v_accvgpr_read_b32 v34, a194
  v_accvgpr_read_b32 v35, a195
  v_accvgpr_read_b32 v36, a196
  v_accvgpr_read_b32 v37, a197
  v_accvgpr_read_b32 v38, a198
  v_accvgpr_read_b32 v39, a199
  s_add_u32 m0, s55, 49152
  s_nop 0
  buffer_load_dwordx4 v16, s[44:47], s52 offen  lds
  v_cvt_pk_bf16_f32 v64, v32, v33
  v_cvt_pk_bf16_f32 v65, v34, v35
  v_cvt_pk_bf16_f32 v66, v36, v37
  v_cvt_pk_bf16_f32 v67, v38, v39
  s_nop 0
  v_permlane16_swap_b32 v64, v66
  v_permlane16_swap_b32 v65, v67
  buffer_store_dwordx4 v[64:67], v30, s[4:7], s63 offen offset:0 sc1
  v_accvgpr_read_b32 v40, a200
  v_accvgpr_read_b32 v41, a201
  v_accvgpr_read_b32 v42, a202
  v_accvgpr_read_b32 v43, a203
  v_accvgpr_read_b32 v44, a204
  v_accvgpr_read_b32 v45, a205
  v_accvgpr_read_b32 v46, a206
  v_accvgpr_read_b32 v47, a207
  s_add_u32 m0, s55, 114688
  s_nop 0
  buffer_load_dwordx4 v24, s[48:51], s53 offen lds
  v_cvt_pk_bf16_f32 v68, v40, v41
  v_cvt_pk_bf16_f32 v69, v42, v43
  v_cvt_pk_bf16_f32 v70, v44, v45
  v_cvt_pk_bf16_f32 v71, v46, v47
  s_nop 0
  v_permlane16_swap_b32 v68, v70
  v_permlane16_swap_b32 v69, v71
  buffer_store_dwordx4 v[68:71], v30, s[4:7], s63 offen offset:1024 sc1
  v_accvgpr_read_b32 v32, a208
  v_accvgpr_read_b32 v33, a209
  v_accvgpr_read_b32 v34, a210
  v_accvgpr_read_b32 v35, a211
  v_accvgpr_read_b32 v36, a212
  v_accvgpr_read_b32 v37, a213
  v_accvgpr_read_b32 v38, a214
  v_accvgpr_read_b32 v39, a215
  s_add_u32 m0, s55, 53248
  s_nop 0
  buffer_load_dwordx4 v17, s[44:47], s52 offen  lds
  v_cvt_pk_bf16_f32 v72, v32, v33
  v_cvt_pk_bf16_f32 v73, v34, v35
  v_cvt_pk_bf16_f32 v74, v36, v37
  v_cvt_pk_bf16_f32 v75, v38, v39
  s_nop 0
  v_permlane16_swap_b32 v72, v74
  v_permlane16_swap_b32 v73, v75
  buffer_store_dwordx4 v[72:75], v30, s[4:7], s63 offen offset:2048 sc1
  v_accvgpr_read_b32 v40, a216
  v_accvgpr_read_b32 v41, a217
  v_accvgpr_read_b32 v42, a218
  v_accvgpr_read_b32 v43, a219
  v_accvgpr_read_b32 v44, a220
  v_accvgpr_read_b32 v45, a221
  v_accvgpr_read_b32 v46, a222
  v_accvgpr_read_b32 v47, a223
  s_add_u32 m0, s55, 118784
  s_nop 0
  buffer_load_dwordx4 v25, s[48:51], s53 offen lds
  v_cvt_pk_bf16_f32 v76, v40, v41
  v_cvt_pk_bf16_f32 v77, v42, v43
  v_cvt_pk_bf16_f32 v78, v44, v45
  v_cvt_pk_bf16_f32 v79, v46, v47
  s_nop 0
  v_permlane16_swap_b32 v76, v78
  v_permlane16_swap_b32 v77, v79
  buffer_store_dwordx4 v[76:79], v30, s[4:7], s63 offen offset:3072 sc1
  s_add_u32 s63, s63, 131072
  v_accvgpr_read_b32 v32, a224
  v_accvgpr_read_b32 v33, a225
  v_accvgpr_read_b32 v34, a226
  v_accvgpr_read_b32 v35, a227
  v_accvgpr_read_b32 v36, a228
  v_accvgpr_read_b32 v37, a229
  v_accvgpr_read_b32 v38, a230
  v_accvgpr_read_b32 v39, a231
  v_cvt_pk_bf16_f32 v80, v32, v33
  v_cvt_pk_bf16_f32 v81, v34, v35
  v_cvt_pk_bf16_f32 v82, v36, v37
  v_cvt_pk_bf16_f32 v83, v38, v39
  s_nop 0
  v_permlane16_swap_b32 v80, v82
  v_permlane16_swap_b32 v81, v83
  buffer_store_dwordx4 v[80:83], v30, s[4:7], s63 offen offset:0 sc1
  v_accvgpr_read_b32 v40, a232
  v_accvgpr_read_b32 v41, a233
  v_accvgpr_read_b32 v42, a234
  v_accvgpr_read_b32 v43, a235
  v_accvgpr_read_b32 v44, a236
  v_accvgpr_read_b32 v45, a237
  v_accvgpr_read_b32 v46, a238
  v_accvgpr_read_b32 v47, a239
  v_cvt_pk_bf16_f32 v84, v40, v41
  v_cvt_pk_bf16_f32 v85, v42, v43
  v_cvt_pk_bf16_f32 v86, v44, v45
  v_cvt_pk_bf16_f32 v87, v46, v47
  s_nop 0
  v_permlane16_swap_b32 v84, v86
  v_permlane16_swap_b32 v85, v87
  buffer_store_dwordx4 v[84:87], v30, s[4:7], s63 offen offset:1024 sc1
  v_accvgpr_read_b32 v32, a240
  v_accvgpr_read_b32 v33, a241
  v_accvgpr_read_b32 v34, a242
  v_accvgpr_read_b32 v35, a243
  v_accvgpr_read_b32 v36, a244
  v_accvgpr_read_b32 v37, a245
  v_accvgpr_read_b32 v38, a246
  v_accvgpr_read_b32 v39, a247
  v_cvt_pk_bf16_f32 v88, v32, v33
  v_cvt_pk_bf16_f32 v89, v34, v35
  v_cvt_pk_bf16_f32 v90, v36, v37
  v_cvt_pk_bf16_f32 v91, v38, v39
  s_nop 0
  v_permlane16_swap_b32 v88, v90
  v_permlane16_swap_b32 v89, v91
  buffer_store_dwordx4 v[88:91], v30, s[4:7], s63 offen offset:2048 sc1
  v_accvgpr_read_b32 v40, a248
  v_accvgpr_read_b32 v41, a249
  v_accvgpr_read_b32 v42, a250
  v_accvgpr_read_b32 v43, a251
  v_accvgpr_read_b32 v44, a252
  v_accvgpr_read_b32 v45, a253
  v_accvgpr_read_b32 v46, a254
  v_accvgpr_read_b32 v47, a255
  v_cvt_pk_bf16_f32 v92, v40, v41
  v_cvt_pk_bf16_f32 v93, v42, v43
  v_cvt_pk_bf16_f32 v94, v44, v45
  v_cvt_pk_bf16_f32 v95, v46, v47
  s_nop 0
  v_permlane16_swap_b32 v92, v94
  v_permlane16_swap_b32 v93, v95
  buffer_store_dwordx4 v[92:95], v30, s[4:7], s63 offen offset:3072 sc1
  s_add_u32 s63, s63, 131072
  s_lshl_b32 s38, s27, 2
  s_add_u32 s38, s38, 64
  s_mov_b32 s39, 4
  s_waitcnt vmcnt(29)
  s_branch run
epi_2:
  s_cmp_lg_u32 s26, 2
  s_cbranch_scc1 epi_3
  s_lshl_b32 s63, s27, 21
  s_lshl_b32 s58, s61, 14
  s_add_u32 s63, s63, s58
  s_add_u32 s63, s63, 16777216
  v_and_b32 v30, 1, v29
  v_lshlrev_b32 v30, 5, v30
  v_lshrrev_b32 v160, 1, v29
  v_lshl_add_u32 v30, v160, 4, v30
  s_mul_i32 s58, s56, 1048576
  s_mul_i32 s59, s57, 8192
  s_add_u32 s58, s58, s59
  v_add_u32 v30, v28, v30
  v_lshl_add_u32 v30, v30, 4, s58
  v_add_u32 v31, 4096, v30
  v_accvgpr_read_b32 v32, a0
  v_accvgpr_read_b32 v33, a1
  v_accvgpr_read_b32 v34, a2
  v_accvgpr_read_b32 v35, a3
  v_accvgpr_read_b32 v36, a32
  v_accvgpr_read_b32 v37, a33
  v_accvgpr_read_b32 v38, a34
  v_accvgpr_read_b32 v39, a35
  s_add_u32 m0, s55, 0
  s_nop 0
  buffer_load_dwordx4 v12, s[44:47], s52 offen  lds
  v_cvt_pk_bf16_f32 v64, v32, v33
  v_cvt_pk_bf16_f32 v65, v34, v35
  v_cvt_pk_bf16_f32 v66, v36, v37
  v_cvt_pk_bf16_f32 v67, v38, v39
  s_nop 0
  v_permlane16_swap_b32 v64, v66
  v_permlane16_swap_b32 v65, v67
  buffer_store_dwordx4 v[64:67], v30, s[4:7], s63 offen offset:0 sc1
  v_accvgpr_read_b32 v40, a4
  v_accvgpr_read_b32 v41, a5
  v_accvgpr_read_b32 v42, a6
  v_accvgpr_read_b32 v43, a7
  v_accvgpr_read_b32 v44, a36
  v_accvgpr_read_b32 v45, a37
  v_accvgpr_read_b32 v46, a38
  v_accvgpr_read_b32 v47, a39
  s_add_u32 m0, s55, 65536
  s_nop 0
  buffer_load_dwordx4 v20, s[48:51], s53 offen lds
  v_cvt_pk_bf16_f32 v68, v40, v41
  v_cvt_pk_bf16_f32 v69, v42, v43
  v_cvt_pk_bf16_f32 v70, v44, v45
  v_cvt_pk_bf16_f32 v71, v46, v47
  s_nop 0
  v_permlane16_swap_b32 v68, v70
  v_permlane16_swap_b32 v69, v71
  buffer_store_dwordx4 v[68:71], v30, s[4:7], s63 offen offset:1024 sc1
  v_accvgpr_read_b32 v32, a8
  v_accvgpr_read_b32 v33, a9
  v_accvgpr_read_b32 v34, a10
  v_accvgpr_read_b32 v35, a11
  v_accvgpr_read_b32 v36, a40
  v_accvgpr_read_b32 v37, a41
  v_accvgpr_read_b32 v38, a42
  v_accvgpr_read_b32 v39, a43
  s_add_u32 m0, s55, 4096
  s_nop 0
  buffer_load_dwordx4 v13, s[44:47], s52 offen  lds
  v_cvt_pk_bf16_f32 v72, v32, v33
  v_cvt_pk_bf16_f32 v73, v34, v35
  v_cvt_pk_bf16_f32 v74, v36, v37
  v_cvt_pk_bf16_f32 v75, v38, v39
  s_nop 0
  v_permlane16_swap_b32 v72, v74
  v_permlane16_swap_b32 v73, v75
  buffer_store_dwordx4 v[72:75], v30, s[4:7], s63 offen offset:2048 sc1
  v_accvgpr_read_b32 v40, a12
  v_accvgpr_read_b32 v41, a13
  v_accvgpr_read_b32 v42, a14
  v_accvgpr_read_b32 v43, a15
  v_accvgpr_read_b32 v44, a44
  v_accvgpr_read_b32 v45, a45
  v_accvgpr_read_b32 v46, a46
  v_accvgpr_read_b32 v47, a47
  s_add_u32 m0, s55, 69632
  s_nop 0
  buffer_load_dwordx4 v21, s[48:51], s53 offen lds
  v_cvt_pk_bf16_f32 v76, v40, v41
  v_cvt_pk_bf16_f32 v77, v42, v43
  v_cvt_pk_bf16_f32 v78, v44, v45
  v_cvt_pk_bf16_f32 v79, v46, v47
  s_nop 0
  v_permlane16_swap_b32 v76, v78
  v_permlane16_swap_b32 v77, v79
  buffer_store_dwordx4 v[76:79], v30, s[4:7], s63 offen offset:3072 sc1
  v_accvgpr_read_b32 v32, a16
  v_accvgpr_read_b32 v33, a17
  v_accvgpr_read_b32 v34, a18
  v_accvgpr_read_b32 v35, a19
  v_accvgpr_read_b32 v36, a48
  v_accvgpr_read_b32 v37, a49
  v_accvgpr_read_b32 v38, a50
  v_accvgpr_read_b32 v39, a51
  s_add_u32 m0, s55, 8192
  s_nop 0
  buffer_load_dwordx4 v14, s[44:47], s52 offen  lds
  v_cvt_pk_bf16_f32 v80, v32, v33
  v_cvt_pk_bf16_f32 v81, v34, v35
  v_cvt_pk_bf16_f32 v82, v36, v37
  v_cvt_pk_bf16_f32 v83, v38, v39
  s_nop 0
  v_permlane16_swap_b32 v80, v82
  v_permlane16_swap_b32 v81, v83
  buffer_store_dwordx4 v[80:83], v31, s[4:7], s63 offen offset:0 sc1
  v_accvgpr_read_b32 v40, a20
  v_accvgpr_read_b32 v41, a21
  v_accvgpr_read_b32 v42, a22
  v_accvgpr_read_b32 v43, a23
  v_accvgpr_read_b32 v44, a52
  v_accvgpr_read_b32 v45, a53
  v_accvgpr_read_b32 v46, a54
  v_accvgpr_read_b32 v47, a55
  s_add_u32 m0, s55, 73728
  s_nop 0
  buffer_load_dwordx4 v22, s[48:51], s53 offen lds
  v_cvt_pk_bf16_f32 v84, v40, v41
  v_cvt_pk_bf16_f32 v85, v42, v43
  v_cvt_pk_bf16_f32 v86, v44, v45
  v_cvt_pk_bf16_f32 v87, v46, v47
  s_nop 0
  v_permlane16_swap_b32 v84, v86
  v_permlane16_swap_b32 v85, v87
  buffer_store_dwordx4 v[84:87], v31, s[4:7], s63 offen offset:1024 sc1
  v_accvgpr_read_b32 v32, a24
  v_accvgpr_read_b32 v33, a25
  v_accvgpr_read_b32 v34, a26
  v_accvgpr_read_b32 v35, a27
  v_accvgpr_read_b32 v36, a56
  v_accvgpr_read_b32 v37, a57
  v_accvgpr_read_b32 v38, a58
  v_accvgpr_read_b32 v39, a59
  s_add_u32 m0, s55, 12288
  s_nop 0
  buffer_load_dwordx4 v15, s[44:47], s52 offen  lds
  v_cvt_pk_bf16_f32 v88, v32, v33
  v_cvt_pk_bf16_f32 v89, v34, v35
  v_cvt_pk_bf16_f32 v90, v36, v37
  v_cvt_pk_bf16_f32 v91, v38, v39
  s_nop 0
  v_permlane16_swap_b32 v88, v90
  v_permlane16_swap_b32 v89, v91
  buffer_store_dwordx4 v[88:91], v31, s[4:7], s63 offen offset:2048 sc1
  v_accvgpr_read_b32 v40, a28
  v_accvgpr_read_b32 v41, a29
  v_accvgpr_read_b32 v42, a30
  v_accvgpr_read_b32 v43, a31
  v_accvgpr_read_b32 v44, a60
  v_accvgpr_read_b32 v45, a61
  v_accvgpr_read_b32 v46, a62
  v_accvgpr_read_b32 v47, a63
  s_add_u32 m0, s55, 77824
  s_nop 0
  buffer_load_dwordx4 v23, s[48:51], s53 offen lds
  v_cvt_pk_bf16_f32 v92, v40, v41
  v_cvt_pk_bf16_f32 v93, v42, v43
  v_cvt_pk_bf16_f32 v94, v44, v45
  v_cvt_pk_bf16_f32 v95, v46, v47
  s_nop 0
  v_permlane16_swap_b32 v92, v94
  v_permlane16_swap_b32 v93, v95
  buffer_store_dwordx4 v[92:95], v31, s[4:7], s63 offen offset:3072 sc1
  s_add_u32 s63, s63, 262144
  v_accvgpr_read_b32 v32, a64
  v_accvgpr_read_b32 v33, a65
  v_accvgpr_read_b32 v34, a66
  v_accvgpr_read_b32 v35, a67
  v_accvgpr_read_b32 v36, a96
  v_accvgpr_read_b32 v37, a97
  v_accvgpr_read_b32 v38, a98
  v_accvgpr_read_b32 v39, a99
  s_add_u32 m0, s55, 16384
  s_nop 0
  buffer_load_dwordx4 v16, s[44:47], s52 offen  lds
  v_cvt_pk_bf16_f32 v64, v32, v33
  v_cvt_pk_bf16_f32 v65, v34, v35
  v_cvt_pk_bf16_f32 v66, v36, v37
  v_cvt_pk_bf16_f32 v67, v38, v39
  s_nop 0
  v_permlane16_swap_b32 v64, v66
  v_permlane16_swap_b32 v65, v67
  buffer_store_dwordx4 v[64:67], v30, s[4:7], s63 offen offset:0 sc1
  v_accvgpr_read_b32 v40, a68
  v_accvgpr_read_b32 v41, a69
  v_accvgpr_read_b32 v42, a70
  v_accvgpr_read_b32 v43, a71
  v_accvgpr_read_b32 v44, a100
  v_accvgpr_read_b32 v45, a101
  v_accvgpr_read_b32 v46, a102
  v_accvgpr_read_b32 v47, a103
  s_add_u32 m0, s55, 81920
  s_nop 0
  buffer_load_dwordx4 v24, s[48:51], s53 offen lds
  v_cvt_pk_bf16_f32 v68, v40, v41
  v_cvt_pk_bf16_f32 v69, v42, v43
  v_cvt_pk_bf16_f32 v70, v44, v45
  v_cvt_pk_bf16_f32 v71, v46, v47
  s_nop 0
  v_permlane16_swap_b32 v68, v70
  v_permlane16_swap_b32 v69, v71
  buffer_store_dwordx4 v[68:71], v30, s[4:7], s63 offen offset:1024 sc1
  v_accvgpr_read_b32 v32, a72
  v_accvgpr_read_b32 v33, a73
  v_accvgpr_read_b32 v34, a74
  v_accvgpr_read_b32 v35, a75
  v_accvgpr_read_b32 v36, a104
  v_accvgpr_read_b32 v37, a105
  v_accvgpr_read_b32 v38, a106
  v_accvgpr_read_b32 v39, a107
  s_add_u32 m0, s55, 20480
  s_nop 0
  buffer_load_dwordx4 v17, s[44:47], s52 offen  lds
  v_cvt_pk_bf16_f32 v72, v32, v33
  v_cvt_pk_bf16_f32 v73, v34, v35
  v_cvt_pk_bf16_f32 v74, v36, v37
  v_cvt_pk_bf16_f32 v75, v38, v39
  s_nop 0
  v_permlane16_swap_b32 v72, v74
  v_permlane16_swap_b32 v73, v75
  buffer_store_dwordx4 v[72:75], v30, s[4:7], s63 offen offset:2048 sc1
  v_accvgpr_read_b32 v40, a76
  v_accvgpr_read_b32 v41, a77
  v_accvgpr_read_b32 v42, a78
  v_accvgpr_read_b32 v43, a79
  v_accvgpr_read_b32 v44, a108
  v_accvgpr_read_b32 v45, a109
  v_accvgpr_read_b32 v46, a110
  v_accvgpr_read_b32 v47, a111
  s_add_u32 m0, s55, 86016
  s_nop 0
  buffer_load_dwordx4 v25, s[48:51], s53 offen lds
  v_cvt_pk_bf16_f32 v76, v40, v41
  v_cvt_pk_bf16_f32 v77, v42, v43
  v_cvt_pk_bf16_f32 v78, v44, v45
  v_cvt_pk_bf16_f32 v79, v46, v47
  s_nop 0
  v_permlane16_swap_b32 v76, v78
  v_permlane16_swap_b32 v77, v79
  buffer_store_dwordx4 v[76:79], v30, s[4:7], s63 offen offset:3072 sc1
  v_accvgpr_read_b32 v32, a80
  v_accvgpr_read_b32 v33, a81
  v_accvgpr_read_b32 v34, a82
  v_accvgpr_read_b32 v35, a83
  v_accvgpr_read_b32 v36, a112
  v_accvgpr_read_b32 v37, a113
  v_accvgpr_read_b32 v38, a114
  v_accvgpr_read_b32 v39, a115
  s_add_u32 m0, s55, 24576
  s_nop 0
  buffer_load_dwordx4 v18, s[44:47], s52 offen  lds
  v_cvt_pk_bf16_f32 v80, v32, v33
  v_cvt_pk_bf16_f32 v81, v34, v35
  v_cvt_pk_bf16_f32 v82, v36, v37
  v_cvt_pk_bf16_f32 v83, v38, v39
  s_nop 0
  v_permlane16_swap_b32 v80, v82
  v_permlane16_swap_b32 v81, v83
  buffer_store_dwordx4 v[80:83], v31, s[4:7], s63 offen offset:0 sc1
  v_accvgpr_read_b32 v40, a84
  v_accvgpr_read_b32 v41, a85
  v_accvgpr_read_b32 v42, a86
  v_accvgpr_read_b32 v43, a87
  v_accvgpr_read_b32 v44, a116
  v_accvgpr_read_b32 v45, a117
  v_accvgpr_read_b32 v46, a118
  v_accvgpr_read_b32 v47, a119
  s_add_u32 m0, s55, 90112
  s_nop 0
  buffer_load_dwordx4 v26, s[48:51], s53 offen lds
  v_cvt_pk_bf16_f32 v84, v40, v41
  v_cvt_pk_bf16_f32 v85, v42, v43
  v_cvt_pk_bf16_f32 v86, v44, v45
  v_cvt_pk_bf16_f32 v87, v46, v47
  s_nop 0
  v_permlane16_swap_b32 v84, v86
  v_permlane16_swap_b32 v85, v87
  buffer_store_dwordx4 v[84:87], v31, s[4:7], s63 offen offset:1024 sc1
  v_accvgpr_read_b32 v32, a88
  v_accvgpr_read_b32 v33, a89
  v_accvgpr_read_b32 v34, a90
  v_accvgpr_read_b32 v35, a91
  v_accvgpr_read_b32 v36, a120
  v_accvgpr_read_b32 v37, a121
  v_accvgpr_read_b32 v38, a122
  v_accvgpr_read_b32 v39, a123
  s_add_u32 m0, s55, 28672
  s_nop 0
  buffer_load_dwordx4 v19, s[44:47], s52 offen  lds
  v_cvt_pk_bf16_f32 v88, v32, v33
  v_cvt_pk_bf16_f32 v89, v34, v35
  v_cvt_pk_bf16_f32 v90, v36, v37
  v_cvt_pk_bf16_f32 v91, v38, v39
  s_nop 0
  v_permlane16_swap_b32 v88, v90
  v_permlane16_swap_b32 v89, v91
  buffer_store_dwordx4 v[88:91], v31, s[4:7], s63 offen offset:2048 sc1
  v_accvgpr_read_b32 v40, a92
  v_accvgpr_read_b32 v41, a93
  v_accvgpr_read_b32 v42, a94
  v_accvgpr_read_b32 v43, a95
  v_accvgpr_read_b32 v44, a124
  v_accvgpr_read_b32 v45, a125
  v_accvgpr_read_b32 v46, a126
  v_accvgpr_read_b32 v47, a127
  s_add_u32 m0, s55, 94208
  s_nop 0
  buffer_load_dwordx4 v27, s[48:51], s53 offen lds
  s_add_u32 s52, s52, 128
  s_add_u32 s53, s53, s22
  v_cvt_pk_bf16_f32 v92, v40, v41
  v_cvt_pk_bf16_f32 v93, v42, v43
  v_cvt_pk_bf16_f32 v94, v44, v45
  v_cvt_pk_bf16_f32 v95, v46, v47
  s_nop 0
  v_permlane16_swap_b32 v92, v94
  v_permlane16_swap_b32 v93, v95
  buffer_store_dwordx4 v[92:95], v31, s[4:7], s63 offen offset:3072 sc1
  s_add_u32 s63, s63, 262144
  v_accvgpr_read_b32 v32, a128
  v_accvgpr_read_b32 v33, a129
  v_accvgpr_read_b32 v34, a130
  v_accvgpr_read_b32 v35, a131
  v_accvgpr_read_b32 v36, a160
  v_accvgpr_read_b32 v37, a161
  v_accvgpr_read_b32 v38, a162
  v_accvgpr_read_b32 v39, a163
  s_add_u32 m0, s55, 32768
  s_nop 0
  buffer_load_dwordx4 v12, s[44:47], s52 offen  lds
  v_cvt_pk_bf16_f32 v64, v32, v33
  v_cvt_pk_bf16_f32 v65, v34, v35
  v_cvt_pk_bf16_f32 v66, v36, v37
  v_cvt_pk_bf16_f32 v67, v38, v39
  s_nop 0
  v_permlane16_swap_b32 v64, v66
  v_permlane16_swap_b32 v65, v67
  buffer_store_dwordx4 v[64:67], v30, s[4:7], s63 offen offset:0 sc1
  v_accvgpr_read_b32 v40, a132
  v_accvgpr_read_b32 v41, a133
  v_accvgpr_read_b32 v42, a134
  v_accvgpr_read_b32 v43, a135
  v_accvgpr_read_b32 v44, a164
  v_accvgpr_read_b32 v45, a165
  v_accvgpr_read_b32 v46, a166
  v_accvgpr_read_b32 v47, a167
  s_add_u32 m0, s55, 98304
  s_nop 0
  buffer_load_dwordx4 v20, s[48:51], s53 offen lds
  v_cvt_pk_bf16_f32 v68, v40, v41
  v_cvt_pk_bf16_f32 v69, v42, v43
  v_cvt_pk_bf16_f32 v70, v44, v45
  v_cvt_pk_bf16_f32 v71, v46, v47
  s_nop 0
  v_permlane16_swap_b32 v68, v70
  v_permlane16_swap_b32 v69, v71
  buffer_store_dwordx4 v[68:71], v30, s[4:7], s63 offen offset:1024 sc1
  v_accvgpr_read_b32 v32, a136
  v_accvgpr_read_b32 v33, a137
  v_accvgpr_read_b32 v34, a138
  v_accvgpr_read_b32 v35, a139
  v_accvgpr_read_b32 v36, a168
  v_accvgpr_read_b32 v37, a169
  v_accvgpr_read_b32 v38, a170
  v_accvgpr_read_b32 v39, a171
  s_add_u32 m0, s55, 36864
  s_nop 0
  buffer_load_dwordx4 v13, s[44:47], s52 offen  lds
  v_cvt_pk_bf16_f32 v72, v32, v33
  v_cvt_pk_bf16_f32 v73, v34, v35
  v_cvt_pk_bf16_f32 v74, v36, v37
  v_cvt_pk_bf16_f32 v75, v38, v39
  s_nop 0
  v_permlane16_swap_b32 v72, v74
  v_permlane16_swap_b32 v73, v75
  buffer_store_dwordx4 v[72:75], v30, s[4:7], s63 offen offset:2048 sc1
  v_accvgpr_read_b32 v40, a140
  v_accvgpr_read_b32 v41, a141
  v_accvgpr_read_b32 v42, a142
  v_accvgpr_read_b32 v43, a143
  v_accvgpr_read_b32 v44, a172
  v_accvgpr_read_b32 v45, a173
  v_accvgpr_read_b32 v46, a174
  v_accvgpr_read_b32 v47, a175
  s_add_u32 m0, s55, 102400
  s_nop 0
  buffer_load_dwordx4 v21, s[48:51], s53 offen lds
  v_cvt_pk_bf16_f32 v76, v40, v41
  v_cvt_pk_bf16_f32 v77, v42, v43
  v_cvt_pk_bf16_f32 v78, v44, v45
  v_cvt_pk_bf16_f32 v79, v46, v47
  s_nop 0
  v_permlane16_swap_b32 v76, v78
  v_permlane16_swap_b32 v77, v79
  buffer_store_dwordx4 v[76:79], v30, s[4:7], s63 offen offset:3072 sc1
  v_accvgpr_read_b32 v32, a144
  v_accvgpr_read_b32 v33, a145
  v_accvgpr_read_b32 v34, a146
  v_accvgpr_read_b32 v35, a147
  v_accvgpr_read_b32 v36, a176
  v_accvgpr_read_b32 v37, a177
  v_accvgpr_read_b32 v38, a178
  v_accvgpr_read_b32 v39, a179
  s_add_u32 m0, s55, 40960
  s_nop 0
  buffer_load_dwordx4 v14, s[44:47], s52 offen  lds
  v_cvt_pk_bf16_f32 v80, v32, v33
  v_cvt_pk_bf16_f32 v81, v34, v35
  v_cvt_pk_bf16_f32 v82, v36, v37
  v_cvt_pk_bf16_f32 v83, v38, v39
  s_nop 0
  v_permlane16_swap_b32 v80, v82
  v_permlane16_swap_b32 v81, v83
  buffer_store_dwordx4 v[80:83], v31, s[4:7], s63 offen offset:0 sc1
  v_accvgpr_read_b32 v40, a148
  v_accvgpr_read_b32 v41, a149
  v_accvgpr_read_b32 v42, a150
  v_accvgpr_read_b32 v43, a151
  v_accvgpr_read_b32 v44, a180
  v_accvgpr_read_b32 v45, a181
  v_accvgpr_read_b32 v46, a182
  v_accvgpr_read_b32 v47, a183
  s_add_u32 m0, s55, 106496
  s_nop 0
  buffer_load_dwordx4 v22, s[48:51], s53 offen lds
  v_cvt_pk_bf16_f32 v84, v40, v41
  v_cvt_pk_bf16_f32 v85, v42, v43
  v_cvt_pk_bf16_f32 v86, v44, v45
  v_cvt_pk_bf16_f32 v87, v46, v47
  s_nop 0
  v_permlane16_swap_b32 v84, v86
  v_permlane16_swap_b32 v85, v87
  buffer_store_dwordx4 v[84:87], v31, s[4:7], s63 offen offset:1024 sc1
  v_accvgpr_read_b32 v32, a152
  v_accvgpr_read_b32 v33, a153
  v_accvgpr_read_b32 v34, a154
  v_accvgpr_read_b32 v35, a155
  v_accvgpr_read_b32 v36, a184
  v_accvgpr_read_b32 v37, a185
  v_accvgpr_read_b32 v38, a186
  v_accvgpr_read_b32 v39, a187
  s_add_u32 m0, s55, 45056
  s_nop 0
  buffer_load_dwordx4 v15, s[44:47], s52 offen  lds
  v_cvt_pk_bf16_f32 v88, v32, v33
  v_cvt_pk_bf16_f32 v89, v34, v35
  v_cvt_pk_bf16_f32 v90, v36, v37
  v_cvt_pk_bf16_f32 v91, v38, v39
  s_nop 0
  v_permlane16_swap_b32 v88, v90
  v_permlane16_swap_b32 v89, v91
  buffer_store_dwordx4 v[88:91], v31, s[4:7], s63 offen offset:2048 sc1
  v_accvgpr_read_b32 v40, a156
  v_accvgpr_read_b32 v41, a157
  v_accvgpr_read_b32 v42, a158
  v_accvgpr_read_b32 v43, a159
  v_accvgpr_read_b32 v44, a188
  v_accvgpr_read_b32 v45, a189
  v_accvgpr_read_b32 v46, a190
  v_accvgpr_read_b32 v47, a191
  s_add_u32 m0, s55, 110592
  s_nop 0
  buffer_load_dwordx4 v23, s[48:51], s53 offen lds
  v_cvt_pk_bf16_f32 v92, v40, v41
  v_cvt_pk_bf16_f32 v93, v42, v43
  v_cvt_pk_bf16_f32 v94, v44, v45
  v_cvt_pk_bf16_f32 v95, v46, v47
  s_nop 0
  v_permlane16_swap_b32 v92, v94
  v_permlane16_swap_b32 v93, v95
  buffer_store_dwordx4 v[92:95], v31, s[4:7], s63 offen offset:3072 sc1
  s_add_u32 s63, s63, 262144
  v_accvgpr_read_b32 v32, a192
  v_accvgpr_read_b32 v33, a193
  v_accvgpr_read_b32 v34, a194
  v_accvgpr_read_b32 v35, a195
  v_accvgpr_read_b32 v36, a224
  v_accvgpr_read_b32 v37, a225
  v_accvgpr_read_b32 v38, a226
  v_accvgpr_read_b32 v39, a227
  s_add_u32 m0, s55, 49152
  s_nop 0
  buffer_load_dwordx4 v16, s[44:47], s52 offen  lds
  v_cvt_pk_bf16_f32 v64, v32, v33
  v_cvt_pk_bf16_f32 v65, v34, v35
  v_cvt_pk_bf16_f32 v66, v36, v37
  v_cvt_pk_bf16_f32 v67, v38, v39
  s_nop 0
  v_permlane16_swap_b32 v64, v66
  v_permlane16_swap_b32 v65, v67
  buffer_store_dwordx4 v[64:67], v30, s[4:7], s63 offen offset:0 sc1
  v_accvgpr_read_b32 v40, a196
  v_accvgpr_read_b32 v41, a197
  v_accvgpr_read_b32 v42, a198
  v_accvgpr_read_b32 v43, a199
  v_accvgpr_read_b32 v44, a228
  v_accvgpr_read_b32 v45, a229
  v_accvgpr_read_b32 v46, a230
  v_accvgpr_read_b32 v47, a231
  s_add_u32 m0, s55, 114688
  s_nop 0
  buffer_load_dwordx4 v24, s[48:51], s53 offen lds
  v_cvt_pk_bf16_f32 v68, v40, v41
  v_cvt_pk_bf16_f32 v69, v42, v43
  v_cvt_pk_bf16_f32 v70, v44, v45
  v_cvt_pk_bf16_f32 v71, v46, v47
  s_nop 0
  v_permlane16_swap_b32 v68, v70
  v_permlane16_swap_b32 v69, v71
  buffer_store_dwordx4 v[68:71], v30, s[4:7], s63 offen offset:1024 sc1
  v_accvgpr_read_b32 v32, a200
  v_accvgpr_read_b32 v33, a201
  v_accvgpr_read_b32 v34, a202
  v_accvgpr_read_b32 v35, a203
  v_accvgpr_read_b32 v36, a232
  v_accvgpr_read_b32 v37, a233
  v_accvgpr_read_b32 v38, a234
  v_accvgpr_read_b32 v39, a235
  s_add_u32 m0, s55, 53248
  s_nop 0
  buffer_load_dwordx4 v17, s[44:47], s52 offen  lds
  v_cvt_pk_bf16_f32 v72, v32, v33
  v_cvt_pk_bf16_f32 v73, v34, v35
  v_cvt_pk_bf16_f32 v74, v36, v37
  v_cvt_pk_bf16_f32 v75, v38, v39
  s_nop 0
  v_permlane16_swap_b32 v72, v74
  v_permlane16_swap_b32 v73, v75
  buffer_store_dwordx4 v[72:75], v30, s[4:7], s63 offen offset:2048 sc1
  v_accvgpr_read_b32 v40, a204
  v_accvgpr_read_b32 v41, a205
  v_accvgpr_read_b32 v42, a206
  v_accvgpr_read_b32 v43, a207
  v_accvgpr_read_b32 v44, a236
  v_accvgpr_read_b32 v45, a237
  v_accvgpr_read_b32 v46, a238
  v_accvgpr_read_b32 v47, a239
  s_add_u32 m0, s55, 118784
  s_nop 0
  buffer_load_dwordx4 v25, s[48:51], s53 offen lds
  v_cvt_pk_bf16_f32 v76, v40, v41
  v_cvt_pk_bf16_f32 v77, v42, v43
  v_cvt_pk_bf16_f32 v78, v44, v45
  v_cvt_pk_bf16_f32 v79, v46, v47
  s_nop 0
  v_permlane16_swap_b32 v76, v78
  v_permlane16_swap_b32 v77, v79
  buffer_store_dwordx4 v[76:79], v30, s[4:7], s63 offen offset:3072 sc1
  v_accvgpr_read_b32 v32, a208
  v_accvgpr_read_b32 v33, a209
  v_accvgpr_read_b32 v34, a210
  v_accvgpr_read_b32 v35, a211
  v_accvgpr_read_b32 v36, a240
  v_accvgpr_read_b32 v37, a241
  v_accvgpr_read_b32 v38, a242
  v_accvgpr_read_b32 v39, a243
  v_cvt_pk_bf16_f32 v80, v32, v33
  v_cvt_pk_bf16_f32 v81, v34, v35
  v_cvt_pk_bf16_f32 v82, v36, v37
  v_cvt_pk_bf16_f32 v83, v38, v39
  s_nop 0
  v_permlane16_swap_b32 v80, v82
  v_permlane16_swap_b32 v81, v83
  buffer_store_dwordx4 v[80:83], v31, s[4:7], s63 offen offset:0 sc1
  v_accvgpr_read_b32 v40, a212
  v_accvgpr_read_b32 v41, a213
  v_accvgpr_read_b32 v42, a214
  v_accvgpr_read_b32 v43, a215
  v_accvgpr_read_b32 v44, a244
  v_accvgpr_read_b32 v45, a245
  v_accvgpr_read_b32 v46, a246
  v_accvgpr_read_b32 v47, a247
  v_cvt_pk_bf16_f32 v84, v40, v41
  v_cvt_pk_bf16_f32 v85, v42, v43
  v_cvt_pk_bf16_f32 v86, v44, v45
  v_cvt_pk_bf16_f32 v87, v46, v47
  s_nop 0
  v_permlane16_swap_b32 v84, v86
  v_permlane16_swap_b32 v85, v87
  buffer_store_dwordx4 v[84:87], v31, s[4:7], s63 offen offset:1024 sc1
  v_accvgpr_read_b32 v32, a216
  v_accvgpr_read_b32 v33, a217
  v_accvgpr_read_b32 v34, a218
  v_accvgpr_read_b32 v35, a219
  v_accvgpr_read_b32 v36, a248
  v_accvgpr_read_b32 v37, a249
  v_accvgpr_read_b32 v38, a250
  v_accvgpr_read_b32 v39, a251
  v_cvt_pk_bf16_f32 v88, v32, v33
  v_cvt_pk_bf16_f32 v89, v34, v35
  v_cvt_pk_bf16_f32 v90, v36, v37
  v_cvt_pk_bf16_f32 v91, v38, v39
  s_nop 0
  v_permlane16_swap_b32 v88, v90
  v_permlane16_swap_b32 v89, v91
  buffer_store_dwordx4 v[88:91], v31, s[4:7], s63 offen offset:2048 sc1
  v_accvgpr_read_b32 v40, a220
  v_accvgpr_read_b32 v41, a221
  v_accvgpr_read_b32 v42, a222
  v_accvgpr_read_b32 v43, a223
  v_accvgpr_read_b32 v44, a252
  v_accvgpr_read_b32 v45, a253
  v_accvgpr_read_b32 v46, a254
  v_accvgpr_read_b32 v47, a255
  v_cvt_pk_bf16_f32 v92, v40, v41
  v_cvt_pk_bf16_f32 v93, v42, v43
  v_cvt_pk_bf16_f32 v94, v44, v45
  v_cvt_pk_bf16_f32 v95, v46, v47
  s_nop 0
  v_permlane16_swap_b32 v92, v94
  v_permlane16_swap_b32 v93, v95
  buffer_store_dwordx4 v[92:95], v31, s[4:7], s63 offen offset:3072 sc1
  s_add_u32 s63, s63, 262144
  s_lshl_b32 s38, s27, 2
  s_add_u32 s38, s38, 64
  s_mov_b32 s39, 4
  s_waitcnt vmcnt(29)
  s_branch run
epi_3:
  s_cmp_lg_u32 s26, 3
  s_cbranch_scc1 epi_4
  s_lshl_b32 s37, s27, 4
  s_add_u32 s37, s37, s61
  s_mul_i32 s36, s37, 4682
  s_lshr_b32 s36, s36, 16
  s_mul_i32 s58, s36, 14
  s_sub_u32 s37, s37, s58
  s_lshl_b32 s37, s37, 9
  v_mov_b32 v224, 0xbdd2d3e8
  v_mov_b32 v225, 0xbdd2d3e8
  v_mov_b32 v226, 0xc0135761
  v_mov_b32 v227, 0xc0135761
  v_mov_b32 v228, 0x3f800000
  v_mov_b32 v229, 0x3f800000
  s_mul_i32 s63, s36, 1835008
  s_lshl_b32 s37, s37, 4
  s_add_u32 s63, s63, s37
  s_add_u32 s63, s63, 67108864
  v_and_b32 v30, 1, v29
  v_lshlrev_b32 v30, 5, v30
  v_lshrrev_b32 v160, 1, v29
  v_lshl_add_u32 v30, v160, 4, v30
  s_mul_i32 s58, s56, 917504
  s_mul_i32 s59, s57, 4096
  s_add_u32 s58, s58, s59
  v_add_u32 v30, v30, v28
  v_lshl_add_u32 v30, v30, 4, s58
  v_accvgpr_read_b32 v32, a0
  v_accvgpr_read_b32 v33, a1
  v_accvgpr_read_b32 v34, a2
  v_accvgpr_read_b32 v35, a3
  v_accvgpr_read_b32 v36, a4
  v_accvgpr_read_b32 v37, a5
  v_accvgpr_read_b32 v38, a6
  v_accvgpr_read_b32 v39, a7
  s_add_u32 m0, s55, 0
  s_nop 0
  buffer_load_dwordx4 v12, s[44:47], s52 offen  lds
  v_pk_mul_f32 v[48:49], v[32:33], v[32:33]
  v_pk_mul_f32 v[50:51], v[34:35], v[34:35]
  v_pk_mul_f32 v[52:53], v[36:37], v[36:37]
  v_pk_mul_f32 v[54:55], v[38:39], v[38:39]
  v_pk_fma_f32 v[48:49], v[48:49], v[224:225], v[226:227]
  v_pk_fma_f32 v[50:51], v[50:51], v[224:225], v[226:227]
  v_pk_fma_f32 v[52:53], v[52:53], v[224:225], v[226:227]
  v_pk_fma_f32 v[54:55], v[54:55], v[224:225], v[226:227]
  v_pk_mul_f32 v[48:49], v[48:49], v[32:33]
  v_pk_mul_f32 v[50:51], v[50:51], v[34:35]
  v_pk_mul_f32 v[52:53], v[52:53], v[36:37]
  v_pk_mul_f32 v[54:55], v[54:55], v[38:39]
  v_exp_f32 v48, v48
  v_exp_f32 v49, v49
  v_exp_f32 v50, v50
  v_exp_f32 v51, v51
  v_exp_f32 v52, v52
  v_exp_f32 v53, v53
  v_exp_f32 v54, v54
  v_exp_f32 v55, v55
  v_pk_add_f32 v[48:49], v[48:49], v[228:229]
  v_pk_add_f32 v[50:51], v[50:51], v[228:229]
  v_pk_add_f32 v[52:53], v[52:53], v[228:229]
  v_pk_add_f32 v[54:55], v[54:55], v[228:229]
  v_rcp_f32 v48, v48
  v_rcp_f32 v49, v49
  v_rcp_f32 v50, v50
  v_rcp_f32 v51, v51
  v_rcp_f32 v52, v52
  v_rcp_f32 v53, v53
  v_rcp_f32 v54, v54
  v_rcp_f32 v55, v55
  v_pk_mul_f32 v[32:33], v[32:33], v[48:49]
  v_pk_mul_f32 v[34:35], v[34:35], v[50:51]
  v_pk_mul_f32 v[36:37], v[36:37], v[52:53]
  v_pk_mul_f32 v[38:39], v[38:39], v[54:55]
  v_cvt_pk_bf16_f32 v64, v32, v33
  v_cvt_pk_bf16_f32 v65, v34, v35
  v_cvt_pk_bf16_f32 v66, v36, v37
  v_cvt_pk_bf16_f32 v67, v38, v39
  s_nop 0
  v_permlane16_swap_b32 v64, v66
  v_permlane16_swap_b32 v65, v67
  buffer_store_dwordx4 v[64:67], v30, s[4:7], s63 offen offset:0 sc1
  v_accvgpr_read_b32 v40, a8
  v_accvgpr_read_b32 v41, a9
  v_accvgpr_read_b32 v42, a10
  v_accvgpr_read_b32 v43, a11
  v_accvgpr_read_b32 v44, a12
  v_accvgpr_read_b32 v45, a13
  v_accvgpr_read_b32 v46, a14
  v_accvgpr_read_b32 v47, a15
  s_add_u32 m0, s55, 65536
  s_nop 0
  buffer_load_dwordx4 v20, s[48:51], s53 offen lds
  v_pk_mul_f32 v[56:57], v[40:41], v[40:41]
  v_pk_mul_f32 v[58:59], v[42:43], v[42:43]
  v_pk_mul_f32 v[60:61], v[44:45], v[44:45]
  v_pk_mul_f32 v[62:63], v[46:47], v[46:47]
  v_pk_fma_f32 v[56:57], v[56:57], v[224:225], v[226:227]
  v_pk_fma_f32 v[58:59], v[58:59], v[224:225], v[226:227]
  v_pk_fma_f32 v[60:61], v[60:61], v[224:225], v[226:227]
  v_pk_fma_f32 v[62:63], v[62:63], v[224:225], v[226:227]
  v_pk_mul_f32 v[56:57], v[56:57], v[40:41]
  v_pk_mul_f32 v[58:59], v[58:59], v[42:43]
  v_pk_mul_f32 v[60:61], v[60:61], v[44:45]
  v_pk_mul_f32 v[62:63], v[62:63], v[46:47]
  v_exp_f32 v56, v56
  v_exp_f32 v57, v57
  v_exp_f32 v58, v58
  v_exp_f32 v59, v59
  v_exp_f32 v60, v60
  v_exp_f32 v61, v61
  v_exp_f32 v62, v62
  v_exp_f32 v63, v63
  v_pk_add_f32 v[56:57], v[56:57], v[228:229]
  v_pk_add_f32 v[58:59], v[58:59], v[228:229]
  v_pk_add_f32 v[60:61], v[60:61], v[228:229]
  v_pk_add_f32 v[62:63], v[62:63], v[228:229]
  v_rcp_f32 v56, v56
  v_rcp_f32 v57, v57
  v_rcp_f32 v58, v58
  v_rcp_f32 v59, v59
  v_rcp_f32 v60, v60
  v_rcp_f32 v61, v61
  v_rcp_f32 v62, v62
  v_rcp_f32 v63, v63
  v_pk_mul_f32 v[40:41], v[40:41], v[56:57]
  v_pk_mul_f32 v[42:43], v[42:43], v[58:59]
  v_pk_mul_f32 v[44:45], v[44:45], v[60:61]
  v_pk_mul_f32 v[46:47], v[46:47], v[62:63]
  v_cvt_pk_bf16_f32 v68, v40, v41
  v_cvt_pk_bf16_f32 v69, v42, v43
  v_cvt_pk_bf16_f32 v70, v44, v45
  v_cvt_pk_bf16_f32 v71, v46, v47
  s_nop 0
  v_permlane16_swap_b32 v68, v70
  v_permlane16_swap_b32 v69, v71
  buffer_store_dwordx4 v[68:71], v30, s[4:7], s63 offen offset:1024 sc1
  v_accvgpr_read_b32 v32, a16
  v_accvgpr_read_b32 v33, a17
  v_accvgpr_read_b32 v34, a18
  v_accvgpr_read_b32 v35, a19
  v_accvgpr_read_b32 v36, a20
  v_accvgpr_read_b32 v37, a21
  v_accvgpr_read_b32 v38, a22
  v_accvgpr_read_b32 v39, a23
  s_add_u32 m0, s55, 4096
  s_nop 0
  buffer_load_dwordx4 v13, s[44:47], s52 offen  lds
  v_pk_mul_f32 v[48:49], v[32:33], v[32:33]
  v_pk_mul_f32 v[50:51], v[34:35], v[34:35]
  v_pk_mul_f32 v[52:53], v[36:37], v[36:37]
  v_pk_mul_f32 v[54:55], v[38:39], v[38:39]
  v_pk_fma_f32 v[48:49], v[48:49], v[224:225], v[226:227]
  v_pk_fma_f32 v[50:51], v[50:51], v[224:225], v[226:227]
  v_pk_fma_f32 v[52:53], v[52:53], v[224:225], v[226:227]
  v_pk_fma_f32 v[54:55], v[54:55], v[224:225], v[226:227]
  v_pk_mul_f32 v[48:49], v[48:49], v[32:33]
  v_pk_mul_f32 v[50:51], v[50:51], v[34:35]
  v_pk_mul_f32 v[52:53], v[52:53], v[36:37]
  v_pk_mul_f32 v[54:55], v[54:55], v[38:39]
  v_exp_f32 v48, v48
  v_exp_f32 v49, v49
  v_exp_f32 v50, v50
  v_exp_f32 v51, v51
  v_exp_f32 v52, v52
  v_exp_f32 v53, v53
  v_exp_f32 v54, v54
  v_exp_f32 v55, v55
  v_pk_add_f32 v[48:49], v[48:49], v[228:229]
  v_pk_add_f32 v[50:51], v[50:51], v[228:229]
  v_pk_add_f32 v[52:53], v[52:53], v[228:229]
  v_pk_add_f32 v[54:55], v[54:55], v[228:229]
  v_rcp_f32 v48, v48
  v_rcp_f32 v49, v49
  v_rcp_f32 v50, v50
  v_rcp_f32 v51, v51
  v_rcp_f32 v52, v52
  v_rcp_f32 v53, v53
  v_rcp_f32 v54, v54
  v_rcp_f32 v55, v55
  v_pk_mul_f32 v[32:33], v[32:33], v[48:49]
  v_pk_mul_f32 v[34:35], v[34:35], v[50:51]
  v_pk_mul_f32 v[36:37], v[36:37], v[52:53]
  v_pk_mul_f32 v[38:39], v[38:39], v[54:55]
  v_cvt_pk_bf16_f32 v72, v32, v33
  v_cvt_pk_bf16_f32 v73, v34, v35
  v_cvt_pk_bf16_f32 v74, v36, v37
  v_cvt_pk_bf16_f32 v75, v38, v39
  s_nop 0
  v_permlane16_swap_b32 v72, v74
  v_permlane16_swap_b32 v73, v75
  buffer_store_dwordx4 v[72:75], v30, s[4:7], s63 offen offset:2048 sc1
  v_accvgpr_read_b32 v40, a24
  v_accvgpr_read_b32 v41, a25
  v_accvgpr_read_b32 v42, a26
  v_accvgpr_read_b32 v43, a27
  v_accvgpr_read_b32 v44, a28
  v_accvgpr_read_b32 v45, a29
  v_accvgpr_read_b32 v46, a30
  v_accvgpr_read_b32 v47, a31
  s_add_u32 m0, s55, 69632
  s_nop 0
  buffer_load_dwordx4 v21, s[48:51], s53 offen lds
  v_pk_mul_f32 v[56:57], v[40:41], v[40:41]
  v_pk_mul_f32 v[58:59], v[42:43], v[42:43]
  v_pk_mul_f32 v[60:61], v[44:45], v[44:45]
  v_pk_mul_f32 v[62:63], v[46:47], v[46:47]
  v_pk_fma_f32 v[56:57], v[56:57], v[224:225], v[226:227]
  v_pk_fma_f32 v[58:59], v[58:59], v[224:225], v[226:227]
  v_pk_fma_f32 v[60:61], v[60:61], v[224:225], v[226:227]
  v_pk_fma_f32 v[62:63], v[62:63], v[224:225], v[226:227]
  v_pk_mul_f32 v[56:57], v[56:57], v[40:41]
  v_pk_mul_f32 v[58:59], v[58:59], v[42:43]
  v_pk_mul_f32 v[60:61], v[60:61], v[44:45]
  v_pk_mul_f32 v[62:63], v[62:63], v[46:47]
  v_exp_f32 v56, v56
  v_exp_f32 v57, v57
  v_exp_f32 v58, v58
  v_exp_f32 v59, v59
  v_exp_f32 v60, v60
  v_exp_f32 v61, v61
  v_exp_f32 v62, v62
  v_exp_f32 v63, v63
  v_pk_add_f32 v[56:57], v[56:57], v[228:229]
  v_pk_add_f32 v[58:59], v[58:59], v[228:229]
  v_pk_add_f32 v[60:61], v[60:61], v[228:229]
  v_pk_add_f32 v[62:63], v[62:63], v[228:229]
  v_rcp_f32 v56, v56
  v_rcp_f32 v57, v57
  v_rcp_f32 v58, v58
  v_rcp_f32 v59, v59
  v_rcp_f32 v60, v60
  v_rcp_f32 v61, v61
  v_rcp_f32 v62, v62
  v_rcp_f32 v63, v63
  v_pk_mul_f32 v[40:41], v[40:41], v[56:57]
  v_pk_mul_f32 v[42:43], v[42:43], v[58:59]
  v_pk_mul_f32 v[44:45], v[44:45], v[60:61]
  v_pk_mul_f32 v[46:47], v[46:47], v[62:63]
  v_cvt_pk_bf16_f32 v76, v40, v41
  v_cvt_pk_bf16_f32 v77, v42, v43
  v_cvt_pk_bf16_f32 v78, v44, v45
  v_cvt_pk_bf16_f32 v79, v46, v47
  s_nop 0
  v_permlane16_swap_b32 v76, v78
  v_permlane16_swap_b32 v77, v79
  buffer_store_dwordx4 v[76:79], v30, s[4:7], s63 offen offset:3072 sc1
  s_add_u32 s63, s63, 114688
  v_accvgpr_read_b32 v32, a32
  v_accvgpr_read_b32 v33, a33
  v_accvgpr_read_b32 v34, a34
  v_accvgpr_read_b32 v35, a35
  v_accvgpr_read_b32 v36, a36
  v_accvgpr_read_b32 v37, a37
  v_accvgpr_read_b32 v38, a38
  v_accvgpr_read_b32 v39, a39
  s_add_u32 m0, s55, 8192
  s_nop 0
  buffer_load_dwordx4 v14, s[44:47], s52 offen  lds
  v_pk_mul_f32 v[48:49], v[32:33], v[32:33]
  v_pk_mul_f32 v[50:51], v[34:35], v[34:35]
  v_pk_mul_f32 v[52:53], v[36:37], v[36:37]
  v_pk_mul_f32 v[54:55], v[38:39], v[38:39]
  v_pk_fma_f32 v[48:49], v[48:49], v[224:225], v[226:227]
  v_pk_fma_f32 v[50:51], v[50:51], v[224:225], v[226:227]
  v_pk_fma_f32 v[52:53], v[52:53], v[224:225], v[226:227]
  v_pk_fma_f32 v[54:55], v[54:55], v[224:225], v[226:227]
  v_pk_mul_f32 v[48:49], v[48:49], v[32:33]
  v_pk_mul_f32 v[50:51], v[50:51], v[34:35]
  v_pk_mul_f32 v[52:53], v[52:53], v[36:37]
  v_pk_mul_f32 v[54:55], v[54:55], v[38:39]
  v_exp_f32 v48, v48
  v_exp_f32 v49, v49
  v_exp_f32 v50, v50
  v_exp_f32 v51, v51
  v_exp_f32 v52, v52
  v_exp_f32 v53, v53
  v_exp_f32 v54, v54
  v_exp_f32 v55, v55
  v_pk_add_f32 v[48:49], v[48:49], v[228:229]
  v_pk_add_f32 v[50:51], v[50:51], v[228:229]
  v_pk_add_f32 v[52:53], v[52:53], v[228:229]
  v_pk_add_f32 v[54:55], v[54:55], v[228:229]
  v_rcp_f32 v48, v48
  v_rcp_f32 v49, v49
  v_rcp_f32 v50, v50
  v_rcp_f32 v51, v51
  v_rcp_f32 v52, v52
  v_rcp_f32 v53, v53
  v_rcp_f32 v54, v54
  v_rcp_f32 v55, v55
  v_pk_mul_f32 v[32:33], v[32:33], v[48:49]
  v_pk_mul_f32 v[34:35], v[34:35], v[50:51]
  v_pk_mul_f32 v[36:37], v[36:37], v[52:53]
  v_pk_mul_f32 v[38:39], v[38:39], v[54:55]
  v_cvt_pk_bf16_f32 v80, v32, v33
  v_cvt_pk_bf16_f32 v81, v34, v35
  v_cvt_pk_bf16_f32 v82, v36, v37
  v_cvt_pk_bf16_f32 v83, v38, v39
  s_nop 0
  v_permlane16_swap_b32 v80, v82
  v_permlane16_swap_b32 v81, v83
  buffer_store_dwordx4 v[80:83], v30, s[4:7], s63 offen offset:0 sc1
  v_accvgpr_read_b32 v40, a40
  v_accvgpr_read_b32 v41, a41
  v_accvgpr_read_b32 v42, a42
  v_accvgpr_read_b32 v43, a43
  v_accvgpr_read_b32 v44, a44
  v_accvgpr_read_b32 v45, a45
  v_accvgpr_read_b32 v46, a46
  v_accvgpr_read_b32 v47, a47
  s_add_u32 m0, s55, 73728
  s_nop 0
  buffer_load_dwordx4 v22, s[48:51], s53 offen lds
  v_pk_mul_f32 v[56:57], v[40:41], v[40:41]
  v_pk_mul_f32 v[58:59], v[42:43], v[42:43]
  v_pk_mul_f32 v[60:61], v[44:45], v[44:45]
  v_pk_mul_f32 v[62:63], v[46:47], v[46:47]
  v_pk_fma_f32 v[56:57], v[56:57], v[224:225], v[226:227]
  v_pk_fma_f32 v[58:59], v[58:59], v[224:225], v[226:227]
  v_pk_fma_f32 v[60:61], v[60:61], v[224:225], v[226:227]
  v_pk_fma_f32 v[62:63], v[62:63], v[224:225], v[226:227]
  v_pk_mul_f32 v[56:57], v[56:57], v[40:41]
  v_pk_mul_f32 v[58:59], v[58:59], v[42:43]
  v_pk_mul_f32 v[60:61], v[60:61], v[44:45]
  v_pk_mul_f32 v[62:63], v[62:63], v[46:47]
  v_exp_f32 v56, v56
  v_exp_f32 v57, v57
  v_exp_f32 v58, v58
  v_exp_f32 v59, v59
  v_exp_f32 v60, v60
  v_exp_f32 v61, v61
  v_exp_f32 v62, v62
  v_exp_f32 v63, v63
  v_pk_add_f32 v[56:57], v[56:57], v[228:229]
  v_pk_add_f32 v[58:59], v[58:59], v[228:229]
  v_pk_add_f32 v[60:61], v[60:61], v[228:229]
  v_pk_add_f32 v[62:63], v[62:63], v[228:229]
  v_rcp_f32 v56, v56
  v_rcp_f32 v57, v57
  v_rcp_f32 v58, v58
  v_rcp_f32 v59, v59
  v_rcp_f32 v60, v60
  v_rcp_f32 v61, v61
  v_rcp_f32 v62, v62
  v_rcp_f32 v63, v63
  v_pk_mul_f32 v[40:41], v[40:41], v[56:57]
  v_pk_mul_f32 v[42:43], v[42:43], v[58:59]
  v_pk_mul_f32 v[44:45], v[44:45], v[60:61]
  v_pk_mul_f32 v[46:47], v[46:47], v[62:63]
  v_cvt_pk_bf16_f32 v84, v40, v41
  v_cvt_pk_bf16_f32 v85, v42, v43
  v_cvt_pk_bf16_f32 v86, v44, v45
  v_cvt_pk_bf16_f32 v87, v46, v47
  s_nop 0
  v_permlane16_swap_b32 v84, v86
  v_permlane16_swap_b32 v85, v87
  buffer_store_dwordx4 v[84:87], v30, s[4:7], s63 offen offset:1024 sc1
  v_accvgpr_read_b32 v32, a48
  v_accvgpr_read_b32 v33, a49
  v_accvgpr_read_b32 v34, a50
  v_accvgpr_read_b32 v35, a51
  v_accvgpr_read_b32 v36, a52
  v_accvgpr_read_b32 v37, a53
  v_accvgpr_read_b32 v38, a54
  v_accvgpr_read_b32 v39, a55
  s_add_u32 m0, s55, 12288
  s_nop 0
  buffer_load_dwordx4 v15, s[44:47], s52 offen  lds
  v_pk_mul_f32 v[48:49], v[32:33], v[32:33]
  v_pk_mul_f32 v[50:51], v[34:35], v[34:35]
  v_pk_mul_f32 v[52:53], v[36:37], v[36:37]
  v_pk_mul_f32 v[54:55], v[38:39], v[38:39]
  v_pk_fma_f32 v[48:49], v[48:49], v[224:225], v[226:227]
  v_pk_fma_f32 v[50:51], v[50:51], v[224:225], v[226:227]
  v_pk_fma_f32 v[52:53], v[52:53], v[224:225], v[226:227]
  v_pk_fma_f32 v[54:55], v[54:55], v[224:225], v[226:227]
  v_pk_mul_f32 v[48:49], v[48:49], v[32:33]
  v_pk_mul_f32 v[50:51], v[50:51], v[34:35]
  v_pk_mul_f32 v[52:53], v[52:53], v[36:37]
  v_pk_mul_f32 v[54:55], v[54:55], v[38:39]
  v_exp_f32 v48, v48
  v_exp_f32 v49, v49
  v_exp_f32 v50, v50
  v_exp_f32 v51, v51
  v_exp_f32 v52, v52
  v_exp_f32 v53, v53
  v_exp_f32 v54, v54
  v_exp_f32 v55, v55
  v_pk_add_f32 v[48:49], v[48:49], v[228:229]
  v_pk_add_f32 v[50:51], v[50:51], v[228:229]
  v_pk_add_f32 v[52:53], v[52:53], v[228:229]
  v_pk_add_f32 v[54:55], v[54:55], v[228:229]
  v_rcp_f32 v48, v48
  v_rcp_f32 v49, v49
  v_rcp_f32 v50, v50
  v_rcp_f32 v51, v51
  v_rcp_f32 v52, v52
  v_rcp_f32 v53, v53
  v_rcp_f32 v54, v54
  v_rcp_f32 v55, v55
  v_pk_mul_f32 v[32:33], v[32:33], v[48:49]
  v_pk_mul_f32 v[34:35], v[34:35], v[50:51]
  v_pk_mul_f32 v[36:37], v[36:37], v[52:53]
  v_pk_mul_f32 v[38:39], v[38:39], v[54:55]
  v_cvt_pk_bf16_f32 v88, v32, v33
  v_cvt_pk_bf16_f32 v89, v34, v35
  v_cvt_pk_bf16_f32 v90, v36, v37
  v_cvt_pk_bf16_f32 v91, v38, v39
  s_nop 0
  v_permlane16_swap_b32 v88, v90
  v_permlane16_swap_b32 v89, v91
  buffer_store_dwordx4 v[88:91], v30, s[4:7], s63 offen offset:2048 sc1
  v_accvgpr_read_b32 v40, a56
  v_accvgpr_read_b32 v41, a57
  v_accvgpr_read_b32 v42, a58
  v_accvgpr_read_b32 v43, a59
  v_accvgpr_read_b32 v44, a60
  v_accvgpr_read_b32 v45, a61
  v_accvgpr_read_b32 v46, a62
  v_accvgpr_read_b32 v47, a63
  s_add_u32 m0, s55, 77824
  s_nop 0
  buffer_load_dwordx4 v23, s[48:51], s53 offen lds
  v_pk_mul_f32 v[56:57], v[40:41], v[40:41]
  v_pk_mul_f32 v[58:59], v[42:43], v[42:43]
  v_pk_mul_f32 v[60:61], v[44:45], v[44:45]
  v_pk_mul_f32 v[62:63], v[46:47], v[46:47]
  v_pk_fma_f32 v[56:57], v[56:57], v[224:225], v[226:227]
  v_pk_fma_f32 v[58:59], v[58:59], v[224:225], v[226:227]
  v_pk_fma_f32 v[60:61], v[60:61], v[224:225], v[226:227]
  v_pk_fma_f32 v[62:63], v[62:63], v[224:225], v[226:227]
  v_pk_mul_f32 v[56:57], v[56:57], v[40:41]
  v_pk_mul_f32 v[58:59], v[58:59], v[42:43]
  v_pk_mul_f32 v[60:61], v[60:61], v[44:45]
  v_pk_mul_f32 v[62:63], v[62:63], v[46:47]
  v_exp_f32 v56, v56
  v_exp_f32 v57, v57
  v_exp_f32 v58, v58
  v_exp_f32 v59, v59
  v_exp_f32 v60, v60
  v_exp_f32 v61, v61
  v_exp_f32 v62, v62
  v_exp_f32 v63, v63
  v_pk_add_f32 v[56:57], v[56:57], v[228:229]
  v_pk_add_f32 v[58:59], v[58:59], v[228:229]
  v_pk_add_f32 v[60:61], v[60:61], v[228:229]
  v_pk_add_f32 v[62:63], v[62:63], v[228:229]
  v_rcp_f32 v56, v56
  v_rcp_f32 v57, v57
  v_rcp_f32 v58, v58
  v_rcp_f32 v59, v59
  v_rcp_f32 v60, v60
  v_rcp_f32 v61, v61
  v_rcp_f32 v62, v62
  v_rcp_f32 v63, v63
  v_pk_mul_f32 v[40:41], v[40:41], v[56:57]
  v_pk_mul_f32 v[42:43], v[42:43], v[58:59]
  v_pk_mul_f32 v[44:45], v[44:45], v[60:61]
  v_pk_mul_f32 v[46:47], v[46:47], v[62:63]
  v_cvt_pk_bf16_f32 v92, v40, v41
  v_cvt_pk_bf16_f32 v93, v42, v43
  v_cvt_pk_bf16_f32 v94, v44, v45
  v_cvt_pk_bf16_f32 v95, v46, v47
  s_nop 0
  v_permlane16_swap_b32 v92, v94
  v_permlane16_swap_b32 v93, v95
  buffer_store_dwordx4 v[92:95], v30, s[4:7], s63 offen offset:3072 sc1
  s_add_u32 s63, s63, 114688
  v_accvgpr_read_b32 v32, a64
  v_accvgpr_read_b32 v33, a65
  v_accvgpr_read_b32 v34, a66
  v_accvgpr_read_b32 v35, a67
  v_accvgpr_read_b32 v36, a68
  v_accvgpr_read_b32 v37, a69
  v_accvgpr_read_b32 v38, a70
  v_accvgpr_read_b32 v39, a71
  s_add_u32 m0, s55, 16384
  s_nop 0
  buffer_load_dwordx4 v16, s[44:47], s52 offen  lds
  v_pk_mul_f32 v[48:49], v[32:33], v[32:33]
  v_pk_mul_f32 v[50:51], v[34:35], v[34:35]
  v_pk_mul_f32 v[52:53], v[36:37], v[36:37]
  v_pk_mul_f32 v[54:55], v[38:39], v[38:39]
  v_pk_fma_f32 v[48:49], v[48:49], v[224:225], v[226:227]
  v_pk_fma_f32 v[50:51], v[50:51], v[224:225], v[226:227]
  v_pk_fma_f32 v[52:53], v[52:53], v[224:225], v[226:227]
  v_pk_fma_f32 v[54:55], v[54:55], v[224:225], v[226:227]
  v_pk_mul_f32 v[48:49], v[48:49], v[32:33]
  v_pk_mul_f32 v[50:51], v[50:51], v[34:35]
  v_pk_mul_f32 v[52:53], v[52:53], v[36:37]
  v_pk_mul_f32 v[54:55], v[54:55], v[38:39]
  v_exp_f32 v48, v48
  v_exp_f32 v49, v49
  v_exp_f32 v50, v50
  v_exp_f32 v51, v51
  v_exp_f32 v52, v52
  v_exp_f32 v53, v53
  v_exp_f32 v54, v54
  v_exp_f32 v55, v55
  v_pk_add_f32 v[48:49], v[48:49], v[228:229]
  v_pk_add_f32 v[50:51], v[50:51], v[228:229]
  v_pk_add_f32 v[52:53], v[52:53], v[228:229]
  v_pk_add_f32 v[54:55], v[54:55], v[228:229]
  v_rcp_f32 v48, v48
  v_rcp_f32 v49, v49
  v_rcp_f32 v50, v50
  v_rcp_f32 v51, v51
  v_rcp_f32 v52, v52
  v_rcp_f32 v53, v53
  v_rcp_f32 v54, v54
  v_rcp_f32 v55, v55
  v_pk_mul_f32 v[32:33], v[32:33], v[48:49]
  v_pk_mul_f32 v[34:35], v[34:35], v[50:51]
  v_pk_mul_f32 v[36:37], v[36:37], v[52:53]
  v_pk_mul_f32 v[38:39], v[38:39], v[54:55]
  v_cvt_pk_bf16_f32 v64, v32, v33
  v_cvt_pk_bf16_f32 v65, v34, v35
  v_cvt_pk_bf16_f32 v66, v36, v37
  v_cvt_pk_bf16_f32 v67, v38, v39
  s_nop 0
  v_permlane16_swap_b32 v64, v66
  v_permlane16_swap_b32 v65, v67
  buffer_store_dwordx4 v[64:67], v30, s[4:7], s63 offen offset:0 sc1
  v_accvgpr_read_b32 v40, a72
  v_accvgpr_read_b32 v41, a73
  v_accvgpr_read_b32 v42, a74
  v_accvgpr_read_b32 v43, a75
  v_accvgpr_read_b32 v44, a76
  v_accvgpr_read_b32 v45, a77
  v_accvgpr_read_b32 v46, a78
  v_accvgpr_read_b32 v47, a79
  s_add_u32 m0, s55, 81920
  s_nop 0
  buffer_load_dwordx4 v24, s[48:51], s53 offen lds
  v_pk_mul_f32 v[56:57], v[40:41], v[40:41]
  v_pk_mul_f32 v[58:59], v[42:43], v[42:43]
  v_pk_mul_f32 v[60:61], v[44:45], v[44:45]
  v_pk_mul_f32 v[62:63], v[46:47], v[46:47]
  v_pk_fma_f32 v[56:57], v[56:57], v[224:225], v[226:227]
  v_pk_fma_f32 v[58:59], v[58:59], v[224:225], v[226:227]
  v_pk_fma_f32 v[60:61], v[60:61], v[224:225], v[226:227]
  v_pk_fma_f32 v[62:63], v[62:63], v[224:225], v[226:227]
  v_pk_mul_f32 v[56:57], v[56:57], v[40:41]
  v_pk_mul_f32 v[58:59], v[58:59], v[42:43]
  v_pk_mul_f32 v[60:61], v[60:61], v[44:45]
  v_pk_mul_f32 v[62:63], v[62:63], v[46:47]
  v_exp_f32 v56, v56
  v_exp_f32 v57, v57
  v_exp_f32 v58, v58
  v_exp_f32 v59, v59
  v_exp_f32 v60, v60
  v_exp_f32 v61, v61
  v_exp_f32 v62, v62
  v_exp_f32 v63, v63
  v_pk_add_f32 v[56:57], v[56:57], v[228:229]
  v_pk_add_f32 v[58:59], v[58:59], v[228:229]
  v_pk_add_f32 v[60:61], v[60:61], v[228:229]
  v_pk_add_f32 v[62:63], v[62:63], v[228:229]
  v_rcp_f32 v56, v56
  v_rcp_f32 v57, v57
  v_rcp_f32 v58, v58
  v_rcp_f32 v59, v59
  v_rcp_f32 v60, v60
  v_rcp_f32 v61, v61
  v_rcp_f32 v62, v62
  v_rcp_f32 v63, v63
  v_pk_mul_f32 v[40:41], v[40:41], v[56:57]
  v_pk_mul_f32 v[42:43], v[42:43], v[58:59]
  v_pk_mul_f32 v[44:45], v[44:45], v[60:61]
  v_pk_mul_f32 v[46:47], v[46:47], v[62:63]
  v_cvt_pk_bf16_f32 v68, v40, v41
  v_cvt_pk_bf16_f32 v69, v42, v43
  v_cvt_pk_bf16_f32 v70, v44, v45
  v_cvt_pk_bf16_f32 v71, v46, v47
  s_nop 0
  v_permlane16_swap_b32 v68, v70
  v_permlane16_swap_b32 v69, v71
  buffer_store_dwordx4 v[68:71], v30, s[4:7], s63 offen offset:1024 sc1
  v_accvgpr_read_b32 v32, a80
  v_accvgpr_read_b32 v33, a81
  v_accvgpr_read_b32 v34, a82
  v_accvgpr_read_b32 v35, a83
  v_accvgpr_read_b32 v36, a84
  v_accvgpr_read_b32 v37, a85
  v_accvgpr_read_b32 v38, a86
  v_accvgpr_read_b32 v39, a87
  s_add_u32 m0, s55, 20480
  s_nop 0
  buffer_load_dwordx4 v17, s[44:47], s52 offen  lds
  v_pk_mul_f32 v[48:49], v[32:33], v[32:33]
  v_pk_mul_f32 v[50:51], v[34:35], v[34:35]
  v_pk_mul_f32 v[52:53], v[36:37], v[36:37]
  v_pk_mul_f32 v[54:55], v[38:39], v[38:39]
  v_pk_fma_f32 v[48:49], v[48:49], v[224:225], v[226:227]
  v_pk_fma_f32 v[50:51], v[50:51], v[224:225], v[226:227]
  v_pk_fma_f32 v[52:53], v[52:53], v[224:225], v[226:227]
  v_pk_fma_f32 v[54:55], v[54:55], v[224:225], v[226:227]
  v_pk_mul_f32 v[48:49], v[48:49], v[32:33]
  v_pk_mul_f32 v[50:51], v[50:51], v[34:35]
  v_pk_mul_f32 v[52:53], v[52:53], v[36:37]
  v_pk_mul_f32 v[54:55], v[54:55], v[38:39]
  v_exp_f32 v48, v48
  v_exp_f32 v49, v49
  v_exp_f32 v50, v50
  v_exp_f32 v51, v51
  v_exp_f32 v52, v52
  v_exp_f32 v53, v53
  v_exp_f32 v54, v54
  v_exp_f32 v55, v55
  v_pk_add_f32 v[48:49], v[48:49], v[228:229]
  v_pk_add_f32 v[50:51], v[50:51], v[228:229]
  v_pk_add_f32 v[52:53], v[52:53], v[228:229]
  v_pk_add_f32 v[54:55], v[54:55], v[228:229]
  v_rcp_f32 v48, v48
  v_rcp_f32 v49, v49
  v_rcp_f32 v50, v50
  v_rcp_f32 v51, v51
  v_rcp_f32 v52, v52
  v_rcp_f32 v53, v53
  v_rcp_f32 v54, v54
  v_rcp_f32 v55, v55
  v_pk_mul_f32 v[32:33], v[32:33], v[48:49]
  v_pk_mul_f32 v[34:35], v[34:35], v[50:51]
  v_pk_mul_f32 v[36:37], v[36:37], v[52:53]
  v_pk_mul_f32 v[38:39], v[38:39], v[54:55]
  v_cvt_pk_bf16_f32 v72, v32, v33
  v_cvt_pk_bf16_f32 v73, v34, v35
  v_cvt_pk_bf16_f32 v74, v36, v37
  v_cvt_pk_bf16_f32 v75, v38, v39
  s_nop 0
  v_permlane16_swap_b32 v72, v74
  v_permlane16_swap_b32 v73, v75
  buffer_store_dwordx4 v[72:75], v30, s[4:7], s63 offen offset:2048 sc1
  v_accvgpr_read_b32 v40, a88
  v_accvgpr_read_b32 v41, a89
  v_accvgpr_read_b32 v42, a90
  v_accvgpr_read_b32 v43, a91
  v_accvgpr_read_b32 v44, a92
  v_accvgpr_read_b32 v45, a93
  v_accvgpr_read_b32 v46, a94
  v_accvgpr_read_b32 v47, a95
  s_add_u32 m0, s55, 86016
  s_nop 0
  buffer_load_dwordx4 v25, s[48:51], s53 offen lds
  v_pk_mul_f32 v[56:57], v[40:41], v[40:41]
  v_pk_mul_f32 v[58:59], v[42:43], v[42:43]
  v_pk_mul_f32 v[60:61], v[44:45], v[44:45]
  v_pk_mul_f32 v[62:63], v[46:47], v[46:47]
  v_pk_fma_f32 v[56:57], v[56:57], v[224:225], v[226:227]
  v_pk_fma_f32 v[58:59], v[58:59], v[224:225], v[226:227]
  v_pk_fma_f32 v[60:61], v[60:61], v[224:225], v[226:227]
  v_pk_fma_f32 v[62:63], v[62:63], v[224:225], v[226:227]
  v_pk_mul_f32 v[56:57], v[56:57], v[40:41]
  v_pk_mul_f32 v[58:59], v[58:59], v[42:43]
  v_pk_mul_f32 v[60:61], v[60:61], v[44:45]
  v_pk_mul_f32 v[62:63], v[62:63], v[46:47]
  v_exp_f32 v56, v56
  v_exp_f32 v57, v57
  v_exp_f32 v58, v58
  v_exp_f32 v59, v59
  v_exp_f32 v60, v60
  v_exp_f32 v61, v61
  v_exp_f32 v62, v62
  v_exp_f32 v63, v63
  v_pk_add_f32 v[56:57], v[56:57], v[228:229]
  v_pk_add_f32 v[58:59], v[58:59], v[228:229]
  v_pk_add_f32 v[60:61], v[60:61], v[228:229]
  v_pk_add_f32 v[62:63], v[62:63], v[228:229]
  v_rcp_f32 v56, v56
  v_rcp_f32 v57, v57
  v_rcp_f32 v58, v58
  v_rcp_f32 v59, v59
  v_rcp_f32 v60, v60
  v_rcp_f32 v61, v61
  v_rcp_f32 v62, v62
  v_rcp_f32 v63, v63
  v_pk_mul_f32 v[40:41], v[40:41], v[56:57]
  v_pk_mul_f32 v[42:43], v[42:43], v[58:59]
  v_pk_mul_f32 v[44:45], v[44:45], v[60:61]
  v_pk_mul_f32 v[46:47], v[46:47], v[62:63]
  v_cvt_pk_bf16_f32 v76, v40, v41
  v_cvt_pk_bf16_f32 v77, v42, v43
  v_cvt_pk_bf16_f32 v78, v44, v45
  v_cvt_pk_bf16_f32 v79, v46, v47
  s_nop 0
  v_permlane16_swap_b32 v76, v78
  v_permlane16_swap_b32 v77, v79
  buffer_store_dwordx4 v[76:79], v30, s[4:7], s63 offen offset:3072 sc1
  s_add_u32 s63, s63, 114688
  v_accvgpr_read_b32 v32, a96
  v_accvgpr_read_b32 v33, a97
  v_accvgpr_read_b32 v34, a98
  v_accvgpr_read_b32 v35, a99
  v_accvgpr_read_b32 v36, a100
  v_accvgpr_read_b32 v37, a101
  v_accvgpr_read_b32 v38, a102
  v_accvgpr_read_b32 v39, a103
  s_add_u32 m0, s55, 24576
  s_nop 0
  buffer_load_dwordx4 v18, s[44:47], s52 offen  lds
  v_pk_mul_f32 v[48:49], v[32:33], v[32:33]
  v_pk_mul_f32 v[50:51], v[34:35], v[34:35]
  v_pk_mul_f32 v[52:53], v[36:37], v[36:37]
  v_pk_mul_f32 v[54:55], v[38:39], v[38:39]
  v_pk_fma_f32 v[48:49], v[48:49], v[224:225], v[226:227]
  v_pk_fma_f32 v[50:51], v[50:51], v[224:225], v[226:227]
  v_pk_fma_f32 v[52:53], v[52:53], v[224:225], v[226:227]
  v_pk_fma_f32 v[54:55], v[54:55], v[224:225], v[226:227]
  v_pk_mul_f32 v[48:49], v[48:49], v[32:33]
  v_pk_mul_f32 v[50:51], v[50:51], v[34:35]
  v_pk_mul_f32 v[52:53], v[52:53], v[36:37]
  v_pk_mul_f32 v[54:55], v[54:55], v[38:39]
  v_exp_f32 v48, v48
  v_exp_f32 v49, v49
  v_exp_f32 v50, v50
  v_exp_f32 v51, v51
  v_exp_f32 v52, v52
  v_exp_f32 v53, v53
  v_exp_f32 v54, v54
  v_exp_f32 v55, v55
  v_pk_add_f32 v[48:49], v[48:49], v[228:229]
  v_pk_add_f32 v[50:51], v[50:51], v[228:229]
  v_pk_add_f32 v[52:53], v[52:53], v[228:229]
  v_pk_add_f32 v[54:55], v[54:55], v[228:229]
  v_rcp_f32 v48, v48
  v_rcp_f32 v49, v49
  v_rcp_f32 v50, v50
  v_rcp_f32 v51, v51
  v_rcp_f32 v52, v52
  v_rcp_f32 v53, v53
  v_rcp_f32 v54, v54
  v_rcp_f32 v55, v55
  v_pk_mul_f32 v[32:33], v[32:33], v[48:49]
  v_pk_mul_f32 v[34:35], v[34:35], v[50:51]
  v_pk_mul_f32 v[36:37], v[36:37], v[52:53]
  v_pk_mul_f32 v[38:39], v[38:39], v[54:55]
  v_cvt_pk_bf16_f32 v80, v32, v33
  v_cvt_pk_bf16_f32 v81, v34, v35
  v_cvt_pk_bf16_f32 v82, v36, v37
  v_cvt_pk_bf16_f32 v83, v38, v39
  s_nop 0
  v_permlane16_swap_b32 v80, v82
  v_permlane16_swap_b32 v81, v83
  buffer_store_dwordx4 v[80:83], v30, s[4:7], s63 offen offset:0 sc1
  v_accvgpr_read_b32 v40, a104
  v_accvgpr_read_b32 v41, a105
  v_accvgpr_read_b32 v42, a106
  v_accvgpr_read_b32 v43, a107
  v_accvgpr_read_b32 v44, a108
  v_accvgpr_read_b32 v45, a109
  v_accvgpr_read_b32 v46, a110
  v_accvgpr_read_b32 v47, a111
  s_add_u32 m0, s55, 90112
  s_nop 0
  buffer_load_dwordx4 v26, s[48:51], s53 offen lds
  v_pk_mul_f32 v[56:57], v[40:41], v[40:41]
  v_pk_mul_f32 v[58:59], v[42:43], v[42:43]
  v_pk_mul_f32 v[60:61], v[44:45], v[44:45]
  v_pk_mul_f32 v[62:63], v[46:47], v[46:47]
  v_pk_fma_f32 v[56:57], v[56:57], v[224:225], v[226:227]
  v_pk_fma_f32 v[58:59], v[58:59], v[224:225], v[226:227]
  v_pk_fma_f32 v[60:61], v[60:61], v[224:225], v[226:227]
  v_pk_fma_f32 v[62:63], v[62:63], v[224:225], v[226:227]
  v_pk_mul_f32 v[56:57], v[56:57], v[40:41]
  v_pk_mul_f32 v[58:59], v[58:59], v[42:43]
  v_pk_mul_f32 v[60:61], v[60:61], v[44:45]
  v_pk_mul_f32 v[62:63], v[62:63], v[46:47]
  v_exp_f32 v56, v56
  v_exp_f32 v57, v57
  v_exp_f32 v58, v58
  v_exp_f32 v59, v59
  v_exp_f32 v60, v60
  v_exp_f32 v61, v61
  v_exp_f32 v62, v62
  v_exp_f32 v63, v63
  v_pk_add_f32 v[56:57], v[56:57], v[228:229]
  v_pk_add_f32 v[58:59], v[58:59], v[228:229]
  v_pk_add_f32 v[60:61], v[60:61], v[228:229]
  v_pk_add_f32 v[62:63], v[62:63], v[228:229]
  v_rcp_f32 v56, v56
  v_rcp_f32 v57, v57
  v_rcp_f32 v58, v58
  v_rcp_f32 v59, v59
  v_rcp_f32 v60, v60
  v_rcp_f32 v61, v61
  v_rcp_f32 v62, v62
  v_rcp_f32 v63, v63
  v_pk_mul_f32 v[40:41], v[40:41], v[56:57]
  v_pk_mul_f32 v[42:43], v[42:43], v[58:59]
  v_pk_mul_f32 v[44:45], v[44:45], v[60:61]
  v_pk_mul_f32 v[46:47], v[46:47], v[62:63]
  v_cvt_pk_bf16_f32 v84, v40, v41
  v_cvt_pk_bf16_f32 v85, v42, v43
  v_cvt_pk_bf16_f32 v86, v44, v45
  v_cvt_pk_bf16_f32 v87, v46, v47
  s_nop 0
  v_permlane16_swap_b32 v84, v86
  v_permlane16_swap_b32 v85, v87
  buffer_store_dwordx4 v[84:87], v30, s[4:7], s63 offen offset:1024 sc1
  v_accvgpr_read_b32 v32, a112
  v_accvgpr_read_b32 v33, a113
  v_accvgpr_read_b32 v34, a114
  v_accvgpr_read_b32 v35, a115
  v_accvgpr_read_b32 v36, a116
  v_accvgpr_read_b32 v37, a117
  v_accvgpr_read_b32 v38, a118
  v_accvgpr_read_b32 v39, a119
  s_add_u32 m0, s55, 28672
  s_nop 0
  buffer_load_dwordx4 v19, s[44:47], s52 offen  lds
  v_pk_mul_f32 v[48:49], v[32:33], v[32:33]
  v_pk_mul_f32 v[50:51], v[34:35], v[34:35]
  v_pk_mul_f32 v[52:53], v[36:37], v[36:37]
  v_pk_mul_f32 v[54:55], v[38:39], v[38:39]
  v_pk_fma_f32 v[48:49], v[48:49], v[224:225], v[226:227]
  v_pk_fma_f32 v[50:51], v[50:51], v[224:225], v[226:227]
  v_pk_fma_f32 v[52:53], v[52:53], v[224:225], v[226:227]
  v_pk_fma_f32 v[54:55], v[54:55], v[224:225], v[226:227]
  v_pk_mul_f32 v[48:49], v[48:49], v[32:33]
  v_pk_mul_f32 v[50:51], v[50:51], v[34:35]
  v_pk_mul_f32 v[52:53], v[52:53], v[36:37]
  v_pk_mul_f32 v[54:55], v[54:55], v[38:39]
  v_exp_f32 v48, v48
  v_exp_f32 v49, v49
  v_exp_f32 v50, v50
  v_exp_f32 v51, v51
  v_exp_f32 v52, v52
  v_exp_f32 v53, v53
  v_exp_f32 v54, v54
  v_exp_f32 v55, v55
  v_pk_add_f32 v[48:49], v[48:49], v[228:229]
  v_pk_add_f32 v[50:51], v[50:51], v[228:229]
  v_pk_add_f32 v[52:53], v[52:53], v[228:229]
  v_pk_add_f32 v[54:55], v[54:55], v[228:229]
  v_rcp_f32 v48, v48
  v_rcp_f32 v49, v49
  v_rcp_f32 v50, v50
  v_rcp_f32 v51, v51
  v_rcp_f32 v52, v52
  v_rcp_f32 v53, v53
  v_rcp_f32 v54, v54
  v_rcp_f32 v55, v55
  v_pk_mul_f32 v[32:33], v[32:33], v[48:49]
  v_pk_mul_f32 v[34:35], v[34:35], v[50:51]
  v_pk_mul_f32 v[36:37], v[36:37], v[52:53]
  v_pk_mul_f32 v[38:39], v[38:39], v[54:55]
  v_cvt_pk_bf16_f32 v88, v32, v33
  v_cvt_pk_bf16_f32 v89, v34, v35
  v_cvt_pk_bf16_f32 v90, v36, v37
  v_cvt_pk_bf16_f32 v91, v38, v39
  s_nop 0
  v_permlane16_swap_b32 v88, v90
  v_permlane16_swap_b32 v89, v91
  buffer_store_dwordx4 v[88:91], v30, s[4:7], s63 offen offset:2048 sc1
  v_accvgpr_read_b32 v40, a120
  v_accvgpr_read_b32 v41, a121
  v_accvgpr_read_b32 v42, a122
  v_accvgpr_read_b32 v43, a123
  v_accvgpr_read_b32 v44, a124
  v_accvgpr_read_b32 v45, a125
  v_accvgpr_read_b32 v46, a126
  v_accvgpr_read_b32 v47, a127
  s_add_u32 m0, s55, 94208
  s_nop 0
  buffer_load_dwordx4 v27, s[48:51], s53 offen lds
  s_add_u32 s52, s52, 128
  s_add_u32 s53, s53, s22
  v_pk_mul_f32 v[56:57], v[40:41], v[40:41]
  v_pk_mul_f32 v[58:59], v[42:43], v[42:43]
  v_pk_mul_f32 v[60:61], v[44:45], v[44:45]
  v_pk_mul_f32 v[62:63], v[46:47], v[46:47]
  v_pk_fma_f32 v[56:57], v[56:57], v[224:225], v[226:227]
  v_pk_fma_f32 v[58:59], v[58:59], v[224:225], v[226:227]
  v_pk_fma_f32 v[60:61], v[60:61], v[224:225], v[226:227]
  v_pk_fma_f32 v[62:63], v[62:63], v[224:225], v[226:227]
  v_pk_mul_f32 v[56:57], v[56:57], v[40:41]
  v_pk_mul_f32 v[58:59], v[58:59], v[42:43]
  v_pk_mul_f32 v[60:61], v[60:61], v[44:45]
  v_pk_mul_f32 v[62:63], v[62:63], v[46:47]
  v_exp_f32 v56, v56
  v_exp_f32 v57, v57
  v_exp_f32 v58, v58
  v_exp_f32 v59, v59
  v_exp_f32 v60, v60
  v_exp_f32 v61, v61
  v_exp_f32 v62, v62
  v_exp_f32 v63, v63
  v_pk_add_f32 v[56:57], v[56:57], v[228:229]
  v_pk_add_f32 v[58:59], v[58:59], v[228:229]
  v_pk_add_f32 v[60:61], v[60:61], v[228:229]
  v_pk_add_f32 v[62:63], v[62:63], v[228:229]
  v_rcp_f32 v56, v56
  v_rcp_f32 v57, v57
  v_rcp_f32 v58, v58
  v_rcp_f32 v59, v59
  v_rcp_f32 v60, v60
  v_rcp_f32 v61, v61
  v_rcp_f32 v62, v62
  v_rcp_f32 v63, v63
  v_pk_mul_f32 v[40:41], v[40:41], v[56:57]
  v_pk_mul_f32 v[42:43], v[42:43], v[58:59]
  v_pk_mul_f32 v[44:45], v[44:45], v[60:61]
  v_pk_mul_f32 v[46:47], v[46:47], v[62:63]
  v_cvt_pk_bf16_f32 v92, v40, v41
  v_cvt_pk_bf16_f32 v93, v42, v43
  v_cvt_pk_bf16_f32 v94, v44, v45
  v_cvt_pk_bf16_f32 v95, v46, v47
  s_nop 0
  v_permlane16_swap_b32 v92, v94
  v_permlane16_swap_b32 v93, v95
  buffer_store_dwordx4 v[92:95], v30, s[4:7], s63 offen offset:3072 sc1
  s_add_u32 s63, s63, 114688
  v_accvgpr_read_b32 v32, a128
  v_accvgpr_read_b32 v33, a129
  v_accvgpr_read_b32 v34, a130
  v_accvgpr_read_b32 v35, a131
  v_accvgpr_read_b32 v36, a132
  v_accvgpr_read_b32 v37, a133
  v_accvgpr_read_b32 v38, a134
  v_accvgpr_read_b32 v39, a135
  s_add_u32 m0, s55, 32768
  s_nop 0
  buffer_load_dwordx4 v12, s[44:47], s52 offen  lds
  v_pk_mul_f32 v[48:49], v[32:33], v[32:33]
  v_pk_mul_f32 v[50:51], v[34:35], v[34:35]
  v_pk_mul_f32 v[52:53], v[36:37], v[36:37]
  v_pk_mul_f32 v[54:55], v[38:39], v[38:39]
  v_pk_fma_f32 v[48:49], v[48:49], v[224:225], v[226:227]
  v_pk_fma_f32 v[50:51], v[50:51], v[224:225], v[226:227]
  v_pk_fma_f32 v[52:53], v[52:53], v[224:225], v[226:227]
  v_pk_fma_f32 v[54:55], v[54:55], v[224:225], v[226:227]
  v_pk_mul_f32 v[48:49], v[48:49], v[32:33]
  v_pk_mul_f32 v[50:51], v[50:51], v[34:35]
  v_pk_mul_f32 v[52:53], v[52:53], v[36:37]
  v_pk_mul_f32 v[54:55], v[54:55], v[38:39]
  v_exp_f32 v48, v48
  v_exp_f32 v49, v49
  v_exp_f32 v50, v50
  v_exp_f32 v51, v51
  v_exp_f32 v52, v52
  v_exp_f32 v53, v53
  v_exp_f32 v54, v54
  v_exp_f32 v55, v55
  v_pk_add_f32 v[48:49], v[48:49], v[228:229]
  v_pk_add_f32 v[50:51], v[50:51], v[228:229]
  v_pk_add_f32 v[52:53], v[52:53], v[228:229]
  v_pk_add_f32 v[54:55], v[54:55], v[228:229]
  v_rcp_f32 v48, v48
  v_rcp_f32 v49, v49
  v_rcp_f32 v50, v50
  v_rcp_f32 v51, v51
  v_rcp_f32 v52, v52
  v_rcp_f32 v53, v53
  v_rcp_f32 v54, v54
  v_rcp_f32 v55, v55
  v_pk_mul_f32 v[32:33], v[32:33], v[48:49]
  v_pk_mul_f32 v[34:35], v[34:35], v[50:51]
  v_pk_mul_f32 v[36:37], v[36:37], v[52:53]
  v_pk_mul_f32 v[38:39], v[38:39], v[54:55]
  v_cvt_pk_bf16_f32 v64, v32, v33
  v_cvt_pk_bf16_f32 v65, v34, v35
  v_cvt_pk_bf16_f32 v66, v36, v37
  v_cvt_pk_bf16_f32 v67, v38, v39
  s_nop 0
  v_permlane16_swap_b32 v64, v66
  v_permlane16_swap_b32 v65, v67
  buffer_store_dwordx4 v[64:67], v30, s[4:7], s63 offen offset:0 sc1
  v_accvgpr_read_b32 v40, a136
  v_accvgpr_read_b32 v41, a137
  v_accvgpr_read_b32 v42, a138
  v_accvgpr_read_b32 v43, a139
  v_accvgpr_read_b32 v44, a140
  v_accvgpr_read_b32 v45, a141
  v_accvgpr_read_b32 v46, a142
  v_accvgpr_read_b32 v47, a143
  s_add_u32 m0, s55, 98304
  s_nop 0
  buffer_load_dwordx4 v20, s[48:51], s53 offen lds
  v_pk_mul_f32 v[56:57], v[40:41], v[40:41]
  v_pk_mul_f32 v[58:59], v[42:43], v[42:43]
  v_pk_mul_f32 v[60:61], v[44:45], v[44:45]
  v_pk_mul_f32 v[62:63], v[46:47], v[46:47]
  v_pk_fma_f32 v[56:57], v[56:57], v[224:225], v[226:227]
  v_pk_fma_f32 v[58:59], v[58:59], v[224:225], v[226:227]
  v_pk_fma_f32 v[60:61], v[60:61], v[224:225], v[226:227]
  v_pk_fma_f32 v[62:63], v[62:63], v[224:225], v[226:227]
  v_pk_mul_f32 v[56:57], v[56:57], v[40:41]
  v_pk_mul_f32 v[58:59], v[58:59], v[42:43]
  v_pk_mul_f32 v[60:61], v[60:61], v[44:45]
  v_pk_mul_f32 v[62:63], v[62:63], v[46:47]
  v_exp_f32 v56, v56
  v_exp_f32 v57, v57
  v_exp_f32 v58, v58
  v_exp_f32 v59, v59
  v_exp_f32 v60, v60
  v_exp_f32 v61, v61
  v_exp_f32 v62, v62
  v_exp_f32 v63, v63
  v_pk_add_f32 v[56:57], v[56:57], v[228:229]
  v_pk_add_f32 v[58:59], v[58:59], v[228:229]
  v_pk_add_f32 v[60:61], v[60:61], v[228:229]
  v_pk_add_f32 v[62:63], v[62:63], v[228:229]
  v_rcp_f32 v56, v56
  v_rcp_f32 v57, v57
  v_rcp_f32 v58, v58
  v_rcp_f32 v59, v59
  v_rcp_f32 v60, v60
  v_rcp_f32 v61, v61
  v_rcp_f32 v62, v62
  v_rcp_f32 v63, v63
  v_pk_mul_f32 v[40:41], v[40:41], v[56:57]
  v_pk_mul_f32 v[42:43], v[42:43], v[58:59]
  v_pk_mul_f32 v[44:45], v[44:45], v[60:61]
  v_pk_mul_f32 v[46:47], v[46:47], v[62:63]
  v_cvt_pk_bf16_f32 v68, v40, v41
  v_cvt_pk_bf16_f32 v69, v42, v43
  v_cvt_pk_bf16_f32 v70, v44, v45
  v_cvt_pk_bf16_f32 v71, v46, v47
  s_nop 0
  v_permlane16_swap_b32 v68, v70
  v_permlane16_swap_b32 v69, v71
  buffer_store_dwordx4 v[68:71], v30, s[4:7], s63 offen offset:1024 sc1
  v_accvgpr_read_b32 v32, a144
  v_accvgpr_read_b32 v33, a145
  v_accvgpr_read_b32 v34, a146
  v_accvgpr_read_b32 v35, a147
  v_accvgpr_read_b32 v36, a148
  v_accvgpr_read_b32 v37, a149
  v_accvgpr_read_b32 v38, a150
  v_accvgpr_read_b32 v39, a151
  s_add_u32 m0, s55, 36864
  s_nop 0
  buffer_load_dwordx4 v13, s[44:47], s52 offen  lds
  v_pk_mul_f32 v[48:49], v[32:33], v[32:33]
  v_pk_mul_f32 v[50:51], v[34:35], v[34:35]
  v_pk_mul_f32 v[52:53], v[36:37], v[36:37]
  v_pk_mul_f32 v[54:55], v[38:39], v[38:39]
  v_pk_fma_f32 v[48:49], v[48:49], v[224:225], v[226:227]
  v_pk_fma_f32 v[50:51], v[50:51], v[224:225], v[226:227]
  v_pk_fma_f32 v[52:53], v[52:53], v[224:225], v[226:227]
  v_pk_fma_f32 v[54:55], v[54:55], v[224:225], v[226:227]
  v_pk_mul_f32 v[48:49], v[48:49], v[32:33]
  v_pk_mul_f32 v[50:51], v[50:51], v[34:35]
  v_pk_mul_f32 v[52:53], v[52:53], v[36:37]
  v_pk_mul_f32 v[54:55], v[54:55], v[38:39]
  v_exp_f32 v48, v48
  v_exp_f32 v49, v49
  v_exp_f32 v50, v50
  v_exp_f32 v51, v51
  v_exp_f32 v52, v52
  v_exp_f32 v53, v53
  v_exp_f32 v54, v54
  v_exp_f32 v55, v55
  v_pk_add_f32 v[48:49], v[48:49], v[228:229]
  v_pk_add_f32 v[50:51], v[50:51], v[228:229]
  v_pk_add_f32 v[52:53], v[52:53], v[228:229]
  v_pk_add_f32 v[54:55], v[54:55], v[228:229]
  v_rcp_f32 v48, v48
  v_rcp_f32 v49, v49
  v_rcp_f32 v50, v50
  v_rcp_f32 v51, v51
  v_rcp_f32 v52, v52
  v_rcp_f32 v53, v53
  v_rcp_f32 v54, v54
  v_rcp_f32 v55, v55
  v_pk_mul_f32 v[32:33], v[32:33], v[48:49]
  v_pk_mul_f32 v[34:35], v[34:35], v[50:51]
  v_pk_mul_f32 v[36:37], v[36:37], v[52:53]
  v_pk_mul_f32 v[38:39], v[38:39], v[54:55]
  v_cvt_pk_bf16_f32 v72, v32, v33
  v_cvt_pk_bf16_f32 v73, v34, v35
  v_cvt_pk_bf16_f32 v74, v36, v37
  v_cvt_pk_bf16_f32 v75, v38, v39
  s_nop 0
  v_permlane16_swap_b32 v72, v74
  v_permlane16_swap_b32 v73, v75
  buffer_store_dwordx4 v[72:75], v30, s[4:7], s63 offen offset:2048 sc1
  v_accvgpr_read_b32 v40, a152
  v_accvgpr_read_b32 v41, a153
  v_accvgpr_read_b32 v42, a154
  v_accvgpr_read_b32 v43, a155
  v_accvgpr_read_b32 v44, a156
  v_accvgpr_read_b32 v45, a157
  v_accvgpr_read_b32 v46, a158
  v_accvgpr_read_b32 v47, a159
  s_add_u32 m0, s55, 102400
  s_nop 0
  buffer_load_dwordx4 v21, s[48:51], s53 offen lds
  v_pk_mul_f32 v[56:57], v[40:41], v[40:41]
  v_pk_mul_f32 v[58:59], v[42:43], v[42:43]
  v_pk_mul_f32 v[60:61], v[44:45], v[44:45]
  v_pk_mul_f32 v[62:63], v[46:47], v[46:47]
  v_pk_fma_f32 v[56:57], v[56:57], v[224:225], v[226:227]
  v_pk_fma_f32 v[58:59], v[58:59], v[224:225], v[226:227]
  v_pk_fma_f32 v[60:61], v[60:61], v[224:225], v[226:227]
  v_pk_fma_f32 v[62:63], v[62:63], v[224:225], v[226:227]
  v_pk_mul_f32 v[56:57], v[56:57], v[40:41]
  v_pk_mul_f32 v[58:59], v[58:59], v[42:43]
  v_pk_mul_f32 v[60:61], v[60:61], v[44:45]
  v_pk_mul_f32 v[62:63], v[62:63], v[46:47]
  v_exp_f32 v56, v56
  v_exp_f32 v57, v57
  v_exp_f32 v58, v58
  v_exp_f32 v59, v59
  v_exp_f32 v60, v60
  v_exp_f32 v61, v61
  v_exp_f32 v62, v62
  v_exp_f32 v63, v63
  v_pk_add_f32 v[56:57], v[56:57], v[228:229]
  v_pk_add_f32 v[58:59], v[58:59], v[228:229]
  v_pk_add_f32 v[60:61], v[60:61], v[228:229]
  v_pk_add_f32 v[62:63], v[62:63], v[228:229]
  v_rcp_f32 v56, v56
  v_rcp_f32 v57, v57
  v_rcp_f32 v58, v58
  v_rcp_f32 v59, v59
  v_rcp_f32 v60, v60
  v_rcp_f32 v61, v61
  v_rcp_f32 v62, v62
  v_rcp_f32 v63, v63
  v_pk_mul_f32 v[40:41], v[40:41], v[56:57]
  v_pk_mul_f32 v[42:43], v[42:43], v[58:59]
  v_pk_mul_f32 v[44:45], v[44:45], v[60:61]
  v_pk_mul_f32 v[46:47], v[46:47], v[62:63]
  v_cvt_pk_bf16_f32 v76, v40, v41
  v_cvt_pk_bf16_f32 v77, v42, v43
  v_cvt_pk_bf16_f32 v78, v44, v45
  v_cvt_pk_bf16_f32 v79, v46, v47
  s_nop 0
  v_permlane16_swap_b32 v76, v78
  v_permlane16_swap_b32 v77, v79
  buffer_store_dwordx4 v[76:79], v30, s[4:7], s63 offen offset:3072 sc1
  s_add_u32 s63, s63, 114688
  v_accvgpr_read_b32 v32, a160
  v_accvgpr_read_b32 v33, a161
  v_accvgpr_read_b32 v34, a162
  v_accvgpr_read_b32 v35, a163
  v_accvgpr_read_b32 v36, a164
  v_accvgpr_read_b32 v37, a165
  v_accvgpr_read_b32 v38, a166
  v_accvgpr_read_b32 v39, a167
  s_add_u32 m0, s55, 40960
  s_nop 0
  buffer_load_dwordx4 v14, s[44:47], s52 offen  lds
  v_pk_mul_f32 v[48:49], v[32:33], v[32:33]
  v_pk_mul_f32 v[50:51], v[34:35], v[34:35]
  v_pk_mul_f32 v[52:53], v[36:37], v[36:37]
  v_pk_mul_f32 v[54:55], v[38:39], v[38:39]
  v_pk_fma_f32 v[48:49], v[48:49], v[224:225], v[226:227]
  v_pk_fma_f32 v[50:51], v[50:51], v[224:225], v[226:227]
  v_pk_fma_f32 v[52:53], v[52:53], v[224:225], v[226:227]
  v_pk_fma_f32 v[54:55], v[54:55], v[224:225], v[226:227]
  v_pk_mul_f32 v[48:49], v[48:49], v[32:33]
  v_pk_mul_f32 v[50:51], v[50:51], v[34:35]
  v_pk_mul_f32 v[52:53], v[52:53], v[36:37]
  v_pk_mul_f32 v[54:55], v[54:55], v[38:39]
  v_exp_f32 v48, v48
  v_exp_f32 v49, v49
  v_exp_f32 v50, v50
  v_exp_f32 v51, v51
  v_exp_f32 v52, v52
  v_exp_f32 v53, v53
  v_exp_f32 v54, v54
  v_exp_f32 v55, v55
  v_pk_add_f32 v[48:49], v[48:49], v[228:229]
  v_pk_add_f32 v[50:51], v[50:51], v[228:229]
  v_pk_add_f32 v[52:53], v[52:53], v[228:229]
  v_pk_add_f32 v[54:55], v[54:55], v[228:229]
  v_rcp_f32 v48, v48
  v_rcp_f32 v49, v49
  v_rcp_f32 v50, v50
  v_rcp_f32 v51, v51
  v_rcp_f32 v52, v52
  v_rcp_f32 v53, v53
  v_rcp_f32 v54, v54
  v_rcp_f32 v55, v55
  v_pk_mul_f32 v[32:33], v[32:33], v[48:49]
  v_pk_mul_f32 v[34:35], v[34:35], v[50:51]
  v_pk_mul_f32 v[36:37], v[36:37], v[52:53]
  v_pk_mul_f32 v[38:39], v[38:39], v[54:55]
  v_cvt_pk_bf16_f32 v80, v32, v33
  v_cvt_pk_bf16_f32 v81, v34, v35
  v_cvt_pk_bf16_f32 v82, v36, v37
  v_cvt_pk_bf16_f32 v83, v38, v39
  s_nop 0
  v_permlane16_swap_b32 v80, v82
  v_permlane16_swap_b32 v81, v83
  buffer_store_dwordx4 v[80:83], v30, s[4:7], s63 offen offset:0 sc1
  v_accvgpr_read_b32 v40, a168
  v_accvgpr_read_b32 v41, a169
  v_accvgpr_read_b32 v42, a170
  v_accvgpr_read_b32 v43, a171
  v_accvgpr_read_b32 v44, a172
  v_accvgpr_read_b32 v45, a173
  v_accvgpr_read_b32 v46, a174
  v_accvgpr_read_b32 v47, a175
  s_add_u32 m0, s55, 106496
  s_nop 0
  buffer_load_dwordx4 v22, s[48:51], s53 offen lds
  v_pk_mul_f32 v[56:57], v[40:41], v[40:41]
  v_pk_mul_f32 v[58:59], v[42:43], v[42:43]
  v_pk_mul_f32 v[60:61], v[44:45], v[44:45]
  v_pk_mul_f32 v[62:63], v[46:47], v[46:47]
  v_pk_fma_f32 v[56:57], v[56:57], v[224:225], v[226:227]
  v_pk_fma_f32 v[58:59], v[58:59], v[224:225], v[226:227]
  v_pk_fma_f32 v[60:61], v[60:61], v[224:225], v[226:227]
  v_pk_fma_f32 v[62:63], v[62:63], v[224:225], v[226:227]
  v_pk_mul_f32 v[56:57], v[56:57], v[40:41]
  v_pk_mul_f32 v[58:59], v[58:59], v[42:43]
  v_pk_mul_f32 v[60:61], v[60:61], v[44:45]
  v_pk_mul_f32 v[62:63], v[62:63], v[46:47]
  v_exp_f32 v56, v56
  v_exp_f32 v57, v57
  v_exp_f32 v58, v58
  v_exp_f32 v59, v59
  v_exp_f32 v60, v60
  v_exp_f32 v61, v61
  v_exp_f32 v62, v62
  v_exp_f32 v63, v63
  v_pk_add_f32 v[56:57], v[56:57], v[228:229]
  v_pk_add_f32 v[58:59], v[58:59], v[228:229]
  v_pk_add_f32 v[60:61], v[60:61], v[228:229]
  v_pk_add_f32 v[62:63], v[62:63], v[228:229]
  v_rcp_f32 v56, v56
  v_rcp_f32 v57, v57
  v_rcp_f32 v58, v58
  v_rcp_f32 v59, v59
  v_rcp_f32 v60, v60
  v_rcp_f32 v61, v61
  v_rcp_f32 v62, v62
  v_rcp_f32 v63, v63
  v_pk_mul_f32 v[40:41], v[40:41], v[56:57]
  v_pk_mul_f32 v[42:43], v[42:43], v[58:59]
  v_pk_mul_f32 v[44:45], v[44:45], v[60:61]
  v_pk_mul_f32 v[46:47], v[46:47], v[62:63]
  v_cvt_pk_bf16_f32 v84, v40, v41
  v_cvt_pk_bf16_f32 v85, v42, v43
  v_cvt_pk_bf16_f32 v86, v44, v45
  v_cvt_pk_bf16_f32 v87, v46, v47
  s_nop 0
  v_permlane16_swap_b32 v84, v86
  v_permlane16_swap_b32 v85, v87
  buffer_store_dwordx4 v[84:87], v30, s[4:7], s63 offen offset:1024 sc1
  v_accvgpr_read_b32 v32, a176
  v_accvgpr_read_b32 v33, a177
  v_accvgpr_read_b32 v34, a178
  v_accvgpr_read_b32 v35, a179
  v_accvgpr_read_b32 v36, a180
  v_accvgpr_read_b32 v37, a181
  v_accvgpr_read_b32 v38, a182
  v_accvgpr_read_b32 v39, a183
  s_add_u32 m0, s55, 45056
  s_nop 0
  buffer_load_dwordx4 v15, s[44:47], s52 offen  lds
  v_pk_mul_f32 v[48:49], v[32:33], v[32:33]
  v_pk_mul_f32 v[50:51], v[34:35], v[34:35]
  v_pk_mul_f32 v[52:53], v[36:37], v[36:37]
  v_pk_mul_f32 v[54:55], v[38:39], v[38:39]
  v_pk_fma_f32 v[48:49], v[48:49], v[224:225], v[226:227]
  v_pk_fma_f32 v[50:51], v[50:51], v[224:225], v[226:227]
  v_pk_fma_f32 v[52:53], v[52:53], v[224:225], v[226:227]
  v_pk_fma_f32 v[54:55], v[54:55], v[224:225], v[226:227]
  v_pk_mul_f32 v[48:49], v[48:49], v[32:33]
  v_pk_mul_f32 v[50:51], v[50:51], v[34:35]
  v_pk_mul_f32 v[52:53], v[52:53], v[36:37]
  v_pk_mul_f32 v[54:55], v[54:55], v[38:39]
  v_exp_f32 v48, v48
  v_exp_f32 v49, v49
  v_exp_f32 v50, v50
  v_exp_f32 v51, v51
  v_exp_f32 v52, v52
  v_exp_f32 v53, v53
  v_exp_f32 v54, v54
  v_exp_f32 v55, v55
  v_pk_add_f32 v[48:49], v[48:49], v[228:229]
  v_pk_add_f32 v[50:51], v[50:51], v[228:229]
  v_pk_add_f32 v[52:53], v[52:53], v[228:229]
  v_pk_add_f32 v[54:55], v[54:55], v[228:229]
  v_rcp_f32 v48, v48
  v_rcp_f32 v49, v49
  v_rcp_f32 v50, v50
  v_rcp_f32 v51, v51
  v_rcp_f32 v52, v52
  v_rcp_f32 v53, v53
  v_rcp_f32 v54, v54
  v_rcp_f32 v55, v55
  v_pk_mul_f32 v[32:33], v[32:33], v[48:49]
  v_pk_mul_f32 v[34:35], v[34:35], v[50:51]
  v_pk_mul_f32 v[36:37], v[36:37], v[52:53]
  v_pk_mul_f32 v[38:39], v[38:39], v[54:55]
  v_cvt_pk_bf16_f32 v88, v32, v33
  v_cvt_pk_bf16_f32 v89, v34, v35
  v_cvt_pk_bf16_f32 v90, v36, v37
  v_cvt_pk_bf16_f32 v91, v38, v39
  s_nop 0
  v_permlane16_swap_b32 v88, v90
  v_permlane16_swap_b32 v89, v91
  buffer_store_dwordx4 v[88:91], v30, s[4:7], s63 offen offset:2048 sc1
  v_accvgpr_read_b32 v40, a184
  v_accvgpr_read_b32 v41, a185
  v_accvgpr_read_b32 v42, a186
  v_accvgpr_read_b32 v43, a187
  v_accvgpr_read_b32 v44, a188
  v_accvgpr_read_b32 v45, a189
  v_accvgpr_read_b32 v46, a190
  v_accvgpr_read_b32 v47, a191
  s_add_u32 m0, s55, 110592
  s_nop 0
  buffer_load_dwordx4 v23, s[48:51], s53 offen lds
  v_pk_mul_f32 v[56:57], v[40:41], v[40:41]
  v_pk_mul_f32 v[58:59], v[42:43], v[42:43]
  v_pk_mul_f32 v[60:61], v[44:45], v[44:45]
  v_pk_mul_f32 v[62:63], v[46:47], v[46:47]
  v_pk_fma_f32 v[56:57], v[56:57], v[224:225], v[226:227]
  v_pk_fma_f32 v[58:59], v[58:59], v[224:225], v[226:227]
  v_pk_fma_f32 v[60:61], v[60:61], v[224:225], v[226:227]
  v_pk_fma_f32 v[62:63], v[62:63], v[224:225], v[226:227]
  v_pk_mul_f32 v[56:57], v[56:57], v[40:41]
  v_pk_mul_f32 v[58:59], v[58:59], v[42:43]
  v_pk_mul_f32 v[60:61], v[60:61], v[44:45]
  v_pk_mul_f32 v[62:63], v[62:63], v[46:47]
  v_exp_f32 v56, v56
  v_exp_f32 v57, v57
  v_exp_f32 v58, v58
  v_exp_f32 v59, v59
  v_exp_f32 v60, v60
  v_exp_f32 v61, v61
  v_exp_f32 v62, v62
  v_exp_f32 v63, v63
  v_pk_add_f32 v[56:57], v[56:57], v[228:229]
  v_pk_add_f32 v[58:59], v[58:59], v[228:229]
  v_pk_add_f32 v[60:61], v[60:61], v[228:229]
  v_pk_add_f32 v[62:63], v[62:63], v[228:229]
  v_rcp_f32 v56, v56
  v_rcp_f32 v57, v57
  v_rcp_f32 v58, v58
  v_rcp_f32 v59, v59
  v_rcp_f32 v60, v60
  v_rcp_f32 v61, v61
  v_rcp_f32 v62, v62
  v_rcp_f32 v63, v63
  v_pk_mul_f32 v[40:41], v[40:41], v[56:57]
  v_pk_mul_f32 v[42:43], v[42:43], v[58:59]
  v_pk_mul_f32 v[44:45], v[44:45], v[60:61]
  v_pk_mul_f32 v[46:47], v[46:47], v[62:63]
  v_cvt_pk_bf16_f32 v92, v40, v41
  v_cvt_pk_bf16_f32 v93, v42, v43
  v_cvt_pk_bf16_f32 v94, v44, v45
  v_cvt_pk_bf16_f32 v95, v46, v47
  s_nop 0
  v_permlane16_swap_b32 v92, v94
  v_permlane16_swap_b32 v93, v95
  buffer_store_dwordx4 v[92:95], v30, s[4:7], s63 offen offset:3072 sc1
  s_add_u32 s63, s63, 114688
  v_accvgpr_read_b32 v32, a192
  v_accvgpr_read_b32 v33, a193
  v_accvgpr_read_b32 v34, a194
  v_accvgpr_read_b32 v35, a195
  v_accvgpr_read_b32 v36, a196
  v_accvgpr_read_b32 v37, a197
  v_accvgpr_read_b32 v38, a198
  v_accvgpr_read_b32 v39, a199
  s_add_u32 m0, s55, 49152
  s_nop 0
  buffer_load_dwordx4 v16, s[44:47], s52 offen  lds
  v_pk_mul_f32 v[48:49], v[32:33], v[32:33]
  v_pk_mul_f32 v[50:51], v[34:35], v[34:35]
  v_pk_mul_f32 v[52:53], v[36:37], v[36:37]
  v_pk_mul_f32 v[54:55], v[38:39], v[38:39]
  v_pk_fma_f32 v[48:49], v[48:49], v[224:225], v[226:227]
  v_pk_fma_f32 v[50:51], v[50:51], v[224:225], v[226:227]
  v_pk_fma_f32 v[52:53], v[52:53], v[224:225], v[226:227]
  v_pk_fma_f32 v[54:55], v[54:55], v[224:225], v[226:227]
  v_pk_mul_f32 v[48:49], v[48:49], v[32:33]
  v_pk_mul_f32 v[50:51], v[50:51], v[34:35]
  v_pk_mul_f32 v[52:53], v[52:53], v[36:37]
  v_pk_mul_f32 v[54:55], v[54:55], v[38:39]
  v_exp_f32 v48, v48
  v_exp_f32 v49, v49
  v_exp_f32 v50, v50
  v_exp_f32 v51, v51
  v_exp_f32 v52, v52
  v_exp_f32 v53, v53
  v_exp_f32 v54, v54
  v_exp_f32 v55, v55
  v_pk_add_f32 v[48:49], v[48:49], v[228:229]
  v_pk_add_f32 v[50:51], v[50:51], v[228:229]
  v_pk_add_f32 v[52:53], v[52:53], v[228:229]
  v_pk_add_f32 v[54:55], v[54:55], v[228:229]
  v_rcp_f32 v48, v48
  v_rcp_f32 v49, v49
  v_rcp_f32 v50, v50
  v_rcp_f32 v51, v51
  v_rcp_f32 v52, v52
  v_rcp_f32 v53, v53
  v_rcp_f32 v54, v54
  v_rcp_f32 v55, v55
  v_pk_mul_f32 v[32:33], v[32:33], v[48:49]
  v_pk_mul_f32 v[34:35], v[34:35], v[50:51]
  v_pk_mul_f32 v[36:37], v[36:37], v[52:53]
  v_pk_mul_f32 v[38:39], v[38:39], v[54:55]
  v_cvt_pk_bf16_f32 v64, v32, v33
  v_cvt_pk_bf16_f32 v65, v34, v35
  v_cvt_pk_bf16_f32 v66, v36, v37
  v_cvt_pk_bf16_f32 v67, v38, v39
  s_nop 0
  v_permlane16_swap_b32 v64, v66
  v_permlane16_swap_b32 v65, v67
  buffer_store_dwordx4 v[64:67], v30, s[4:7], s63 offen offset:0 sc1
  v_accvgpr_read_b32 v40, a200
  v_accvgpr_read_b32 v41, a201
  v_accvgpr_read_b32 v42, a202
  v_accvgpr_read_b32 v43, a203
  v_accvgpr_read_b32 v44, a204
  v_accvgpr_read_b32 v45, a205
  v_accvgpr_read_b32 v46, a206
  v_accvgpr_read_b32 v47, a207
  s_add_u32 m0, s55, 114688
  s_nop 0
  buffer_load_dwordx4 v24, s[48:51], s53 offen lds
  v_pk_mul_f32 v[56:57], v[40:41], v[40:41]
  v_pk_mul_f32 v[58:59], v[42:43], v[42:43]
  v_pk_mul_f32 v[60:61], v[44:45], v[44:45]
  v_pk_mul_f32 v[62:63], v[46:47], v[46:47]
  v_pk_fma_f32 v[56:57], v[56:57], v[224:225], v[226:227]
  v_pk_fma_f32 v[58:59], v[58:59], v[224:225], v[226:227]
  v_pk_fma_f32 v[60:61], v[60:61], v[224:225], v[226:227]
  v_pk_fma_f32 v[62:63], v[62:63], v[224:225], v[226:227]
  v_pk_mul_f32 v[56:57], v[56:57], v[40:41]
  v_pk_mul_f32 v[58:59], v[58:59], v[42:43]
  v_pk_mul_f32 v[60:61], v[60:61], v[44:45]
  v_pk_mul_f32 v[62:63], v[62:63], v[46:47]
  v_exp_f32 v56, v56
  v_exp_f32 v57, v57
  v_exp_f32 v58, v58
  v_exp_f32 v59, v59
  v_exp_f32 v60, v60
  v_exp_f32 v61, v61
  v_exp_f32 v62, v62
  v_exp_f32 v63, v63
  v_pk_add_f32 v[56:57], v[56:57], v[228:229]
  v_pk_add_f32 v[58:59], v[58:59], v[228:229]
  v_pk_add_f32 v[60:61], v[60:61], v[228:229]
  v_pk_add_f32 v[62:63], v[62:63], v[228:229]
  v_rcp_f32 v56, v56
  v_rcp_f32 v57, v57
  v_rcp_f32 v58, v58
  v_rcp_f32 v59, v59
  v_rcp_f32 v60, v60
  v_rcp_f32 v61, v61
  v_rcp_f32 v62, v62
  v_rcp_f32 v63, v63
  v_pk_mul_f32 v[40:41], v[40:41], v[56:57]
  v_pk_mul_f32 v[42:43], v[42:43], v[58:59]
  v_pk_mul_f32 v[44:45], v[44:45], v[60:61]
  v_pk_mul_f32 v[46:47], v[46:47], v[62:63]
  v_cvt_pk_bf16_f32 v68, v40, v41
  v_cvt_pk_bf16_f32 v69, v42, v43
  v_cvt_pk_bf16_f32 v70, v44, v45
  v_cvt_pk_bf16_f32 v71, v46, v47
  s_nop 0
  v_permlane16_swap_b32 v68, v70
  v_permlane16_swap_b32 v69, v71
  buffer_store_dwordx4 v[68:71], v30, s[4:7], s63 offen offset:1024 sc1
  v_accvgpr_read_b32 v32, a208
  v_accvgpr_read_b32 v33, a209
  v_accvgpr_read_b32 v34, a210
  v_accvgpr_read_b32 v35, a211
  v_accvgpr_read_b32 v36, a212
  v_accvgpr_read_b32 v37, a213
  v_accvgpr_read_b32 v38, a214
  v_accvgpr_read_b32 v39, a215
  s_add_u32 m0, s55, 53248
  s_nop 0
  buffer_load_dwordx4 v17, s[44:47], s52 offen  lds
  v_pk_mul_f32 v[48:49], v[32:33], v[32:33]
  v_pk_mul_f32 v[50:51], v[34:35], v[34:35]
  v_pk_mul_f32 v[52:53], v[36:37], v[36:37]
  v_pk_mul_f32 v[54:55], v[38:39], v[38:39]
  v_pk_fma_f32 v[48:49], v[48:49], v[224:225], v[226:227]
  v_pk_fma_f32 v[50:51], v[50:51], v[224:225], v[226:227]
  v_pk_fma_f32 v[52:53], v[52:53], v[224:225], v[226:227]
  v_pk_fma_f32 v[54:55], v[54:55], v[224:225], v[226:227]
  v_pk_mul_f32 v[48:49], v[48:49], v[32:33]
  v_pk_mul_f32 v[50:51], v[50:51], v[34:35]
  v_pk_mul_f32 v[52:53], v[52:53], v[36:37]
  v_pk_mul_f32 v[54:55], v[54:55], v[38:39]
  v_exp_f32 v48, v48
  v_exp_f32 v49, v49
  v_exp_f32 v50, v50
  v_exp_f32 v51, v51
  v_exp_f32 v52, v52
  v_exp_f32 v53, v53
  v_exp_f32 v54, v54
  v_exp_f32 v55, v55
  v_pk_add_f32 v[48:49], v[48:49], v[228:229]
  v_pk_add_f32 v[50:51], v[50:51], v[228:229]
  v_pk_add_f32 v[52:53], v[52:53], v[228:229]
  v_pk_add_f32 v[54:55], v[54:55], v[228:229]
  v_rcp_f32 v48, v48
  v_rcp_f32 v49, v49
  v_rcp_f32 v50, v50
  v_rcp_f32 v51, v51
  v_rcp_f32 v52, v52
  v_rcp_f32 v53, v53
  v_rcp_f32 v54, v54
  v_rcp_f32 v55, v55
  v_pk_mul_f32 v[32:33], v[32:33], v[48:49]
  v_pk_mul_f32 v[34:35], v[34:35], v[50:51]
  v_pk_mul_f32 v[36:37], v[36:37], v[52:53]
  v_pk_mul_f32 v[38:39], v[38:39], v[54:55]
  v_cvt_pk_bf16_f32 v72, v32, v33
  v_cvt_pk_bf16_f32 v73, v34, v35
  v_cvt_pk_bf16_f32 v74, v36, v37
  v_cvt_pk_bf16_f32 v75, v38, v39
  s_nop 0
  v_permlane16_swap_b32 v72, v74
  v_permlane16_swap_b32 v73, v75
  buffer_store_dwordx4 v[72:75], v30, s[4:7], s63 offen offset:2048 sc1
  v_accvgpr_read_b32 v40, a216
  v_accvgpr_read_b32 v41, a217
  v_accvgpr_read_b32 v42, a218
  v_accvgpr_read_b32 v43, a219
  v_accvgpr_read_b32 v44, a220
  v_accvgpr_read_b32 v45, a221
  v_accvgpr_read_b32 v46, a222
  v_accvgpr_read_b32 v47, a223
  s_add_u32 m0, s55, 118784
  s_nop 0
  buffer_load_dwordx4 v25, s[48:51], s53 offen lds
  v_pk_mul_f32 v[56:57], v[40:41], v[40:41]
  v_pk_mul_f32 v[58:59], v[42:43], v[42:43]
  v_pk_mul_f32 v[60:61], v[44:45], v[44:45]
  v_pk_mul_f32 v[62:63], v[46:47], v[46:47]
  v_pk_fma_f32 v[56:57], v[56:57], v[224:225], v[226:227]
  v_pk_fma_f32 v[58:59], v[58:59], v[224:225], v[226:227]
  v_pk_fma_f32 v[60:61], v[60:61], v[224:225], v[226:227]
  v_pk_fma_f32 v[62:63], v[62:63], v[224:225], v[226:227]
  v_pk_mul_f32 v[56:57], v[56:57], v[40:41]
  v_pk_mul_f32 v[58:59], v[58:59], v[42:43]
  v_pk_mul_f32 v[60:61], v[60:61], v[44:45]
  v_pk_mul_f32 v[62:63], v[62:63], v[46:47]
  v_exp_f32 v56, v56
  v_exp_f32 v57, v57
  v_exp_f32 v58, v58
  v_exp_f32 v59, v59
  v_exp_f32 v60, v60
  v_exp_f32 v61, v61
  v_exp_f32 v62, v62
  v_exp_f32 v63, v63
  v_pk_add_f32 v[56:57], v[56:57], v[228:229]
  v_pk_add_f32 v[58:59], v[58:59], v[228:229]
  v_pk_add_f32 v[60:61], v[60:61], v[228:229]
  v_pk_add_f32 v[62:63], v[62:63], v[228:229]
  v_rcp_f32 v56, v56
  v_rcp_f32 v57, v57
  v_rcp_f32 v58, v58
  v_rcp_f32 v59, v59
  v_rcp_f32 v60, v60
  v_rcp_f32 v61, v61
  v_rcp_f32 v62, v62
  v_rcp_f32 v63, v63
  v_pk_mul_f32 v[40:41], v[40:41], v[56:57]
  v_pk_mul_f32 v[42:43], v[42:43], v[58:59]
  v_pk_mul_f32 v[44:45], v[44:45], v[60:61]
  v_pk_mul_f32 v[46:47], v[46:47], v[62:63]
  v_cvt_pk_bf16_f32 v76, v40, v41
  v_cvt_pk_bf16_f32 v77, v42, v43
  v_cvt_pk_bf16_f32 v78, v44, v45
  v_cvt_pk_bf16_f32 v79, v46, v47
  s_nop 0
  v_permlane16_swap_b32 v76, v78
  v_permlane16_swap_b32 v77, v79
  buffer_store_dwordx4 v[76:79], v30, s[4:7], s63 offen offset:3072 sc1
  s_add_u32 s63, s63, 114688
  v_accvgpr_read_b32 v32, a224
  v_accvgpr_read_b32 v33, a225
  v_accvgpr_read_b32 v34, a226
  v_accvgpr_read_b32 v35, a227
  v_accvgpr_read_b32 v36, a228
  v_accvgpr_read_b32 v37, a229
  v_accvgpr_read_b32 v38, a230
  v_accvgpr_read_b32 v39, a231
  v_pk_mul_f32 v[48:49], v[32:33], v[32:33]
  v_pk_mul_f32 v[50:51], v[34:35], v[34:35]
  v_pk_mul_f32 v[52:53], v[36:37], v[36:37]
  v_pk_mul_f32 v[54:55], v[38:39], v[38:39]
  v_pk_fma_f32 v[48:49], v[48:49], v[224:225], v[226:227]
  v_pk_fma_f32 v[50:51], v[50:51], v[224:225], v[226:227]
  v_pk_fma_f32 v[52:53], v[52:53], v[224:225], v[226:227]
  v_pk_fma_f32 v[54:55], v[54:55], v[224:225], v[226:227]
  v_pk_mul_f32 v[48:49], v[48:49], v[32:33]
  v_pk_mul_f32 v[50:51], v[50:51], v[34:35]
  v_pk_mul_f32 v[52:53], v[52:53], v[36:37]
  v_pk_mul_f32 v[54:55], v[54:55], v[38:39]
  v_exp_f32 v48, v48
  v_exp_f32 v49, v49
  v_exp_f32 v50, v50
  v_exp_f32 v51, v51
  v_exp_f32 v52, v52
  v_exp_f32 v53, v53
  v_exp_f32 v54, v54
  v_exp_f32 v55, v55
  v_pk_add_f32 v[48:49], v[48:49], v[228:229]
  v_pk_add_f32 v[50:51], v[50:51], v[228:229]
  v_pk_add_f32 v[52:53], v[52:53], v[228:229]
  v_pk_add_f32 v[54:55], v[54:55], v[228:229]
  v_rcp_f32 v48, v48
  v_rcp_f32 v49, v49
  v_rcp_f32 v50, v50
  v_rcp_f32 v51, v51
  v_rcp_f32 v52, v52
  v_rcp_f32 v53, v53
  v_rcp_f32 v54, v54
  v_rcp_f32 v55, v55
  v_pk_mul_f32 v[32:33], v[32:33], v[48:49]
  v_pk_mul_f32 v[34:35], v[34:35], v[50:51]
  v_pk_mul_f32 v[36:37], v[36:37], v[52:53]
  v_pk_mul_f32 v[38:39], v[38:39], v[54:55]
  v_cvt_pk_bf16_f32 v80, v32, v33
  v_cvt_pk_bf16_f32 v81, v34, v35
  v_cvt_pk_bf16_f32 v82, v36, v37
  v_cvt_pk_bf16_f32 v83, v38, v39
  s_nop 0
  v_permlane16_swap_b32 v80, v82
  v_permlane16_swap_b32 v81, v83
  buffer_store_dwordx4 v[80:83], v30, s[4:7], s63 offen offset:0 sc1
  v_accvgpr_read_b32 v40, a232
  v_accvgpr_read_b32 v41, a233
  v_accvgpr_read_b32 v42, a234
  v_accvgpr_read_b32 v43, a235
  v_accvgpr_read_b32 v44, a236
  v_accvgpr_read_b32 v45, a237
  v_accvgpr_read_b32 v46, a238
  v_accvgpr_read_b32 v47, a239
  v_pk_mul_f32 v[56:57], v[40:41], v[40:41]
  v_pk_mul_f32 v[58:59], v[42:43], v[42:43]
  v_pk_mul_f32 v[60:61], v[44:45], v[44:45]
  v_pk_mul_f32 v[62:63], v[46:47], v[46:47]
  v_pk_fma_f32 v[56:57], v[56:57], v[224:225], v[226:227]
  v_pk_fma_f32 v[58:59], v[58:59], v[224:225], v[226:227]
  v_pk_fma_f32 v[60:61], v[60:61], v[224:225], v[226:227]
  v_pk_fma_f32 v[62:63], v[62:63], v[224:225], v[226:227]
  v_pk_mul_f32 v[56:57], v[56:57], v[40:41]
  v_pk_mul_f32 v[58:59], v[58:59], v[42:43]
  v_pk_mul_f32 v[60:61], v[60:61], v[44:45]
  v_pk_mul_f32 v[62:63], v[62:63], v[46:47]
  v_exp_f32 v56, v56
  v_exp_f32 v57, v57
  v_exp_f32 v58, v58
  v_exp_f32 v59, v59
  v_exp_f32 v60, v60
  v_exp_f32 v61, v61
  v_exp_f32 v62, v62
  v_exp_f32 v63, v63
  v_pk_add_f32 v[56:57], v[56:57], v[228:229]
  v_pk_add_f32 v[58:59], v[58:59], v[228:229]
  v_pk_add_f32 v[60:61], v[60:61], v[228:229]
  v_pk_add_f32 v[62:63], v[62:63], v[228:229]
  v_rcp_f32 v56, v56
  v_rcp_f32 v57, v57
  v_rcp_f32 v58, v58
  v_rcp_f32 v59, v59
  v_rcp_f32 v60, v60
  v_rcp_f32 v61, v61
  v_rcp_f32 v62, v62
  v_rcp_f32 v63, v63
  v_pk_mul_f32 v[40:41], v[40:41], v[56:57]
  v_pk_mul_f32 v[42:43], v[42:43], v[58:59]
  v_pk_mul_f32 v[44:45], v[44:45], v[60:61]
  v_pk_mul_f32 v[46:47], v[46:47], v[62:63]
  v_cvt_pk_bf16_f32 v84, v40, v41
  v_cvt_pk_bf16_f32 v85, v42, v43
  v_cvt_pk_bf16_f32 v86, v44, v45
  v_cvt_pk_bf16_f32 v87, v46, v47
  s_nop 0
  v_permlane16_swap_b32 v84, v86
  v_permlane16_swap_b32 v85, v87
  buffer_store_dwordx4 v[84:87], v30, s[4:7], s63 offen offset:1024 sc1
  v_accvgpr_read_b32 v32, a240
  v_accvgpr_read_b32 v33, a241
  v_accvgpr_read_b32 v34, a242
  v_accvgpr_read_b32 v35, a243
  v_accvgpr_read_b32 v36, a244
  v_accvgpr_read_b32 v37, a245
  v_accvgpr_read_b32 v38, a246
  v_accvgpr_read_b32 v39, a247
  v_pk_mul_f32 v[48:49], v[32:33], v[32:33]
  v_pk_mul_f32 v[50:51], v[34:35], v[34:35]
  v_pk_mul_f32 v[52:53], v[36:37], v[36:37]
  v_pk_mul_f32 v[54:55], v[38:39], v[38:39]
  v_pk_fma_f32 v[48:49], v[48:49], v[224:225], v[226:227]
  v_pk_fma_f32 v[50:51], v[50:51], v[224:225], v[226:227]
  v_pk_fma_f32 v[52:53], v[52:53], v[224:225], v[226:227]
  v_pk_fma_f32 v[54:55], v[54:55], v[224:225], v[226:227]
  v_pk_mul_f32 v[48:49], v[48:49], v[32:33]
  v_pk_mul_f32 v[50:51], v[50:51], v[34:35]
  v_pk_mul_f32 v[52:53], v[52:53], v[36:37]
  v_pk_mul_f32 v[54:55], v[54:55], v[38:39]
  v_exp_f32 v48, v48
  v_exp_f32 v49, v49
  v_exp_f32 v50, v50
  v_exp_f32 v51, v51
  v_exp_f32 v52, v52
  v_exp_f32 v53, v53
  v_exp_f32 v54, v54
  v_exp_f32 v55, v55
  v_pk_add_f32 v[48:49], v[48:49], v[228:229]
  v_pk_add_f32 v[50:51], v[50:51], v[228:229]
  v_pk_add_f32 v[52:53], v[52:53], v[228:229]
  v_pk_add_f32 v[54:55], v[54:55], v[228:229]
  v_rcp_f32 v48, v48
  v_rcp_f32 v49, v49
  v_rcp_f32 v50, v50
  v_rcp_f32 v51, v51
  v_rcp_f32 v52, v52
  v_rcp_f32 v53, v53
  v_rcp_f32 v54, v54
  v_rcp_f32 v55, v55
  v_pk_mul_f32 v[32:33], v[32:33], v[48:49]
  v_pk_mul_f32 v[34:35], v[34:35], v[50:51]
  v_pk_mul_f32 v[36:37], v[36:37], v[52:53]
  v_pk_mul_f32 v[38:39], v[38:39], v[54:55]
  v_cvt_pk_bf16_f32 v88, v32, v33
  v_cvt_pk_bf16_f32 v89, v34, v35
  v_cvt_pk_bf16_f32 v90, v36, v37
  v_cvt_pk_bf16_f32 v91, v38, v39
  s_nop 0
  v_permlane16_swap_b32 v88, v90
  v_permlane16_swap_b32 v89, v91
  buffer_store_dwordx4 v[88:91], v30, s[4:7], s63 offen offset:2048 sc1
  v_accvgpr_read_b32 v40, a248
  v_accvgpr_read_b32 v41, a249
  v_accvgpr_read_b32 v42, a250
  v_accvgpr_read_b32 v43, a251
  v_accvgpr_read_b32 v44, a252
  v_accvgpr_read_b32 v45, a253
  v_accvgpr_read_b32 v46, a254
  v_accvgpr_read_b32 v47, a255
  v_pk_mul_f32 v[56:57], v[40:41], v[40:41]
  v_pk_mul_f32 v[58:59], v[42:43], v[42:43]
  v_pk_mul_f32 v[60:61], v[44:45], v[44:45]
  v_pk_mul_f32 v[62:63], v[46:47], v[46:47]
  v_pk_fma_f32 v[56:57], v[56:57], v[224:225], v[226:227]
  v_pk_fma_f32 v[58:59], v[58:59], v[224:225], v[226:227]
  v_pk_fma_f32 v[60:61], v[60:61], v[224:225], v[226:227]
  v_pk_fma_f32 v[62:63], v[62:63], v[224:225], v[226:227]
  v_pk_mul_f32 v[56:57], v[56:57], v[40:41]
  v_pk_mul_f32 v[58:59], v[58:59], v[42:43]
  v_pk_mul_f32 v[60:61], v[60:61], v[44:45]
  v_pk_mul_f32 v[62:63], v[62:63], v[46:47]
  v_exp_f32 v56, v56
  v_exp_f32 v57, v57
  v_exp_f32 v58, v58
  v_exp_f32 v59, v59
  v_exp_f32 v60, v60
  v_exp_f32 v61, v61
  v_exp_f32 v62, v62
  v_exp_f32 v63, v63
  v_pk_add_f32 v[56:57], v[56:57], v[228:229]
  v_pk_add_f32 v[58:59], v[58:59], v[228:229]
  v_pk_add_f32 v[60:61], v[60:61], v[228:229]
  v_pk_add_f32 v[62:63], v[62:63], v[228:229]
  v_rcp_f32 v56, v56
  v_rcp_f32 v57, v57
  v_rcp_f32 v58, v58
  v_rcp_f32 v59, v59
  v_rcp_f32 v60, v60
  v_rcp_f32 v61, v61
  v_rcp_f32 v62, v62
  v_rcp_f32 v63, v63
  v_pk_mul_f32 v[40:41], v[40:41], v[56:57]
  v_pk_mul_f32 v[42:43], v[42:43], v[58:59]
  v_pk_mul_f32 v[44:45], v[44:45], v[60:61]
  v_pk_mul_f32 v[46:47], v[46:47], v[62:63]
  v_cvt_pk_bf16_f32 v92, v40, v41
  v_cvt_pk_bf16_f32 v93, v42, v43
  v_cvt_pk_bf16_f32 v94, v44, v45
  v_cvt_pk_bf16_f32 v95, v46, v47
  s_nop 0
  v_permlane16_swap_b32 v92, v94
  v_permlane16_swap_b32 v93, v95
  buffer_store_dwordx4 v[92:95], v30, s[4:7], s63 offen offset:3072 sc1
  s_add_u32 s63, s63, 114688
  s_lshl_b32 s38, s36, 2
  s_add_u32 s38, s38, 128
  s_mov_b32 s39, 1
  s_waitcnt vmcnt(29)
  s_branch run
epi_4:
  s_cmp_lg_u32 s26, 4
  s_cbranch_scc1 epi_5
  s_cmp_eq_u32 s50, 0
  s_cbranch_scc1 nodma4
  s_add_u32 m0, s55, 0
  s_nop 0
  buffer_load_dwordx4 v12, s[44:47], s52 offen  lds
  s_add_u32 m0, s55, 65536
  s_nop 0
  buffer_load_dwordx4 v20, s[48:51], s53 offen lds
  s_add_u32 m0, s55, 4096
  s_nop 0
  buffer_load_dwordx4 v13, s[44:47], s52 offen  lds
  s_add_u32 m0, s55, 69632
  s_nop 0
  buffer_load_dwordx4 v21, s[48:51], s53 offen lds
  s_add_u32 m0, s55, 8192
  s_nop 0
  buffer_load_dwordx4 v14, s[44:47], s52 offen  lds
  s_add_u32 m0, s55, 73728
  s_nop 0
  buffer_load_dwordx4 v22, s[48:51], s53 offen lds
  s_add_u32 m0, s55, 12288
  s_nop 0
  buffer_load_dwordx4 v15, s[44:47], s52 offen  lds
  s_add_u32 m0, s55, 77824
  s_nop 0
  buffer_load_dwordx4 v23, s[48:51], s53 offen lds
  s_add_u32 m0, s55, 16384
  s_nop 0
  buffer_load_dwordx4 v16, s[44:47], s52 offen  lds
  s_add_u32 m0, s55, 81920
  s_nop 0
  buffer_load_dwordx4 v24, s[48:51], s53 offen lds
  s_add_u32 m0, s55, 20480
  s_nop 0
  buffer_load_dwordx4 v17, s[44:47], s52 offen  lds
  s_add_u32 m0, s55, 86016
  s_nop 0
  buffer_load_dwordx4 v25, s[48:51], s53 offen lds
  s_add_u32 m0, s55, 24576
  s_nop 0
  buffer_load_dwordx4 v18, s[44:47], s52 offen  lds
  s_add_u32 m0, s55, 90112
  s_nop 0
  buffer_load_dwordx4 v26, s[48:51], s53 offen lds
  s_add_u32 m0, s55, 28672
  s_nop 0
  buffer_load_dwordx4 v19, s[44:47], s52 offen  lds
  s_add_u32 m0, s55, 94208
  s_nop 0
  buffer_load_dwordx4 v27, s[48:51], s53 offen lds
  s_add_u32 s52, s52, 128
  s_add_u32 s53, s53, s22
  s_add_u32 m0, s55, 32768
  s_nop 0
  buffer_load_dwordx4 v12, s[44:47], s52 offen  lds
  s_add_u32 m0, s55, 98304
  s_nop 0
  buffer_load_dwordx4 v20, s[48:51], s53 offen lds
  s_add_u32 m0, s55, 36864
  s_nop 0
  buffer_load_dwordx4 v13, s[44:47], s52 offen  lds
  s_add_u32 m0, s55, 102400
  s_nop 0
  buffer_load_dwordx4 v21, s[48:51], s53 offen lds
  s_add_u32 m0, s55, 40960
  s_nop 0
  buffer_load_dwordx4 v14, s[44:47], s52 offen  lds
  s_add_u32 m0, s55, 106496
  s_nop 0
  buffer_load_dwordx4 v22, s[48:51], s53 offen lds
  s_add_u32 m0, s55, 45056
  s_nop 0
  buffer_load_dwordx4 v15, s[44:47], s52 offen  lds
  s_add_u32 m0, s55, 110592
  s_nop 0
  buffer_load_dwordx4 v23, s[48:51], s53 offen lds
  s_add_u32 m0, s55, 49152
  s_nop 0
  buffer_load_dwordx4 v16, s[44:47], s52 offen  lds
  s_add_u32 m0, s55, 114688
  s_nop 0
  buffer_load_dwordx4 v24, s[48:51], s53 offen lds
  s_add_u32 m0, s55, 53248
  s_nop 0
  buffer_load_dwordx4 v17, s[44:47], s52 offen  lds
  s_add_u32 m0, s55, 118784
  s_nop 0
  buffer_load_dwordx4 v25, s[48:51], s53 offen lds
nodma4:
  v_and_b32 v30, 1, v29
  v_lshlrev_b32 v30, 5, v30
  v_lshrrev_b32 v160, 1, v29
  v_lshl_add_u32 v30, v160, 4, v30
  s_lshl_b32 s36, s61, 1
  s_add_u32 s36, s36, s57
  s_lshl_b32 s37, s27, 3
  s_add_u32 s37, s37, s56
  v_lshrrev_b32 v250, 2, v28
  v_and_b32 v251, 3, v28
  v_lshl_add_u32 v251, v250, 3, v251
  v_add_u32 v240, v28, v30
  v_lshlrev_b32 v240, 4, v240
  v_add_u32 v241, 131072, v240
  v_and_b32 v252, 1, v28
  v_lshl_add_u32 v252, v250, 1, v252
  v_lshlrev_b32 v252, 4, v252
  v_lshl_add_u32 v242, v30, 3, v252
  v_lshlrev_b32 v243, 4, v1
  v_add_u32 v244, 4096, v243
  v_mov_b32 v230, 0
  v_mov_b32 v249, 0xd028965f
  v_lshlrev_b32 v252, 3, v29
  v_sub_u32 v252, v28, v252
  s_lshl_b32 s58, s37, 18
  s_lshl_b32 s59, s36, 12
  s_add_u32 s30, s58, s59
  s_add_u32 s34, s30, 50331648
  s_add_u32 s30, s30, 0
  s_lshl_b32 s63, s36, 13
  s_add_u32 s32, s58, s63
  s_lshr_b32 s33, s32, 2
  s_add_u32 s32, s32, 16777216
  s_add_u32 s33, s33, 96468992
  s_lshl_b32 s31, s37, 16
  s_lshr_b32 s59, s59, 1
  s_add_u32 s31, s31, s59
  s_add_u32 s31, s31, 92274688
  s_lshl_b32 s35, s36, 7
  s_add_u32 s35, s35, 100679680
  v_mov_b32 v248, 0
  v_mov_b32 v229, 0
  s_mov_b32 s21, 1040356334
  v_mov_b32 v236, 0x3f803f80
  v_mov_b32 v237, 0x3f803f80
  v_mov_b32 v238, 0x3f803f80
  v_mov_b32 v239, 0x3f803f80
  v_cmp_le_i32 s[68:69], 0, v252
  v_cmp_le_i32 s[70:71], 1, v252
  v_cmp_le_i32 s[72:73], 2, v252
  v_cmp_le_i32 s[74:75], 3, v252
  v_cmp_le_i32 s[76:77], 4, v252
  v_cmp_le_i32 s[78:79], 5, v252
  v_cmp_le_i32 s[80:81], 6, v252
  v_cmp_le_i32 s[82:83], 7, v252
  v_cmp_le_i32 s[84:85], -16, v252
  v_cmp_le_i32 s[86:87], -15, v252
  v_cmp_le_i32 s[88:89], -14, v252
  v_cmp_le_i32 s[90:91], -13, v252
  v_cmp_le_i32 s[92:93], -12, v252
  v_cmp_le_i32 s[94:95], -11, v252
  v_cmp_le_i32 s[96:97], -10, v252
  v_cmp_le_i32 s[98:99], -9, v252
  v_min3_u32 v164, v164, v165, v166
  v_min_u32 v164, v164, v167
  v_cmp_gt_u32 vcc, 128, v168
  v_readfirstlane_b32 s20, v164
  s_cbranch_vccz pg_172_c
pg_172_r:
  s_sub_u32 s23, s23, 1
  s_cbranch_scc1 rec_exit
  buffer_load_dword v168, v248, s[40:43], 0 offen offset:36 sc1
  s_waitcnt vmcnt(0)
  v_cmp_gt_u32 vcc, 128, v168
  s_cbranch_vccnz pg_172_r
pg_172:
  s_sub_u32 s23, s23, 1
  s_cbranch_scc1 rec_exit
  buffer_load_dwordx4 v[184:187], v248, s[4:7], s35 offen sc1
  s_waitcnt vmcnt(0)
  v_min3_u32 v184, v184, v185, v186
  v_min_u32 v184, v184, v187
  s_nop 0
  v_readfirstlane_b32 s20, v184
pg_172_c:
  s_max_u32 s58, s37, 2
  s_cmp_lt_u32 s58, s20
  s_cbranch_scc1 pg_172_ok
  s_sleep 4
  s_branch pg_172
pg_172_ok:
  s_add_u32 s58, s30, 0
  buffer_load_dwordx4 v[64:67], v240, s[4:7], s58 offen offset:0 sc1
  buffer_load_dwordx4 v[68:71], v240, s[4:7], s58 offen offset:1024 sc1
  buffer_load_dwordx4 v[72:75], v240, s[4:7], s58 offen offset:2048 sc1
  buffer_load_dwordx4 v[76:79], v240, s[4:7], s58 offen offset:3072 sc1
  buffer_load_dwordx4 v[80:83], v241, s[4:7], s58 offen offset:0 sc1
  buffer_load_dwordx4 v[84:87], v241, s[4:7], s58 offen offset:1024 sc1
  buffer_load_dwordx4 v[88:91], v241, s[4:7], s58 offen offset:2048 sc1
  buffer_load_dwordx4 v[92:95], v241, s[4:7], s58 offen offset:3072 sc1
  buffer_load_dwordx4 v[96:99], v242, s[4:7], s31 offen offset:0 sc1
  buffer_load_dwordx4 v[100:103], v242, s[4:7], s31 offen offset:512 sc1
  buffer_load_dwordx4 v[104:107], v242, s[4:7], s31 offen offset:1024 sc1
  buffer_load_dwordx4 v[108:111], v242, s[4:7], s31 offen offset:1536 sc1
  s_add_u32 s58, s32, 0
  buffer_load_dwordx4 v[112:115], v243, s[4:7], s58 offen offset:0 sc1
  buffer_load_dwordx4 v[116:119], v243, s[4:7], s58 offen offset:1024 sc1
  buffer_load_dwordx4 v[120:123], v243, s[4:7], s58 offen offset:2048 sc1
  buffer_load_dwordx4 v[124:127], v243, s[4:7], s58 offen offset:3072 sc1
  buffer_load_dwordx4 v[128:131], v244, s[4:7], s58 offen offset:0 sc1
  buffer_load_dwordx4 v[132:135], v244, s[4:7], s58 offen offset:1024 sc1
  buffer_load_dwordx4 v[136:139], v244, s[4:7], s58 offen offset:2048 sc1
  buffer_load_dwordx4 v[140:143], v244, s[4:7], s58 offen offset:3072 sc1
  buffer_load_dwordx4 v[144:147], v243, s[4:7], s33 offen offset:0 sc1
  buffer_load_dwordx4 v[148:151], v243, s[4:7], s33 offen offset:1024 sc1
  v_accvgpr_read_b32 v184, a0
  v_accvgpr_read_b32 v185, a1
  v_accvgpr_read_b32 v186, a2
  v_accvgpr_read_b32 v187, a3
  v_accvgpr_read_b32 v188, a4
  v_accvgpr_read_b32 v189, a5
  v_accvgpr_read_b32 v190, a6
  v_accvgpr_read_b32 v191, a7
  v_cvt_pk_bf16_f32 v32, v184, v185
  v_cvt_pk_bf16_f32 v33, v186, v187
  v_cvt_pk_bf16_f32 v34, v188, v189
  v_cvt_pk_bf16_f32 v35, v190, v191
  s_nop 0
  v_permlane16_swap_b32 v32, v34
  v_permlane16_swap_b32 v33, v35
  v_accvgpr_read_b32 v184, a8
  v_accvgpr_read_b32 v185, a9
  v_accvgpr_read_b32 v186, a10
  v_accvgpr_read_b32 v187, a11
  v_accvgpr_read_b32 v188, a12
  v_accvgpr_read_b32 v189, a13
  v_accvgpr_read_b32 v190, a14
  v_accvgpr_read_b32 v191, a15
  v_cvt_pk_bf16_f32 v36, v184, v185
  v_cvt_pk_bf16_f32 v37, v186, v187
  v_cvt_pk_bf16_f32 v38, v188, v189
  v_cvt_pk_bf16_f32 v39, v190, v191
  s_nop 0
  v_permlane16_swap_b32 v36, v38
  v_permlane16_swap_b32 v37, v39
  v_accvgpr_read_b32 v184, a16
  v_accvgpr_read_b32 v185, a17
  v_accvgpr_read_b32 v186, a18
  v_accvgpr_read_b32 v187, a19
  v_accvgpr_read_b32 v188, a20
  v_accvgpr_read_b32 v189, a21
  v_accvgpr_read_b32 v190, a22
  v_accvgpr_read_b32 v191, a23
  v_cvt_pk_bf16_f32 v40, v184, v185
  v_cvt_pk_bf16_f32 v41, v186, v187
  v_cvt_pk_bf16_f32 v42, v188, v189
  v_cvt_pk_bf16_f32 v43, v190, v191
  s_nop 0
  v_permlane16_swap_b32 v40, v42
  v_permlane16_swap_b32 v41, v43
  v_accvgpr_read_b32 v184, a24
  v_accvgpr_read_b32 v185, a25
  v_accvgpr_read_b32 v186, a26
  v_accvgpr_read_b32 v187, a27
  v_accvgpr_read_b32 v188, a28
  v_accvgpr_read_b32 v189, a29
  v_accvgpr_read_b32 v190, a30
  v_accvgpr_read_b32 v191, a31
  v_cvt_pk_bf16_f32 v44, v184, v185
  v_cvt_pk_bf16_f32 v45, v186, v187
  v_cvt_pk_bf16_f32 v46, v188, v189
  v_cvt_pk_bf16_f32 v47, v190, v191
  s_nop 0
  v_permlane16_swap_b32 v44, v46
  v_permlane16_swap_b32 v45, v47
  v_accvgpr_read_b32 v184, a32
  v_accvgpr_read_b32 v185, a33
  v_accvgpr_read_b32 v186, a34
  v_accvgpr_read_b32 v187, a35
  v_accvgpr_read_b32 v188, a36
  v_accvgpr_read_b32 v189, a37
  v_accvgpr_read_b32 v190, a38
  v_accvgpr_read_b32 v191, a39
  v_cvt_pk_bf16_f32 v48, v184, v185
  v_cvt_pk_bf16_f32 v49, v186, v187
  v_cvt_pk_bf16_f32 v50, v188, v189
  v_cvt_pk_bf16_f32 v51, v190, v191
  s_nop 0
  v_permlane16_swap_b32 v48, v50
  v_permlane16_swap_b32 v49, v51
  v_accvgpr_read_b32 v184, a40
  v_accvgpr_read_b32 v185, a41
  v_accvgpr_read_b32 v186, a42
  v_accvgpr_read_b32 v187, a43
  v_accvgpr_read_b32 v188, a44
  v_accvgpr_read_b32 v189, a45
  v_accvgpr_read_b32 v190, a46
  v_accvgpr_read_b32 v191, a47
  v_cvt_pk_bf16_f32 v52, v184, v185
  v_cvt_pk_bf16_f32 v53, v186, v187
  v_cvt_pk_bf16_f32 v54, v188, v189
  v_cvt_pk_bf16_f32 v55, v190, v191
  s_nop 0
  v_permlane16_swap_b32 v52, v54
  v_permlane16_swap_b32 v53, v55
  v_accvgpr_read_b32 v184, a48
  v_accvgpr_read_b32 v185, a49
  v_accvgpr_read_b32 v186, a50
  v_accvgpr_read_b32 v187, a51
  v_accvgpr_read_b32 v188, a52
  v_accvgpr_read_b32 v189, a53
  v_accvgpr_read_b32 v190, a54
  v_accvgpr_read_b32 v191, a55
  v_cvt_pk_bf16_f32 v56, v184, v185
  v_cvt_pk_bf16_f32 v57, v186, v187
  v_cvt_pk_bf16_f32 v58, v188, v189
  v_cvt_pk_bf16_f32 v59, v190, v191
  s_nop 0
  v_permlane16_swap_b32 v56, v58
  v_permlane16_swap_b32 v57, v59
  v_accvgpr_read_b32 v184, a56
  v_accvgpr_read_b32 v185, a57
  v_accvgpr_read_b32 v186, a58
  v_accvgpr_read_b32 v187, a59
  v_accvgpr_read_b32 v188, a60
  v_accvgpr_read_b32 v189, a61
  v_accvgpr_read_b32 v190, a62
  v_accvgpr_read_b32 v191, a63
  v_cvt_pk_bf16_f32 v60, v184, v185
  v_cvt_pk_bf16_f32 v61, v186, v187
  v_cvt_pk_bf16_f32 v62, v188, v189
  v_cvt_pk_bf16_f32 v63, v190, v191
  s_nop 0
  v_permlane16_swap_b32 v60, v62
  v_permlane16_swap_b32 v61, v63
  s_add_u32 s58, s30, 524288
  buffer_load_dwordx4 a[0:3], v240, s[4:7], s58 offen offset:0 sc1
  buffer_load_dwordx4 a[4:7], v240, s[4:7], s58 offen offset:1024 sc1
  buffer_load_dwordx4 a[8:11], v240, s[4:7], s58 offen offset:2048 sc1
  buffer_load_dwordx4 a[12:15], v240, s[4:7], s58 offen offset:3072 sc1
  buffer_load_dwordx4 a[16:19], v241, s[4:7], s58 offen offset:0 sc1
  buffer_load_dwordx4 a[20:23], v241, s[4:7], s58 offen offset:1024 sc1
  buffer_load_dwordx4 a[24:27], v241, s[4:7], s58 offen offset:2048 sc1
  buffer_load_dwordx4 a[28:31], v241, s[4:7], s58 offen offset:3072 sc1
  s_waitcnt vmcnt(55)
  s_add_u32 s58, s32, 524288
  buffer_load_dwordx4 a[32:35], v243, s[4:7], s58 offen offset:0 sc1
  buffer_load_dwordx4 a[36:39], v243, s[4:7], s58 offen offset:1024 sc1
  buffer_load_dwordx4 a[40:43], v243, s[4:7], s58 offen offset:2048 sc1
  buffer_load_dwordx4 a[44:47], v243, s[4:7], s58 offen offset:3072 sc1
  buffer_load_dwordx4 a[48:51], v244, s[4:7], s58 offen offset:0 sc1
  buffer_load_dwordx4 a[52:55], v244, s[4:7], s58 offen offset:1024 sc1
  buffer_load_dwordx4 a[56:59], v244, s[4:7], s58 offen offset:2048 sc1
  buffer_load_dwordx4 a[60:63], v244, s[4:7], s58 offen offset:3072 sc1
  s_waitcnt vmcnt(26)
  v_mfma_f32_16x16x32_bf16 v[168:171], v[96:99], v[32:35], 0
  v_mfma_f32_16x16x32_bf16 v[180:183], v[96:99], v[48:51], 0
  v_mfma_f32_16x16x32_bf16 v[168:171], v[100:103], v[36:39], v[168:171]
  v_mfma_f32_16x16x32_bf16 v[180:183], v[100:103], v[52:55], v[180:183]
  v_mfma_f32_16x16x32_bf16 v[168:171], v[104:107], v[40:43], v[168:171]
  v_mfma_f32_16x16x32_bf16 v[180:183], v[104:107], v[56:59], v[180:183]
  v_mfma_f32_16x16x32_bf16 v[168:171], v[108:111], v[44:47], v[168:171]
  v_mfma_f32_16x16x32_bf16 v[180:183], v[108:111], v[60:63], v[180:183]
  v_mfma_f32_16x16x32_bf16 v[160:163], v[64:67], v[32:35], 0
  v_mfma_f32_16x16x32_bf16 v[164:167], v[80:83], v[32:35], 0
  v_mfma_f32_16x16x32_bf16 v[172:175], v[64:67], v[48:51], 0
  v_mfma_f32_16x16x32_bf16 v[176:179], v[80:83], v[48:51], 0
  s_add_u32 s31, s31, 131072
  s_add_u32 s33, s33, 131072
  buffer_load_dwordx4 v[96:99], v242, s[4:7], s31 offen offset:0 sc1
  buffer_load_dwordx4 v[100:103], v242, s[4:7], s31 offen offset:512 sc1
  buffer_load_dwordx4 v[104:107], v242, s[4:7], s31 offen offset:1024 sc1
  buffer_load_dwordx4 v[108:111], v242, s[4:7], s31 offen offset:1536 sc1
  buffer_load_dwordx4 v[152:155], v243, s[4:7], s33 offen offset:0 sc1
  buffer_load_dwordx4 v[156:159], v243, s[4:7], s33 offen offset:1024 sc1
  v_mfma_f32_16x16x32_bf16 v[160:163], v[68:71], v[36:39], v[160:163]
  v_mfma_f32_16x16x32_bf16 v[164:167], v[84:87], v[36:39], v[164:167]
  v_mfma_f32_16x16x32_bf16 v[172:175], v[68:71], v[52:55], v[172:175]
  v_mfma_f32_16x16x32_bf16 v[176:179], v[84:87], v[52:55], v[176:179]
  v_mfma_f32_16x16x32_bf16 v[160:163], v[72:75], v[40:43], v[160:163]
  v_mfma_f32_16x16x32_bf16 v[164:167], v[88:91], v[40:43], v[164:167]
  v_mfma_f32_16x16x32_bf16 v[172:175], v[72:75], v[56:59], v[172:175]
  v_mfma_f32_16x16x32_bf16 v[176:179], v[88:91], v[56:59], v[176:179]
  v_mfma_f32_16x16x32_bf16 v[160:163], v[76:79], v[44:47], v[160:163]
  v_mfma_f32_16x16x32_bf16 v[164:167], v[92:95], v[44:47], v[164:167]
  v_mfma_f32_16x16x32_bf16 v[172:175], v[76:79], v[60:63], v[172:175]
  v_mfma_f32_16x16x32_bf16 v[176:179], v[92:95], v[60:63], v[176:179]
  s_add_u32 s58, s30, 1048576
  buffer_load_dwordx4 v[64:67], v240, s[4:7], s58 offen offset:0 sc1
  buffer_load_dwordx4 v[68:71], v240, s[4:7], s58 offen offset:1024 sc1
  buffer_load_dwordx4 v[72:75], v240, s[4:7], s58 offen offset:2048 sc1
  buffer_load_dwordx4 v[76:79], v240, s[4:7], s58 offen offset:3072 sc1
  buffer_load_dwordx4 v[80:83], v241, s[4:7], s58 offen offset:0 sc1
  buffer_load_dwordx4 v[84:87], v241, s[4:7], s58 offen offset:1024 sc1
  buffer_load_dwordx4 v[88:91], v241, s[4:7], s58 offen offset:2048 sc1
  buffer_load_dwordx4 v[92:95], v241, s[4:7], s58 offen offset:3072 sc1
  s_nop 7
  v_cndmask_b32 v160, v249, v160, s[68:69]
  v_cndmask_b32 v161, v249, v161, s[70:71]
  v_cndmask_b32 v162, v249, v162, s[72:73]
  v_cndmask_b32 v163, v249, v163, s[74:75]
  v_cndmask_b32 v164, v249, v164, s[76:77]
  v_cndmask_b32 v165, v249, v165, s[78:79]
  v_cndmask_b32 v166, v249, v166, s[80:81]
  v_cndmask_b32 v167, v249, v167, s[82:83]
  v_max3_f32 v188, v160, v161, v162
  v_max3_f32 v189, v163, v164, v165
  v_max3_f32 v188, v166, v167, v188
  v_max3_f32 v189, v168, v169, v189
  v_max_f32 v188, v188, v189
  v_mov_b32 v189, v188
  s_nop 1
  v_permlane16_swap_b32 v188, v189
  s_nop 0
  v_max_f32 v188, v188, v189
  v_mov_b32 v189, v188
  s_nop 1
  v_permlane32_swap_b32 v188, v189
  s_nop 0
  v_max_f32 v188, v188, v189
  v_mul_f32 v188, s21, v188
  v_fma_f32 v160, v160, s21, -v188
  v_fma_f32 v161, v161, s21, -v188
  v_fma_f32 v162, v162, s21, -v188
  v_fma_f32 v163, v163, s21, -v188
  v_fma_f32 v164, v164, s21, -v188
  v_fma_f32 v165, v165, s21, -v188
  v_fma_f32 v166, v166, s21, -v188
  v_fma_f32 v167, v167, s21, -v188
  v_fma_f32 v168, v168, s21, -v188
  v_fma_f32 v169, v169, s21, -v188
  v_exp_f32 v160, v160
  v_exp_f32 v161, v161
  v_exp_f32 v162, v162
  v_exp_f32 v163, v163
  v_exp_f32 v164, v164
  v_exp_f32 v165, v165
  v_exp_f32 v166, v166
  v_exp_f32 v167, v167
  v_exp_f32 v168, v168
  v_exp_f32 v169, v169
  v_cvt_pk_bf16_f32 v224, v160, v161
  v_cvt_pk_bf16_f32 v225, v162, v163
  v_cvt_pk_bf16_f32 v226, v164, v165
  v_cvt_pk_bf16_f32 v227, v166, v167
  v_cvt_pk_bf16_f32 v228, v168, v169
  v_mov_b32 v231, v228
  s_waitcnt vmcnt(30)
  s_nop 0
  v_mfma_f32_16x16x32_bf16 v[232:235], v[236:239], v[224:227], 0
  v_mfma_f32_16x16x32_bf16 v[192:195], v[112:115], v[224:227], 0
  v_mfma_f32_16x16x32_bf16 v[196:199], v[116:119], v[224:227], 0
  v_mfma_f32_16x16x32_bf16 v[200:203], v[120:123], v[224:227], 0
  v_mfma_f32_16x16x32_bf16 v[204:207], v[124:127], v[224:227], 0
  v_mfma_f32_16x16x32_bf16 v[208:211], v[128:131], v[224:227], 0
  v_mfma_f32_16x16x32_bf16 v[212:215], v[132:135], v[224:227], 0
  v_mfma_f32_16x16x32_bf16 v[216:219], v[136:139], v[224:227], 0
  v_mfma_f32_16x16x32_bf16 v[220:223], v[140:143], v[224:227], 0
  v_mfma_f32_16x16x16_bf16 v[232:235], v[236:237], v[228:229], v[232:235]
  v_mfma_f32_16x16x16_bf16 v[192:195], v[144:145], v[228:229], v[192:195]
  v_mfma_f32_16x16x16_bf16 v[196:199], v[144:145], v[230:231], v[196:199]
  v_mfma_f32_16x16x16_bf16 v[200:203], v[146:147], v[228:229], v[200:203]
  v_mfma_f32_16x16x16_bf16 v[204:207], v[146:147], v[230:231], v[204:207]
  v_mfma_f32_16x16x16_bf16 v[208:211], v[148:149], v[228:229], v[208:211]
  v_mfma_f32_16x16x16_bf16 v[212:215], v[148:149], v[230:231], v[212:215]
  v_mfma_f32_16x16x16_bf16 v[216:219], v[150:151], v[228:229], v[216:219]
  v_mfma_f32_16x16x16_bf16 v[220:223], v[150:151], v[230:231], v[220:223]
  v_rcp_f32 v232, v232
  s_nop 0
  v_pk_mul_f32 v[192:193], v[192:193], v[232:233] op_sel_hi:[1,0]
  v_pk_mul_f32 v[194:195], v[194:195], v[232:233] op_sel_hi:[1,0]
  v_pk_mul_f32 v[196:197], v[196:197], v[232:233] op_sel_hi:[1,0]
  v_pk_mul_f32 v[198:199], v[198:199], v[232:233] op_sel_hi:[1,0]
  v_cvt_pk_bf16_f32 v252, v192, v193
  v_cvt_pk_bf16_f32 v253, v194, v195
  v_cvt_pk_bf16_f32 v254, v196, v197
  v_cvt_pk_bf16_f32 v255, v198, v199
  s_nop 0
  v_permlane16_swap_b32 v252, v254
  v_permlane16_swap_b32 v253, v255
  buffer_store_dwordx4 v[252:255], v240, s[4:7], s34 offen offset:0 sc1
  v_pk_mul_f32 v[200:201], v[200:201], v[232:233] op_sel_hi:[1,0]
  v_pk_mul_f32 v[202:203], v[202:203], v[232:233] op_sel_hi:[1,0]
  v_pk_mul_f32 v[204:205], v[204:205], v[232:233] op_sel_hi:[1,0]
  v_pk_mul_f32 v[206:207], v[206:207], v[232:233] op_sel_hi:[1,0]
  v_cvt_pk_bf16_f32 v184, v200, v201
  v_cvt_pk_bf16_f32 v185, v202, v203
  v_cvt_pk_bf16_f32 v186, v204, v205
  v_cvt_pk_bf16_f32 v187, v206, v207
  s_nop 0
  v_permlane16_swap_b32 v184, v186
  v_permlane16_swap_b32 v185, v187
  buffer_store_dwordx4 v[184:187], v240, s[4:7], s34 offen offset:1024 sc1
  v_pk_mul_f32 v[208:209], v[208:209], v[232:233] op_sel_hi:[1,0]
  v_pk_mul_f32 v[210:211], v[210:211], v[232:233] op_sel_hi:[1,0]
  v_pk_mul_f32 v[212:213], v[212:213], v[232:233] op_sel_hi:[1,0]
  v_pk_mul_f32 v[214:215], v[214:215], v[232:233] op_sel_hi:[1,0]
  v_cvt_pk_bf16_f32 v252, v208, v209
  v_cvt_pk_bf16_f32 v253, v210, v211
  v_cvt_pk_bf16_f32 v254, v212, v213
  v_cvt_pk_bf16_f32 v255, v214, v215
  s_nop 0
  v_permlane16_swap_b32 v252, v254
  v_permlane16_swap_b32 v253, v255
  buffer_store_dwordx4 v[252:255], v240, s[4:7], s34 offen offset:2048 sc1
  v_pk_mul_f32 v[216:217], v[216:217], v[232:233] op_sel_hi:[1,0]
  v_pk_mul_f32 v[218:219], v[218:219], v[232:233] op_sel_hi:[1,0]
  v_pk_mul_f32 v[220:221], v[220:221], v[232:233] op_sel_hi:[1,0]
  v_pk_mul_f32 v[222:223], v[222:223], v[232:233] op_sel_hi:[1,0]
  v_cvt_pk_bf16_f32 v184, v216, v217
  v_cvt_pk_bf16_f32 v185, v218, v219
  v_cvt_pk_bf16_f32 v186, v220, v221
  v_cvt_pk_bf16_f32 v187, v222, v223
  s_nop 0
  v_permlane16_swap_b32 v184, v186
  v_permlane16_swap_b32 v185, v187
  buffer_store_dwordx4 v[184:187], v240, s[4:7], s34 offen offset:3072 sc1
  v_cndmask_b32 v172, v249, v172, s[84:85]
  v_cndmask_b32 v173, v249, v173, s[86:87]
  v_cndmask_b32 v174, v249, v174, s[88:89]
  v_cndmask_b32 v175, v249, v175, s[90:91]
  v_cndmask_b32 v176, v249, v176, s[92:93]
  v_cndmask_b32 v177, v249, v177, s[94:95]
  v_cndmask_b32 v178, v249, v178, s[96:97]
  v_cndmask_b32 v179, v249, v179, s[98:99]
  v_max3_f32 v188, v172, v173, v174
  v_max3_f32 v189, v175, v176, v177
  v_max3_f32 v188, v178, v179, v188
  v_max3_f32 v189, v180, v181, v189
  v_max_f32 v188, v188, v189
  v_mov_b32 v189, v188
  s_nop 1
  v_permlane16_swap_b32 v188, v189
  s_nop 0
  v_max_f32 v188, v188, v189
  v_mov_b32 v189, v188
  s_nop 1
  v_permlane32_swap_b32 v188, v189
  s_nop 0
  v_max_f32 v188, v188, v189
  v_mul_f32 v188, s21, v188
  v_fma_f32 v172, v172, s21, -v188
  v_fma_f32 v173, v173, s21, -v188
  v_fma_f32 v174, v174, s21, -v188
  v_fma_f32 v175, v175, s21, -v188
  v_fma_f32 v176, v176, s21, -v188
  v_fma_f32 v177, v177, s21, -v188
  v_fma_f32 v178, v178, s21, -v188
  v_fma_f32 v179, v179, s21, -v188
  v_fma_f32 v180, v180, s21, -v188
  v_fma_f32 v181, v181, s21, -v188
  v_exp_f32 v172, v172
  v_exp_f32 v173, v173
  v_exp_f32 v174, v174
  v_exp_f32 v175, v175
  v_exp_f32 v176, v176
  v_exp_f32 v177, v177
  v_exp_f32 v178, v178
  v_exp_f32 v179, v179
  v_exp_f32 v180, v180
  v_exp_f32 v181, v181
  v_cvt_pk_bf16_f32 v224, v172, v173
  v_cvt_pk_bf16_f32 v225, v174, v175
  v_cvt_pk_bf16_f32 v226, v176, v177
  v_cvt_pk_bf16_f32 v227, v178, v179
  v_cvt_pk_bf16_f32 v228, v180, v181
  v_mov_b32 v231, v228
  s_nop 0
  v_mfma_f32_16x16x32_bf16 v[232:235], v[236:239], v[224:227], 0
  v_mfma_f32_16x16x32_bf16 v[192:195], v[112:115], v[224:227], 0
  v_mfma_f32_16x16x32_bf16 v[196:199], v[116:119], v[224:227], 0
  v_mfma_f32_16x16x32_bf16 v[200:203], v[120:123], v[224:227], 0
  v_mfma_f32_16x16x32_bf16 v[204:207], v[124:127], v[224:227], 0
  v_mfma_f32_16x16x32_bf16 v[208:211], v[128:131], v[224:227], 0
  v_mfma_f32_16x16x32_bf16 v[212:215], v[132:135], v[224:227], 0
  v_mfma_f32_16x16x32_bf16 v[216:219], v[136:139], v[224:227], 0
  v_mfma_f32_16x16x32_bf16 v[220:223], v[140:143], v[224:227], 0
  v_mfma_f32_16x16x16_bf16 v[232:235], v[236:237], v[228:229], v[232:235]
  v_mfma_f32_16x16x16_bf16 v[192:195], v[144:145], v[228:229], v[192:195]
  v_mfma_f32_16x16x16_bf16 v[196:199], v[144:145], v[230:231], v[196:199]
  v_mfma_f32_16x16x16_bf16 v[200:203], v[146:147], v[228:229], v[200:203]
  v_mfma_f32_16x16x16_bf16 v[204:207], v[146:147], v[230:231], v[204:207]
  v_mfma_f32_16x16x16_bf16 v[208:211], v[148:149], v[228:229], v[208:211]
  v_mfma_f32_16x16x16_bf16 v[212:215], v[148:149], v[230:231], v[212:215]
  v_mfma_f32_16x16x16_bf16 v[216:219], v[150:151], v[228:229], v[216:219]
  v_mfma_f32_16x16x16_bf16 v[220:223], v[150:151], v[230:231], v[220:223]
  s_add_u32 s58, s32, 1048576
  buffer_load_dwordx4 v[112:115], v243, s[4:7], s58 offen offset:0 sc1
  buffer_load_dwordx4 v[116:119], v243, s[4:7], s58 offen offset:1024 sc1
  buffer_load_dwordx4 v[120:123], v243, s[4:7], s58 offen offset:2048 sc1
  buffer_load_dwordx4 v[124:127], v243, s[4:7], s58 offen offset:3072 sc1
  buffer_load_dwordx4 v[128:131], v244, s[4:7], s58 offen offset:0 sc1
  buffer_load_dwordx4 v[132:135], v244, s[4:7], s58 offen offset:1024 sc1
  buffer_load_dwordx4 v[136:139], v244, s[4:7], s58 offen offset:2048 sc1
  buffer_load_dwordx4 v[140:143], v244, s[4:7], s58 offen offset:3072 sc1
  v_rcp_f32 v232, v232
  s_nop 0
  v_pk_mul_f32 v[192:193], v[192:193], v[232:233] op_sel_hi:[1,0]
  v_pk_mul_f32 v[194:195], v[194:195], v[232:233] op_sel_hi:[1,0]
  v_pk_mul_f32 v[196:197], v[196:197], v[232:233] op_sel_hi:[1,0]
  v_pk_mul_f32 v[198:199], v[198:199], v[232:233] op_sel_hi:[1,0]
  v_cvt_pk_bf16_f32 v252, v192, v193
  v_cvt_pk_bf16_f32 v253, v194, v195
  v_cvt_pk_bf16_f32 v254, v196, v197
  v_cvt_pk_bf16_f32 v255, v198, v199
  s_nop 0
  v_permlane16_swap_b32 v252, v254
  v_permlane16_swap_b32 v253, v255
  buffer_store_dwordx4 v[252:255], v241, s[4:7], s34 offen offset:0 sc1
  v_pk_mul_f32 v[200:201], v[200:201], v[232:233] op_sel_hi:[1,0]
  v_pk_mul_f32 v[202:203], v[202:203], v[232:233] op_sel_hi:[1,0]
  v_pk_mul_f32 v[204:205], v[204:205], v[232:233] op_sel_hi:[1,0]
  v_pk_mul_f32 v[206:207], v[206:207], v[232:233] op_sel_hi:[1,0]
  v_cvt_pk_bf16_f32 v184, v200, v201
  v_cvt_pk_bf16_f32 v185, v202, v203
  v_cvt_pk_bf16_f32 v186, v204, v205
  v_cvt_pk_bf16_f32 v187, v206, v207
  s_nop 0
  v_permlane16_swap_b32 v184, v186
  v_permlane16_swap_b32 v185, v187
  buffer_store_dwordx4 v[184:187], v241, s[4:7], s34 offen offset:1024 sc1
  v_pk_mul_f32 v[208:209], v[208:209], v[232:233] op_sel_hi:[1,0]
  v_pk_mul_f32 v[210:211], v[210:211], v[232:233] op_sel_hi:[1,0]
  v_pk_mul_f32 v[212:213], v[212:213], v[232:233] op_sel_hi:[1,0]
  v_pk_mul_f32 v[214:215], v[214:215], v[232:233] op_sel_hi:[1,0]
  v_cvt_pk_bf16_f32 v252, v208, v209
  v_cvt_pk_bf16_f32 v253, v210, v211
  v_cvt_pk_bf16_f32 v254, v212, v213
  v_cvt_pk_bf16_f32 v255, v214, v215
  s_nop 0
  v_permlane16_swap_b32 v252, v254
  v_permlane16_swap_b32 v253, v255
  buffer_store_dwordx4 v[252:255], v241, s[4:7], s34 offen offset:2048 sc1
  v_pk_mul_f32 v[216:217], v[216:217], v[232:233] op_sel_hi:[1,0]
  v_pk_mul_f32 v[218:219], v[218:219], v[232:233] op_sel_hi:[1,0]
  v_pk_mul_f32 v[220:221], v[220:221], v[232:233] op_sel_hi:[1,0]
  v_pk_mul_f32 v[222:223], v[222:223], v[232:233] op_sel_hi:[1,0]
  v_cvt_pk_bf16_f32 v184, v216, v217
  v_cvt_pk_bf16_f32 v185, v218, v219
  v_cvt_pk_bf16_f32 v186, v220, v221
  v_cvt_pk_bf16_f32 v187, v222, v223
  s_nop 0
  v_permlane16_swap_b32 v184, v186
  v_permlane16_swap_b32 v185, v187
  buffer_store_dwordx4 v[184:187], v241, s[4:7], s34 offen offset:3072 sc1
  s_cmp_lt_u32 s37, 48
  s_cbranch_scc1 pg_172_ns
  s_lshl_b32 s38, s37, 2
  s_mov_b32 s39, 1
  s_waitcnt vmcnt(0)
  s_cmp_eq_u32 s38, 0
  s_cbranch_scc1 fr_173
  v_mov_b32 v160, s39
  v_mov_b32 v161, s38
  s_mov_b64 exec, 1
  buffer_atomic_add v160, v161, s[40:43], 0 offen sc1
  s_mov_b64 exec, -1
  s_mov_b32 s38, 0
fr_173:
pg_172_ns:
  s_add_u32 s34, s34, 524288
  s_add_u32 s37, s37, 2
  v_accvgpr_read_b32 v184, a64
  v_accvgpr_read_b32 v185, a65
  v_accvgpr_read_b32 v186, a66
  v_accvgpr_read_b32 v187, a67
  v_accvgpr_read_b32 v188, a68
  v_accvgpr_read_b32 v189, a69
  v_accvgpr_read_b32 v190, a70
  v_accvgpr_read_b32 v191, a71
  v_cvt_pk_bf16_f32 v32, v184, v185
  v_cvt_pk_bf16_f32 v33, v186, v187
  v_cvt_pk_bf16_f32 v34, v188, v189
  v_cvt_pk_bf16_f32 v35, v190, v191
  s_nop 0
  v_permlane16_swap_b32 v32, v34
  v_permlane16_swap_b32 v33, v35
  v_accvgpr_read_b32 v184, a72
  v_accvgpr_read_b32 v185, a73
  v_accvgpr_read_b32 v186, a74
  v_accvgpr_read_b32 v187, a75
  v_accvgpr_read_b32 v188, a76
  v_accvgpr_read_b32 v189, a77
  v_accvgpr_read_b32 v190, a78
  v_accvgpr_read_b32 v191, a79
  v_cvt_pk_bf16_f32 v36, v184, v185
  v_cvt_pk_bf16_f32 v37, v186, v187
  v_cvt_pk_bf16_f32 v38, v188, v189
  v_cvt_pk_bf16_f32 v39, v190, v191
  s_nop 0
  v_permlane16_swap_b32 v36, v38
  v_permlane16_swap_b32 v37, v39
  v_accvgpr_read_b32 v184, a80
  v_accvgpr_read_b32 v185, a81
  v_accvgpr_read_b32 v186, a82
  v_accvgpr_read_b32 v187, a83
  v_accvgpr_read_b32 v188, a84
  v_accvgpr_read_b32 v189, a85
  v_accvgpr_read_b32 v190, a86
  v_accvgpr_read_b32 v191, a87
  v_cvt_pk_bf16_f32 v40, v184, v185
  v_cvt_pk_bf16_f32 v41, v186, v187
  v_cvt_pk_bf16_f32 v42, v188, v189
  v_cvt_pk_bf16_f32 v43, v190, v191
  s_nop 0
  v_permlane16_swap_b32 v40, v42
  v_permlane16_swap_b32 v41, v43
  v_accvgpr_read_b32 v184, a88
  v_accvgpr_read_b32 v185, a89
  v_accvgpr_read_b32 v186, a90
  v_accvgpr_read_b32 v187, a91
  v_accvgpr_read_b32 v188, a92
  v_accvgpr_read_b32 v189, a93
  v_accvgpr_read_b32 v190, a94
  v_accvgpr_read_b32 v191, a95
  v_cvt_pk_bf16_f32 v44, v184, v185
  v_cvt_pk_bf16_f32 v45, v186, v187
  v_cvt_pk_bf16_f32 v46, v188, v189
  v_cvt_pk_bf16_f32 v47, v190, v191
  s_nop 0
  v_permlane16_swap_b32 v44, v46
  v_permlane16_swap_b32 v45, v47
  v_accvgpr_read_b32 v184, a96
  v_accvgpr_read_b32 v185, a97
  v_accvgpr_read_b32 v186, a98
  v_accvgpr_read_b32 v187, a99
  v_accvgpr_read_b32 v188, a100
  v_accvgpr_read_b32 v189, a101
  v_accvgpr_read_b32 v190, a102
  v_accvgpr_read_b32 v191, a103
  v_cvt_pk_bf16_f32 v48, v184, v185
  v_cvt_pk_bf16_f32 v49, v186, v187
  v_cvt_pk_bf16_f32 v50, v188, v189
  v_cvt_pk_bf16_f32 v51, v190, v191
  s_nop 0
  v_permlane16_swap_b32 v48, v50
  v_permlane16_swap_b32 v49, v51
  v_accvgpr_read_b32 v184, a104
  v_accvgpr_read_b32 v185, a105
  v_accvgpr_read_b32 v186, a106
  v_accvgpr_read_b32 v187, a107
  v_accvgpr_read_b32 v188, a108
  v_accvgpr_read_b32 v189, a109
  v_accvgpr_read_b32 v190, a110
  v_accvgpr_read_b32 v191, a111
  v_cvt_pk_bf16_f32 v52, v184, v185
  v_cvt_pk_bf16_f32 v53, v186, v187
  v_cvt_pk_bf16_f32 v54, v188, v189
  v_cvt_pk_bf16_f32 v55, v190, v191
  s_nop 0
  v_permlane16_swap_b32 v52, v54
  v_permlane16_swap_b32 v53, v55
  v_accvgpr_read_b32 v184, a112
  v_accvgpr_read_b32 v185, a113
  v_accvgpr_read_b32 v186, a114
  v_accvgpr_read_b32 v187, a115
  v_accvgpr_read_b32 v188, a116
  v_accvgpr_read_b32 v189, a117
  v_accvgpr_read_b32 v190, a118
  v_accvgpr_read_b32 v191, a119
  v_cvt_pk_bf16_f32 v56, v184, v185
  v_cvt_pk_bf16_f32 v57, v186, v187
  v_cvt_pk_bf16_f32 v58, v188, v189
  v_cvt_pk_bf16_f32 v59, v190, v191
  s_nop 0
  v_permlane16_swap_b32 v56, v58
  v_permlane16_swap_b32 v57, v59
  v_accvgpr_read_b32 v184, a120
  v_accvgpr_read_b32 v185, a121
  v_accvgpr_read_b32 v186, a122
  v_accvgpr_read_b32 v187, a123
  v_accvgpr_read_b32 v188, a124
  v_accvgpr_read_b32 v189, a125
  v_accvgpr_read_b32 v190, a126
  v_accvgpr_read_b32 v191, a127
  v_cvt_pk_bf16_f32 v60, v184, v185
  v_cvt_pk_bf16_f32 v61, v186, v187
  v_cvt_pk_bf16_f32 v62, v188, v189
  v_cvt_pk_bf16_f32 v63, v190, v191
  s_nop 0
  v_permlane16_swap_b32 v60, v62
  v_permlane16_swap_b32 v61, v63
  s_add_u32 s58, s30, 1572864
  buffer_load_dwordx4 a[64:67], v240, s[4:7], s58 offen offset:0 sc1
  buffer_load_dwordx4 a[68:71], v240, s[4:7], s58 offen offset:1024 sc1
  buffer_load_dwordx4 a[72:75], v240, s[4:7], s58 offen offset:2048 sc1
  buffer_load_dwordx4 a[76:79], v240, s[4:7], s58 offen offset:3072 sc1
  buffer_load_dwordx4 a[80:83], v241, s[4:7], s58 offen offset:0 sc1
  buffer_load_dwordx4 a[84:87], v241, s[4:7], s58 offen offset:1024 sc1
  buffer_load_dwordx4 a[88:91], v241, s[4:7], s58 offen offset:2048 sc1
  buffer_load_dwordx4 a[92:95], v241, s[4:7], s58 offen offset:3072 sc1
  s_add_u32 s58, s32, 1572864
  buffer_load_dwordx4 a[96:99], v243, s[4:7], s58 offen offset:0 sc1
  buffer_load_dwordx4 a[100:103], v243, s[4:7], s58 offen offset:1024 sc1
  buffer_load_dwordx4 a[104:107], v243, s[4:7], s58 offen offset:2048 sc1
  buffer_load_dwordx4 a[108:111], v243, s[4:7], s58 offen offset:3072 sc1
  buffer_load_dwordx4 a[112:115], v244, s[4:7], s58 offen offset:0 sc1
  buffer_load_dwordx4 a[116:119], v244, s[4:7], s58 offen offset:1024 sc1
  buffer_load_dwordx4 a[120:123], v244, s[4:7], s58 offen offset:2048 sc1
  buffer_load_dwordx4 a[124:127], v244, s[4:7], s58 offen offset:3072 sc1
  s_cmp_lt_u32 s37, s20
  s_cbranch_scc1 pg_174_kn
pg_174:
  s_sub_u32 s23, s23, 1
  s_cbranch_scc1 rec_exit
  buffer_load_dwordx4 v[184:187], v248, s[4:7], s35 offen sc1
  s_waitcnt vmcnt(0)
  v_min3_u32 v184, v184, v185, v186
  v_min_u32 v184, v184, v187
  s_nop 0
  v_readfirstlane_b32 s20, v184
pg_174_c:
  s_max_u32 s58, s37, 2
  s_cmp_lt_u32 s58, s20
  s_cbranch_scc1 pg_174_ok
  s_sleep 4
  s_branch pg_174
pg_174_ok:
  buffer_load_dwordx4 v[96:99], v242, s[4:7], s31 offen offset:0 sc1
  buffer_load_dwordx4 v[100:103], v242, s[4:7], s31 offen offset:512 sc1
  buffer_load_dwordx4 v[104:107], v242, s[4:7], s31 offen offset:1024 sc1
  buffer_load_dwordx4 v[108:111], v242, s[4:7], s31 offen offset:1536 sc1
  buffer_load_dwordx4 v[152:155], v243, s[4:7], s33 offen offset:0 sc1
  buffer_load_dwordx4 v[156:159], v243, s[4:7], s33 offen offset:1024 sc1
  s_waitcnt vmcnt(0)
pg_174_kn:
  s_waitcnt vmcnt(42)
  v_mfma_f32_16x16x32_bf16 v[168:171], v[96:99], v[32:35], 0
  v_mfma_f32_16x16x32_bf16 v[180:183], v[96:99], v[48:51], 0
  v_mfma_f32_16x16x32_bf16 v[168:171], v[100:103], v[36:39], v[168:171]
  v_mfma_f32_16x16x32_bf16 v[180:183], v[100:103], v[52:55], v[180:183]
  v_mfma_f32_16x16x32_bf16 v[168:171], v[104:107], v[40:43], v[168:171]
  v_mfma_f32_16x16x32_bf16 v[180:183], v[104:107], v[56:59], v[180:183]
  v_mfma_f32_16x16x32_bf16 v[168:171], v[108:111], v[44:47], v[168:171]
  v_mfma_f32_16x16x32_bf16 v[180:183], v[108:111], v[60:63], v[180:183]
  v_mfma_f32_16x16x32_bf16 v[160:163], a[0:3], v[32:35], 0
  v_mfma_f32_16x16x32_bf16 v[164:167], a[16:19], v[32:35], 0
  v_mfma_f32_16x16x32_bf16 v[172:175], a[0:3], v[48:51], 0
  v_mfma_f32_16x16x32_bf16 v[176:179], a[16:19], v[48:51], 0
  s_add_u32 s31, s31, 131072
  s_add_u32 s33, s33, 131072
  buffer_load_dwordx4 v[96:99], v242, s[4:7], s31 offen offset:0 sc1
  buffer_load_dwordx4 v[100:103], v242, s[4:7], s31 offen offset:512 sc1
  buffer_load_dwordx4 v[104:107], v242, s[4:7], s31 offen offset:1024 sc1
  buffer_load_dwordx4 v[108:111], v242, s[4:7], s31 offen offset:1536 sc1
  buffer_load_dwordx4 v[144:147], v243, s[4:7], s33 offen offset:0 sc1
  buffer_load_dwordx4 v[148:151], v243, s[4:7], s33 offen offset:1024 sc1
  v_mfma_f32_16x16x32_bf16 v[160:163], a[4:7], v[36:39], v[160:163]
  v_mfma_f32_16x16x32_bf16 v[164:167], a[20:23], v[36:39], v[164:167]
  v_mfma_f32_16x16x32_bf16 v[172:175], a[4:7], v[52:55], v[172:175]
  v_mfma_f32_16x16x32_bf16 v[176:179], a[20:23], v[52:55], v[176:179]
  v_mfma_f32_16x16x32_bf16 v[160:163], a[8:11], v[40:43], v[160:163]
  v_mfma_f32_16x16x32_bf16 v[164:167], a[24:27], v[40:43], v[164:167]
  v_mfma_f32_16x16x32_bf16 v[172:175], a[8:11], v[56:59], v[172:175]
  v_mfma_f32_16x16x32_bf16 v[176:179], a[24:27], v[56:59], v[176:179]
  v_mfma_f32_16x16x32_bf16 v[160:163], a[12:15], v[44:47], v[160:163]
  v_mfma_f32_16x16x32_bf16 v[164:167], a[28:31], v[44:47], v[164:167]
  v_mfma_f32_16x16x32_bf16 v[172:175], a[12:15], v[60:63], v[172:175]
  v_mfma_f32_16x16x32_bf16 v[176:179], a[28:31], v[60:63], v[176:179]
  s_nop 7
  v_cndmask_b32 v160, v249, v160, s[68:69]
  v_cndmask_b32 v161, v249, v161, s[70:71]
  v_cndmask_b32 v162, v249, v162, s[72:73]
  v_cndmask_b32 v163, v249, v163, s[74:75]
  v_cndmask_b32 v164, v249, v164, s[76:77]
  v_cndmask_b32 v165, v249, v165, s[78:79]
  v_cndmask_b32 v166, v249, v166, s[80:81]
  v_cndmask_b32 v167, v249, v167, s[82:83]
  v_max3_f32 v188, v160, v161, v162
  v_max3_f32 v189, v163, v164, v165
  v_max3_f32 v188, v166, v167, v188
  v_max3_f32 v189, v168, v169, v189
  v_max_f32 v188, v188, v189
  v_mov_b32 v189, v188
  s_nop 1
  v_permlane16_swap_b32 v188, v189
  s_nop 0
  v_max_f32 v188, v188, v189
  v_mov_b32 v189, v188
  s_nop 1
  v_permlane32_swap_b32 v188, v189
  s_nop 0
  v_max_f32 v188, v188, v189
  v_mul_f32 v188, s21, v188
  v_fma_f32 v160, v160, s21, -v188
  v_fma_f32 v161, v161, s21, -v188
  v_fma_f32 v162, v162, s21, -v188
  v_fma_f32 v163, v163, s21, -v188
  v_fma_f32 v164, v164, s21, -v188
  v_fma_f32 v165, v165, s21, -v188
  v_fma_f32 v166, v166, s21, -v188
  v_fma_f32 v167, v167, s21, -v188
  v_fma_f32 v168, v168, s21, -v188
  v_fma_f32 v169, v169, s21, -v188
  v_exp_f32 v160, v160
  v_exp_f32 v161, v161
  v_exp_f32 v162, v162
  v_exp_f32 v163, v163
  v_exp_f32 v164, v164
  v_exp_f32 v165, v165
  v_exp_f32 v166, v166
  v_exp_f32 v167, v167
  v_exp_f32 v168, v168
  v_exp_f32 v169, v169
  v_cvt_pk_bf16_f32 v224, v160, v161
  v_cvt_pk_bf16_f32 v225, v162, v163
  v_cvt_pk_bf16_f32 v226, v164, v165
  v_cvt_pk_bf16_f32 v227, v166, v167
  v_cvt_pk_bf16_f32 v228, v168, v169
  v_mov_b32 v231, v228
  s_waitcnt vmcnt(46)
  s_nop 0
  v_mfma_f32_16x16x32_bf16 v[232:235], v[236:239], v[224:227], 0
  v_mfma_f32_16x16x32_bf16 v[192:195], a[32:35], v[224:227], 0
  v_mfma_f32_16x16x32_bf16 v[196:199], a[36:39], v[224:227], 0
  v_mfma_f32_16x16x32_bf16 v[200:203], a[40:43], v[224:227], 0
  v_mfma_f32_16x16x32_bf16 v[204:207], a[44:47], v[224:227], 0
  v_mfma_f32_16x16x32_bf16 v[208:211], a[48:51], v[224:227], 0
  v_mfma_f32_16x16x32_bf16 v[212:215], a[52:55], v[224:227], 0
  v_mfma_f32_16x16x32_bf16 v[216:219], a[56:59], v[224:227], 0
  v_mfma_f32_16x16x32_bf16 v[220:223], a[60:63], v[224:227], 0
  v_mfma_f32_16x16x16_bf16 v[232:235], v[236:237], v[228:229], v[232:235]
  v_mfma_f32_16x16x16_bf16 v[192:195], v[152:153], v[228:229], v[192:195]
  v_mfma_f32_16x16x16_bf16 v[196:199], v[152:153], v[230:231], v[196:199]
  v_mfma_f32_16x16x16_bf16 v[200:203], v[154:155], v[228:229], v[200:203]
  v_mfma_f32_16x16x16_bf16 v[204:207], v[154:155], v[230:231], v[204:207]
  v_mfma_f32_16x16x16_bf16 v[208:211], v[156:157], v[228:229], v[208:211]
  v_mfma_f32_16x16x16_bf16 v[212:215], v[156:157], v[230:231], v[212:215]
  v_mfma_f32_16x16x16_bf16 v[216:219], v[158:159], v[228:229], v[216:219]
  v_mfma_f32_16x16x16_bf16 v[220:223], v[158:159], v[230:231], v[220:223]
  v_rcp_f32 v232, v232
  s_nop 0
  v_pk_mul_f32 v[192:193], v[192:193], v[232:233] op_sel_hi:[1,0]
  v_pk_mul_f32 v[194:195], v[194:195], v[232:233] op_sel_hi:[1,0]
  v_pk_mul_f32 v[196:197], v[196:197], v[232:233] op_sel_hi:[1,0]
  v_pk_mul_f32 v[198:199], v[198:199], v[232:233] op_sel_hi:[1,0]
  v_cvt_pk_bf16_f32 v252, v192, v193
  v_cvt_pk_bf16_f32 v253, v194, v195
  v_cvt_pk_bf16_f32 v254, v196, v197
  v_cvt_pk_bf16_f32 v255, v198, v199
  s_nop 0
  v_permlane16_swap_b32 v252, v254
  v_permlane16_swap_b32 v253, v255
  buffer_store_dwordx4 v[252:255], v240, s[4:7], s34 offen offset:0 sc1
  v_pk_mul_f32 v[200:201], v[200:201], v[232:233] op_sel_hi:[1,0]
  v_pk_mul_f32 v[202:203], v[202:203], v[232:233] op_sel_hi:[1,0]
  v_pk_mul_f32 v[204:205], v[204:205], v[232:233] op_sel_hi:[1,0]
  v_pk_mul_f32 v[206:207], v[206:207], v[232:233] op_sel_hi:[1,0]
  v_cvt_pk_bf16_f32 v184, v200, v201
  v_cvt_pk_bf16_f32 v185, v202, v203
  v_cvt_pk_bf16_f32 v186, v204, v205
  v_cvt_pk_bf16_f32 v187, v206, v207
  s_nop 0
  v_permlane16_swap_b32 v184, v186
  v_permlane16_swap_b32 v185, v187
  buffer_store_dwordx4 v[184:187], v240, s[4:7], s34 offen offset:1024 sc1
  v_pk_mul_f32 v[208:209], v[208:209], v[232:233] op_sel_hi:[1,0]
  v_pk_mul_f32 v[210:211], v[210:211], v[232:233] op_sel_hi:[1,0]
  v_pk_mul_f32 v[212:213], v[212:213], v[232:233] op_sel_hi:[1,0]
  v_pk_mul_f32 v[214:215], v[214:215], v[232:233] op_sel_hi:[1,0]
  v_cvt_pk_bf16_f32 v252, v208, v209
  v_cvt_pk_bf16_f32 v253, v210, v211
  v_cvt_pk_bf16_f32 v254, v212, v213
  v_cvt_pk_bf16_f32 v255, v214, v215
  s_nop 0
  v_permlane16_swap_b32 v252, v254
  v_permlane16_swap_b32 v253, v255
  buffer_store_dwordx4 v[252:255], v240, s[4:7], s34 offen offset:2048 sc1
  v_pk_mul_f32 v[216:217], v[216:217], v[232:233] op_sel_hi:[1,0]
  v_pk_mul_f32 v[218:219], v[218:219], v[232:233] op_sel_hi:[1,0]
  v_pk_mul_f32 v[220:221], v[220:221], v[232:233] op_sel_hi:[1,0]
  v_pk_mul_f32 v[222:223], v[222:223], v[232:233] op_sel_hi:[1,0]
  v_cvt_pk_bf16_f32 v184, v216, v217
  v_cvt_pk_bf16_f32 v185, v218, v219
  v_cvt_pk_bf16_f32 v186, v220, v221
  v_cvt_pk_bf16_f32 v187, v222, v223
  s_nop 0
  v_permlane16_swap_b32 v184, v186
  v_permlane16_swap_b32 v185, v187
  buffer_store_dwordx4 v[184:187], v240, s[4:7], s34 offen offset:3072 sc1
  v_cndmask_b32 v172, v249, v172, s[84:85]
  v_cndmask_b32 v173, v249, v173, s[86:87]
  v_cndmask_b32 v174, v249, v174, s[88:89]
  v_cndmask_b32 v175, v249, v175, s[90:91]
  v_cndmask_b32 v176, v249, v176, s[92:93]
  v_cndmask_b32 v177, v249, v177, s[94:95]
  v_cndmask_b32 v178, v249, v178, s[96:97]
  v_cndmask_b32 v179, v249, v179, s[98:99]
  v_max3_f32 v188, v172, v173, v174
  v_max3_f32 v189, v175, v176, v177
  v_max3_f32 v188, v178, v179, v188
  v_max3_f32 v189, v180, v181, v189
  v_max_f32 v188, v188, v189
  v_mov_b32 v189, v188
  s_nop 1
  v_permlane16_swap_b32 v188, v189
  s_nop 0
  v_max_f32 v188, v188, v189
  v_mov_b32 v189, v188
  s_nop 1
  v_permlane32_swap_b32 v188, v189
  s_nop 0
  v_max_f32 v188, v188, v189
  v_mul_f32 v188, s21, v188
  v_fma_f32 v172, v172, s21, -v188
  v_fma_f32 v173, v173, s21, -v188
  v_fma_f32 v174, v174, s21, -v188
  v_fma_f32 v175, v175, s21, -v188
  v_fma_f32 v176, v176, s21, -v188
  v_fma_f32 v177, v177, s21, -v188
  v_fma_f32 v178, v178, s21, -v188
  v_fma_f32 v179, v179, s21, -v188
  v_fma_f32 v180, v180, s21, -v188
  v_fma_f32 v181, v181, s21, -v188
  v_exp_f32 v172, v172
  v_exp_f32 v173, v173
  v_exp_f32 v174, v174
  v_exp_f32 v175, v175
  v_exp_f32 v176, v176
  v_exp_f32 v177, v177
  v_exp_f32 v178, v178
  v_exp_f32 v179, v179
  v_exp_f32 v180, v180
  v_exp_f32 v181, v181
  v_cvt_pk_bf16_f32 v224, v172, v173
  v_cvt_pk_bf16_f32 v225, v174, v175
  v_cvt_pk_bf16_f32 v226, v176, v177
  v_cvt_pk_bf16_f32 v227, v178, v179
  v_cvt_pk_bf16_f32 v228, v180, v181
  v_mov_b32 v231, v228
  s_nop 0
  v_mfma_f32_16x16x32_bf16 v[232:235], v[236:239], v[224:227], 0
  v_mfma_f32_16x16x32_bf16 v[192:195], a[32:35], v[224:227], 0
  v_mfma_f32_16x16x32_bf16 v[196:199], a[36:39], v[224:227], 0
  v_mfma_f32_16x16x32_bf16 v[200:203], a[40:43], v[224:227], 0
  v_mfma_f32_16x16x32_bf16 v[204:207], a[44:47], v[224:227], 0
  v_mfma_f32_16x16x32_bf16 v[208:211], a[48:51], v[224:227], 0
  v_mfma_f32_16x16x32_bf16 v[212:215], a[52:55], v[224:227], 0
  v_mfma_f32_16x16x32_bf16 v[216:219], a[56:59], v[224:227], 0
  v_mfma_f32_16x16x32_bf16 v[220:223], a[60:63], v[224:227], 0
  v_mfma_f32_16x16x16_bf16 v[232:235], v[236:237], v[228:229], v[232:235]
  v_mfma_f32_16x16x16_bf16 v[192:195], v[152:153], v[228:229], v[192:195]
  v_mfma_f32_16x16x16_bf16 v[196:199], v[152:153], v[230:231], v[196:199]
  v_mfma_f32_16x16x16_bf16 v[200:203], v[154:155], v[228:229], v[200:203]
  v_mfma_f32_16x16x16_bf16 v[204:207], v[154:155], v[230:231], v[204:207]
  v_mfma_f32_16x16x16_bf16 v[208:211], v[156:157], v[228:229], v[208:211]
  v_mfma_f32_16x16x16_bf16 v[212:215], v[156:157], v[230:231], v[212:215]
  v_mfma_f32_16x16x16_bf16 v[216:219], v[158:159], v[228:229], v[216:219]
  v_mfma_f32_16x16x16_bf16 v[220:223], v[158:159], v[230:231], v[220:223]
  v_rcp_f32 v232, v232
  s_nop 0
  v_pk_mul_f32 v[192:193], v[192:193], v[232:233] op_sel_hi:[1,0]
  v_pk_mul_f32 v[194:195], v[194:195], v[232:233] op_sel_hi:[1,0]
  v_pk_mul_f32 v[196:197], v[196:197], v[232:233] op_sel_hi:[1,0]
  v_pk_mul_f32 v[198:199], v[198:199], v[232:233] op_sel_hi:[1,0]
  v_cvt_pk_bf16_f32 v252, v192, v193
  v_cvt_pk_bf16_f32 v253, v194, v195
  v_cvt_pk_bf16_f32 v254, v196, v197
  v_cvt_pk_bf16_f32 v255, v198, v199
  s_nop 0
  v_permlane16_swap_b32 v252, v254
  v_permlane16_swap_b32 v253, v255
  buffer_store_dwordx4 v[252:255], v241, s[4:7], s34 offen offset:0 sc1
  v_pk_mul_f32 v[200:201], v[200:201], v[232:233] op_sel_hi:[1,0]
  v_pk_mul_f32 v[202:203], v[202:203], v[232:233] op_sel_hi:[1,0]
  v_pk_mul_f32 v[204:205], v[204:205], v[232:233] op_sel_hi:[1,0]
  v_pk_mul_f32 v[206:207], v[206:207], v[232:233] op_sel_hi:[1,0]
  v_cvt_pk_bf16_f32 v184, v200, v201
  v_cvt_pk_bf16_f32 v185, v202, v203
  v_cvt_pk_bf16_f32 v186, v204, v205
  v_cvt_pk_bf16_f32 v187, v206, v207
  s_nop 0
  v_permlane16_swap_b32 v184, v186
  v_permlane16_swap_b32 v185, v187
  buffer_store_dwordx4 v[184:187], v241, s[4:7], s34 offen offset:1024 sc1
  v_pk_mul_f32 v[208:209], v[208:209], v[232:233] op_sel_hi:[1,0]
  v_pk_mul_f32 v[210:211], v[210:211], v[232:233] op_sel_hi:[1,0]
  v_pk_mul_f32 v[212:213], v[212:213], v[232:233] op_sel_hi:[1,0]
  v_pk_mul_f32 v[214:215], v[214:215], v[232:233] op_sel_hi:[1,0]
  v_cvt_pk_bf16_f32 v252, v208, v209
  v_cvt_pk_bf16_f32 v253, v210, v211
  v_cvt_pk_bf16_f32 v254, v212, v213
  v_cvt_pk_bf16_f32 v255, v214, v215
  s_nop 0
  v_permlane16_swap_b32 v252, v254
  v_permlane16_swap_b32 v253, v255
  buffer_store_dwordx4 v[252:255], v241, s[4:7], s34 offen offset:2048 sc1
  v_pk_mul_f32 v[216:217], v[216:217], v[232:233] op_sel_hi:[1,0]
  v_pk_mul_f32 v[218:219], v[218:219], v[232:233] op_sel_hi:[1,0]
  v_pk_mul_f32 v[220:221], v[220:221], v[232:233] op_sel_hi:[1,0]
  v_pk_mul_f32 v[222:223], v[222:223], v[232:233] op_sel_hi:[1,0]
  v_cvt_pk_bf16_f32 v184, v216, v217
  v_cvt_pk_bf16_f32 v185, v218, v219
  v_cvt_pk_bf16_f32 v186, v220, v221
  v_cvt_pk_bf16_f32 v187, v222, v223
  s_nop 0
  v_permlane16_swap_b32 v184, v186
  v_permlane16_swap_b32 v185, v187
  buffer_store_dwordx4 v[184:187], v241, s[4:7], s34 offen offset:3072 sc1
  s_cmp_lt_u32 s37, 48
  s_cbranch_scc1 pg_174_ns
  s_lshl_b32 s38, s37, 2
  s_mov_b32 s39, 1
  s_waitcnt vmcnt(0)
  s_cmp_eq_u32 s38, 0
  s_cbranch_scc1 fr_175
  v_mov_b32 v160, s39
  v_mov_b32 v161, s38
  s_mov_b64 exec, 1
  buffer_atomic_add v160, v161, s[40:43], 0 offen sc1
  s_mov_b64 exec, -1
  s_mov_b32 s38, 0
fr_175:
pg_174_ns:
  s_add_u32 s34, s34, 524288
  s_add_u32 s37, s37, 2
  v_accvgpr_read_b32 v184, a128
  v_accvgpr_read_b32 v185, a129
  v_accvgpr_read_b32 v186, a130
  v_accvgpr_read_b32 v187, a131
  v_accvgpr_read_b32 v188, a132
  v_accvgpr_read_b32 v189, a133
  v_accvgpr_read_b32 v190, a134
  v_accvgpr_read_b32 v191, a135
  v_cvt_pk_bf16_f32 v32, v184, v185
  v_cvt_pk_bf16_f32 v33, v186, v187
  v_cvt_pk_bf16_f32 v34, v188, v189
  v_cvt_pk_bf16_f32 v35, v190, v191
  s_nop 0
  v_permlane16_swap_b32 v32, v34
  v_permlane16_swap_b32 v33, v35
  v_accvgpr_read_b32 v184, a136
  v_accvgpr_read_b32 v185, a137
  v_accvgpr_read_b32 v186, a138
  v_accvgpr_read_b32 v187, a139
  v_accvgpr_read_b32 v188, a140
  v_accvgpr_read_b32 v189, a141
  v_accvgpr_read_b32 v190, a142
  v_accvgpr_read_b32 v191, a143
  v_cvt_pk_bf16_f32 v36, v184, v185
  v_cvt_pk_bf16_f32 v37, v186, v187
  v_cvt_pk_bf16_f32 v38, v188, v189
  v_cvt_pk_bf16_f32 v39, v190, v191
  s_nop 0
  v_permlane16_swap_b32 v36, v38
  v_permlane16_swap_b32 v37, v39
  v_accvgpr_read_b32 v184, a144
  v_accvgpr_read_b32 v185, a145
  v_accvgpr_read_b32 v186, a146
  v_accvgpr_read_b32 v187, a147
  v_accvgpr_read_b32 v188, a148
  v_accvgpr_read_b32 v189, a149
  v_accvgpr_read_b32 v190, a150
  v_accvgpr_read_b32 v191, a151
  v_cvt_pk_bf16_f32 v40, v184, v185
  v_cvt_pk_bf16_f32 v41, v186, v187
  v_cvt_pk_bf16_f32 v42, v188, v189
  v_cvt_pk_bf16_f32 v43, v190, v191
  s_nop 0
  v_permlane16_swap_b32 v40, v42
  v_permlane16_swap_b32 v41, v43
  v_accvgpr_read_b32 v184, a152
  v_accvgpr_read_b32 v185, a153
  v_accvgpr_read_b32 v186, a154
  v_accvgpr_read_b32 v187, a155
  v_accvgpr_read_b32 v188, a156
  v_accvgpr_read_b32 v189, a157
  v_accvgpr_read_b32 v190, a158
  v_accvgpr_read_b32 v191, a159
  v_cvt_pk_bf16_f32 v44, v184, v185
  v_cvt_pk_bf16_f32 v45, v186, v187
  v_cvt_pk_bf16_f32 v46, v188, v189
  v_cvt_pk_bf16_f32 v47, v190, v191
  s_nop 0
  v_permlane16_swap_b32 v44, v46
  v_permlane16_swap_b32 v45, v47
  v_accvgpr_read_b32 v184, a160
  v_accvgpr_read_b32 v185, a161
  v_accvgpr_read_b32 v186, a162
  v_accvgpr_read_b32 v187, a163
  v_accvgpr_read_b32 v188, a164
  v_accvgpr_read_b32 v189, a165
  v_accvgpr_read_b32 v190, a166
  v_accvgpr_read_b32 v191, a167
  v_cvt_pk_bf16_f32 v48, v184, v185
  v_cvt_pk_bf16_f32 v49, v186, v187
  v_cvt_pk_bf16_f32 v50, v188, v189
  v_cvt_pk_bf16_f32 v51, v190, v191
  s_nop 0
  v_permlane16_swap_b32 v48, v50
  v_permlane16_swap_b32 v49, v51
  v_accvgpr_read_b32 v184, a168
  v_accvgpr_read_b32 v185, a169
  v_accvgpr_read_b32 v186, a170
  v_accvgpr_read_b32 v187, a171
  v_accvgpr_read_b32 v188, a172
  v_accvgpr_read_b32 v189, a173
  v_accvgpr_read_b32 v190, a174
  v_accvgpr_read_b32 v191, a175
  v_cvt_pk_bf16_f32 v52, v184, v185
  v_cvt_pk_bf16_f32 v53, v186, v187
  v_cvt_pk_bf16_f32 v54, v188, v189
  v_cvt_pk_bf16_f32 v55, v190, v191
  s_nop 0
  v_permlane16_swap_b32 v52, v54
  v_permlane16_swap_b32 v53, v55
  v_accvgpr_read_b32 v184, a176
  v_accvgpr_read_b32 v185, a177
  v_accvgpr_read_b32 v186, a178
  v_accvgpr_read_b32 v187, a179
  v_accvgpr_read_b32 v188, a180
  v_accvgpr_read_b32 v189, a181
  v_accvgpr_read_b32 v190, a182
  v_accvgpr_read_b32 v191, a183
  v_cvt_pk_bf16_f32 v56, v184, v185
  v_cvt_pk_bf16_f32 v57, v186, v187
  v_cvt_pk_bf16_f32 v58, v188, v189
  v_cvt_pk_bf16_f32 v59, v190, v191
  s_nop 0
  v_permlane16_swap_b32 v56, v58
  v_permlane16_swap_b32 v57, v59
  v_accvgpr_read_b32 v184, a184
  v_accvgpr_read_b32 v185, a185
  v_accvgpr_read_b32 v186, a186
  v_accvgpr_read_b32 v187, a187
  v_accvgpr_read_b32 v188, a188
  v_accvgpr_read_b32 v189, a189
  v_accvgpr_read_b32 v190, a190
  v_accvgpr_read_b32 v191, a191
  v_cvt_pk_bf16_f32 v60, v184, v185
  v_cvt_pk_bf16_f32 v61, v186, v187
  v_cvt_pk_bf16_f32 v62, v188, v189
  v_cvt_pk_bf16_f32 v63, v190, v191
  s_nop 0
  v_permlane16_swap_b32 v60, v62
  v_permlane16_swap_b32 v61, v63
  s_cmp_lt_u32 s37, s20
  s_cbranch_scc1 pg_176_kn
pg_176:
  s_sub_u32 s23, s23, 1
  s_cbranch_scc1 rec_exit
  buffer_load_dwordx4 v[184:187], v248, s[4:7], s35 offen sc1
  s_waitcnt vmcnt(0)
  v_min3_u32 v184, v184, v185, v186
  v_min_u32 v184, v184, v187
  s_nop 0
  v_readfirstlane_b32 s20, v184
pg_176_c:
  s_max_u32 s58, s37, 2
  s_cmp_lt_u32 s58, s20
  s_cbranch_scc1 pg_176_ok
  s_sleep 4
  s_branch pg_176
pg_176_ok:
  buffer_load_dwordx4 v[96:99], v242, s[4:7], s31 offen offset:0 sc1
  buffer_load_dwordx4 v[100:103], v242, s[4:7], s31 offen offset:512 sc1
  buffer_load_dwordx4 v[104:107], v242, s[4:7], s31 offen offset:1024 sc1
  buffer_load_dwordx4 v[108:111], v242, s[4:7], s31 offen offset:1536 sc1
  buffer_load_dwordx4 v[144:147], v243, s[4:7], s33 offen offset:0 sc1
  buffer_load_dwordx4 v[148:151], v243, s[4:7], s33 offen offset:1024 sc1
  s_waitcnt vmcnt(0)
pg_176_kn:
  s_waitcnt vmcnt(10)
  v_mfma_f32_16x16x32_bf16 v[168:171], v[96:99], v[32:35], 0
  v_mfma_f32_16x16x32_bf16 v[180:183], v[96:99], v[48:51], 0
  v_mfma_f32_16x16x32_bf16 v[168:171], v[100:103], v[36:39], v[168:171]
  v_mfma_f32_16x16x32_bf16 v[180:183], v[100:103], v[52:55], v[180:183]
  v_mfma_f32_16x16x32_bf16 v[168:171], v[104:107], v[40:43], v[168:171]
  v_mfma_f32_16x16x32_bf16 v[180:183], v[104:107], v[56:59], v[180:183]
  v_mfma_f32_16x16x32_bf16 v[168:171], v[108:111], v[44:47], v[168:171]
  v_mfma_f32_16x16x32_bf16 v[180:183], v[108:111], v[60:63], v[180:183]
  v_mfma_f32_16x16x32_bf16 v[160:163], v[64:67], v[32:35], 0
  v_mfma_f32_16x16x32_bf16 v[164:167], v[80:83], v[32:35], 0
  v_mfma_f32_16x16x32_bf16 v[172:175], v[64:67], v[48:51], 0
  v_mfma_f32_16x16x32_bf16 v[176:179], v[80:83], v[48:51], 0
  s_add_u32 s31, s31, 131072
  s_add_u32 s33, s33, 131072
  buffer_load_dwordx4 v[96:99], v242, s[4:7], s31 offen offset:0 sc1
  buffer_load_dwordx4 v[100:103], v242, s[4:7], s31 offen offset:512 sc1
  buffer_load_dwordx4 v[104:107], v242, s[4:7], s31 offen offset:1024 sc1
  buffer_load_dwordx4 v[108:111], v242, s[4:7], s31 offen offset:1536 sc1
  buffer_load_dwordx4 v[152:155], v243, s[4:7], s33 offen offset:0 sc1
  buffer_load_dwordx4 v[156:159], v243, s[4:7], s33 offen offset:1024 sc1
  v_mfma_f32_16x16x32_bf16 v[160:163], v[68:71], v[36:39], v[160:163]
  v_mfma_f32_16x16x32_bf16 v[164:167], v[84:87], v[36:39], v[164:167]
  v_mfma_f32_16x16x32_bf16 v[172:175], v[68:71], v[52:55], v[172:175]
  v_mfma_f32_16x16x32_bf16 v[176:179], v[84:87], v[52:55], v[176:179]
  v_mfma_f32_16x16x32_bf16 v[160:163], v[72:75], v[40:43], v[160:163]
  v_mfma_f32_16x16x32_bf16 v[164:167], v[88:91], v[40:43], v[164:167]
  v_mfma_f32_16x16x32_bf16 v[172:175], v[72:75], v[56:59], v[172:175]
  v_mfma_f32_16x16x32_bf16 v[176:179], v[88:91], v[56:59], v[176:179]
  v_mfma_f32_16x16x32_bf16 v[160:163], v[76:79], v[44:47], v[160:163]
  v_mfma_f32_16x16x32_bf16 v[164:167], v[92:95], v[44:47], v[164:167]
  v_mfma_f32_16x16x32_bf16 v[172:175], v[76:79], v[60:63], v[172:175]
  v_mfma_f32_16x16x32_bf16 v[176:179], v[92:95], v[60:63], v[176:179]
  s_nop 7
  v_cndmask_b32 v160, v249, v160, s[68:69]
  v_cndmask_b32 v161, v249, v161, s[70:71]
  v_cndmask_b32 v162, v249, v162, s[72:73]
  v_cndmask_b32 v163, v249, v163, s[74:75]
  v_cndmask_b32 v164, v249, v164, s[76:77]
  v_cndmask_b32 v165, v249, v165, s[78:79]
  v_cndmask_b32 v166, v249, v166, s[80:81]
  v_cndmask_b32 v167, v249, v167, s[82:83]
  v_max3_f32 v188, v160, v161, v162
  v_max3_f32 v189, v163, v164, v165
  v_max3_f32 v188, v166, v167, v188
  v_max3_f32 v189, v168, v169, v189
  v_max_f32 v188, v188, v189
  v_mov_b32 v189, v188
  s_nop 1
  v_permlane16_swap_b32 v188, v189
  s_nop 0
  v_max_f32 v188, v188, v189
  v_mov_b32 v189, v188
  s_nop 1
  v_permlane32_swap_b32 v188, v189
  s_nop 0
  v_max_f32 v188, v188, v189
  v_mul_f32 v188, s21, v188
  v_fma_f32 v160, v160, s21, -v188
  v_fma_f32 v161, v161, s21, -v188
  v_fma_f32 v162, v162, s21, -v188
  v_fma_f32 v163, v163, s21, -v188
  v_fma_f32 v164, v164, s21, -v188
  v_fma_f32 v165, v165, s21, -v188
  v_fma_f32 v166, v166, s21, -v188
  v_fma_f32 v167, v167, s21, -v188
  v_fma_f32 v168, v168, s21, -v188
  v_fma_f32 v169, v169, s21, -v188
  v_exp_f32 v160, v160
  v_exp_f32 v161, v161
  v_exp_f32 v162, v162
  v_exp_f32 v163, v163
  v_exp_f32 v164, v164
  v_exp_f32 v165, v165
  v_exp_f32 v166, v166
  v_exp_f32 v167, v167
  v_exp_f32 v168, v168
  v_exp_f32 v169, v169
  v_cvt_pk_bf16_f32 v224, v160, v161
  v_cvt_pk_bf16_f32 v225, v162, v163
  v_cvt_pk_bf16_f32 v226, v164, v165
  v_cvt_pk_bf16_f32 v227, v166, v167
  v_cvt_pk_bf16_f32 v228, v168, v169
  v_mov_b32 v231, v228
  s_waitcnt vmcnt(14)
  s_nop 0
  v_mfma_f32_16x16x32_bf16 v[232:235], v[236:239], v[224:227], 0
  v_mfma_f32_16x16x32_bf16 v[192:195], v[112:115], v[224:227], 0
  v_mfma_f32_16x16x32_bf16 v[196:199], v[116:119], v[224:227], 0
  v_mfma_f32_16x16x32_bf16 v[200:203], v[120:123], v[224:227], 0
  v_mfma_f32_16x16x32_bf16 v[204:207], v[124:127], v[224:227], 0
  v_mfma_f32_16x16x32_bf16 v[208:211], v[128:131], v[224:227], 0
  v_mfma_f32_16x16x32_bf16 v[212:215], v[132:135], v[224:227], 0
  v_mfma_f32_16x16x32_bf16 v[216:219], v[136:139], v[224:227], 0
  v_mfma_f32_16x16x32_bf16 v[220:223], v[140:143], v[224:227], 0
  v_mfma_f32_16x16x16_bf16 v[232:235], v[236:237], v[228:229], v[232:235]
  v_mfma_f32_16x16x16_bf16 v[192:195], v[144:145], v[228:229], v[192:195]
  v_mfma_f32_16x16x16_bf16 v[196:199], v[144:145], v[230:231], v[196:199]
  v_mfma_f32_16x16x16_bf16 v[200:203], v[146:147], v[228:229], v[200:203]
  v_mfma_f32_16x16x16_bf16 v[204:207], v[146:147], v[230:231], v[204:207]
  v_mfma_f32_16x16x16_bf16 v[208:211], v[148:149], v[228:229], v[208:211]
  v_mfma_f32_16x16x16_bf16 v[212:215], v[148:149], v[230:231], v[212:215]
  v_mfma_f32_16x16x16_bf16 v[216:219], v[150:151], v[228:229], v[216:219]
  v_mfma_f32_16x16x16_bf16 v[220:223], v[150:151], v[230:231], v[220:223]
  v_rcp_f32 v232, v232
  s_nop 0
  v_pk_mul_f32 v[192:193], v[192:193], v[232:233] op_sel_hi:[1,0]
  v_pk_mul_f32 v[194:195], v[194:195], v[232:233] op_sel_hi:[1,0]
  v_pk_mul_f32 v[196:197], v[196:197], v[232:233] op_sel_hi:[1,0]
  v_pk_mul_f32 v[198:199], v[198:199], v[232:233] op_sel_hi:[1,0]
  v_cvt_pk_bf16_f32 v252, v192, v193
  v_cvt_pk_bf16_f32 v253, v194, v195
  v_cvt_pk_bf16_f32 v254, v196, v197
  v_cvt_pk_bf16_f32 v255, v198, v199
  s_nop 0
  v_permlane16_swap_b32 v252, v254
  v_permlane16_swap_b32 v253, v255
  buffer_store_dwordx4 v[252:255], v240, s[4:7], s34 offen offset:0 sc1
  v_pk_mul_f32 v[200:201], v[200:201], v[232:233] op_sel_hi:[1,0]
  v_pk_mul_f32 v[202:203], v[202:203], v[232:233] op_sel_hi:[1,0]
  v_pk_mul_f32 v[204:205], v[204:205], v[232:233] op_sel_hi:[1,0]
  v_pk_mul_f32 v[206:207], v[206:207], v[232:233] op_sel_hi:[1,0]
  v_cvt_pk_bf16_f32 v184, v200, v201
  v_cvt_pk_bf16_f32 v185, v202, v203
  v_cvt_pk_bf16_f32 v186, v204, v205
  v_cvt_pk_bf16_f32 v187, v206, v207
  s_nop 0
  v_permlane16_swap_b32 v184, v186
  v_permlane16_swap_b32 v185, v187
  buffer_store_dwordx4 v[184:187], v240, s[4:7], s34 offen offset:1024 sc1
  v_pk_mul_f32 v[208:209], v[208:209], v[232:233] op_sel_hi:[1,0]
  v_pk_mul_f32 v[210:211], v[210:211], v[232:233] op_sel_hi:[1,0]
  v_pk_mul_f32 v[212:213], v[212:213], v[232:233] op_sel_hi:[1,0]
  v_pk_mul_f32 v[214:215], v[214:215], v[232:233] op_sel_hi:[1,0]
  v_cvt_pk_bf16_f32 v252, v208, v209
  v_cvt_pk_bf16_f32 v253, v210, v211
  v_cvt_pk_bf16_f32 v254, v212, v213
  v_cvt_pk_bf16_f32 v255, v214, v215
  s_nop 0
  v_permlane16_swap_b32 v252, v254
  v_permlane16_swap_b32 v253, v255
  buffer_store_dwordx4 v[252:255], v240, s[4:7], s34 offen offset:2048 sc1
  v_pk_mul_f32 v[216:217], v[216:217], v[232:233] op_sel_hi:[1,0]
  v_pk_mul_f32 v[218:219], v[218:219], v[232:233] op_sel_hi:[1,0]
  v_pk_mul_f32 v[220:221], v[220:221], v[232:233] op_sel_hi:[1,0]
  v_pk_mul_f32 v[222:223], v[222:223], v[232:233] op_sel_hi:[1,0]
  v_cvt_pk_bf16_f32 v184, v216, v217
  v_cvt_pk_bf16_f32 v185, v218, v219
  v_cvt_pk_bf16_f32 v186, v220, v221
  v_cvt_pk_bf16_f32 v187, v222, v223
  s_nop 0
  v_permlane16_swap_b32 v184, v186
  v_permlane16_swap_b32 v185, v187
  buffer_store_dwordx4 v[184:187], v240, s[4:7], s34 offen offset:3072 sc1
  v_cndmask_b32 v172, v249, v172, s[84:85]
  v_cndmask_b32 v173, v249, v173, s[86:87]
  v_cndmask_b32 v174, v249, v174, s[88:89]
  v_cndmask_b32 v175, v249, v175, s[90:91]
  v_cndmask_b32 v176, v249, v176, s[92:93]
  v_cndmask_b32 v177, v249, v177, s[94:95]
  v_cndmask_b32 v178, v249, v178, s[96:97]
  v_cndmask_b32 v179, v249, v179, s[98:99]
  v_max3_f32 v188, v172, v173, v174
  v_max3_f32 v189, v175, v176, v177
  v_max3_f32 v188, v178, v179, v188
  v_max3_f32 v189, v180, v181, v189
  v_max_f32 v188, v188, v189
  v_mov_b32 v189, v188
  s_nop 1
  v_permlane16_swap_b32 v188, v189
  s_nop 0
  v_max_f32 v188, v188, v189
  v_mov_b32 v189, v188
  s_nop 1
  v_permlane32_swap_b32 v188, v189
  s_nop 0
  v_max_f32 v188, v188, v189
  v_mul_f32 v188, s21, v188
  v_fma_f32 v172, v172, s21, -v188
  v_fma_f32 v173, v173, s21, -v188
  v_fma_f32 v174, v174, s21, -v188
  v_fma_f32 v175, v175, s21, -v188
  v_fma_f32 v176, v176, s21, -v188
  v_fma_f32 v177, v177, s21, -v188
  v_fma_f32 v178, v178, s21, -v188
  v_fma_f32 v179, v179, s21, -v188
  v_fma_f32 v180, v180, s21, -v188
  v_fma_f32 v181, v181, s21, -v188
  v_exp_f32 v172, v172
  v_exp_f32 v173, v173
  v_exp_f32 v174, v174
  v_exp_f32 v175, v175
  v_exp_f32 v176, v176
  v_exp_f32 v177, v177
  v_exp_f32 v178, v178
  v_exp_f32 v179, v179
  v_exp_f32 v180, v180
  v_exp_f32 v181, v181
  v_cvt_pk_bf16_f32 v224, v172, v173
  v_cvt_pk_bf16_f32 v225, v174, v175
  v_cvt_pk_bf16_f32 v226, v176, v177
  v_cvt_pk_bf16_f32 v227, v178, v179
  v_cvt_pk_bf16_f32 v228, v180, v181
  v_mov_b32 v231, v228
  s_nop 0
  v_mfma_f32_16x16x32_bf16 v[232:235], v[236:239], v[224:227], 0
  v_mfma_f32_16x16x32_bf16 v[192:195], v[112:115], v[224:227], 0
  v_mfma_f32_16x16x32_bf16 v[196:199], v[116:119], v[224:227], 0
  v_mfma_f32_16x16x32_bf16 v[200:203], v[120:123], v[224:227], 0
  v_mfma_f32_16x16x32_bf16 v[204:207], v[124:127], v[224:227], 0
  v_mfma_f32_16x16x32_bf16 v[208:211], v[128:131], v[224:227], 0
  v_mfma_f32_16x16x32_bf16 v[212:215], v[132:135], v[224:227], 0
  v_mfma_f32_16x16x32_bf16 v[216:219], v[136:139], v[224:227], 0
  v_mfma_f32_16x16x32_bf16 v[220:223], v[140:143], v[224:227], 0
  v_mfma_f32_16x16x16_bf16 v[232:235], v[236:237], v[228:229], v[232:235]
  v_mfma_f32_16x16x16_bf16 v[192:195], v[144:145], v[228:229], v[192:195]
  v_mfma_f32_16x16x16_bf16 v[196:199], v[144:145], v[230:231], v[196:199]
  v_mfma_f32_16x16x16_bf16 v[200:203], v[146:147], v[228:229], v[200:203]
  v_mfma_f32_16x16x16_bf16 v[204:207], v[146:147], v[230:231], v[204:207]
  v_mfma_f32_16x16x16_bf16 v[208:211], v[148:149], v[228:229], v[208:211]
  v_mfma_f32_16x16x16_bf16 v[212:215], v[148:149], v[230:231], v[212:215]
  v_mfma_f32_16x16x16_bf16 v[216:219], v[150:151], v[228:229], v[216:219]
  v_mfma_f32_16x16x16_bf16 v[220:223], v[150:151], v[230:231], v[220:223]
  v_rcp_f32 v232, v232
  s_nop 0
  v_pk_mul_f32 v[192:193], v[192:193], v[232:233] op_sel_hi:[1,0]
  v_pk_mul_f32 v[194:195], v[194:195], v[232:233] op_sel_hi:[1,0]
  v_pk_mul_f32 v[196:197], v[196:197], v[232:233] op_sel_hi:[1,0]
  v_pk_mul_f32 v[198:199], v[198:199], v[232:233] op_sel_hi:[1,0]
  v_cvt_pk_bf16_f32 v252, v192, v193
  v_cvt_pk_bf16_f32 v253, v194, v195
  v_cvt_pk_bf16_f32 v254, v196, v197
  v_cvt_pk_bf16_f32 v255, v198, v199
  s_nop 0
  v_permlane16_swap_b32 v252, v254
  v_permlane16_swap_b32 v253, v255
  buffer_store_dwordx4 v[252:255], v241, s[4:7], s34 offen offset:0 sc1
  v_pk_mul_f32 v[200:201], v[200:201], v[232:233] op_sel_hi:[1,0]
  v_pk_mul_f32 v[202:203], v[202:203], v[232:233] op_sel_hi:[1,0]
  v_pk_mul_f32 v[204:205], v[204:205], v[232:233] op_sel_hi:[1,0]
  v_pk_mul_f32 v[206:207], v[206:207], v[232:233] op_sel_hi:[1,0]
  v_cvt_pk_bf16_f32 v184, v200, v201
  v_cvt_pk_bf16_f32 v185, v202, v203
  v_cvt_pk_bf16_f32 v186, v204, v205
  v_cvt_pk_bf16_f32 v187, v206, v207
  s_nop 0
  v_permlane16_swap_b32 v184, v186
  v_permlane16_swap_b32 v185, v187
  buffer_store_dwordx4 v[184:187], v241, s[4:7], s34 offen offset:1024 sc1
  v_pk_mul_f32 v[208:209], v[208:209], v[232:233] op_sel_hi:[1,0]
  v_pk_mul_f32 v[210:211], v[210:211], v[232:233] op_sel_hi:[1,0]
  v_pk_mul_f32 v[212:213], v[212:213], v[232:233] op_sel_hi:[1,0]
  v_pk_mul_f32 v[214:215], v[214:215], v[232:233] op_sel_hi:[1,0]
  v_cvt_pk_bf16_f32 v252, v208, v209
  v_cvt_pk_bf16_f32 v253, v210, v211
  v_cvt_pk_bf16_f32 v254, v212, v213
  v_cvt_pk_bf16_f32 v255, v214, v215
  s_nop 0
  v_permlane16_swap_b32 v252, v254
  v_permlane16_swap_b32 v253, v255
  buffer_store_dwordx4 v[252:255], v241, s[4:7], s34 offen offset:2048 sc1
  v_pk_mul_f32 v[216:217], v[216:217], v[232:233] op_sel_hi:[1,0]
  v_pk_mul_f32 v[218:219], v[218:219], v[232:233] op_sel_hi:[1,0]
  v_pk_mul_f32 v[220:221], v[220:221], v[232:233] op_sel_hi:[1,0]
  v_pk_mul_f32 v[222:223], v[222:223], v[232:233] op_sel_hi:[1,0]
  v_cvt_pk_bf16_f32 v184, v216, v217
  v_cvt_pk_bf16_f32 v185, v218, v219
  v_cvt_pk_bf16_f32 v186, v220, v221
  v_cvt_pk_bf16_f32 v187, v222, v223
  s_nop 0
  v_permlane16_swap_b32 v184, v186
  v_permlane16_swap_b32 v185, v187
  buffer_store_dwordx4 v[184:187], v241, s[4:7], s34 offen offset:3072 sc1
  s_cmp_lt_u32 s37, 48
  s_cbranch_scc1 pg_176_ns
  s_lshl_b32 s38, s37, 2
  s_mov_b32 s39, 1
  s_waitcnt vmcnt(0)
  s_cmp_eq_u32 s38, 0
  s_cbranch_scc1 fr_177
  v_mov_b32 v160, s39
  v_mov_b32 v161, s38
  s_mov_b64 exec, 1
  buffer_atomic_add v160, v161, s[40:43], 0 offen sc1
  s_mov_b64 exec, -1
  s_mov_b32 s38, 0
fr_177:
pg_176_ns:
  s_add_u32 s34, s34, 524288
  s_add_u32 s37, s37, 2
  v_accvgpr_read_b32 v184, a192
  v_accvgpr_read_b32 v185, a193
  v_accvgpr_read_b32 v186, a194
  v_accvgpr_read_b32 v187, a195
  v_accvgpr_read_b32 v188, a196
  v_accvgpr_read_b32 v189, a197
  v_accvgpr_read_b32 v190, a198
  v_accvgpr_read_b32 v191, a199
  v_cvt_pk_bf16_f32 v32, v184, v185
  v_cvt_pk_bf16_f32 v33, v186, v187
  v_cvt_pk_bf16_f32 v34, v188, v189
  v_cvt_pk_bf16_f32 v35, v190, v191
  s_nop 0
  v_permlane16_swap_b32 v32, v34
  v_permlane16_swap_b32 v33, v35
  v_accvgpr_read_b32 v184, a200
  v_accvgpr_read_b32 v185, a201
  v_accvgpr_read_b32 v186, a202
  v_accvgpr_read_b32 v187, a203
  v_accvgpr_read_b32 v188, a204
  v_accvgpr_read_b32 v189, a205
  v_accvgpr_read_b32 v190, a206
  v_accvgpr_read_b32 v191, a207
  v_cvt_pk_bf16_f32 v36, v184, v185
  v_cvt_pk_bf16_f32 v37, v186, v187
  v_cvt_pk_bf16_f32 v38, v188, v189
  v_cvt_pk_bf16_f32 v39, v190, v191
  s_nop 0
  v_permlane16_swap_b32 v36, v38
  v_permlane16_swap_b32 v37, v39
  v_accvgpr_read_b32 v184, a208
  v_accvgpr_read_b32 v185, a209
  v_accvgpr_read_b32 v186, a210
  v_accvgpr_read_b32 v187, a211
  v_accvgpr_read_b32 v188, a212
  v_accvgpr_read_b32 v189, a213
  v_accvgpr_read_b32 v190, a214
  v_accvgpr_read_b32 v191, a215
  v_cvt_pk_bf16_f32 v40, v184, v185
  v_cvt_pk_bf16_f32 v41, v186, v187
  v_cvt_pk_bf16_f32 v42, v188, v189
  v_cvt_pk_bf16_f32 v43, v190, v191
  s_nop 0
  v_permlane16_swap_b32 v40, v42
  v_permlane16_swap_b32 v41, v43
  v_accvgpr_read_b32 v184, a216
  v_accvgpr_read_b32 v185, a217
  v_accvgpr_read_b32 v186, a218
  v_accvgpr_read_b32 v187, a219
  v_accvgpr_read_b32 v188, a220
  v_accvgpr_read_b32 v189, a221
  v_accvgpr_read_b32 v190, a222
  v_accvgpr_read_b32 v191, a223
  v_cvt_pk_bf16_f32 v44, v184, v185
  v_cvt_pk_bf16_f32 v45, v186, v187
  v_cvt_pk_bf16_f32 v46, v188, v189
  v_cvt_pk_bf16_f32 v47, v190, v191
  s_nop 0
  v_permlane16_swap_b32 v44, v46
  v_permlane16_swap_b32 v45, v47
  v_accvgpr_read_b32 v184, a224
  v_accvgpr_read_b32 v185, a225
  v_accvgpr_read_b32 v186, a226
  v_accvgpr_read_b32 v187, a227
  v_accvgpr_read_b32 v188, a228
  v_accvgpr_read_b32 v189, a229
  v_accvgpr_read_b32 v190, a230
  v_accvgpr_read_b32 v191, a231
  v_cvt_pk_bf16_f32 v48, v184, v185
  v_cvt_pk_bf16_f32 v49, v186, v187
  v_cvt_pk_bf16_f32 v50, v188, v189
  v_cvt_pk_bf16_f32 v51, v190, v191
  s_nop 0
  v_permlane16_swap_b32 v48, v50
  v_permlane16_swap_b32 v49, v51
  v_accvgpr_read_b32 v184, a232
  v_accvgpr_read_b32 v185, a233
  v_accvgpr_read_b32 v186, a234
  v_accvgpr_read_b32 v187, a235
  v_accvgpr_read_b32 v188, a236
  v_accvgpr_read_b32 v189, a237
  v_accvgpr_read_b32 v190, a238
  v_accvgpr_read_b32 v191, a239
  v_cvt_pk_bf16_f32 v52, v184, v185
  v_cvt_pk_bf16_f32 v53, v186, v187
  v_cvt_pk_bf16_f32 v54, v188, v189
  v_cvt_pk_bf16_f32 v55, v190, v191
  s_nop 0
  v_permlane16_swap_b32 v52, v54
  v_permlane16_swap_b32 v53, v55
  v_accvgpr_read_b32 v184, a240
  v_accvgpr_read_b32 v185, a241
  v_accvgpr_read_b32 v186, a242
  v_accvgpr_read_b32 v187, a243
  v_accvgpr_read_b32 v188, a244
  v_accvgpr_read_b32 v189, a245
  v_accvgpr_read_b32 v190, a246
  v_accvgpr_read_b32 v191, a247
  v_cvt_pk_bf16_f32 v56, v184, v185
  v_cvt_pk_bf16_f32 v57, v186, v187
  v_cvt_pk_bf16_f32 v58, v188, v189
  v_cvt_pk_bf16_f32 v59, v190, v191
  s_nop 0
  v_permlane16_swap_b32 v56, v58
  v_permlane16_swap_b32 v57, v59
  v_accvgpr_read_b32 v184, a248
  v_accvgpr_read_b32 v185, a249
  v_accvgpr_read_b32 v186, a250
  v_accvgpr_read_b32 v187, a251
  v_accvgpr_read_b32 v188, a252
  v_accvgpr_read_b32 v189, a253
  v_accvgpr_read_b32 v190, a254
  v_accvgpr_read_b32 v191, a255
  v_cvt_pk_bf16_f32 v60, v184, v185
  v_cvt_pk_bf16_f32 v61, v186, v187
  v_cvt_pk_bf16_f32 v62, v188, v189
  v_cvt_pk_bf16_f32 v63, v190, v191
  s_nop 0
  v_permlane16_swap_b32 v60, v62
  v_permlane16_swap_b32 v61, v63
  s_cmp_lt_u32 s37, s20
  s_cbranch_scc1 pg_178_kn
pg_178:
  s_sub_u32 s23, s23, 1
  s_cbranch_scc1 rec_exit
  buffer_load_dwordx4 v[184:187], v248, s[4:7], s35 offen sc1
  s_waitcnt vmcnt(0)
  v_min3_u32 v184, v184, v185, v186
  v_min_u32 v184, v184, v187
  s_nop 0
  v_readfirstlane_b32 s20, v184
pg_178_c:
  s_max_u32 s58, s37, 2
  s_cmp_lt_u32 s58, s20
  s_cbranch_scc1 pg_178_ok
  s_sleep 4
  s_branch pg_178
pg_178_ok:
  buffer_load_dwordx4 v[96:99], v242, s[4:7], s31 offen offset:0 sc1
  buffer_load_dwordx4 v[100:103], v242, s[4:7], s31 offen offset:512 sc1
  buffer_load_dwordx4 v[104:107], v242, s[4:7], s31 offen offset:1024 sc1
  buffer_load_dwordx4 v[108:111], v242, s[4:7], s31 offen offset:1536 sc1
  buffer_load_dwordx4 v[152:155], v243, s[4:7], s33 offen offset:0 sc1
  buffer_load_dwordx4 v[156:159], v243, s[4:7], s33 offen offset:1024 sc1
  s_waitcnt vmcnt(0)
pg_178_kn:
  s_waitcnt vmcnt(10)
  v_mfma_f32_16x16x32_bf16 v[168:171], v[96:99], v[32:35], 0
  v_mfma_f32_16x16x32_bf16 v[180:183], v[96:99], v[48:51], 0
  v_mfma_f32_16x16x32_bf16 v[168:171], v[100:103], v[36:39], v[168:171]
  v_mfma_f32_16x16x32_bf16 v[180:183], v[100:103], v[52:55], v[180:183]
  v_mfma_f32_16x16x32_bf16 v[168:171], v[104:107], v[40:43], v[168:171]
  v_mfma_f32_16x16x32_bf16 v[180:183], v[104:107], v[56:59], v[180:183]
  v_mfma_f32_16x16x32_bf16 v[168:171], v[108:111], v[44:47], v[168:171]
  v_mfma_f32_16x16x32_bf16 v[180:183], v[108:111], v[60:63], v[180:183]
  v_mfma_f32_16x16x32_bf16 v[160:163], a[64:67], v[32:35], 0
  v_mfma_f32_16x16x32_bf16 v[164:167], a[80:83], v[32:35], 0
  v_mfma_f32_16x16x32_bf16 v[172:175], a[64:67], v[48:51], 0
  v_mfma_f32_16x16x32_bf16 v[176:179], a[80:83], v[48:51], 0
  v_mfma_f32_16x16x32_bf16 v[160:163], a[68:71], v[36:39], v[160:163]
  v_mfma_f32_16x16x32_bf16 v[164:167], a[84:87], v[36:39], v[164:167]
  v_mfma_f32_16x16x32_bf16 v[172:175], a[68:71], v[52:55], v[172:175]
  v_mfma_f32_16x16x32_bf16 v[176:179], a[84:87], v[52:55], v[176:179]
  v_mfma_f32_16x16x32_bf16 v[160:163], a[72:75], v[40:43], v[160:163]
  v_mfma_f32_16x16x32_bf16 v[164:167], a[88:91], v[40:43], v[164:167]
  v_mfma_f32_16x16x32_bf16 v[172:175], a[72:75], v[56:59], v[172:175]
  v_mfma_f32_16x16x32_bf16 v[176:179], a[88:91], v[56:59], v[176:179]
  v_mfma_f32_16x16x32_bf16 v[160:163], a[76:79], v[44:47], v[160:163]
  v_mfma_f32_16x16x32_bf16 v[164:167], a[92:95], v[44:47], v[164:167]
  v_mfma_f32_16x16x32_bf16 v[172:175], a[76:79], v[60:63], v[172:175]
  v_mfma_f32_16x16x32_bf16 v[176:179], a[92:95], v[60:63], v[176:179]
  s_nop 7
  v_cndmask_b32 v160, v249, v160, s[68:69]
  v_cndmask_b32 v161, v249, v161, s[70:71]
  v_cndmask_b32 v162, v249, v162, s[72:73]
  v_cndmask_b32 v163, v249, v163, s[74:75]
  v_cndmask_b32 v164, v249, v164, s[76:77]
  v_cndmask_b32 v165, v249, v165, s[78:79]
  v_cndmask_b32 v166, v249, v166, s[80:81]
  v_cndmask_b32 v167, v249, v167, s[82:83]
  v_max3_f32 v188, v160, v161, v162
  v_max3_f32 v189, v163, v164, v165
  v_max3_f32 v188, v166, v167, v188
  v_max3_f32 v189, v168, v169, v189
  v_max_f32 v188, v188, v189
  v_mov_b32 v189, v188
  s_nop 1
  v_permlane16_swap_b32 v188, v189
  s_nop 0
  v_max_f32 v188, v188, v189
  v_mov_b32 v189, v188
  s_nop 1
  v_permlane32_swap_b32 v188, v189
  s_nop 0
  v_max_f32 v188, v188, v189
  v_mul_f32 v188, s21, v188
  v_fma_f32 v160, v160, s21, -v188
  v_fma_f32 v161, v161, s21, -v188
  v_fma_f32 v162, v162, s21, -v188
  v_fma_f32 v163, v163, s21, -v188
  v_fma_f32 v164, v164, s21, -v188
  v_fma_f32 v165, v165, s21, -v188
  v_fma_f32 v166, v166, s21, -v188
  v_fma_f32 v167, v167, s21, -v188
  v_fma_f32 v168, v168, s21, -v188
  v_fma_f32 v169, v169, s21, -v188
  v_exp_f32 v160, v160
  v_exp_f32 v161, v161
  v_exp_f32 v162, v162
  v_exp_f32 v163, v163
  v_exp_f32 v164, v164
  v_exp_f32 v165, v165
  v_exp_f32 v166, v166
  v_exp_f32 v167, v167
  v_exp_f32 v168, v168
  v_exp_f32 v169, v169
  v_cvt_pk_bf16_f32 v224, v160, v161
  v_cvt_pk_bf16_f32 v225, v162, v163
  v_cvt_pk_bf16_f32 v226, v164, v165
  v_cvt_pk_bf16_f32 v227, v166, v167
  v_cvt_pk_bf16_f32 v228, v168, v169
  v_mov_b32 v231, v228
  s_waitcnt vmcnt(8)
  s_nop 0
  v_mfma_f32_16x16x32_bf16 v[232:235], v[236:239], v[224:227], 0
  v_mfma_f32_16x16x32_bf16 v[192:195], a[96:99], v[224:227], 0
  v_mfma_f32_16x16x32_bf16 v[196:199], a[100:103], v[224:227], 0
  v_mfma_f32_16x16x32_bf16 v[200:203], a[104:107], v[224:227], 0
  v_mfma_f32_16x16x32_bf16 v[204:207], a[108:111], v[224:227], 0
  v_mfma_f32_16x16x32_bf16 v[208:211], a[112:115], v[224:227], 0
  v_mfma_f32_16x16x32_bf16 v[212:215], a[116:119], v[224:227], 0
  v_mfma_f32_16x16x32_bf16 v[216:219], a[120:123], v[224:227], 0
  v_mfma_f32_16x16x32_bf16 v[220:223], a[124:127], v[224:227], 0
  v_mfma_f32_16x16x16_bf16 v[232:235], v[236:237], v[228:229], v[232:235]
  v_mfma_f32_16x16x16_bf16 v[192:195], v[152:153], v[228:229], v[192:195]
  v_mfma_f32_16x16x16_bf16 v[196:199], v[152:153], v[230:231], v[196:199]
  v_mfma_f32_16x16x16_bf16 v[200:203], v[154:155], v[228:229], v[200:203]
  v_mfma_f32_16x16x16_bf16 v[204:207], v[154:155], v[230:231], v[204:207]
  v_mfma_f32_16x16x16_bf16 v[208:211], v[156:157], v[228:229], v[208:211]
  v_mfma_f32_16x16x16_bf16 v[212:215], v[156:157], v[230:231], v[212:215]
  v_mfma_f32_16x16x16_bf16 v[216:219], v[158:159], v[228:229], v[216:219]
  v_mfma_f32_16x16x16_bf16 v[220:223], v[158:159], v[230:231], v[220:223]
  v_rcp_f32 v232, v232
  s_nop 0
  v_pk_mul_f32 v[192:193], v[192:193], v[232:233] op_sel_hi:[1,0]
  v_pk_mul_f32 v[194:195], v[194:195], v[232:233] op_sel_hi:[1,0]
  v_pk_mul_f32 v[196:197], v[196:197], v[232:233] op_sel_hi:[1,0]
  v_pk_mul_f32 v[198:199], v[198:199], v[232:233] op_sel_hi:[1,0]
  v_cvt_pk_bf16_f32 v252, v192, v193
  v_cvt_pk_bf16_f32 v253, v194, v195
  v_cvt_pk_bf16_f32 v254, v196, v197
  v_cvt_pk_bf16_f32 v255, v198, v199
  s_nop 0
  v_permlane16_swap_b32 v252, v254
  v_permlane16_swap_b32 v253, v255
  buffer_store_dwordx4 v[252:255], v240, s[4:7], s34 offen offset:0 sc1
  v_pk_mul_f32 v[200:201], v[200:201], v[232:233] op_sel_hi:[1,0]
  v_pk_mul_f32 v[202:203], v[202:203], v[232:233] op_sel_hi:[1,0]
  v_pk_mul_f32 v[204:205], v[204:205], v[232:233] op_sel_hi:[1,0]
  v_pk_mul_f32 v[206:207], v[206:207], v[232:233] op_sel_hi:[1,0]
  v_cvt_pk_bf16_f32 v184, v200, v201
  v_cvt_pk_bf16_f32 v185, v202, v203
  v_cvt_pk_bf16_f32 v186, v204, v205
  v_cvt_pk_bf16_f32 v187, v206, v207
  s_nop 0
  v_permlane16_swap_b32 v184, v186
  v_permlane16_swap_b32 v185, v187
  buffer_store_dwordx4 v[184:187], v240, s[4:7], s34 offen offset:1024 sc1
  v_pk_mul_f32 v[208:209], v[208:209], v[232:233] op_sel_hi:[1,0]
  v_pk_mul_f32 v[210:211], v[210:211], v[232:233] op_sel_hi:[1,0]
  v_pk_mul_f32 v[212:213], v[212:213], v[232:233] op_sel_hi:[1,0]
  v_pk_mul_f32 v[214:215], v[214:215], v[232:233] op_sel_hi:[1,0]
  v_cvt_pk_bf16_f32 v252, v208, v209
  v_cvt_pk_bf16_f32 v253, v210, v211
  v_cvt_pk_bf16_f32 v254, v212, v213
  v_cvt_pk_bf16_f32 v255, v214, v215
  s_nop 0
  v_permlane16_swap_b32 v252, v254
  v_permlane16_swap_b32 v253, v255
  buffer_store_dwordx4 v[252:255], v240, s[4:7], s34 offen offset:2048 sc1
  v_pk_mul_f32 v[216:217], v[216:217], v[232:233] op_sel_hi:[1,0]
  v_pk_mul_f32 v[218:219], v[218:219], v[232:233] op_sel_hi:[1,0]
  v_pk_mul_f32 v[220:221], v[220:221], v[232:233] op_sel_hi:[1,0]
  v_pk_mul_f32 v[222:223], v[222:223], v[232:233] op_sel_hi:[1,0]
  v_cvt_pk_bf16_f32 v184, v216, v217
  v_cvt_pk_bf16_f32 v185, v218, v219
  v_cvt_pk_bf16_f32 v186, v220, v221
  v_cvt_pk_bf16_f32 v187, v222, v223
  s_nop 0
  v_permlane16_swap_b32 v184, v186
  v_permlane16_swap_b32 v185, v187
  buffer_store_dwordx4 v[184:187], v240, s[4:7], s34 offen offset:3072 sc1
  v_cndmask_b32 v172, v249, v172, s[84:85]
  v_cndmask_b32 v173, v249, v173, s[86:87]
  v_cndmask_b32 v174, v249, v174, s[88:89]
  v_cndmask_b32 v175, v249, v175, s[90:91]
  v_cndmask_b32 v176, v249, v176, s[92:93]
  v_cndmask_b32 v177, v249, v177, s[94:95]
  v_cndmask_b32 v178, v249, v178, s[96:97]
  v_cndmask_b32 v179, v249, v179, s[98:99]
  v_max3_f32 v188, v172, v173, v174
  v_max3_f32 v189, v175, v176, v177
  v_max3_f32 v188, v178, v179, v188
  v_max3_f32 v189, v180, v181, v189
  v_max_f32 v188, v188, v189
  v_mov_b32 v189, v188
  s_nop 1
  v_permlane16_swap_b32 v188, v189
  s_nop 0
  v_max_f32 v188, v188, v189
  v_mov_b32 v189, v188
  s_nop 1
  v_permlane32_swap_b32 v188, v189
  s_nop 0
  v_max_f32 v188, v188, v189
  v_mul_f32 v188, s21, v188
  v_fma_f32 v172, v172, s21, -v188
  v_fma_f32 v173, v173, s21, -v188
  v_fma_f32 v174, v174, s21, -v188
  v_fma_f32 v175, v175, s21, -v188
  v_fma_f32 v176, v176, s21, -v188
  v_fma_f32 v177, v177, s21, -v188
  v_fma_f32 v178, v178, s21, -v188
  v_fma_f32 v179, v179, s21, -v188
  v_fma_f32 v180, v180, s21, -v188
  v_fma_f32 v181, v181, s21, -v188
  v_exp_f32 v172, v172
  v_exp_f32 v173, v173
  v_exp_f32 v174, v174
  v_exp_f32 v175, v175
  v_exp_f32 v176, v176
  v_exp_f32 v177, v177
  v_exp_f32 v178, v178
  v_exp_f32 v179, v179
  v_exp_f32 v180, v180
  v_exp_f32 v181, v181
  v_cvt_pk_bf16_f32 v224, v172, v173
  v_cvt_pk_bf16_f32 v225, v174, v175
  v_cvt_pk_bf16_f32 v226, v176, v177
  v_cvt_pk_bf16_f32 v227, v178, v179
  v_cvt_pk_bf16_f32 v228, v180, v181
  v_mov_b32 v231, v228
  s_nop 0
  v_mfma_f32_16x16x32_bf16 v[232:235], v[236:239], v[224:227], 0
  v_mfma_f32_16x16x32_bf16 v[192:195], a[96:99], v[224:227], 0
  v_mfma_f32_16x16x32_bf16 v[196:199], a[100:103], v[224:227], 0
  v_mfma_f32_16x16x32_bf16 v[200:203], a[104:107], v[224:227], 0
  v_mfma_f32_16x16x32_bf16 v[204:207], a[108:111], v[224:227], 0
  v_mfma_f32_16x16x32_bf16 v[208:211], a[112:115], v[224:227], 0
  v_mfma_f32_16x16x32_bf16 v[212:215], a[116:119], v[224:227], 0
  v_mfma_f32_16x16x32_bf16 v[216:219], a[120:123], v[224:227], 0
  v_mfma_f32_16x16x32_bf16 v[220:223], a[124:127], v[224:227], 0
  v_mfma_f32_16x16x16_bf16 v[232:235], v[236:237], v[228:229], v[232:235]
  v_mfma_f32_16x16x16_bf16 v[192:195], v[152:153], v[228:229], v[192:195]
  v_mfma_f32_16x16x16_bf16 v[196:199], v[152:153], v[230:231], v[196:199]
  v_mfma_f32_16x16x16_bf16 v[200:203], v[154:155], v[228:229], v[200:203]
  v_mfma_f32_16x16x16_bf16 v[204:207], v[154:155], v[230:231], v[204:207]
  v_mfma_f32_16x16x16_bf16 v[208:211], v[156:157], v[228:229], v[208:211]
  v_mfma_f32_16x16x16_bf16 v[212:215], v[156:157], v[230:231], v[212:215]
  v_mfma_f32_16x16x16_bf16 v[216:219], v[158:159], v[228:229], v[216:219]
  v_mfma_f32_16x16x16_bf16 v[220:223], v[158:159], v[230:231], v[220:223]
  v_rcp_f32 v232, v232
  s_nop 0
  v_pk_mul_f32 v[192:193], v[192:193], v[232:233] op_sel_hi:[1,0]
  v_pk_mul_f32 v[194:195], v[194:195], v[232:233] op_sel_hi:[1,0]
  v_pk_mul_f32 v[196:197], v[196:197], v[232:233] op_sel_hi:[1,0]
  v_pk_mul_f32 v[198:199], v[198:199], v[232:233] op_sel_hi:[1,0]
  v_cvt_pk_bf16_f32 v252, v192, v193
  v_cvt_pk_bf16_f32 v253, v194, v195
  v_cvt_pk_bf16_f32 v254, v196, v197
  v_cvt_pk_bf16_f32 v255, v198, v199
  s_nop 0
  v_permlane16_swap_b32 v252, v254
  v_permlane16_swap_b32 v253, v255
  buffer_store_dwordx4 v[252:255], v241, s[4:7], s34 offen offset:0 sc1
  v_pk_mul_f32 v[200:201], v[200:201], v[232:233] op_sel_hi:[1,0]
  v_pk_mul_f32 v[202:203], v[202:203], v[232:233] op_sel_hi:[1,0]
  v_pk_mul_f32 v[204:205], v[204:205], v[232:233] op_sel_hi:[1,0]
  v_pk_mul_f32 v[206:207], v[206:207], v[232:233] op_sel_hi:[1,0]
  v_cvt_pk_bf16_f32 v184, v200, v201
  v_cvt_pk_bf16_f32 v185, v202, v203
  v_cvt_pk_bf16_f32 v186, v204, v205
  v_cvt_pk_bf16_f32 v187, v206, v207
  s_nop 0
  v_permlane16_swap_b32 v184, v186
  v_permlane16_swap_b32 v185, v187
  buffer_store_dwordx4 v[184:187], v241, s[4:7], s34 offen offset:1024 sc1
  v_pk_mul_f32 v[208:209], v[208:209], v[232:233] op_sel_hi:[1,0]
  v_pk_mul_f32 v[210:211], v[210:211], v[232:233] op_sel_hi:[1,0]
  v_pk_mul_f32 v[212:213], v[212:213], v[232:233] op_sel_hi:[1,0]
  v_pk_mul_f32 v[214:215], v[214:215], v[232:233] op_sel_hi:[1,0]
  v_cvt_pk_bf16_f32 v252, v208, v209
  v_cvt_pk_bf16_f32 v253, v210, v211
  v_cvt_pk_bf16_f32 v254, v212, v213
  v_cvt_pk_bf16_f32 v255, v214, v215
  s_nop 0
  v_permlane16_swap_b32 v252, v254
  v_permlane16_swap_b32 v253, v255
  buffer_store_dwordx4 v[252:255], v241, s[4:7], s34 offen offset:2048 sc1
  v_pk_mul_f32 v[216:217], v[216:217], v[232:233] op_sel_hi:[1,0]
  v_pk_mul_f32 v[218:219], v[218:219], v[232:233] op_sel_hi:[1,0]
  v_pk_mul_f32 v[220:221], v[220:221], v[232:233] op_sel_hi:[1,0]
  v_pk_mul_f32 v[222:223], v[222:223], v[232:233] op_sel_hi:[1,0]
  v_cvt_pk_bf16_f32 v184, v216, v217
  v_cvt_pk_bf16_f32 v185, v218, v219
  v_cvt_pk_bf16_f32 v186, v220, v221
  v_cvt_pk_bf16_f32 v187, v222, v223
  s_nop 0
  v_permlane16_swap_b32 v184, v186
  v_permlane16_swap_b32 v185, v187
  buffer_store_dwordx4 v[184:187], v241, s[4:7], s34 offen offset:3072 sc1
  s_cmp_lt_u32 s37, 48
  s_cbranch_scc1 pg_178_ns
  s_lshl_b32 s38, s37, 2
  s_mov_b32 s39, 1
  s_waitcnt vmcnt(0)
  s_cmp_eq_u32 s38, 0
  s_cbranch_scc1 fr_179
  v_mov_b32 v160, s39
  v_mov_b32 v161, s38
  s_mov_b64 exec, 1
  buffer_atomic_add v160, v161, s[40:43], 0 offen sc1
  s_mov_b64 exec, -1
  s_mov_b32 s38, 0
fr_179:
pg_178_ns:
  s_add_u32 s34, s34, 524288
  s_add_u32 s37, s37, 2
  s_lshl_b32 s38, s27, 2
  s_add_u32 s38, s38, 160
  s_mov_b32 s39, 1
  s_waitcnt vmcnt(63)
  s_branch run
epi_5:
  s_cmp_lg_u32 s26, 5
  s_cbranch_scc1 epi_6
  v_and_b32 v30, 1, v29
  v_lshlrev_b32 v30, 5, v30
  v_lshrrev_b32 v160, 1, v29
  v_lshl_add_u32 v30, v160, 4, v30
  s_mul_i32 s58, s56, 262144
  s_mul_i32 s59, s57, 2048
  s_add_u32 s58, s58, s59
  v_add_u32 v30, v30, v28
  v_lshl_add_u32 v30, v30, 4, s58
  v_accvgpr_read_b32 v32, a0
  v_accvgpr_read_b32 v33, a1
  v_accvgpr_read_b32 v34, a2
  v_accvgpr_read_b32 v35, a3
  v_accvgpr_read_b32 v36, a4
  v_accvgpr_read_b32 v37, a5
  v_accvgpr_read_b32 v38, a6
  v_accvgpr_read_b32 v39, a7
  s_add_u32 m0, s55, 0
  s_nop 0
  buffer_load_dwordx4 v12, s[44:47], s52 offen  lds
  s_add_u32 m0, s55, 65536
  s_nop 0
  buffer_load_dwordx4 v20, s[48:51], s53 offen lds
  v_cvt_pk_bf16_f32 v64, v32, v33
  v_cvt_pk_bf16_f32 v65, v34, v35
  v_cvt_pk_bf16_f32 v66, v36, v37
  v_cvt_pk_bf16_f32 v67, v38, v39
  s_nop 0
  v_permlane16_swap_b32 v64, v66
  v_permlane16_swap_b32 v65, v67
  buffer_store_dwordx4 v[64:67], v30, s[4:7], s63 offen offset:0 sc1
  v_accvgpr_read_b32 v40, a8
  v_accvgpr_read_b32 v41, a9
  v_accvgpr_read_b32 v42, a10
  v_accvgpr_read_b32 v43, a11
  v_accvgpr_read_b32 v44, a12
  v_accvgpr_read_b32 v45, a13
  v_accvgpr_read_b32 v46, a14
  v_accvgpr_read_b32 v47, a15
  s_add_u32 m0, s55, 4096
  s_nop 0
  buffer_load_dwordx4 v13, s[44:47], s52 offen  lds
  s_add_u32 m0, s55, 69632
  s_nop 0
  buffer_load_dwordx4 v21, s[48:51], s53 offen lds
  v_cvt_pk_bf16_f32 v68, v40, v41
  v_cvt_pk_bf16_f32 v69, v42, v43
  v_cvt_pk_bf16_f32 v70, v44, v45
  v_cvt_pk_bf16_f32 v71, v46, v47
  s_nop 0
  v_permlane16_swap_b32 v68, v70
  v_permlane16_swap_b32 v69, v71
  buffer_store_dwordx4 v[68:71], v30, s[4:7], s63 offen offset:1024 sc1
  s_add_u32 s63, s63, 32768
  v_accvgpr_read_b32 v32, a16
  v_accvgpr_read_b32 v33, a17
  v_accvgpr_read_b32 v34, a18
  v_accvgpr_read_b32 v35, a19
  v_accvgpr_read_b32 v36, a20
  v_accvgpr_read_b32 v37, a21
  v_accvgpr_read_b32 v38, a22
  v_accvgpr_read_b32 v39, a23
  s_add_u32 m0, s55, 8192
  s_nop 0
  buffer_load_dwordx4 v14, s[44:47], s52 offen  lds
  s_add_u32 m0, s55, 73728
  s_nop 0
  buffer_load_dwordx4 v22, s[48:51], s53 offen lds
  v_cvt_pk_bf16_f32 v72, v32, v33
  v_cvt_pk_bf16_f32 v73, v34, v35
  v_cvt_pk_bf16_f32 v74, v36, v37
  v_cvt_pk_bf16_f32 v75, v38, v39
  s_nop 0
  v_permlane16_swap_b32 v72, v74
  v_permlane16_swap_b32 v73, v75
  buffer_store_dwordx4 v[72:75], v30, s[4:7], s63 offen offset:0 sc1
  v_accvgpr_read_b32 v40, a24
  v_accvgpr_read_b32 v41, a25
  v_accvgpr_read_b32 v42, a26
  v_accvgpr_read_b32 v43, a27
  v_accvgpr_read_b32 v44, a28
  v_accvgpr_read_b32 v45, a29
  v_accvgpr_read_b32 v46, a30
  v_accvgpr_read_b32 v47, a31
  s_add_u32 m0, s55, 12288
  s_nop 0
  buffer_load_dwordx4 v15, s[44:47], s52 offen  lds
  s_add_u32 m0, s55, 77824
  s_nop 0
  buffer_load_dwordx4 v23, s[48:51], s53 offen lds
  v_cvt_pk_bf16_f32 v76, v40, v41
  v_cvt_pk_bf16_f32 v77, v42, v43
  v_cvt_pk_bf16_f32 v78, v44, v45
  v_cvt_pk_bf16_f32 v79, v46, v47
  s_nop 0
  v_permlane16_swap_b32 v76, v78
  v_permlane16_swap_b32 v77, v79
  buffer_store_dwordx4 v[76:79], v30, s[4:7], s63 offen offset:1024 sc1
  s_add_u32 s63, s63, 32768
  v_accvgpr_read_b32 v32, a32
  v_accvgpr_read_b32 v33, a33
  v_accvgpr_read_b32 v34, a34
  v_accvgpr_read_b32 v35, a35
  v_accvgpr_read_b32 v36, a36
  v_accvgpr_read_b32 v37, a37
  v_accvgpr_read_b32 v38, a38
  v_accvgpr_read_b32 v39, a39
  s_add_u32 m0, s55, 16384
  s_nop 0
  buffer_load_dwordx4 v16, s[44:47], s52 offen  lds
  s_add_u32 m0, s55, 81920
  s_nop 0
  buffer_load_dwordx4 v24, s[48:51], s53 offen lds
  v_cvt_pk_bf16_f32 v80, v32, v33
  v_cvt_pk_bf16_f32 v81, v34, v35
  v_cvt_pk_bf16_f32 v82, v36, v37
  v_cvt_pk_bf16_f32 v83, v38, v39
  s_nop 0
  v_permlane16_swap_b32 v80, v82
  v_permlane16_swap_b32 v81, v83
  buffer_store_dwordx4 v[80:83], v30, s[4:7], s63 offen offset:0 sc1
  v_accvgpr_read_b32 v40, a40
  v_accvgpr_read_b32 v41, a41
  v_accvgpr_read_b32 v42, a42
  v_accvgpr_read_b32 v43, a43
  v_accvgpr_read_b32 v44, a44
  v_accvgpr_read_b32 v45, a45
  v_accvgpr_read_b32 v46, a46
  v_accvgpr_read_b32 v47, a47
  s_add_u32 m0, s55, 20480
  s_nop 0
  buffer_load_dwordx4 v17, s[44:47], s52 offen  lds
  s_add_u32 m0, s55, 86016
  s_nop 0
  buffer_load_dwordx4 v25, s[48:51], s53 offen lds
  v_cvt_pk_bf16_f32 v84, v40, v41
  v_cvt_pk_bf16_f32 v85, v42, v43
  v_cvt_pk_bf16_f32 v86, v44, v45
  v_cvt_pk_bf16_f32 v87, v46, v47
  s_nop 0
  v_permlane16_swap_b32 v84, v86
  v_permlane16_swap_b32 v85, v87
  buffer_store_dwordx4 v[84:87], v30, s[4:7], s63 offen offset:1024 sc1
  s_add_u32 s63, s63, 32768
  v_accvgpr_read_b32 v32, a48
  v_accvgpr_read_b32 v33, a49
  v_accvgpr_read_b32 v34, a50
  v_accvgpr_read_b32 v35, a51
  v_accvgpr_read_b32 v36, a52
  v_accvgpr_read_b32 v37, a53
  v_accvgpr_read_b32 v38, a54
  v_accvgpr_read_b32 v39, a55
  s_add_u32 m0, s55, 24576
  s_nop 0
  buffer_load_dwordx4 v18, s[44:47], s52 offen  lds
  s_add_u32 m0, s55, 90112
  s_nop 0
  buffer_load_dwordx4 v26, s[48:51], s53 offen lds
  v_cvt_pk_bf16_f32 v88, v32, v33
  v_cvt_pk_bf16_f32 v89, v34, v35
  v_cvt_pk_bf16_f32 v90, v36, v37
  v_cvt_pk_bf16_f32 v91, v38, v39
  s_nop 0
  v_permlane16_swap_b32 v88, v90
  v_permlane16_swap_b32 v89, v91
  buffer_store_dwordx4 v[88:91], v30, s[4:7], s63 offen offset:0 sc1
  v_accvgpr_read_b32 v40, a56
  v_accvgpr_read_b32 v41, a57
  v_accvgpr_read_b32 v42, a58
  v_accvgpr_read_b32 v43, a59
  v_accvgpr_read_b32 v44, a60
  v_accvgpr_read_b32 v45, a61
  v_accvgpr_read_b32 v46, a62
  v_accvgpr_read_b32 v47, a63
  s_add_u32 m0, s55, 28672
  s_nop 0
  buffer_load_dwordx4 v19, s[44:47], s52 offen  lds
  s_add_u32 m0, s55, 94208
  s_nop 0
  buffer_load_dwordx4 v27, s[48:51], s53 offen lds
  s_add_u32 s52, s52, 128
  s_add_u32 s53, s53, s22
  v_cvt_pk_bf16_f32 v92, v40, v41
  v_cvt_pk_bf16_f32 v93, v42, v43
  v_cvt_pk_bf16_f32 v94, v44, v45
  v_cvt_pk_bf16_f32 v95, v46, v47
  s_nop 0
  v_permlane16_swap_b32 v92, v94
  v_permlane16_swap_b32 v93, v95
  buffer_store_dwordx4 v[92:95], v30, s[4:7], s63 offen offset:1024 sc1
  s_add_u32 s63, s63, 32768
  v_accvgpr_read_b32 v32, a64
  v_accvgpr_read_b32 v33, a65
  v_accvgpr_read_b32 v34, a66
  v_accvgpr_read_b32 v35, a67
  v_accvgpr_read_b32 v36, a68
  v_accvgpr_read_b32 v37, a69
  v_accvgpr_read_b32 v38, a70
  v_accvgpr_read_b32 v39, a71
  s_add_u32 m0, s55, 32768
  s_nop 0
  buffer_load_dwordx4 v12, s[44:47], s52 offen  lds
  s_add_u32 m0, s55, 98304
  s_nop 0
  buffer_load_dwordx4 v20, s[48:51], s53 offen lds
  v_cvt_pk_bf16_f32 v64, v32, v33
  v_cvt_pk_bf16_f32 v65, v34, v35
  v_cvt_pk_bf16_f32 v66, v36, v37
  v_cvt_pk_bf16_f32 v67, v38, v39
  s_nop 0
  v_permlane16_swap_b32 v64, v66
  v_permlane16_swap_b32 v65, v67
  buffer_store_dwordx4 v[64:67], v30, s[4:7], s63 offen offset:0 sc1
  v_accvgpr_read_b32 v40, a72
  v_accvgpr_read_b32 v41, a73
  v_accvgpr_read_b32 v42, a74
  v_accvgpr_read_b32 v43, a75
  v_accvgpr_read_b32 v44, a76
  v_accvgpr_read_b32 v45, a77
  v_accvgpr_read_b32 v46, a78
  v_accvgpr_read_b32 v47, a79
  s_add_u32 m0, s55, 36864
  s_nop 0
  buffer_load_dwordx4 v13, s[44:47], s52 offen  lds
  s_add_u32 m0, s55, 102400
  s_nop 0
  buffer_load_dwordx4 v21, s[48:51], s53 offen lds
  v_cvt_pk_bf16_f32 v68, v40, v41
  v_cvt_pk_bf16_f32 v69, v42, v43
  v_cvt_pk_bf16_f32 v70, v44, v45
  v_cvt_pk_bf16_f32 v71, v46, v47
  s_nop 0
  v_permlane16_swap_b32 v68, v70
  v_permlane16_swap_b32 v69, v71
  buffer_store_dwordx4 v[68:71], v30, s[4:7], s63 offen offset:1024 sc1
  s_add_u32 s63, s63, 32768
  v_accvgpr_read_b32 v32, a80
  v_accvgpr_read_b32 v33, a81
  v_accvgpr_read_b32 v34, a82
  v_accvgpr_read_b32 v35, a83
  v_accvgpr_read_b32 v36, a84
  v_accvgpr_read_b32 v37, a85
  v_accvgpr_read_b32 v38, a86
  v_accvgpr_read_b32 v39, a87
  s_add_u32 m0, s55, 40960
  s_nop 0
  buffer_load_dwordx4 v14, s[44:47], s52 offen  lds
  s_add_u32 m0, s55, 106496
  s_nop 0
  buffer_load_dwordx4 v22, s[48:51], s53 offen lds
  v_cvt_pk_bf16_f32 v72, v32, v33
  v_cvt_pk_bf16_f32 v73, v34, v35
  v_cvt_pk_bf16_f32 v74, v36, v37
  v_cvt_pk_bf16_f32 v75, v38, v39
  s_nop 0
  v_permlane16_swap_b32 v72, v74
  v_permlane16_swap_b32 v73, v75
  buffer_store_dwordx4 v[72:75], v30, s[4:7], s63 offen offset:0 sc1
  v_accvgpr_read_b32 v40, a88
  v_accvgpr_read_b32 v41, a89
  v_accvgpr_read_b32 v42, a90
  v_accvgpr_read_b32 v43, a91
  v_accvgpr_read_b32 v44, a92
  v_accvgpr_read_b32 v45, a93
  v_accvgpr_read_b32 v46, a94
  v_accvgpr_read_b32 v47, a95
  s_add_u32 m0, s55, 45056
  s_nop 0
  buffer_load_dwordx4 v15, s[44:47], s52 offen  lds
  s_add_u32 m0, s55, 110592
  s_nop 0
  buffer_load_dwordx4 v23, s[48:51], s53 offen lds
  v_cvt_pk_bf16_f32 v76, v40, v41
  v_cvt_pk_bf16_f32 v77, v42, v43
  v_cvt_pk_bf16_f32 v78, v44, v45
  v_cvt_pk_bf16_f32 v79, v46, v47
  s_nop 0
  v_permlane16_swap_b32 v76, v78
  v_permlane16_swap_b32 v77, v79
  buffer_store_dwordx4 v[76:79], v30, s[4:7], s63 offen offset:1024 sc1
  s_add_u32 s63, s63, 32768
  v_accvgpr_read_b32 v32, a96
  v_accvgpr_read_b32 v33, a97
  v_accvgpr_read_b32 v34, a98
  v_accvgpr_read_b32 v35, a99
  v_accvgpr_read_b32 v36, a100
  v_accvgpr_read_b32 v37, a101
  v_accvgpr_read_b32 v38, a102
  v_accvgpr_read_b32 v39, a103
  s_add_u32 m0, s55, 49152
  s_nop 0
  buffer_load_dwordx4 v16, s[44:47], s52 offen  lds
  s_add_u32 m0, s55, 114688
  s_nop 0
  buffer_load_dwordx4 v24, s[48:51], s53 offen lds
  v_cvt_pk_bf16_f32 v80, v32, v33
  v_cvt_pk_bf16_f32 v81, v34, v35
  v_cvt_pk_bf16_f32 v82, v36, v37
  v_cvt_pk_bf16_f32 v83, v38, v39
  s_nop 0
  v_permlane16_swap_b32 v80, v82
  v_permlane16_swap_b32 v81, v83
  buffer_store_dwordx4 v[80:83], v30, s[4:7], s63 offen offset:0 sc1
  v_accvgpr_read_b32 v40, a104
  v_accvgpr_read_b32 v41, a105
  v_accvgpr_read_b32 v42, a106
  v_accvgpr_read_b32 v43, a107
  v_accvgpr_read_b32 v44, a108
  v_accvgpr_read_b32 v45, a109
  v_accvgpr_read_b32 v46, a110
  v_accvgpr_read_b32 v47, a111
  s_add_u32 m0, s55, 53248
  s_nop 0
  buffer_load_dwordx4 v17, s[44:47], s52 offen  lds
  s_add_u32 m0, s55, 118784
  s_nop 0
  buffer_load_dwordx4 v25, s[48:51], s53 offen lds
  v_cvt_pk_bf16_f32 v84, v40, v41
  v_cvt_pk_bf16_f32 v85, v42, v43
  v_cvt_pk_bf16_f32 v86, v44, v45
  v_cvt_pk_bf16_f32 v87, v46, v47
  s_nop 0
  v_permlane16_swap_b32 v84, v86
  v_permlane16_swap_b32 v85, v87
  buffer_store_dwordx4 v[84:87], v30, s[4:7], s63 offen offset:1024 sc1
  s_add_u32 s63, s63, 32768
  v_accvgpr_read_b32 v32, a112
  v_accvgpr_read_b32 v33, a113
  v_accvgpr_read_b32 v34, a114
  v_accvgpr_read_b32 v35, a115
  v_accvgpr_read_b32 v36, a116
  v_accvgpr_read_b32 v37, a117
  v_accvgpr_read_b32 v38, a118
  v_accvgpr_read_b32 v39, a119
  v_cvt_pk_bf16_f32 v88, v32, v33
  v_cvt_pk_bf16_f32 v89, v34, v35
  v_cvt_pk_bf16_f32 v90, v36, v37
  v_cvt_pk_bf16_f32 v91, v38, v39
  s_nop 0
  v_permlane16_swap_b32 v88, v90
  v_permlane16_swap_b32 v89, v91
  buffer_store_dwordx4 v[88:91], v30, s[4:7], s63 offen offset:0 sc1
  v_accvgpr_read_b32 v40, a120
  v_accvgpr_read_b32 v41, a121
  v_accvgpr_read_b32 v42, a122
  v_accvgpr_read_b32 v43, a123
  v_accvgpr_read_b32 v44, a124
  v_accvgpr_read_b32 v45, a125
  v_accvgpr_read_b32 v46, a126
  v_accvgpr_read_b32 v47, a127
  v_cvt_pk_bf16_f32 v92, v40, v41
  v_cvt_pk_bf16_f32 v93, v42, v43
  v_cvt_pk_bf16_f32 v94, v44, v45
  v_cvt_pk_bf16_f32 v95, v46, v47
  s_nop 0
  v_permlane16_swap_b32 v92, v94
  v_permlane16_swap_b32 v93, v95
  buffer_store_dwordx4 v[92:95], v30, s[4:7], s63 offen offset:1024 sc1
  s_add_u32 s63, s63, 32768
  s_lshl_b32 s38, s27, 2
  s_add_u32 s38, s38, 112
  s_mov_b32 s39, 1
  s_waitcnt vmcnt(21)
  s_branch run
epi_6:
  s_cmp_eq_u32 s50, 0
  s_cbranch_scc1 nodma6
  s_add_u32 m0, s55, 0
  s_nop 0
  buffer_load_dwordx4 v12, s[44:47], s52 offen  lds
  s_add_u32 m0, s55, 65536
  s_nop 0
  buffer_load_dwordx4 v20, s[48:51], s53 offen lds
  s_add_u32 m0, s55, 4096
  s_nop 0
  buffer_load_dwordx4 v13, s[44:47], s52 offen  lds
  s_add_u32 m0, s55, 69632
  s_nop 0
  buffer_load_dwordx4 v21, s[48:51], s53 offen lds
  s_add_u32 m0, s55, 8192
  s_nop 0
  buffer_load_dwordx4 v14, s[44:47], s52 offen  lds
  s_add_u32 m0, s55, 73728
  s_nop 0
  buffer_load_dwordx4 v22, s[48:51], s53 offen lds
  s_add_u32 m0, s55, 12288
  s_nop 0
  buffer_load_dwordx4 v15, s[44:47], s52 offen  lds
  s_add_u32 m0, s55, 77824
  s_nop 0
  buffer_load_dwordx4 v23, s[48:51], s53 offen lds
  s_add_u32 m0, s55, 16384
  s_nop 0
  buffer_load_dwordx4 v16, s[44:47], s52 offen  lds
  s_add_u32 m0, s55, 81920
  s_nop 0
  buffer_load_dwordx4 v24, s[48:51], s53 offen lds
  s_add_u32 m0, s55, 20480
  s_nop 0
  buffer_load_dwordx4 v17, s[44:47], s52 offen  lds
  s_add_u32 m0, s55, 86016
  s_nop 0
  buffer_load_dwordx4 v25, s[48:51], s53 offen lds
  s_add_u32 m0, s55, 24576
  s_nop 0
  buffer_load_dwordx4 v18, s[44:47], s52 offen  lds
  s_add_u32 m0, s55, 90112
  s_nop 0
  buffer_load_dwordx4 v26, s[48:51], s53 offen lds
  s_add_u32 m0, s55, 28672
  s_nop 0
  buffer_load_dwordx4 v19, s[44:47], s52 offen  lds
  s_add_u32 m0, s55, 94208
  s_nop 0
  buffer_load_dwordx4 v27, s[48:51], s53 offen lds
  s_add_u32 s52, s52, 128
  s_add_u32 s53, s53, s22
  s_add_u32 m0, s55, 32768
  s_nop 0
  buffer_load_dwordx4 v12, s[44:47], s52 offen  lds
  s_add_u32 m0, s55, 98304
  s_nop 0
  buffer_load_dwordx4 v20, s[48:51], s53 offen lds
  s_add_u32 m0, s55, 36864
  s_nop 0
  buffer_load_dwordx4 v13, s[44:47], s52 offen  lds
  s_add_u32 m0, s55, 102400
  s_nop 0
  buffer_load_dwordx4 v21, s[48:51], s53 offen lds
  s_add_u32 m0, s55, 40960
  s_nop 0
  buffer_load_dwordx4 v14, s[44:47], s52 offen  lds
  s_add_u32 m0, s55, 106496
  s_nop 0
  buffer_load_dwordx4 v22, s[48:51], s53 offen lds
  s_add_u32 m0, s55, 45056
  s_nop 0
  buffer_load_dwordx4 v15, s[44:47], s52 offen  lds
  s_add_u32 m0, s55, 110592
  s_nop 0
  buffer_load_dwordx4 v23, s[48:51], s53 offen lds
  s_add_u32 m0, s55, 49152
  s_nop 0
  buffer_load_dwordx4 v16, s[44:47], s52 offen  lds
  s_add_u32 m0, s55, 114688
  s_nop 0
  buffer_load_dwordx4 v24, s[48:51], s53 offen lds
  s_add_u32 m0, s55, 53248
  s_nop 0
  buffer_load_dwordx4 v17, s[44:47], s52 offen  lds
  s_add_u32 m0, s55, 118784
  s_nop 0
  buffer_load_dwordx4 v25, s[48:51], s53 offen lds
nodma6:
  v_and_b32 v30, 1, v29
  v_lshlrev_b32 v30, 5, v30
  v_lshrrev_b32 v160, 1, v29
  v_lshl_add_u32 v30, v160, 4, v30
  s_mul_i32 s58, s56, 131072
  s_mul_i32 s59, s57, 128
  s_add_u32 s58, s58, s59
  v_mul_u32_u24 v160, 2048, v28
  v_add3_u32 v30, v30, v160, s58
  v_accvgpr_read_b32 v32, a0
  v_accvgpr_read_b32 v33, a1
  v_accvgpr_read_b32 v34, a2
  v_accvgpr_read_b32 v35, a3
  v_accvgpr_read_b32 v36, a4
  v_accvgpr_read_b32 v37, a5
  v_accvgpr_read_b32 v38, a6
  v_accvgpr_read_b32 v39, a7
  v_lshlrev_b32 v48, 16, v192
  v_and_b32 v49, 0xffff0000, v192
  v_lshlrev_b32 v50, 16, v193
  v_and_b32 v51, 0xffff0000, v193
  v_lshlrev_b32 v52, 16, v194
  v_and_b32 v53, 0xffff0000, v194
  v_lshlrev_b32 v54, 16, v195
  v_and_b32 v55, 0xffff0000, v195
  v_permlane16_swap_b32 v32, v36
  v_permlane16_swap_b32 v33, v37
  v_permlane16_swap_b32 v34, v38
  v_permlane16_swap_b32 v35, v39
  v_sub_f32 v32, v32, v48
  v_sub_f32 v33, v33, v49
  v_sub_f32 v34, v34, v50
  v_sub_f32 v35, v35, v51
  v_sub_f32 v36, v36, v52
  v_sub_f32 v37, v37, v53
  v_sub_f32 v38, v38, v54
  v_sub_f32 v39, v39, v55
  v_fmac_f32 v48, v32, v224
  v_fmac_f32 v49, v33, v224
  v_fmac_f32 v50, v34, v224
  v_fmac_f32 v51, v35, v224
  v_fmac_f32 v52, v36, v224
  v_fmac_f32 v53, v37, v224
  v_fmac_f32 v54, v38, v224
  v_fmac_f32 v55, v39, v224
  v_cvt_pk_bf16_f32 v64, v48, v49
  v_cvt_pk_bf16_f32 v65, v50, v51
  v_cvt_pk_bf16_f32 v66, v52, v53
  v_cvt_pk_bf16_f32 v67, v54, v55
  buffer_store_dwordx4 v[64:67], v30, s[8:11], s63 offen offset:0
  v_accvgpr_read_b32 v40, a8
  v_accvgpr_read_b32 v41, a9
  v_accvgpr_read_b32 v42, a10
  v_accvgpr_read_b32 v43, a11
  v_accvgpr_read_b32 v44, a12
  v_accvgpr_read_b32 v45, a13
  v_accvgpr_read_b32 v46, a14
  v_accvgpr_read_b32 v47, a15
  v_lshlrev_b32 v56, 16, v196
  v_and_b32 v57, 0xffff0000, v196
  v_lshlrev_b32 v58, 16, v197
  v_and_b32 v59, 0xffff0000, v197
  v_lshlrev_b32 v60, 16, v198
  v_and_b32 v61, 0xffff0000, v198
  v_lshlrev_b32 v62, 16, v199
  v_and_b32 v63, 0xffff0000, v199
  v_permlane16_swap_b32 v40, v44
  v_permlane16_swap_b32 v41, v45
  v_permlane16_swap_b32 v42, v46
  v_permlane16_swap_b32 v43, v47
  v_sub_f32 v40, v40, v56
  v_sub_f32 v41, v41, v57
  v_sub_f32 v42, v42, v58
  v_sub_f32 v43, v43, v59
  v_sub_f32 v44, v44, v60
  v_sub_f32 v45, v45, v61
  v_sub_f32 v46, v46, v62
  v_sub_f32 v47, v47, v63
  v_fmac_f32 v56, v40, v224
  v_fmac_f32 v57, v41, v224
  v_fmac_f32 v58, v42, v224
  v_fmac_f32 v59, v43, v224
  v_fmac_f32 v60, v44, v224
  v_fmac_f32 v61, v45, v224
  v_fmac_f32 v62, v46, v224
  v_fmac_f32 v63, v47, v224
  v_cvt_pk_bf16_f32 v68, v56, v57
  v_cvt_pk_bf16_f32 v69, v58, v59
  v_cvt_pk_bf16_f32 v70, v60, v61
  v_cvt_pk_bf16_f32 v71, v62, v63
  buffer_store_dwordx4 v[68:71], v30, s[8:11], s63 offen offset:64
  s_add_u32 s63, s63, 32768
  v_accvgpr_read_b32 v32, a16
  v_accvgpr_read_b32 v33, a17
  v_accvgpr_read_b32 v34, a18
  v_accvgpr_read_b32 v35, a19
  v_accvgpr_read_b32 v36, a20
  v_accvgpr_read_b32 v37, a21
  v_accvgpr_read_b32 v38, a22
  v_accvgpr_read_b32 v39, a23
  v_lshlrev_b32 v48, 16, v200
  v_and_b32 v49, 0xffff0000, v200
  v_lshlrev_b32 v50, 16, v201
  v_and_b32 v51, 0xffff0000, v201
  v_lshlrev_b32 v52, 16, v202
  v_and_b32 v53, 0xffff0000, v202
  v_lshlrev_b32 v54, 16, v203
  v_and_b32 v55, 0xffff0000, v203
  v_permlane16_swap_b32 v32, v36
  v_permlane16_swap_b32 v33, v37
  v_permlane16_swap_b32 v34, v38
  v_permlane16_swap_b32 v35, v39
  v_sub_f32 v32, v32, v48
  v_sub_f32 v33, v33, v49
  v_sub_f32 v34, v34, v50
  v_sub_f32 v35, v35, v51
  v_sub_f32 v36, v36, v52
  v_sub_f32 v37, v37, v53
  v_sub_f32 v38, v38, v54
  v_sub_f32 v39, v39, v55
  v_fmac_f32 v48, v32, v225
  v_fmac_f32 v49, v33, v225
  v_fmac_f32 v50, v34, v225
  v_fmac_f32 v51, v35, v225
  v_fmac_f32 v52, v36, v225
  v_fmac_f32 v53, v37, v225
  v_fmac_f32 v54, v38, v225
  v_fmac_f32 v55, v39, v225
  v_cvt_pk_bf16_f32 v72, v48, v49
  v_cvt_pk_bf16_f32 v73, v50, v51
  v_cvt_pk_bf16_f32 v74, v52, v53
  v_cvt_pk_bf16_f32 v75, v54, v55
  buffer_store_dwordx4 v[72:75], v30, s[8:11], s63 offen offset:0
  v_accvgpr_read_b32 v40, a24
  v_accvgpr_read_b32 v41, a25
  v_accvgpr_read_b32 v42, a26
  v_accvgpr_read_b32 v43, a27
  v_accvgpr_read_b32 v44, a28
  v_accvgpr_read_b32 v45, a29
  v_accvgpr_read_b32 v46, a30
  v_accvgpr_read_b32 v47, a31
  v_lshlrev_b32 v56, 16, v204
  v_and_b32 v57, 0xffff0000, v204
  v_lshlrev_b32 v58, 16, v205
  v_and_b32 v59, 0xffff0000, v205
  v_lshlrev_b32 v60, 16, v206
  v_and_b32 v61, 0xffff0000, v206
  v_lshlrev_b32 v62, 16, v207
  v_and_b32 v63, 0xffff0000, v207
  v_permlane16_swap_b32 v40, v44
  v_permlane16_swap_b32 v41, v45
  v_permlane16_swap_b32 v42, v46
  v_permlane16_swap_b32 v43, v47
  v_sub_f32 v40, v40, v56
  v_sub_f32 v41, v41, v57
  v_sub_f32 v42, v42, v58
  v_sub_f32 v43, v43, v59
  v_sub_f32 v44, v44, v60
  v_sub_f32 v45, v45, v61
  v_sub_f32 v46, v46, v62
  v_sub_f32 v47, v47, v63
  v_fmac_f32 v56, v40, v225
  v_fmac_f32 v57, v41, v225
  v_fmac_f32 v58, v42, v225
  v_fmac_f32 v59, v43, v225
  v_fmac_f32 v60, v44, v225
  v_fmac_f32 v61, v45, v225
  v_fmac_f32 v62, v46, v225
  v_fmac_f32 v63, v47, v225
  v_cvt_pk_bf16_f32 v76, v56, v57
  v_cvt_pk_bf16_f32 v77, v58, v59
  v_cvt_pk_bf16_f32 v78, v60, v61
  v_cvt_pk_bf16_f32 v79, v62, v63
  buffer_store_dwordx4 v[76:79], v30, s[8:11], s63 offen offset:64
  s_add_u32 s63, s63, 32768
  v_accvgpr_read_b32 v32, a32
  v_accvgpr_read_b32 v33, a33
  v_accvgpr_read_b32 v34, a34
  v_accvgpr_read_b32 v35, a35
  v_accvgpr_read_b32 v36, a36
  v_accvgpr_read_b32 v37, a37
  v_accvgpr_read_b32 v38, a38
  v_accvgpr_read_b32 v39, a39
  v_lshlrev_b32 v48, 16, v208
  v_and_b32 v49, 0xffff0000, v208
  v_lshlrev_b32 v50, 16, v209
  v_and_b32 v51, 0xffff0000, v209
  v_lshlrev_b32 v52, 16, v210
  v_and_b32 v53, 0xffff0000, v210
  v_lshlrev_b32 v54, 16, v211
  v_and_b32 v55, 0xffff0000, v211
  v_permlane16_swap_b32 v32, v36
  v_permlane16_swap_b32 v33, v37
  v_permlane16_swap_b32 v34, v38
  v_permlane16_swap_b32 v35, v39
  v_sub_f32 v32, v32, v48
  v_sub_f32 v33, v33, v49
  v_sub_f32 v34, v34, v50
  v_sub_f32 v35, v35, v51
  v_sub_f32 v36, v36, v52
  v_sub_f32 v37, v37, v53
  v_sub_f32 v38, v38, v54
  v_sub_f32 v39, v39, v55
  v_fmac_f32 v48, v32, v226
  v_fmac_f32 v49, v33, v226
  v_fmac_f32 v50, v34, v226
  v_fmac_f32 v51, v35, v226
  v_fmac_f32 v52, v36, v226
  v_fmac_f32 v53, v37, v226
  v_fmac_f32 v54, v38, v226
  v_fmac_f32 v55, v39, v226
  v_cvt_pk_bf16_f32 v80, v48, v49
  v_cvt_pk_bf16_f32 v81, v50, v51
  v_cvt_pk_bf16_f32 v82, v52, v53
  v_cvt_pk_bf16_f32 v83, v54, v55
  buffer_store_dwordx4 v[80:83], v30, s[8:11], s63 offen offset:0
  v_accvgpr_read_b32 v40, a40
  v_accvgpr_read_b32 v41, a41
  v_accvgpr_read_b32 v42, a42
  v_accvgpr_read_b32 v43, a43
  v_accvgpr_read_b32 v44, a44
  v_accvgpr_read_b32 v45, a45
  v_accvgpr_read_b32 v46, a46
  v_accvgpr_read_b32 v47, a47
  v_lshlrev_b32 v56, 16, v212
  v_and_b32 v57, 0xffff0000, v212
  v_lshlrev_b32 v58, 16, v213
  v_and_b32 v59, 0xffff0000, v213
  v_lshlrev_b32 v60, 16, v214
  v_and_b32 v61, 0xffff0000, v214
  v_lshlrev_b32 v62, 16, v215
  v_and_b32 v63, 0xffff0000, v215
  v_permlane16_swap_b32 v40, v44
  v_permlane16_swap_b32 v41, v45
  v_permlane16_swap_b32 v42, v46
  v_permlane16_swap_b32 v43, v47
  v_sub_f32 v40, v40, v56
  v_sub_f32 v41, v41, v57
  v_sub_f32 v42, v42, v58
  v_sub_f32 v43, v43, v59
  v_sub_f32 v44, v44, v60
  v_sub_f32 v45, v45, v61
  v_sub_f32 v46, v46, v62
  v_sub_f32 v47, v47, v63
  v_fmac_f32 v56, v40, v226
  v_fmac_f32 v57, v41, v226
  v_fmac_f32 v58, v42, v226
  v_fmac_f32 v59, v43, v226
  v_fmac_f32 v60, v44, v226
  v_fmac_f32 v61, v45, v226
  v_fmac_f32 v62, v46, v226
  v_fmac_f32 v63, v47, v226
  v_cvt_pk_bf16_f32 v84, v56, v57
  v_cvt_pk_bf16_f32 v85, v58, v59
  v_cvt_pk_bf16_f32 v86, v60, v61
  v_cvt_pk_bf16_f32 v87, v62, v63
  buffer_store_dwordx4 v[84:87], v30, s[8:11], s63 offen offset:64
  s_add_u32 s63, s63, 32768
  v_accvgpr_read_b32 v32, a48
  v_accvgpr_read_b32 v33, a49
  v_accvgpr_read_b32 v34, a50
  v_accvgpr_read_b32 v35, a51
  v_accvgpr_read_b32 v36, a52
  v_accvgpr_read_b32 v37, a53
  v_accvgpr_read_b32 v38, a54
  v_accvgpr_read_b32 v39, a55
  v_lshlrev_b32 v48, 16, v216
  v_and_b32 v49, 0xffff0000, v216
  v_lshlrev_b32 v50, 16, v217
  v_and_b32 v51, 0xffff0000, v217
  v_lshlrev_b32 v52, 16, v218
  v_and_b32 v53, 0xffff0000, v218
  v_lshlrev_b32 v54, 16, v219
  v_and_b32 v55, 0xffff0000, v219
  v_permlane16_swap_b32 v32, v36
  v_permlane16_swap_b32 v33, v37
  v_permlane16_swap_b32 v34, v38
  v_permlane16_swap_b32 v35, v39
  v_sub_f32 v32, v32, v48
  v_sub_f32 v33, v33, v49
  v_sub_f32 v34, v34, v50
  v_sub_f32 v35, v35, v51
  v_sub_f32 v36, v36, v52
  v_sub_f32 v37, v37, v53
  v_sub_f32 v38, v38, v54
  v_sub_f32 v39, v39, v55
  v_fmac_f32 v48, v32, v227
  v_fmac_f32 v49, v33, v227
  v_fmac_f32 v50, v34, v227
  v_fmac_f32 v51, v35, v227
  v_fmac_f32 v52, v36, v227
  v_fmac_f32 v53, v37, v227
  v_fmac_f32 v54, v38, v227
  v_fmac_f32 v55, v39, v227
  v_cvt_pk_bf16_f32 v88, v48, v49
  v_cvt_pk_bf16_f32 v89, v50, v51
  v_cvt_pk_bf16_f32 v90, v52, v53
  v_cvt_pk_bf16_f32 v91, v54, v55
  buffer_store_dwordx4 v[88:91], v30, s[8:11], s63 offen offset:0
  v_accvgpr_read_b32 v40, a56
  v_accvgpr_read_b32 v41, a57
  v_accvgpr_read_b32 v42, a58
  v_accvgpr_read_b32 v43, a59
  v_accvgpr_read_b32 v44, a60
  v_accvgpr_read_b32 v45, a61
  v_accvgpr_read_b32 v46, a62
  v_accvgpr_read_b32 v47, a63
  v_lshlrev_b32 v56, 16, v220
  v_and_b32 v57, 0xffff0000, v220
  v_lshlrev_b32 v58, 16, v221
  v_and_b32 v59, 0xffff0000, v221
  v_lshlrev_b32 v60, 16, v222
  v_and_b32 v61, 0xffff0000, v222
  v_lshlrev_b32 v62, 16, v223
  v_and_b32 v63, 0xffff0000, v223
  v_permlane16_swap_b32 v40, v44
  v_permlane16_swap_b32 v41, v45
  v_permlane16_swap_b32 v42, v46
  v_permlane16_swap_b32 v43, v47
  v_sub_f32 v40, v40, v56
  v_sub_f32 v41, v41, v57
  v_sub_f32 v42, v42, v58
  v_sub_f32 v43, v43, v59
  v_sub_f32 v44, v44, v60
  v_sub_f32 v45, v45, v61
  v_sub_f32 v46, v46, v62
  v_sub_f32 v47, v47, v63
  v_fmac_f32 v56, v40, v227
  v_fmac_f32 v57, v41, v227
  v_fmac_f32 v58, v42, v227
  v_fmac_f32 v59, v43, v227
  v_fmac_f32 v60, v44, v227
  v_fmac_f32 v61, v45, v227
  v_fmac_f32 v62, v46, v227
  v_fmac_f32 v63, v47, v227
  v_cvt_pk_bf16_f32 v92, v56, v57
  v_cvt_pk_bf16_f32 v93, v58, v59
  v_cvt_pk_bf16_f32 v94, v60, v61
  v_cvt_pk_bf16_f32 v95, v62, v63
  buffer_store_dwordx4 v[92:95], v30, s[8:11], s63 offen offset:64
  s_add_u32 s63, s63, 32768
  s_waitcnt vmcnt(20)
run:
  s_mov_b32 s26, s28
  s_mov_b32 s27, s29
  s_cmp_eq_u32 s14, 0
  s_cselect_b32 s38, s38, 0
  s_cmp_eq_u32 s26, 2
  s_cbranch_scc1 run_v
  s_sub_u32 s58, s26, 1
  s_cmp_ge_u32 s58, 4
  s_cbranch_scc1 run_x
  s_cmp_eq_u32 s26, 3
  s_cbranch_scc1 run_b
  v_mov_b32 v176, 0
  v_mov_b32 v177, 0
  v_mov_b32 v178, 0
  v_mov_b32 v179, 0
  v_mov_b32 v180, 0
  v_mov_b32 v181, 0
  v_mov_b32 v182, 0
  v_mov_b32 v183, 0
  v_mov_b32 v184, 0
  v_mov_b32 v185, 0
  v_mov_b32 v186, 0
  v_mov_b32 v187, 0
  v_mov_b32 v188, 0
  v_mov_b32 v189, 0
  v_mov_b32 v190, 0
  v_mov_b32 v191, 0
run_b:
  v_mov_b32 v163, 0
  s_cmp_eq_u32 s26, 4
  s_cselect_b32 s18, 3, 0
  v_lshlrev_b32 v192, 16, v176
  v_and_b32 v193, 0xffff0000, v176
  v_lshlrev_b32 v194, 16, v177
  v_and_b32 v195, 0xffff0000, v177
  v_lshlrev_b32 v196, 16, v178
  v_and_b32 v197, 0xffff0000, v178
  v_lshlrev_b32 v198, 16, v179
  v_and_b32 v199, 0xffff0000, v179
  v_lshlrev_b32 v200, 16, v180
  v_and_b32 v201, 0xffff0000, v180
  v_lshlrev_b32 v202, 16, v181
  v_and_b32 v203, 0xffff0000, v181
  v_lshlrev_b32 v204, 16, v182
  v_and_b32 v205, 0xffff0000, v182
  v_lshlrev_b32 v206, 16, v183
  v_and_b32 v207, 0xffff0000, v183
  v_lshlrev_b32 v208, 16, v184
  v_and_b32 v209, 0xffff0000, v184
  v_lshlrev_b32 v210, 16, v185
  v_and_b32 v211, 0xffff0000, v185
  v_lshlrev_b32 v212, 16, v186
  v_and_b32 v213, 0xffff0000, v186
  v_lshlrev_b32 v214, 16, v187
  v_and_b32 v215, 0xffff0000, v187
  v_lshlrev_b32 v216, 16, v188
  v_and_b32 v217, 0xffff0000, v188
  v_lshlrev_b32 v218, 16, v189
  v_and_b32 v219, 0xffff0000, v189
  v_lshlrev_b32 v220, 16, v190
  v_and_b32 v221, 0xffff0000, v190
  v_lshlrev_b32 v222, 16, v191
  v_and_b32 v223, 0xffff0000, v191
  v_accvgpr_write_b32 a0, v192
  v_accvgpr_write_b32 a1, v193
  v_accvgpr_write_b32 a2, v194
  v_accvgpr_write_b32 a3, v195
  v_accvgpr_write_b32 a4, v196
  v_accvgpr_write_b32 a5, v197
  v_accvgpr_write_b32 a6, v198
  v_accvgpr_write_b32 a7, v199
  v_accvgpr_write_b32 a8, v200
  v_accvgpr_write_b32 a9, v201
  v_accvgpr_write_b32 a10, v202
  v_accvgpr_write_b32 a11, v203
  v_accvgpr_write_b32 a12, v204
  v_accvgpr_write_b32 a13, v205
  v_accvgpr_write_b32 a14, v206
  v_accvgpr_write_b32 a15, v207
  v_accvgpr_write_b32 a16, v208
  v_accvgpr_write_b32 a17, v209
  v_accvgpr_write_b32 a18, v210
  v_accvgpr_write_b32 a19, v211
  v_accvgpr_write_b32 a20, v212
  v_accvgpr_write_b32 a21, v213
  v_accvgpr_write_b32 a22, v214
  v_accvgpr_write_b32 a23, v215
  v_accvgpr_write_b32 a24, v216
  v_accvgpr_write_b32 a25, v217
  v_accvgpr_write_b32 a26, v218
  v_accvgpr_write_b32 a27, v219
  v_accvgpr_write_b32 a28, v220
  v_accvgpr_write_b32 a29, v221
  v_accvgpr_write_b32 a30, v222
  v_accvgpr_write_b32 a31, v223
  v_accvgpr_write_b32 a32, v192
  v_accvgpr_write_b32 a33, v193
  v_accvgpr_write_b32 a34, v194
  v_accvgpr_write_b32 a35, v195
  v_accvgpr_write_b32 a36, v196
  v_accvgpr_write_b32 a37, v197
  v_accvgpr_write_b32 a38, v198
  v_accvgpr_write_b32 a39, v199
  v_accvgpr_write_b32 a40, v200
  v_accvgpr_write_b32 a41, v201
  v_accvgpr_write_b32 a42, v202
  v_accvgpr_write_b32 a43, v203
  v_accvgpr_write_b32 a44, v204
  v_accvgpr_write_b32 a45, v205
  v_accvgpr_write_b32 a46, v206
  v_accvgpr_write_b32 a47, v207
  v_accvgpr_write_b32 a48, v208
  v_accvgpr_write_b32 a49, v209
  v_accvgpr_write_b32 a50, v210
  v_accvgpr_write_b32 a51, v211
  v_accvgpr_write_b32 a52, v212
  v_accvgpr_write_b32 a53, v213
  v_accvgpr_write_b32 a54, v214
  v_accvgpr_write_b32 a55, v215
  v_accvgpr_write_b32 a56, v216
  v_accvgpr_write_b32 a57, v217
  v_accvgpr_write_b32 a58, v218
  v_accvgpr_write_b32 a59, v219
  v_accvgpr_write_b32 a60, v220
  v_accvgpr_write_b32 a61, v221
  v_accvgpr_write_b32 a62, v222
  v_accvgpr_write_b32 a63, v223
  v_accvgpr_write_b32 a64, v192
  v_accvgpr_write_b32 a65, v193
  v_accvgpr_write_b32 a66, v194
  v_accvgpr_write_b32 a67, v195
  v_accvgpr_write_b32 a68, v196
  v_accvgpr_write_b32 a69, v197
  v_accvgpr_write_b32 a70, v198
  v_accvgpr_write_b32 a71, v199
  v_accvgpr_write_b32 a72, v200
  v_accvgpr_write_b32 a73, v201
  v_accvgpr_write_b32 a74, v202
  v_accvgpr_write_b32 a75, v203
  v_accvgpr_write_b32 a76, v204
  v_accvgpr_write_b32 a77, v205
  v_accvgpr_write_b32 a78, v206
  v_accvgpr_write_b32 a79, v207
  v_accvgpr_write_b32 a80, v208
  v_accvgpr_write_b32 a81, v209
  v_accvgpr_write_b32 a82, v210
  v_accvgpr_write_b32 a83, v211
  v_accvgpr_write_b32 a84, v212
  v_accvgpr_write_b32 a85, v213
  v_accvgpr_write_b32 a86, v214
  v_accvgpr_write_b32 a87, v215
  v_accvgpr_write_b32 a88, v216
  v_accvgpr_write_b32 a89, v217
  v_accvgpr_write_b32 a90, v218
  v_accvgpr_write_b32 a91, v219
  v_accvgpr_write_b32 a92, v220
  v_accvgpr_write_b32 a93, v221
  v_accvgpr_write_b32 a94, v222
  v_accvgpr_write_b32 a95, v223
  v_accvgpr_write_b32 a96, v192
  v_accvgpr_write_b32 a97, v193
  v_accvgpr_write_b32 a98, v194
  v_accvgpr_write_b32 a99, v195
  v_accvgpr_write_b32 a100, v196
  v_accvgpr_write_b32 a101, v197
  v_accvgpr_write_b32 a102, v198
  v_accvgpr_write_b32 a103, v199
  v_accvgpr_write_b32 a104, v200
  v_accvgpr_write_b32 a105, v201
  v_accvgpr_write_b32 a106, v202
  v_accvgpr_write_b32 a107, v203
  v_accvgpr_write_b32 a108, v204
  v_accvgpr_write_b32 a109, v205
  v_accvgpr_write_b32 a110, v206
  v_accvgpr_write_b32 a111, v207
  v_accvgpr_write_b32 a112, v208
  v_accvgpr_write_b32 a113, v209
  v_accvgpr_write_b32 a114, v210
  v_accvgpr_write_b32 a115, v211
  v_accvgpr_write_b32 a116, v212
  v_accvgpr_write_b32 a117, v213
  v_accvgpr_write_b32 a118, v214
  v_accvgpr_write_b32 a119, v215
  v_accvgpr_write_b32 a120, v216
  v_accvgpr_write_b32 a121, v217
  v_accvgpr_write_b32 a122, v218
  v_accvgpr_write_b32 a123, v219
  v_accvgpr_write_b32 a124, v220
  v_accvgpr_write_b32 a125, v221
  v_accvgpr_write_b32 a126, v222
  v_accvgpr_write_b32 a127, v223
  v_accvgpr_write_b32 a128, v192
  v_accvgpr_write_b32 a129, v193
  v_accvgpr_write_b32 a130, v194
  v_accvgpr_write_b32 a131, v195
  v_accvgpr_write_b32 a132, v196
  v_accvgpr_write_b32 a133, v197
  v_accvgpr_write_b32 a134, v198
  v_accvgpr_write_b32 a135, v199
  v_accvgpr_write_b32 a136, v200
  v_accvgpr_write_b32 a137, v201
  v_accvgpr_write_b32 a138, v202
  v_accvgpr_write_b32 a139, v203
  v_accvgpr_write_b32 a140, v204
  v_accvgpr_write_b32 a141, v205
  v_accvgpr_write_b32 a142, v206
  v_accvgpr_write_b32 a143, v207
  v_accvgpr_write_b32 a144, v208
  v_accvgpr_write_b32 a145, v209
  v_accvgpr_write_b32 a146, v210
  v_accvgpr_write_b32 a147, v211
  v_accvgpr_write_b32 a148, v212
  v_accvgpr_write_b32 a149, v213
  v_accvgpr_write_b32 a150, v214
  v_accvgpr_write_b32 a151, v215
  v_accvgpr_write_b32 a152, v216
  v_accvgpr_write_b32 a153, v217
  v_accvgpr_write_b32 a154, v218
  v_accvgpr_write_b32 a155, v219
  v_accvgpr_write_b32 a156, v220
  v_accvgpr_write_b32 a157, v221
  v_accvgpr_write_b32 a158, v222
  v_accvgpr_write_b32 a159, v223
  v_accvgpr_write_b32 a160, v192
  v_accvgpr_write_b32 a161, v193
  v_accvgpr_write_b32 a162, v194
  v_accvgpr_write_b32 a163, v195
  v_accvgpr_write_b32 a164, v196
  v_accvgpr_write_b32 a165, v197
  v_accvgpr_write_b32 a166, v198
  v_accvgpr_write_b32 a167, v199
  v_accvgpr_write_b32 a168, v200
  v_accvgpr_write_b32 a169, v201
  v_accvgpr_write_b32 a170, v202
  v_accvgpr_write_b32 a171, v203
  v_accvgpr_write_b32 a172, v204
  v_accvgpr_write_b32 a173, v205
  v_accvgpr_write_b32 a174, v206
  v_accvgpr_write_b32 a175, v207
  v_accvgpr_write_b32 a176, v208
  v_accvgpr_write_b32 a177, v209
  v_accvgpr_write_b32 a178, v210
  v_accvgpr_write_b32 a179, v211
  v_accvgpr_write_b32 a180, v212
  v_accvgpr_write_b32 a181, v213
  v_accvgpr_write_b32 a182, v214
  v_accvgpr_write_b32 a183, v215
  v_accvgpr_write_b32 a184, v216
  v_accvgpr_write_b32 a185, v217
  v_accvgpr_write_b32 a186, v218
  v_accvgpr_write_b32 a187, v219
  v_accvgpr_write_b32 a188, v220
  v_accvgpr_write_b32 a189, v221
  v_accvgpr_write_b32 a190, v222
  v_accvgpr_write_b32 a191, v223
  v_accvgpr_write_b32 a192, v192
  v_accvgpr_write_b32 a193, v193
  v_accvgpr_write_b32 a194, v194
  v_accvgpr_write_b32 a195, v195
  v_accvgpr_write_b32 a196, v196
  v_accvgpr_write_b32 a197, v197
  v_accvgpr_write_b32 a198, v198
  v_accvgpr_write_b32 a199, v199
  v_accvgpr_write_b32 a200, v200
  v_accvgpr_write_b32 a201, v201
  v_accvgpr_write_b32 a202, v202
  v_accvgpr_write_b32 a203, v203
  v_accvgpr_write_b32 a204, v204
  v_accvgpr_write_b32 a205, v205
  v_accvgpr_write_b32 a206, v206
  v_accvgpr_write_b32 a207, v207
  v_accvgpr_write_b32 a208, v208
  v_accvgpr_write_b32 a209, v209
  v_accvgpr_write_b32 a210, v210
  v_accvgpr_write_b32 a211, v211
  v_accvgpr_write_b32 a212, v212
  v_accvgpr_write_b32 a213, v213
  v_accvgpr_write_b32 a214, v214
  v_accvgpr_write_b32 a215, v215
  v_accvgpr_write_b32 a216, v216
  v_accvgpr_write_b32 a217, v217
  v_accvgpr_write_b32 a218, v218
  v_accvgpr_write_b32 a219, v219
  v_accvgpr_write_b32 a220, v220
  v_accvgpr_write_b32 a221, v221
  v_accvgpr_write_b32 a222, v222
  v_accvgpr_write_b32 a223, v223
  v_accvgpr_write_b32 a224, v192
  v_accvgpr_write_b32 a225, v193
  v_accvgpr_write_b32 a226, v194
  v_accvgpr_write_b32 a227, v195
  v_accvgpr_write_b32 a228, v196
  v_accvgpr_write_b32 a229, v197
  v_accvgpr_write_b32 a230, v198
  v_accvgpr_write_b32 a231, v199
  v_accvgpr_write_b32 a232, v200
  v_accvgpr_write_b32 a233, v201
  v_accvgpr_write_b32 a234, v202
  v_accvgpr_write_b32 a235, v203
  v_accvgpr_write_b32 a236, v204
  v_accvgpr_write_b32 a237, v205
  v_accvgpr_write_b32 a238, v206
  v_accvgpr_write_b32 a239, v207
  v_accvgpr_write_b32 a240, v208
  v_accvgpr_write_b32 a241, v209
  v_accvgpr_write_b32 a242, v210
  v_accvgpr_write_b32 a243, v211
  v_accvgpr_write_b32 a244, v212
  v_accvgpr_write_b32 a245, v213
  v_accvgpr_write_b32 a246, v214
  v_accvgpr_write_b32 a247, v215
  v_accvgpr_write_b32 a248, v216
  v_accvgpr_write_b32 a249, v217
  v_accvgpr_write_b32 a250, v218
  v_accvgpr_write_b32 a251, v219
  v_accvgpr_write_b32 a252, v220
  v_accvgpr_write_b32 a253, v221
  v_accvgpr_write_b32 a254, v222
  v_accvgpr_write_b32 a255, v223
  s_barrier
  ds_read_b128 v[32:35], v2 offset:0
  ds_read_b64_tr_b16 v[64:65], v4 offset:0
  ds_read_b64_tr_b16 v[66:67], v4 offset:2048
  ds_read_b64_tr_b16 v[68:69], v5 offset:0
  ds_read_b64_tr_b16 v[70:71], v5 offset:2048
  ds_read_b128 v[36:39], v2 offset:2048
  ds_read_b64_tr_b16 v[72:73], v6 offset:0
  ds_read_b64_tr_b16 v[74:75], v6 offset:2048
  ds_read_b128 v[40:43], v2 offset:4096
  ds_read_b64_tr_b16 v[76:77], v7 offset:0
  ds_read_b64_tr_b16 v[78:79], v7 offset:2048
  ds_read_b128 v[44:47], v2 offset:6144
  ds_read_b64_tr_b16 v[80:81], v8 offset:0
  ds_read_b64_tr_b16 v[82:83], v8 offset:2048
  ds_read_b128 v[48:51], v2 offset:8192
  ds_read_b64_tr_b16 v[84:85], v9 offset:0
  ds_read_b64_tr_b16 v[86:87], v9 offset:2048
  ds_read_b128 v[52:55], v2 offset:10240
  ds_read_b64_tr_b16 v[88:89], v10 offset:0
  ds_read_b64_tr_b16 v[90:91], v10 offset:2048
  ds_read_b128 v[56:59], v2 offset:12288
  ds_read_b64_tr_b16 v[92:93], v11 offset:0
  ds_read_b64_tr_b16 v[94:95], v11 offset:2048
  ds_read_b128 v[60:63], v2 offset:14336
  s_mov_b32 s54, 8
gl_180:
  s_waitcnt lgkmcnt(15)
  v_mfma_f32_16x16x32_bf16 a[0:3], v[64:67], v[32:35], a[0:3]
  ds_read_b128 v[96:99], v3 offset:0
  s_add_u32 m0, s55, 57344
  v_mfma_f32_16x16x32_bf16 a[4:7], v[68:71], v[32:35], a[4:7]
  buffer_load_dwordx4 v18, s[44:47], s52 offen  lds
  v_mfma_f32_16x16x32_bf16 a[32:35], v[64:67], v[36:39], a[32:35]
  ds_read_b64_tr_b16 v[128:129], v4 offset:16384
  v_mfma_f32_16x16x32_bf16 a[36:39], v[68:71], v[36:39], a[36:39]
  v_mfma_f32_16x16x32_bf16 a[8:11], v[72:75], v[32:35], a[8:11]
  ds_read_b64_tr_b16 v[130:131], v4 offset:18432
  v_mfma_f32_16x16x32_bf16 a[40:43], v[72:75], v[36:39], a[40:43]
  s_add_u32 m0, s55, 122880
  v_mfma_f32_16x16x32_bf16 a[64:67], v[64:67], v[40:43], a[64:67]
  buffer_load_dwordx4 v26, s[48:51], s53 offen lds
  v_mfma_f32_16x16x32_bf16 a[68:71], v[68:71], v[40:43], a[68:71]
  ds_read_b64_tr_b16 v[132:133], v5 offset:16384
  v_mfma_f32_16x16x32_bf16 a[72:75], v[72:75], v[40:43], a[72:75]
  s_waitcnt lgkmcnt(15)
  v_mfma_f32_16x16x32_bf16 a[12:15], v[76:79], v[32:35], a[12:15]
  ds_read_b64_tr_b16 v[134:135], v5 offset:18432
  v_mfma_f32_16x16x32_bf16 a[44:47], v[76:79], v[36:39], a[44:47]
  s_add_u32 m0, s55, 61440
  v_mfma_f32_16x16x32_bf16 a[76:79], v[76:79], v[40:43], a[76:79]
  buffer_load_dwordx4 v19, s[44:47], s52 offen  lds
  ds_read_b128 v[100:103], v3 offset:2048
  v_mfma_f32_16x16x32_bf16 a[96:99], v[64:67], v[44:47], a[96:99]
  v_mfma_f32_16x16x32_bf16 a[100:103], v[68:71], v[44:47], a[100:103]
  v_mfma_f32_16x16x32_bf16 a[104:107], v[72:75], v[44:47], a[104:107]
  ds_read_b64_tr_b16 v[136:137], v6 offset:16384
  v_mfma_f32_16x16x32_bf16 a[108:111], v[76:79], v[44:47], a[108:111]
  s_waitcnt lgkmcnt(15)
  s_add_u32 m0, s55, 126976
  v_mfma_f32_16x16x32_bf16 a[16:19], v[80:83], v[32:35], a[16:19]
  buffer_load_dwordx4 v27, s[48:51], s53 offen lds
  ds_read_b64_tr_b16 v[138:139], v6 offset:18432
  v_mfma_f32_16x16x32_bf16 a[48:51], v[80:83], v[36:39], a[48:51]
  v_mfma_f32_16x16x32_bf16 a[80:83], v[80:83], v[40:43], a[80:83]
  ds_read_b128 v[104:107], v3 offset:4096
  v_mfma_f32_16x16x32_bf16 a[112:115], v[80:83], v[44:47], a[112:115]
  v_mfma_f32_16x16x32_bf16 a[128:131], v[64:67], v[48:51], a[128:131]
  v_mfma_f32_16x16x32_bf16 a[132:135], v[68:71], v[48:51], a[132:135]
  ds_read_b64_tr_b16 v[140:141], v7 offset:16384
  v_mfma_f32_16x16x32_bf16 a[136:139], v[72:75], v[48:51], a[136:139]
  v_mfma_f32_16x16x32_bf16 a[140:143], v[76:79], v[48:51], a[140:143]
  ds_read_b64_tr_b16 v[142:143], v7 offset:18432
  v_mfma_f32_16x16x32_bf16 a[144:147], v[80:83], v[48:51], a[144:147]
  s_waitcnt lgkmcnt(15)
  v_mfma_f32_16x16x32_bf16 a[20:23], v[84:87], v[32:35], a[20:23]
  ds_read_b128 v[108:111], v3 offset:6144
  v_mfma_f32_16x16x32_bf16 a[52:55], v[84:87], v[36:39], a[52:55]
  v_mfma_f32_16x16x32_bf16 a[84:87], v[84:87], v[40:43], a[84:87]
  v_mfma_f32_16x16x32_bf16 a[116:119], v[84:87], v[44:47], a[116:119]
  ds_read_b64_tr_b16 v[144:145], v8 offset:16384
  v_mfma_f32_16x16x32_bf16 a[148:151], v[84:87], v[48:51], a[148:151]
  v_mfma_f32_16x16x32_bf16 a[160:163], v[64:67], v[52:55], a[160:163]
  ds_read_b64_tr_b16 v[146:147], v8 offset:18432
  v_mfma_f32_16x16x32_bf16 a[164:167], v[68:71], v[52:55], a[164:167]
  v_mfma_f32_16x16x32_bf16 a[168:171], v[72:75], v[52:55], a[168:171]
  ds_read_b128 v[112:115], v3 offset:8192
  v_mfma_f32_16x16x32_bf16 a[172:175], v[76:79], v[52:55], a[172:175]
  v_mfma_f32_16x16x32_bf16 a[176:179], v[80:83], v[52:55], a[176:179]
  v_mfma_f32_16x16x32_bf16 a[180:183], v[84:87], v[52:55], a[180:183]
  ds_read_b64_tr_b16 v[148:149], v9 offset:16384
  v_mfma_f32_16x16x32_bf16 a[24:27], v[88:91], v[32:35], a[24:27]
  v_mfma_f32_16x16x32_bf16 a[56:59], v[88:91], v[36:39], a[56:59]
  ds_read_b64_tr_b16 v[150:151], v9 offset:18432
  v_mfma_f32_16x16x32_bf16 a[88:91], v[88:91], v[40:43], a[88:91]
  v_mfma_f32_16x16x32_bf16 a[120:123], v[88:91], v[44:47], a[120:123]
  ds_read_b128 v[116:119], v3 offset:10240
  v_mfma_f32_16x16x32_bf16 a[152:155], v[88:91], v[48:51], a[152:155]
  v_mfma_f32_16x16x32_bf16 a[184:187], v[88:91], v[52:55], a[184:187]
  s_waitcnt lgkmcnt(15)
  v_mfma_f32_16x16x32_bf16 a[192:195], v[64:67], v[56:59], a[192:195]
  ds_read_b64_tr_b16 v[152:153], v10 offset:16384
  v_mfma_f32_16x16x32_bf16 a[196:199], v[68:71], v[56:59], a[196:199]
  v_mfma_f32_16x16x32_bf16 a[200:203], v[72:75], v[56:59], a[200:203]
  ds_read_b64_tr_b16 v[154:155], v10 offset:18432
  v_mfma_f32_16x16x32_bf16 a[204:207], v[76:79], v[56:59], a[204:207]
  v_mfma_f32_16x16x32_bf16 a[208:211], v[80:83], v[56:59], a[208:211]
  ds_read_b128 v[120:123], v3 offset:12288
  v_mfma_f32_16x16x32_bf16 a[212:215], v[84:87], v[56:59], a[212:215]
  v_mfma_f32_16x16x32_bf16 a[216:219], v[88:91], v[56:59], a[216:219]
  v_mfma_f32_16x16x32_bf16 a[28:31], v[92:95], v[32:35], a[28:31]
  ds_read_b64_tr_b16 v[156:157], v11 offset:16384
  v_mfma_f32_16x16x32_bf16 a[60:63], v[92:95], v[36:39], a[60:63]
  v_mfma_f32_16x16x32_bf16 a[92:95], v[92:95], v[40:43], a[92:95]
  ds_read_b64_tr_b16 v[158:159], v11 offset:18432
  v_mfma_f32_16x16x32_bf16 a[124:127], v[92:95], v[44:47], a[124:127]
  v_mfma_f32_16x16x32_bf16 a[156:159], v[92:95], v[48:51], a[156:159]
  ds_read_b128 v[124:127], v3 offset:14336
  v_mfma_f32_16x16x32_bf16 a[188:191], v[92:95], v[52:55], a[188:191]
  v_mfma_f32_16x16x32_bf16 a[220:223], v[92:95], v[56:59], a[220:223]
  v_mfma_f32_16x16x32_bf16 a[224:227], v[64:67], v[60:63], a[224:227]
  v_mfma_f32_16x16x32_bf16 a[228:231], v[68:71], v[60:63], a[228:231]
  v_mfma_f32_16x16x32_bf16 a[232:235], v[72:75], v[60:63], a[232:235]
  v_mfma_f32_16x16x32_bf16 a[236:239], v[76:79], v[60:63], a[236:239]
  v_mfma_f32_16x16x32_bf16 a[240:243], v[80:83], v[60:63], a[240:243]
  v_mfma_f32_16x16x32_bf16 a[244:247], v[84:87], v[60:63], a[244:247]
  v_mfma_f32_16x16x32_bf16 a[248:251], v[88:91], v[60:63], a[248:251]
  v_mfma_f32_16x16x32_bf16 a[252:255], v[92:95], v[60:63], a[252:255]
  s_add_u32 s52, s52, 128
  s_add_u32 s53, s53, s22
  s_cmp_eq_u32 s54, 1
  s_cselect_b32 s46, 0, s46
  s_cselect_b32 s50, 0, s50
  v_mfma_f32_16x16x32_bf16 a[0:3], v[128:131], v[96:99], a[0:3]
  s_waitcnt lgkmcnt(15)
  v_mfma_f32_16x16x32_bf16 a[4:7], v[132:135], v[96:99], a[4:7]
  s_waitcnt vmcnt(0) lgkmcnt(0)
  s_barrier
  s_cmp_eq_u32 s38, 0
  s_cbranch_scc1 fr_181
  v_mov_b32 v160, s39
  v_mov_b32 v161, s38
  s_mov_b64 exec, 1
  buffer_atomic_add v160, v161, s[40:43], 0 offen sc1
  s_mov_b64 exec, -1
  s_mov_b32 s38, 0
fr_181:
  s_cmp_eq_u32 s16, 0
  s_cbranch_scc1 pf_182
  buffer_load_dword v170, v171, s[64:67], 0 offen
  v_add_u32 v171, 8192, v171
  s_sub_u32 s16, s16, 1
pf_182:
  s_cmp_ge_u32 s54, s18
  s_cbranch_scc1 hk_e
  s_cmp_eq_u32 s54, 1
  s_cbranch_scc1 hk_p
  buffer_load_dword v168, v163, s[40:43], 0 offen offset:36 sc1
  s_branch hk_e
hk_p:
  buffer_load_dwordx4 v[164:167], v163, s[4:7], s19 offen sc1
hk_e:
  s_add_u32 m0, s55, 0
  v_mfma_f32_16x16x32_bf16 a[32:35], v[128:131], v[100:103], a[32:35]
  buffer_load_dwordx4 v12, s[44:47], s52 offen  lds
  v_mfma_f32_16x16x32_bf16 a[36:39], v[132:135], v[100:103], a[36:39]
  ds_read_b128 v[32:35], v2 offset:32768
  v_mfma_f32_16x16x32_bf16 a[8:11], v[136:139], v[96:99], a[8:11]
  v_mfma_f32_16x16x32_bf16 a[40:43], v[136:139], v[100:103], a[40:43]
  ds_read_b64_tr_b16 v[64:65], v4 offset:32768
  v_mfma_f32_16x16x32_bf16 a[64:67], v[128:131], v[104:107], a[64:67]
  s_add_u32 m0, s55, 65536
  v_mfma_f32_16x16x32_bf16 a[68:71], v[132:135], v[104:107], a[68:71]
  buffer_load_dwordx4 v20, s[48:51], s53 offen lds
  ds_read_b64_tr_b16 v[66:67], v4 offset:34816
  v_mfma_f32_16x16x32_bf16 a[72:75], v[136:139], v[104:107], a[72:75]
  v_mfma_f32_16x16x32_bf16 a[12:15], v[140:143], v[96:99], a[12:15]
  v_mfma_f32_16x16x32_bf16 a[44:47], v[140:143], v[100:103], a[44:47]
  ds_read_b64_tr_b16 v[68:69], v5 offset:32768
  v_mfma_f32_16x16x32_bf16 a[76:79], v[140:143], v[104:107], a[76:79]
  s_add_u32 m0, s55, 4096
  v_mfma_f32_16x16x32_bf16 a[96:99], v[128:131], v[108:111], a[96:99]
  buffer_load_dwordx4 v13, s[44:47], s52 offen  lds
  ds_read_b64_tr_b16 v[70:71], v5 offset:34816
  v_mfma_f32_16x16x32_bf16 a[100:103], v[132:135], v[108:111], a[100:103]
  v_mfma_f32_16x16x32_bf16 a[104:107], v[136:139], v[108:111], a[104:107]
  ds_read_b128 v[36:39], v2 offset:34816
  v_mfma_f32_16x16x32_bf16 a[108:111], v[140:143], v[108:111], a[108:111]
  v_mfma_f32_16x16x32_bf16 a[16:19], v[144:147], v[96:99], a[16:19]
  s_add_u32 m0, s55, 69632
  v_mfma_f32_16x16x32_bf16 a[48:51], v[144:147], v[100:103], a[48:51]
  buffer_load_dwordx4 v21, s[48:51], s53 offen lds
  ds_read_b64_tr_b16 v[72:73], v6 offset:32768
  v_mfma_f32_16x16x32_bf16 a[80:83], v[144:147], v[104:107], a[80:83]
  v_mfma_f32_16x16x32_bf16 a[112:115], v[144:147], v[108:111], a[112:115]
  ds_read_b64_tr_b16 v[74:75], v6 offset:34816
  v_mfma_f32_16x16x32_bf16 a[128:131], v[128:131], v[112:115], a[128:131]
  v_mfma_f32_16x16x32_bf16 a[132:135], v[132:135], v[112:115], a[132:135]
  s_add_u32 m0, s55, 8192
  v_mfma_f32_16x16x32_bf16 a[136:139], v[136:139], v[112:115], a[136:139]
  buffer_load_dwordx4 v14, s[44:47], s52 offen  lds
  ds_read_b128 v[40:43], v2 offset:36864
  v_mfma_f32_16x16x32_bf16 a[140:143], v[140:143], v[112:115], a[140:143]
  v_mfma_f32_16x16x32_bf16 a[144:147], v[144:147], v[112:115], a[144:147]
  ds_read_b64_tr_b16 v[76:77], v7 offset:32768
  v_mfma_f32_16x16x32_bf16 a[20:23], v[148:151], v[96:99], a[20:23]
  v_mfma_f32_16x16x32_bf16 a[52:55], v[148:151], v[100:103], a[52:55]
  ds_read_b64_tr_b16 v[78:79], v7 offset:34816
  s_add_u32 m0, s55, 73728
  v_mfma_f32_16x16x32_bf16 a[84:87], v[148:151], v[104:107], a[84:87]
  buffer_load_dwordx4 v22, s[48:51], s53 offen lds
  v_mfma_f32_16x16x32_bf16 a[116:119], v[148:151], v[108:111], a[116:119]
  v_mfma_f32_16x16x32_bf16 a[148:151], v[148:151], v[112:115], a[148:151]
  ds_read_b128 v[44:47], v2 offset:38912
  v_mfma_f32_16x16x32_bf16 a[160:163], v[128:131], v[116:119], a[160:163]
  v_mfma_f32_16x16x32_bf16 a[164:167], v[132:135], v[116:119], a[164:167]
  ds_read_b64_tr_b16 v[80:81], v8 offset:32768
  v_mfma_f32_16x16x32_bf16 a[168:171], v[136:139], v[116:119], a[168:171]
  s_add_u32 m0, s55, 12288
  v_mfma_f32_16x16x32_bf16 a[172:175], v[140:143], v[116:119], a[172:175]
  buffer_load_dwordx4 v15, s[44:47], s52 offen  lds
  ds_read_b64_tr_b16 v[82:83], v8 offset:34816
  v_mfma_f32_16x16x32_bf16 a[176:179], v[144:147], v[116:119], a[176:179]
  v_mfma_f32_16x16x32_bf16 a[180:183], v[148:151], v[116:119], a[180:183]
  v_mfma_f32_16x16x32_bf16 a[24:27], v[152:155], v[96:99], a[24:27]
  ds_read_b128 v[48:51], v2 offset:40960
  v_mfma_f32_16x16x32_bf16 a[56:59], v[152:155], v[100:103], a[56:59]
  s_add_u32 m0, s55, 77824
  v_mfma_f32_16x16x32_bf16 a[88:91], v[152:155], v[104:107], a[88:91]
  buffer_load_dwordx4 v23, s[48:51], s53 offen lds
  ds_read_b64_tr_b16 v[84:85], v9 offset:32768
  v_mfma_f32_16x16x32_bf16 a[120:123], v[152:155], v[108:111], a[120:123]
  v_mfma_f32_16x16x32_bf16 a[152:155], v[152:155], v[112:115], a[152:155]
  v_mfma_f32_16x16x32_bf16 a[184:187], v[152:155], v[116:119], a[184:187]
  ds_read_b64_tr_b16 v[86:87], v9 offset:34816
  v_mfma_f32_16x16x32_bf16 a[192:195], v[128:131], v[120:123], a[192:195]
  s_add_u32 m0, s55, 16384
  v_mfma_f32_16x16x32_bf16 a[196:199], v[132:135], v[120:123], a[196:199]
  buffer_load_dwordx4 v16, s[44:47], s52 offen  lds
  ds_read_b128 v[52:55], v2 offset:43008
  v_mfma_f32_16x16x32_bf16 a[200:203], v[136:139], v[120:123], a[200:203]
  v_mfma_f32_16x16x32_bf16 a[204:207], v[140:143], v[120:123], a[204:207]
  ds_read_b64_tr_b16 v[88:89], v10 offset:32768
  v_mfma_f32_16x16x32_bf16 a[208:211], v[144:147], v[120:123], a[208:211]
  v_mfma_f32_16x16x32_bf16 a[212:215], v[148:151], v[120:123], a[212:215]
  s_add_u32 m0, s55, 81920
  v_mfma_f32_16x16x32_bf16 a[216:219], v[152:155], v[120:123], a[216:219]
  buffer_load_dwordx4 v24, s[48:51], s53 offen lds
  ds_read_b64_tr_b16 v[90:91], v10 offset:34816
  v_mfma_f32_16x16x32_bf16 a[28:31], v[156:159], v[96:99], a[28:31]
  v_mfma_f32_16x16x32_bf16 a[60:63], v[156:159], v[100:103], a[60:63]
  ds_read_b128 v[56:59], v2 offset:45056
  v_mfma_f32_16x16x32_bf16 a[92:95], v[156:159], v[104:107], a[92:95]
  v_mfma_f32_16x16x32_bf16 a[124:127], v[156:159], v[108:111], a[124:127]
  ds_read_b64_tr_b16 v[92:93], v11 offset:32768
  s_add_u32 m0, s55, 20480
  v_mfma_f32_16x16x32_bf16 a[156:159], v[156:159], v[112:115], a[156:159]
  buffer_load_dwordx4 v17, s[44:47], s52 offen  lds
  v_mfma_f32_16x16x32_bf16 a[188:191], v[156:159], v[116:119], a[188:191]
  v_mfma_f32_16x16x32_bf16 a[220:223], v[156:159], v[120:123], a[220:223]
  ds_read_b64_tr_b16 v[94:95], v11 offset:34816
  v_mfma_f32_16x16x32_bf16 a[224:227], v[128:131], v[124:127], a[224:227]
  v_mfma_f32_16x16x32_bf16 a[228:231], v[132:135], v[124:127], a[228:231]
  ds_read_b128 v[60:63], v2 offset:47104
  s_add_u32 m0, s55, 86016
  v_mfma_f32_16x16x32_bf16 a[232:235], v[136:139], v[124:127], a[232:235]
  buffer_load_dwordx4 v25, s[48:51], s53 offen lds
  v_mfma_f32_16x16x32_bf16 a[236:239], v[140:143], v[124:127], a[236:239]
  v_mfma_f32_16x16x32_bf16 a[240:243], v[144:147], v[124:127], a[240:243]
  v_mfma_f32_16x16x32_bf16 a[244:247], v[148:151], v[124:127], a[244:247]
  v_mfma_f32_16x16x32_bf16 a[248:251], v[152:155], v[124:127], a[248:251]
  v_mfma_f32_16x16x32_bf16 a[252:255], v[156:159], v[124:127], a[252:255]
  s_waitcnt lgkmcnt(15)
  v_mfma_f32_16x16x32_bf16 a[0:3], v[64:67], v[32:35], a[0:3]
  ds_read_b128 v[96:99], v3 offset:32768
  s_add_u32 m0, s55, 24576
  v_mfma_f32_16x16x32_bf16 a[4:7], v[68:71], v[32:35], a[4:7]
  buffer_load_dwordx4 v18, s[44:47], s52 offen  lds
  v_mfma_f32_16x16x32_bf16 a[32:35], v[64:67], v[36:39], a[32:35]
  ds_read_b64_tr_b16 v[128:129], v4 offset:49152
  v_mfma_f32_16x16x32_bf16 a[36:39], v[68:71], v[36:39], a[36:39]
  v_mfma_f32_16x16x32_bf16 a[8:11], v[72:75], v[32:35], a[8:11]
  ds_read_b64_tr_b16 v[130:131], v4 offset:51200
  v_mfma_f32_16x16x32_bf16 a[40:43], v[72:75], v[36:39], a[40:43]
  s_add_u32 m0, s55, 90112
  v_mfma_f32_16x16x32_bf16 a[64:67], v[64:67], v[40:43], a[64:67]
  buffer_load_dwordx4 v26, s[48:51], s53 offen lds
  v_mfma_f32_16x16x32_bf16 a[68:71], v[68:71], v[40:43], a[68:71]
  ds_read_b64_tr_b16 v[132:133], v5 offset:49152
  v_mfma_f32_16x16x32_bf16 a[72:75], v[72:75], v[40:43], a[72:75]
  s_waitcnt lgkmcnt(15)
  v_mfma_f32_16x16x32_bf16 a[12:15], v[76:79], v[32:35], a[12:15]
  ds_read_b64_tr_b16 v[134:135], v5 offset:51200
  v_mfma_f32_16x16x32_bf16 a[44:47], v[76:79], v[36:39], a[44:47]
  s_add_u32 m0, s55, 28672
  v_mfma_f32_16x16x32_bf16 a[76:79], v[76:79], v[40:43], a[76:79]
  buffer_load_dwordx4 v19, s[44:47], s52 offen  lds
  ds_read_b128 v[100:103], v3 offset:34816
  v_mfma_f32_16x16x32_bf16 a[96:99], v[64:67], v[44:47], a[96:99]
  v_mfma_f32_16x16x32_bf16 a[100:103], v[68:71], v[44:47], a[100:103]
  v_mfma_f32_16x16x32_bf16 a[104:107], v[72:75], v[44:47], a[104:107]
  ds_read_b64_tr_b16 v[136:137], v6 offset:49152
  v_mfma_f32_16x16x32_bf16 a[108:111], v[76:79], v[44:47], a[108:111]
  s_waitcnt lgkmcnt(15)
  s_add_u32 m0, s55, 94208
  v_mfma_f32_16x16x32_bf16 a[16:19], v[80:83], v[32:35], a[16:19]
  buffer_load_dwordx4 v27, s[48:51], s53 offen lds
  ds_read_b64_tr_b16 v[138:139], v6 offset:51200
  v_mfma_f32_16x16x32_bf16 a[48:51], v[80:83], v[36:39], a[48:51]
  v_mfma_f32_16x16x32_bf16 a[80:83], v[80:83], v[40:43], a[80:83]
  ds_read_b128 v[104:107], v3 offset:36864
  v_mfma_f32_16x16x32_bf16 a[112:115], v[80:83], v[44:47], a[112:115]
  v_mfma_f32_16x16x32_bf16 a[128:131], v[64:67], v[48:51], a[128:131]
  v_mfma_f32_16x16x32_bf16 a[132:135], v[68:71], v[48:51], a[132:135]
  ds_read_b64_tr_b16 v[140:141], v7 offset:49152
  v_mfma_f32_16x16x32_bf16 a[136:139], v[72:75], v[48:51], a[136:139]
  v_mfma_f32_16x16x32_bf16 a[140:143], v[76:79], v[48:51], a[140:143]
  ds_read_b64_tr_b16 v[142:143], v7 offset:51200
  v_mfma_f32_16x16x32_bf16 a[144:147], v[80:83], v[48:51], a[144:147]
  s_waitcnt lgkmcnt(15)
  v_mfma_f32_16x16x32_bf16 a[20:23], v[84:87], v[32:35], a[20:23]
  ds_read_b128 v[108:111], v3 offset:38912
  v_mfma_f32_16x16x32_bf16 a[52:55], v[84:87], v[36:39], a[52:55]
  v_mfma_f32_16x16x32_bf16 a[84:87], v[84:87], v[40:43], a[84:87]
  v_mfma_f32_16x16x32_bf16 a[116:119], v[84:87], v[44:47], a[116:119]
  ds_read_b64_tr_b16 v[144:145], v8 offset:49152
  v_mfma_f32_16x16x32_bf16 a[148:151], v[84:87], v[48:51], a[148:151]
  v_mfma_f32_16x16x32_bf16 a[160:163], v[64:67], v[52:55], a[160:163]
  ds_read_b64_tr_b16 v[146:147], v8 offset:51200
  v_mfma_f32_16x16x32_bf16 a[164:167], v[68:71], v[52:55], a[164:167]
  v_mfma_f32_16x16x32_bf16 a[168:171], v[72:75], v[52:55], a[168:171]
  ds_read_b128 v[112:115], v3 offset:40960
  v_mfma_f32_16x16x32_bf16 a[172:175], v[76:79], v[52:55], a[172:175]
  v_mfma_f32_16x16x32_bf16 a[176:179], v[80:83], v[52:55], a[176:179]
  v_mfma_f32_16x16x32_bf16 a[180:183], v[84:87], v[52:55], a[180:183]
  ds_read_b64_tr_b16 v[148:149], v9 offset:49152
  v_mfma_f32_16x16x32_bf16 a[24:27], v[88:91], v[32:35], a[24:27]
  v_mfma_f32_16x16x32_bf16 a[56:59], v[88:91], v[36:39], a[56:59]
  ds_read_b64_tr_b16 v[150:151], v9 offset:51200
  v_mfma_f32_16x16x32_bf16 a[88:91], v[88:91], v[40:43], a[88:91]
  v_mfma_f32_16x16x32_bf16 a[120:123], v[88:91], v[44:47], a[120:123]
  ds_read_b128 v[116:119], v3 offset:43008
  v_mfma_f32_16x16x32_bf16 a[152:155], v[88:91], v[48:51], a[152:155]
  v_mfma_f32_16x16x32_bf16 a[184:187], v[88:91], v[52:55], a[184:187]
  s_waitcnt lgkmcnt(15)
  v_mfma_f32_16x16x32_bf16 a[192:195], v[64:67], v[56:59], a[192:195]
  ds_read_b64_tr_b16 v[152:153], v10 offset:49152
  v_mfma_f32_16x16x32_bf16 a[196:199], v[68:71], v[56:59], a[196:199]
  v_mfma_f32_16x16x32_bf16 a[200:203], v[72:75], v[56:59], a[200:203]
  ds_read_b64_tr_b16 v[154:155], v10 offset:51200
  v_mfma_f32_16x16x32_bf16 a[204:207], v[76:79], v[56:59], a[204:207]
  v_mfma_f32_16x16x32_bf16 a[208:211], v[80:83], v[56:59], a[208:211]
  ds_read_b128 v[120:123], v3 offset:45056
  v_mfma_f32_16x16x32_bf16 a[212:215], v[84:87], v[56:59], a[212:215]
  v_mfma_f32_16x16x32_bf16 a[216:219], v[88:91], v[56:59], a[216:219]
  v_mfma_f32_16x16x32_bf16 a[28:31], v[92:95], v[32:35], a[28:31]
  ds_read_b64_tr_b16 v[156:157], v11 offset:49152
  v_mfma_f32_16x16x32_bf16 a[60:63], v[92:95], v[36:39], a[60:63]
  v_mfma_f32_16x16x32_bf16 a[92:95], v[92:95], v[40:43], a[92:95]
  ds_read_b64_tr_b16 v[158:159], v11 offset:51200
  v_mfma_f32_16x16x32_bf16 a[124:127], v[92:95], v[44:47], a[124:127]
  v_mfma_f32_16x16x32_bf16 a[156:159], v[92:95], v[48:51], a[156:159]
  ds_read_b128 v[124:127], v3 offset:47104
  v_mfma_f32_16x16x32_bf16 a[188:191], v[92:95], v[52:55], a[188:191]
  v_mfma_f32_16x16x32_bf16 a[220:223], v[92:95], v[56:59], a[220:223]
  v_mfma_f32_16x16x32_bf16 a[224:227], v[64:67], v[60:63], a[224:227]
  v_mfma_f32_16x16x32_bf16 a[228:231], v[68:71], v[60:63], a[228:231]
  v_mfma_f32_16x16x32_bf16 a[232:235], v[72:75], v[60:63], a[232:235]
  v_mfma_f32_16x16x32_bf16 a[236:239], v[76:79], v[60:63], a[236:239]
  v_mfma_f32_16x16x32_bf16 a[240:243], v[80:83], v[60:63], a[240:243]
  v_mfma_f32_16x16x32_bf16 a[244:247], v[84:87], v[60:63], a[244:247]
  v_mfma_f32_16x16x32_bf16 a[248:251], v[88:91], v[60:63], a[248:251]
  v_mfma_f32_16x16x32_bf16 a[252:255], v[92:95], v[60:63], a[252:255]
  s_add_u32 s52, s52, 128
  s_add_u32 s53, s53, s22
  v_mfma_f32_16x16x32_bf16 a[0:3], v[128:131], v[96:99], a[0:3]
  s_waitcnt lgkmcnt(15)
  v_mfma_f32_16x16x32_bf16 a[4:7], v[132:135], v[96:99], a[4:7]
  s_waitcnt vmcnt(0) lgkmcnt(0)
  s_barrier
  s_add_u32 m0, s55, 32768
  v_mfma_f32_16x16x32_bf16 a[32:35], v[128:131], v[100:103], a[32:35]
  buffer_load_dwordx4 v12, s[44:47], s52 offen  lds
  v_mfma_f32_16x16x32_bf16 a[36:39], v[132:135], v[100:103], a[36:39]
  ds_read_b128 v[32:35], v2 offset:0
  v_mfma_f32_16x16x32_bf16 a[8:11], v[136:139], v[96:99], a[8:11]
  v_mfma_f32_16x16x32_bf16 a[40:43], v[136:139], v[100:103], a[40:43]
  ds_read_b64_tr_b16 v[64:65], v4 offset:0
  v_mfma_f32_16x16x32_bf16 a[64:67], v[128:131], v[104:107], a[64:67]
  s_add_u32 m0, s55, 98304
  v_mfma_f32_16x16x32_bf16 a[68:71], v[132:135], v[104:107], a[68:71]
  buffer_load_dwordx4 v20, s[48:51], s53 offen lds
  ds_read_b64_tr_b16 v[66:67], v4 offset:2048
  v_mfma_f32_16x16x32_bf16 a[72:75], v[136:139], v[104:107], a[72:75]
  v_mfma_f32_16x16x32_bf16 a[12:15], v[140:143], v[96:99], a[12:15]
  v_mfma_f32_16x16x32_bf16 a[44:47], v[140:143], v[100:103], a[44:47]
  ds_read_b64_tr_b16 v[68:69], v5 offset:0
  v_mfma_f32_16x16x32_bf16 a[76:79], v[140:143], v[104:107], a[76:79]
  s_add_u32 m0, s55, 36864
  v_mfma_f32_16x16x32_bf16 a[96:99], v[128:131], v[108:111], a[96:99]
  buffer_load_dwordx4 v13, s[44:47], s52 offen  lds
  ds_read_b64_tr_b16 v[70:71], v5 offset:2048
  v_mfma_f32_16x16x32_bf16 a[100:103], v[132:135], v[108:111], a[100:103]
  v_mfma_f32_16x16x32_bf16 a[104:107], v[136:139], v[108:111], a[104:107]
  ds_read_b128 v[36:39], v2 offset:2048
  v_mfma_f32_16x16x32_bf16 a[108:111], v[140:143], v[108:111], a[108:111]
  v_mfma_f32_16x16x32_bf16 a[16:19], v[144:147], v[96:99], a[16:19]
  s_add_u32 m0, s55, 102400
  v_mfma_f32_16x16x32_bf16 a[48:51], v[144:147], v[100:103], a[48:51]
  buffer_load_dwordx4 v21, s[48:51], s53 offen lds
  ds_read_b64_tr_b16 v[72:73], v6 offset:0
  v_mfma_f32_16x16x32_bf16 a[80:83], v[144:147], v[104:107], a[80:83]
  v_mfma_f32_16x16x32_bf16 a[112:115], v[144:147], v[108:111], a[112:115]
  ds_read_b64_tr_b16 v[74:75], v6 offset:2048
  v_mfma_f32_16x16x32_bf16 a[128:131], v[128:131], v[112:115], a[128:131]
  v_mfma_f32_16x16x32_bf16 a[132:135], v[132:135], v[112:115], a[132:135]
  s_add_u32 m0, s55, 40960
  v_mfma_f32_16x16x32_bf16 a[136:139], v[136:139], v[112:115], a[136:139]
  buffer_load_dwordx4 v14, s[44:47], s52 offen  lds
  ds_read_b128 v[40:43], v2 offset:4096
  v_mfma_f32_16x16x32_bf16 a[140:143], v[140:143], v[112:115], a[140:143]
  v_mfma_f32_16x16x32_bf16 a[144:147], v[144:147], v[112:115], a[144:147]
  ds_read_b64_tr_b16 v[76:77], v7 offset:0
  v_mfma_f32_16x16x32_bf16 a[20:23], v[148:151], v[96:99], a[20:23]
  v_mfma_f32_16x16x32_bf16 a[52:55], v[148:151], v[100:103], a[52:55]
  ds_read_b64_tr_b16 v[78:79], v7 offset:2048
  s_add_u32 m0, s55, 106496
  v_mfma_f32_16x16x32_bf16 a[84:87], v[148:151], v[104:107], a[84:87]
  buffer_load_dwordx4 v22, s[48:51], s53 offen lds
  v_mfma_f32_16x16x32_bf16 a[116:119], v[148:151], v[108:111], a[116:119]
  v_mfma_f32_16x16x32_bf16 a[148:151], v[148:151], v[112:115], a[148:151]
  ds_read_b128 v[44:47], v2 offset:6144
  v_mfma_f32_16x16x32_bf16 a[160:163], v[128:131], v[116:119], a[160:163]
  v_mfma_f32_16x16x32_bf16 a[164:167], v[132:135], v[116:119], a[164:167]
  ds_read_b64_tr_b16 v[80:81], v8 offset:0
  v_mfma_f32_16x16x32_bf16 a[168:171], v[136:139], v[116:119], a[168:171]
  s_add_u32 m0, s55, 45056
  v_mfma_f32_16x16x32_bf16 a[172:175], v[140:143], v[116:119], a[172:175]
  buffer_load_dwordx4 v15, s[44:47], s52 offen  lds
  ds_read_b64_tr_b16 v[82:83], v8 offset:2048
  v_mfma_f32_16x16x32_bf16 a[176:179], v[144:147], v[116:119], a[176:179]
  v_mfma_f32_16x16x32_bf16 a[180:183], v[148:151], v[116:119], a[180:183]
  v_mfma_f32_16x16x32_bf16 a[24:27], v[152:155], v[96:99], a[24:27]
  ds_read_b128 v[48:51], v2 offset:8192
  v_mfma_f32_16x16x32_bf16 a[56:59], v[152:155], v[100:103], a[56:59]
  s_add_u32 m0, s55, 110592
  v_mfma_f32_16x16x32_bf16 a[88:91], v[152:155], v[104:107], a[88:91]
  buffer_load_dwordx4 v23, s[48:51], s53 offen lds
  ds_read_b64_tr_b16 v[84:85], v9 offset:0
  v_mfma_f32_16x16x32_bf16 a[120:123], v[152:155], v[108:111], a[120:123]
  v_mfma_f32_16x16x32_bf16 a[152:155], v[152:155], v[112:115], a[152:155]
  v_mfma_f32_16x16x32_bf16 a[184:187], v[152:155], v[116:119], a[184:187]
  ds_read_b64_tr_b16 v[86:87], v9 offset:2048
  v_mfma_f32_16x16x32_bf16 a[192:195], v[128:131], v[120:123], a[192:195]
  s_add_u32 m0, s55, 49152
  v_mfma_f32_16x16x32_bf16 a[196:199], v[132:135], v[120:123], a[196:199]
  buffer_load_dwordx4 v16, s[44:47], s52 offen  lds
  ds_read_b128 v[52:55], v2 offset:10240
  v_mfma_f32_16x16x32_bf16 a[200:203], v[136:139], v[120:123], a[200:203]
  v_mfma_f32_16x16x32_bf16 a[204:207], v[140:143], v[120:123], a[204:207]
  ds_read_b64_tr_b16 v[88:89], v10 offset:0
  v_mfma_f32_16x16x32_bf16 a[208:211], v[144:147], v[120:123], a[208:211]
  v_mfma_f32_16x16x32_bf16 a[212:215], v[148:151], v[120:123], a[212:215]
  s_add_u32 m0, s55, 114688
  v_mfma_f32_16x16x32_bf16 a[216:219], v[152:155], v[120:123], a[216:219]
  buffer_load_dwordx4 v24, s[48:51], s53 offen lds
  ds_read_b64_tr_b16 v[90:91], v10 offset:2048
  v_mfma_f32_16x16x32_bf16 a[28:31], v[156:159], v[96:99], a[28:31]
  v_mfma_f32_16x16x32_bf16 a[60:63], v[156:159], v[100:103], a[60:63]
  ds_read_b128 v[56:59], v2 offset:12288
  v_mfma_f32_16x16x32_bf16 a[92:95], v[156:159], v[104:107], a[92:95]
  v_mfma_f32_16x16x32_bf16 a[124:127], v[156:159], v[108:111], a[124:127]
  ds_read_b64_tr_b16 v[92:93], v11 offset:0
  s_add_u32 m0, s55, 53248
  v_mfma_f32_16x16x32_bf16 a[156:159], v[156:159], v[112:115], a[156:159]
  buffer_load_dwordx4 v17, s[44:47], s52 offen  lds
  v_mfma_f32_16x16x32_bf16 a[188:191], v[156:159], v[116:119], a[188:191]
  v_mfma_f32_16x16x32_bf16 a[220:223], v[156:159], v[120:123], a[220:223]
  ds_read_b64_tr_b16 v[94:95], v11 offset:2048
  v_mfma_f32_16x16x32_bf16 a[224:227], v[128:131], v[124:127], a[224:227]
  v_mfma_f32_16x16x32_bf16 a[228:231], v[132:135], v[124:127], a[228:231]
  ds_read_b128 v[60:63], v2 offset:14336
  s_add_u32 m0, s55, 118784
  v_mfma_f32_16x16x32_bf16 a[232:235], v[136:139], v[124:127], a[232:235]
  buffer_load_dwordx4 v25, s[48:51], s53 offen lds
  v_mfma_f32_16x16x32_bf16 a[236:239], v[140:143], v[124:127], a[236:239]
  v_mfma_f32_16x16x32_bf16 a[240:243], v[144:147], v[124:127], a[240:243]
  v_mfma_f32_16x16x32_bf16 a[244:247], v[148:151], v[124:127], a[244:247]
  v_mfma_f32_16x16x32_bf16 a[248:251], v[152:155], v[124:127], a[248:251]
  v_mfma_f32_16x16x32_bf16 a[252:255], v[156:159], v[124:127], a[252:255]
  s_sub_u32 s54, s54, 1
  s_cmp_lg_u32 s54, 0
  s_cbranch_scc1 gl_180
gl_180_e:
  s_waitcnt lgkmcnt(0)
  s_nop 7
  s_branch next_task
run_v:
  v_accvgpr_write_b32 a0, 0
  v_accvgpr_write_b32 a1, 0
  v_accvgpr_write_b32 a2, 0
  v_accvgpr_write_b32 a3, 0
  v_accvgpr_write_b32 a4, 0
  v_accvgpr_write_b32 a5, 0
  v_accvgpr_write_b32 a6, 0
  v_accvgpr_write_b32 a7, 0
  v_accvgpr_write_b32 a8, 0
  v_accvgpr_write_b32 a9, 0
  v_accvgpr_write_b32 a10, 0
  v_accvgpr_write_b32 a11, 0
  v_accvgpr_write_b32 a12, 0
  v_accvgpr_write_b32 a13, 0
  v_accvgpr_write_b32 a14, 0
  v_accvgpr_write_b32 a15, 0
  v_accvgpr_write_b32 a16, 0
  v_accvgpr_write_b32 a17, 0
  v_accvgpr_write_b32 a18, 0
  v_accvgpr_write_b32 a19, 0
  v_accvgpr_write_b32 a20, 0
  v_accvgpr_write_b32 a21, 0
  v_accvgpr_write_b32 a22, 0
  v_accvgpr_write_b32 a23, 0
  v_accvgpr_write_b32 a24, 0
  v_accvgpr_write_b32 a25, 0
  v_accvgpr_write_b32 a26, 0
  v_accvgpr_write_b32 a27, 0
  v_accvgpr_write_b32 a28, 0
  v_accvgpr_write_b32 a29, 0
  v_accvgpr_write_b32 a30, 0
  v_accvgpr_write_b32 a31, 0
  v_accvgpr_write_b32 a32, 0
  v_accvgpr_write_b32 a33, 0
  v_accvgpr_write_b32 a34, 0
  v_accvgpr_write_b32 a35, 0
  v_accvgpr_write_b32 a36, 0
  v_accvgpr_write_b32 a37, 0
  v_accvgpr_write_b32 a38, 0
  v_accvgpr_write_b32 a39, 0
  v_accvgpr_write_b32 a40, 0
  v_accvgpr_write_b32 a41, 0
  v_accvgpr_write_b32 a42, 0
  v_accvgpr_write_b32 a43, 0
  v_accvgpr_write_b32 a44, 0
  v_accvgpr_write_b32 a45, 0
  v_accvgpr_write_b32 a46, 0
  v_accvgpr_write_b32 a47, 0
  v_accvgpr_write_b32 a48, 0
  v_accvgpr_write_b32 a49, 0
  v_accvgpr_write_b32 a50, 0
  v_accvgpr_write_b32 a51, 0
  v_accvgpr_write_b32 a52, 0
  v_accvgpr_write_b32 a53, 0
  v_accvgpr_write_b32 a54, 0
  v_accvgpr_write_b32 a55, 0
  v_accvgpr_write_b32 a56, 0
  v_accvgpr_write_b32 a57, 0
  v_accvgpr_write_b32 a58, 0
  v_accvgpr_write_b32 a59, 0
  v_accvgpr_write_b32 a60, 0
  v_accvgpr_write_b32 a61, 0
  v_accvgpr_write_b32 a62, 0
  v_accvgpr_write_b32 a63, 0
  v_accvgpr_write_b32 a64, 0
  v_accvgpr_write_b32 a65, 0
  v_accvgpr_write_b32 a66, 0
  v_accvgpr_write_b32 a67, 0
  v_accvgpr_write_b32 a68, 0
  v_accvgpr_write_b32 a69, 0
  v_accvgpr_write_b32 a70, 0
  v_accvgpr_write_b32 a71, 0
  v_accvgpr_write_b32 a72, 0
  v_accvgpr_write_b32 a73, 0
  v_accvgpr_write_b32 a74, 0
  v_accvgpr_write_b32 a75, 0
  v_accvgpr_write_b32 a76, 0
  v_accvgpr_write_b32 a77, 0
  v_accvgpr_write_b32 a78, 0
  v_accvgpr_write_b32 a79, 0
  v_accvgpr_write_b32 a80, 0
  v_accvgpr_write_b32 a81, 0
  v_accvgpr_write_b32 a82, 0
  v_accvgpr_write_b32 a83, 0
  v_accvgpr_write_b32 a84, 0
  v_accvgpr_write_b32 a85, 0
  v_accvgpr_write_b32 a86, 0
  v_accvgpr_write_b32 a87, 0
  v_accvgpr_write_b32 a88, 0
  v_accvgpr_write_b32 a89, 0
  v_accvgpr_write_b32 a90, 0
  v_accvgpr_write_b32 a91, 0
  v_accvgpr_write_b32 a92, 0
  v_accvgpr_write_b32 a93, 0
  v_accvgpr_write_b32 a94, 0
  v_accvgpr_write_b32 a95, 0
  v_accvgpr_write_b32 a96, 0
  v_accvgpr_write_b32 a97, 0
  v_accvgpr_write_b32 a98, 0
  v_accvgpr_write_b32 a99, 0
  v_accvgpr_write_b32 a100, 0
  v_accvgpr_write_b32 a101, 0
  v_accvgpr_write_b32 a102, 0
  v_accvgpr_write_b32 a103, 0
  v_accvgpr_write_b32 a104, 0
  v_accvgpr_write_b32 a105, 0
  v_accvgpr_write_b32 a106, 0
  v_accvgpr_write_b32 a107, 0
  v_accvgpr_write_b32 a108, 0
  v_accvgpr_write_b32 a109, 0
  v_accvgpr_write_b32 a110, 0
  v_accvgpr_write_b32 a111, 0
  v_accvgpr_write_b32 a112, 0
  v_accvgpr_write_b32 a113, 0
  v_accvgpr_write_b32 a114, 0
  v_accvgpr_write_b32 a115, 0
  v_accvgpr_write_b32 a116, 0
  v_accvgpr_write_b32 a117, 0
  v_accvgpr_write_b32 a118, 0
  v_accvgpr_write_b32 a119, 0
  v_accvgpr_write_b32 a120, 0
  v_accvgpr_write_b32 a121, 0
  v_accvgpr_write_b32 a122, 0
  v_accvgpr_write_b32 a123, 0
  v_accvgpr_write_b32 a124, 0
  v_accvgpr_write_b32 a125, 0
  v_accvgpr_write_b32 a126, 0
  v_accvgpr_write_b32 a127, 0
  v_accvgpr_write_b32 a128, 0
  v_accvgpr_write_b32 a129, 0
  v_accvgpr_write_b32 a130, 0
  v_accvgpr_write_b32 a131, 0
  v_accvgpr_write_b32 a132, 0
  v_accvgpr_write_b32 a133, 0
  v_accvgpr_write_b32 a134, 0
  v_accvgpr_write_b32 a135, 0
  v_accvgpr_write_b32 a136, 0
  v_accvgpr_write_b32 a137, 0
  v_accvgpr_write_b32 a138, 0
  v_accvgpr_write_b32 a139, 0
  v_accvgpr_write_b32 a140, 0
  v_accvgpr_write_b32 a141, 0
  v_accvgpr_write_b32 a142, 0
  v_accvgpr_write_b32 a143, 0
  v_accvgpr_write_b32 a144, 0
  v_accvgpr_write_b32 a145, 0
  v_accvgpr_write_b32 a146, 0
  v_accvgpr_write_b32 a147, 0
  v_accvgpr_write_b32 a148, 0
  v_accvgpr_write_b32 a149, 0
  v_accvgpr_write_b32 a150, 0
  v_accvgpr_write_b32 a151, 0
  v_accvgpr_write_b32 a152, 0
  v_accvgpr_write_b32 a153, 0
  v_accvgpr_write_b32 a154, 0
  v_accvgpr_write_b32 a155, 0
  v_accvgpr_write_b32 a156, 0
  v_accvgpr_write_b32 a157, 0
  v_accvgpr_write_b32 a158, 0
  v_accvgpr_write_b32 a159, 0
  v_accvgpr_write_b32 a160, 0
  v_accvgpr_write_b32 a161, 0
  v_accvgpr_write_b32 a162, 0
  v_accvgpr_write_b32 a163, 0
  v_accvgpr_write_b32 a164, 0
  v_accvgpr_write_b32 a165, 0
  v_accvgpr_write_b32 a166, 0
  v_accvgpr_write_b32 a167, 0
  v_accvgpr_write_b32 a168, 0
  v_accvgpr_write_b32 a169, 0
  v_accvgpr_write_b32 a170, 0
  v_accvgpr_write_b32 a171, 0
  v_accvgpr_write_b32 a172, 0
  v_accvgpr_write_b32 a173, 0
  v_accvgpr_write_b32 a174, 0
  v_accvgpr_write_b32 a175, 0
  v_accvgpr_write_b32 a176, 0
  v_accvgpr_write_b32 a177, 0
  v_accvgpr_write_b32 a178, 0
  v_accvgpr_write_b32 a179, 0
  v_accvgpr_write_b32 a180, 0
  v_accvgpr_write_b32 a181, 0
  v_accvgpr_write_b32 a182, 0
  v_accvgpr_write_b32 a183, 0
  v_accvgpr_write_b32 a184, 0
  v_accvgpr_write_b32 a185, 0
  v_accvgpr_write_b32 a186, 0
  v_accvgpr_write_b32 a187, 0
  v_accvgpr_write_b32 a188, 0
  v_accvgpr_write_b32 a189, 0
  v_accvgpr_write_b32 a190, 0
  v_accvgpr_write_b32 a191, 0
  v_accvgpr_write_b32 a192, 0
  v_accvgpr_write_b32 a193, 0
  v_accvgpr_write_b32 a194, 0
  v_accvgpr_write_b32 a195, 0
  v_accvgpr_write_b32 a196, 0
  v_accvgpr_write_b32 a197, 0
  v_accvgpr_write_b32 a198, 0
  v_accvgpr_write_b32 a199, 0
  v_accvgpr_write_b32 a200, 0
  v_accvgpr_write_b32 a201, 0
  v_accvgpr_write_b32 a202, 0
  v_accvgpr_write_b32 a203, 0
  v_accvgpr_write_b32 a204, 0
  v_accvgpr_write_b32 a205, 0
  v_accvgpr_write_b32 a206, 0
  v_accvgpr_write_b32 a207, 0
  v_accvgpr_write_b32 a208, 0
  v_accvgpr_write_b32 a209, 0
  v_accvgpr_write_b32 a210, 0
  v_accvgpr_write_b32 a211, 0
  v_accvgpr_write_b32 a212, 0
  v_accvgpr_write_b32 a213, 0
  v_accvgpr_write_b32 a214, 0
  v_accvgpr_write_b32 a215, 0
  v_accvgpr_write_b32 a216, 0
  v_accvgpr_write_b32 a217, 0
  v_accvgpr_write_b32 a218, 0
  v_accvgpr_write_b32 a219, 0
  v_accvgpr_write_b32 a220, 0
  v_accvgpr_write_b32 a221, 0
  v_accvgpr_write_b32 a222, 0
  v_accvgpr_write_b32 a223, 0
  v_accvgpr_write_b32 a224, 0
  v_accvgpr_write_b32 a225, 0
  v_accvgpr_write_b32 a226, 0
  v_accvgpr_write_b32 a227, 0
  v_accvgpr_write_b32 a228, 0
  v_accvgpr_write_b32 a229, 0
  v_accvgpr_write_b32 a230, 0
  v_accvgpr_write_b32 a231, 0
  v_accvgpr_write_b32 a232, 0
  v_accvgpr_write_b32 a233, 0
  v_accvgpr_write_b32 a234, 0
  v_accvgpr_write_b32 a235, 0
  v_accvgpr_write_b32 a236, 0
  v_accvgpr_write_b32 a237, 0
  v_accvgpr_write_b32 a238, 0
  v_accvgpr_write_b32 a239, 0
  v_accvgpr_write_b32 a240, 0
  v_accvgpr_write_b32 a241, 0
  v_accvgpr_write_b32 a242, 0
  v_accvgpr_write_b32 a243, 0
  v_accvgpr_write_b32 a244, 0
  v_accvgpr_write_b32 a245, 0
  v_accvgpr_write_b32 a246, 0
  v_accvgpr_write_b32 a247, 0
  v_accvgpr_write_b32 a248, 0
  v_accvgpr_write_b32 a249, 0
  v_accvgpr_write_b32 a250, 0
  v_accvgpr_write_b32 a251, 0
  v_accvgpr_write_b32 a252, 0
  v_accvgpr_write_b32 a253, 0
  v_accvgpr_write_b32 a254, 0
  v_accvgpr_write_b32 a255, 0
  s_barrier
  ds_read_b128 v[32:35], v2 offset:0
  ds_read_b64_tr_b16 v[64:65], v4 offset:0
  ds_read_b64_tr_b16 v[66:67], v4 offset:2048
  ds_read_b64_tr_b16 v[68:69], v5 offset:0
  ds_read_b64_tr_b16 v[70:71], v5 offset:2048
  ds_read_b128 v[36:39], v2 offset:2048
  ds_read_b64_tr_b16 v[72:73], v6 offset:0
  ds_read_b64_tr_b16 v[74:75], v6 offset:2048
  ds_read_b128 v[40:43], v2 offset:4096
  ds_read_b64_tr_b16 v[76:77], v7 offset:0
  ds_read_b64_tr_b16 v[78:79], v7 offset:2048
  ds_read_b128 v[44:47], v2 offset:6144
  ds_read_b64_tr_b16 v[80:81], v8 offset:0
  ds_read_b64_tr_b16 v[82:83], v8 offset:2048
  ds_read_b128 v[48:51], v2 offset:8192
  ds_read_b64_tr_b16 v[84:85], v9 offset:0
  ds_read_b64_tr_b16 v[86:87], v9 offset:2048
  ds_read_b128 v[52:55], v2 offset:10240
  ds_read_b64_tr_b16 v[88:89], v10 offset:0
  ds_read_b64_tr_b16 v[90:91], v10 offset:2048
  ds_read_b128 v[56:59], v2 offset:12288
  ds_read_b64_tr_b16 v[92:93], v11 offset:0
  ds_read_b64_tr_b16 v[94:95], v11 offset:2048
  ds_read_b128 v[60:63], v2 offset:14336
  s_mov_b32 s54, 8
gl_183:
  s_waitcnt lgkmcnt(15)
  v_mfma_f32_16x16x32_bf16 a[0:3], v[32:35], v[64:67], a[0:3]
  ds_read_b128 v[96:99], v3 offset:0
  s_add_u32 m0, s55, 57344
  v_mfma_f32_16x16x32_bf16 a[4:7], v[32:35], v[68:71], a[4:7]
  buffer_load_dwordx4 v18, s[44:47], s52 offen  lds
  v_mfma_f32_16x16x32_bf16 a[32:35], v[36:39], v[64:67], a[32:35]
  ds_read_b64_tr_b16 v[128:129], v4 offset:16384
  v_mfma_f32_16x16x32_bf16 a[36:39], v[36:39], v[68:71], a[36:39]
  v_mfma_f32_16x16x32_bf16 a[8:11], v[32:35], v[72:75], a[8:11]
  ds_read_b64_tr_b16 v[130:131], v4 offset:18432
  v_mfma_f32_16x16x32_bf16 a[40:43], v[36:39], v[72:75], a[40:43]
  s_add_u32 m0, s55, 122880
  v_mfma_f32_16x16x32_bf16 a[64:67], v[40:43], v[64:67], a[64:67]
  buffer_load_dwordx4 v26, s[48:51], s53 offen lds
  v_mfma_f32_16x16x32_bf16 a[68:71], v[40:43], v[68:71], a[68:71]
  ds_read_b64_tr_b16 v[132:133], v5 offset:16384
  v_mfma_f32_16x16x32_bf16 a[72:75], v[40:43], v[72:75], a[72:75]
  s_waitcnt lgkmcnt(15)
  v_mfma_f32_16x16x32_bf16 a[12:15], v[32:35], v[76:79], a[12:15]
  ds_read_b64_tr_b16 v[134:135], v5 offset:18432
  v_mfma_f32_16x16x32_bf16 a[44:47], v[36:39], v[76:79], a[44:47]
  s_add_u32 m0, s55, 61440
  v_mfma_f32_16x16x32_bf16 a[76:79], v[40:43], v[76:79], a[76:79]
  buffer_load_dwordx4 v19, s[44:47], s52 offen  lds
  ds_read_b128 v[100:103], v3 offset:2048
  v_mfma_f32_16x16x32_bf16 a[96:99], v[44:47], v[64:67], a[96:99]
  v_mfma_f32_16x16x32_bf16 a[100:103], v[44:47], v[68:71], a[100:103]
  v_mfma_f32_16x16x32_bf16 a[104:107], v[44:47], v[72:75], a[104:107]
  ds_read_b64_tr_b16 v[136:137], v6 offset:16384
  v_mfma_f32_16x16x32_bf16 a[108:111], v[44:47], v[76:79], a[108:111]
  s_waitcnt lgkmcnt(15)
  s_add_u32 m0, s55, 126976
  v_mfma_f32_16x16x32_bf16 a[16:19], v[32:35], v[80:83], a[16:19]
  buffer_load_dwordx4 v27, s[48:51], s53 offen lds
  ds_read_b64_tr_b16 v[138:139], v6 offset:18432
  v_mfma_f32_16x16x32_bf16 a[48:51], v[36:39], v[80:83], a[48:51]
  v_mfma_f32_16x16x32_bf16 a[80:83], v[40:43], v[80:83], a[80:83]
  ds_read_b128 v[104:107], v3 offset:4096
  v_mfma_f32_16x16x32_bf16 a[112:115], v[44:47], v[80:83], a[112:115]
  v_mfma_f32_16x16x32_bf16 a[128:131], v[48:51], v[64:67], a[128:131]
  v_mfma_f32_16x16x32_bf16 a[132:135], v[48:51], v[68:71], a[132:135]
  ds_read_b64_tr_b16 v[140:141], v7 offset:16384
  v_mfma_f32_16x16x32_bf16 a[136:139], v[48:51], v[72:75], a[136:139]
  v_mfma_f32_16x16x32_bf16 a[140:143], v[48:51], v[76:79], a[140:143]
  ds_read_b64_tr_b16 v[142:143], v7 offset:18432
  v_mfma_f32_16x16x32_bf16 a[144:147], v[48:51], v[80:83], a[144:147]
  s_waitcnt lgkmcnt(15)
  v_mfma_f32_16x16x32_bf16 a[20:23], v[32:35], v[84:87], a[20:23]
  ds_read_b128 v[108:111], v3 offset:6144
  v_mfma_f32_16x16x32_bf16 a[52:55], v[36:39], v[84:87], a[52:55]
  v_mfma_f32_16x16x32_bf16 a[84:87], v[40:43], v[84:87], a[84:87]
  v_mfma_f32_16x16x32_bf16 a[116:119], v[44:47], v[84:87], a[116:119]
  ds_read_b64_tr_b16 v[144:145], v8 offset:16384
  v_mfma_f32_16x16x32_bf16 a[148:151], v[48:51], v[84:87], a[148:151]
  v_mfma_f32_16x16x32_bf16 a[160:163], v[52:55], v[64:67], a[160:163]
  ds_read_b64_tr_b16 v[146:147], v8 offset:18432
  v_mfma_f32_16x16x32_bf16 a[164:167], v[52:55], v[68:71], a[164:167]
  v_mfma_f32_16x16x32_bf16 a[168:171], v[52:55], v[72:75], a[168:171]
  ds_read_b128 v[112:115], v3 offset:8192
  v_mfma_f32_16x16x32_bf16 a[172:175], v[52:55], v[76:79], a[172:175]
  v_mfma_f32_16x16x32_bf16 a[176:179], v[52:55], v[80:83], a[176:179]
  v_mfma_f32_16x16x32_bf16 a[180:183], v[52:55], v[84:87], a[180:183]
  ds_read_b64_tr_b16 v[148:149], v9 offset:16384
  v_mfma_f32_16x16x32_bf16 a[24:27], v[32:35], v[88:91], a[24:27]
  v_mfma_f32_16x16x32_bf16 a[56:59], v[36:39], v[88:91], a[56:59]
  ds_read_b64_tr_b16 v[150:151], v9 offset:18432
  v_mfma_f32_16x16x32_bf16 a[88:91], v[40:43], v[88:91], a[88:91]
  v_mfma_f32_16x16x32_bf16 a[120:123], v[44:47], v[88:91], a[120:123]
  ds_read_b128 v[116:119], v3 offset:10240
  v_mfma_f32_16x16x32_bf16 a[152:155], v[48:51], v[88:91], a[152:155]
  v_mfma_f32_16x16x32_bf16 a[184:187], v[52:55], v[88:91], a[184:187]
  s_waitcnt lgkmcnt(15)
  v_mfma_f32_16x16x32_bf16 a[192:195], v[56:59], v[64:67], a[192:195]
  ds_read_b64_tr_b16 v[152:153], v10 offset:16384
  v_mfma_f32_16x16x32_bf16 a[196:199], v[56:59], v[68:71], a[196:199]
  v_mfma_f32_16x16x32_bf16 a[200:203], v[56:59], v[72:75], a[200:203]
  ds_read_b64_tr_b16 v[154:155], v10 offset:18432
  v_mfma_f32_16x16x32_bf16 a[204:207], v[56:59], v[76:79], a[204:207]
  v_mfma_f32_16x16x32_bf16 a[208:211], v[56:59], v[80:83], a[208:211]
  ds_read_b128 v[120:123], v3 offset:12288
  v_mfma_f32_16x16x32_bf16 a[212:215], v[56:59], v[84:87], a[212:215]
  v_mfma_f32_16x16x32_bf16 a[216:219], v[56:59], v[88:91], a[216:219]
  v_mfma_f32_16x16x32_bf16 a[28:31], v[32:35], v[92:95], a[28:31]
  ds_read_b64_tr_b16 v[156:157], v11 offset:16384
  v_mfma_f32_16x16x32_bf16 a[60:63], v[36:39], v[92:95], a[60:63]
  v_mfma_f32_16x16x32_bf16 a[92:95], v[40:43], v[92:95], a[92:95]
  ds_read_b64_tr_b16 v[158:159], v11 offset:18432
  v_mfma_f32_16x16x32_bf16 a[124:127], v[44:47], v[92:95], a[124:127]
  v_mfma_f32_16x16x32_bf16 a[156:159], v[48:51], v[92:95], a[156:159]
  ds_read_b128 v[124:127], v3 offset:14336
  v_mfma_f32_16x16x32_bf16 a[188:191], v[52:55], v[92:95], a[188:191]
  v_mfma_f32_16x16x32_bf16 a[220:223], v[56:59], v[92:95], a[220:223]
  v_mfma_f32_16x16x32_bf16 a[224:227], v[60:63], v[64:67], a[224:227]
  v_mfma_f32_16x16x32_bf16 a[228:231], v[60:63], v[68:71], a[228:231]
  v_mfma_f32_16x16x32_bf16 a[232:235], v[60:63], v[72:75], a[232:235]
  v_mfma_f32_16x16x32_bf16 a[236:239], v[60:63], v[76:79], a[236:239]
  v_mfma_f32_16x16x32_bf16 a[240:243], v[60:63], v[80:83], a[240:243]
  v_mfma_f32_16x16x32_bf16 a[244:247], v[60:63], v[84:87], a[244:247]
  v_mfma_f32_16x16x32_bf16 a[248:251], v[60:63], v[88:91], a[248:251]
  v_mfma_f32_16x16x32_bf16 a[252:255], v[60:63], v[92:95], a[252:255]
  s_add_u32 s52, s52, 128
  s_add_u32 s53, s53, s22
  s_cmp_eq_u32 s54, 1
  s_cselect_b32 s46, 0, s46
  s_cselect_b32 s50, 0, s50
  v_mfma_f32_16x16x32_bf16 a[0:3], v[96:99], v[128:131], a[0:3]
  s_waitcnt lgkmcnt(15)
  v_mfma_f32_16x16x32_bf16 a[4:7], v[96:99], v[132:135], a[4:7]
  s_waitcnt vmcnt(0) lgkmcnt(0)
  s_barrier
  s_cmp_eq_u32 s38, 0
  s_cbranch_scc1 fr_184
  v_mov_b32 v160, s39
  v_mov_b32 v161, s38
  s_mov_b64 exec, 1
  buffer_atomic_add v160, v161, s[40:43], 0 offen sc1
  s_mov_b64 exec, -1
  s_mov_b32 s38, 0
fr_184:
  s_cmp_eq_u32 s16, 0
  s_cbranch_scc1 pf_185
  buffer_load_dword v170, v171, s[64:67], 0 offen
  v_add_u32 v171, 8192, v171
  s_sub_u32 s16, s16, 1
pf_185:
  s_add_u32 m0, s55, 0
  v_mfma_f32_16x16x32_bf16 a[32:35], v[100:103], v[128:131], a[32:35]
  buffer_load_dwordx4 v12, s[44:47], s52 offen  lds
  v_mfma_f32_16x16x32_bf16 a[36:39], v[100:103], v[132:135], a[36:39]
  ds_read_b128 v[32:35], v2 offset:32768
  v_mfma_f32_16x16x32_bf16 a[8:11], v[96:99], v[136:139], a[8:11]
  v_mfma_f32_16x16x32_bf16 a[40:43], v[100:103], v[136:139], a[40:43]
  ds_read_b64_tr_b16 v[64:65], v4 offset:32768
  v_mfma_f32_16x16x32_bf16 a[64:67], v[104:107], v[128:131], a[64:67]
  s_add_u32 m0, s55, 65536
  v_mfma_f32_16x16x32_bf16 a[68:71], v[104:107], v[132:135], a[68:71]
  buffer_load_dwordx4 v20, s[48:51], s53 offen lds
  ds_read_b64_tr_b16 v[66:67], v4 offset:34816
  v_mfma_f32_16x16x32_bf16 a[72:75], v[104:107], v[136:139], a[72:75]
  v_mfma_f32_16x16x32_bf16 a[12:15], v[96:99], v[140:143], a[12:15]
  v_mfma_f32_16x16x32_bf16 a[44:47], v[100:103], v[140:143], a[44:47]
  ds_read_b64_tr_b16 v[68:69], v5 offset:32768
  v_mfma_f32_16x16x32_bf16 a[76:79], v[104:107], v[140:143], a[76:79]
  s_add_u32 m0, s55, 4096
  v_mfma_f32_16x16x32_bf16 a[96:99], v[108:111], v[128:131], a[96:99]
  buffer_load_dwordx4 v13, s[44:47], s52 offen  lds
  ds_read_b64_tr_b16 v[70:71], v5 offset:34816
  v_mfma_f32_16x16x32_bf16 a[100:103], v[108:111], v[132:135], a[100:103]
  v_mfma_f32_16x16x32_bf16 a[104:107], v[108:111], v[136:139], a[104:107]
  ds_read_b128 v[36:39], v2 offset:34816
  v_mfma_f32_16x16x32_bf16 a[108:111], v[108:111], v[140:143], a[108:111]
  v_mfma_f32_16x16x32_bf16 a[16:19], v[96:99], v[144:147], a[16:19]
  s_add_u32 m0, s55, 69632
  v_mfma_f32_16x16x32_bf16 a[48:51], v[100:103], v[144:147], a[48:51]
  buffer_load_dwordx4 v21, s[48:51], s53 offen lds
  ds_read_b64_tr_b16 v[72:73], v6 offset:32768
  v_mfma_f32_16x16x32_bf16 a[80:83], v[104:107], v[144:147], a[80:83]
  v_mfma_f32_16x16x32_bf16 a[112:115], v[108:111], v[144:147], a[112:115]
  ds_read_b64_tr_b16 v[74:75], v6 offset:34816
  v_mfma_f32_16x16x32_bf16 a[128:131], v[112:115], v[128:131], a[128:131]
  v_mfma_f32_16x16x32_bf16 a[132:135], v[112:115], v[132:135], a[132:135]
  s_add_u32 m0, s55, 8192
  v_mfma_f32_16x16x32_bf16 a[136:139], v[112:115], v[136:139], a[136:139]
  buffer_load_dwordx4 v14, s[44:47], s52 offen  lds
  ds_read_b128 v[40:43], v2 offset:36864
  v_mfma_f32_16x16x32_bf16 a[140:143], v[112:115], v[140:143], a[140:143]
  v_mfma_f32_16x16x32_bf16 a[144:147], v[112:115], v[144:147], a[144:147]
  ds_read_b64_tr_b16 v[76:77], v7 offset:32768
  v_mfma_f32_16x16x32_bf16 a[20:23], v[96:99], v[148:151], a[20:23]
  v_mfma_f32_16x16x32_bf16 a[52:55], v[100:103], v[148:151], a[52:55]
  ds_read_b64_tr_b16 v[78:79], v7 offset:34816
  s_add_u32 m0, s55, 73728
  v_mfma_f32_16x16x32_bf16 a[84:87], v[104:107], v[148:151], a[84:87]
  buffer_load_dwordx4 v22, s[48:51], s53 offen lds
  v_mfma_f32_16x16x32_bf16 a[116:119], v[108:111], v[148:151], a[116:119]
  v_mfma_f32_16x16x32_bf16 a[148:151], v[112:115], v[148:151], a[148:151]
  ds_read_b128 v[44:47], v2 offset:38912
  v_mfma_f32_16x16x32_bf16 a[160:163], v[116:119], v[128:131], a[160:163]
  v_mfma_f32_16x16x32_bf16 a[164:167], v[116:119], v[132:135], a[164:167]
  ds_read_b64_tr_b16 v[80:81], v8 offset:32768
  v_mfma_f32_16x16x32_bf16 a[168:171], v[116:119], v[136:139], a[168:171]
  s_add_u32 m0, s55, 12288
  v_mfma_f32_16x16x32_bf16 a[172:175], v[116:119], v[140:143], a[172:175]
  buffer_load_dwordx4 v15, s[44:47], s52 offen  lds
  ds_read_b64_tr_b16 v[82:83], v8 offset:34816
  v_mfma_f32_16x16x32_bf16 a[176:179], v[116:119], v[144:147], a[176:179]
  v_mfma_f32_16x16x32_bf16 a[180:183], v[116:119], v[148:151], a[180:183]
  v_mfma_f32_16x16x32_bf16 a[24:27], v[96:99], v[152:155], a[24:27]
  ds_read_b128 v[48:51], v2 offset:40960
  v_mfma_f32_16x16x32_bf16 a[56:59], v[100:103], v[152:155], a[56:59]
  s_add_u32 m0, s55, 77824
  v_mfma_f32_16x16x32_bf16 a[88:91], v[104:107], v[152:155], a[88:91]
  buffer_load_dwordx4 v23, s[48:51], s53 offen lds
  ds_read_b64_tr_b16 v[84:85], v9 offset:32768
  v_mfma_f32_16x16x32_bf16 a[120:123], v[108:111], v[152:155], a[120:123]
  v_mfma_f32_16x16x32_bf16 a[152:155], v[112:115], v[152:155], a[152:155]
  v_mfma_f32_16x16x32_bf16 a[184:187], v[116:119], v[152:155], a[184:187]
  ds_read_b64_tr_b16 v[86:87], v9 offset:34816
  v_mfma_f32_16x16x32_bf16 a[192:195], v[120:123], v[128:131], a[192:195]
  s_add_u32 m0, s55, 16384
  v_mfma_f32_16x16x32_bf16 a[196:199], v[120:123], v[132:135], a[196:199]
  buffer_load_dwordx4 v16, s[44:47], s52 offen  lds
  ds_read_b128 v[52:55], v2 offset:43008
  v_mfma_f32_16x16x32_bf16 a[200:203], v[120:123], v[136:139], a[200:203]
  v_mfma_f32_16x16x32_bf16 a[204:207], v[120:123], v[140:143], a[204:207]
  ds_read_b64_tr_b16 v[88:89], v10 offset:32768
  v_mfma_f32_16x16x32_bf16 a[208:211], v[120:123], v[144:147], a[208:211]
  v_mfma_f32_16x16x32_bf16 a[212:215], v[120:123], v[148:151], a[212:215]
  s_add_u32 m0, s55, 81920
  v_mfma_f32_16x16x32_bf16 a[216:219], v[120:123], v[152:155], a[216:219]
  buffer_load_dwordx4 v24, s[48:51], s53 offen lds
  ds_read_b64_tr_b16 v[90:91], v10 offset:34816
  v_mfma_f32_16x16x32_bf16 a[28:31], v[96:99], v[156:159], a[28:31]
  v_mfma_f32_16x16x32_bf16 a[60:63], v[100:103], v[156:159], a[60:63]
  ds_read_b128 v[56:59], v2 offset:45056
  v_mfma_f32_16x16x32_bf16 a[92:95], v[104:107], v[156:159], a[92:95]
  v_mfma_f32_16x16x32_bf16 a[124:127], v[108:111], v[156:159], a[124:127]
  ds_read_b64_tr_b16 v[92:93], v11 offset:32768
  s_add_u32 m0, s55, 20480
  v_mfma_f32_16x16x32_bf16 a[156:159], v[112:115], v[156:159], a[156:159]
  buffer_load_dwordx4 v17, s[44:47], s52 offen  lds
  v_mfma_f32_16x16x32_bf16 a[188:191], v[116:119], v[156:159], a[188:191]
  v_mfma_f32_16x16x32_bf16 a[220:223], v[120:123], v[156:159], a[220:223]
  ds_read_b64_tr_b16 v[94:95], v11 offset:34816
  v_mfma_f32_16x16x32_bf16 a[224:227], v[124:127], v[128:131], a[224:227]
  v_mfma_f32_16x16x32_bf16 a[228:231], v[124:127], v[132:135], a[228:231]
  ds_read_b128 v[60:63], v2 offset:47104
  s_add_u32 m0, s55, 86016
  v_mfma_f32_16x16x32_bf16 a[232:235], v[124:127], v[136:139], a[232:235]
  buffer_load_dwordx4 v25, s[48:51], s53 offen lds
  v_mfma_f32_16x16x32_bf16 a[236:239], v[124:127], v[140:143], a[236:239]
  v_mfma_f32_16x16x32_bf16 a[240:243], v[124:127], v[144:147], a[240:243]
  v_mfma_f32_16x16x32_bf16 a[244:247], v[124:127], v[148:151], a[244:247]
  v_mfma_f32_16x16x32_bf16 a[248:251], v[124:127], v[152:155], a[248:251]
  v_mfma_f32_16x16x32_bf16 a[252:255], v[124:127], v[156:159], a[252:255]
  s_waitcnt lgkmcnt(15)
  v_mfma_f32_16x16x32_bf16 a[0:3], v[32:35], v[64:67], a[0:3]
  ds_read_b128 v[96:99], v3 offset:32768
  s_add_u32 m0, s55, 24576
  v_mfma_f32_16x16x32_bf16 a[4:7], v[32:35], v[68:71], a[4:7]
  buffer_load_dwordx4 v18, s[44:47], s52 offen  lds
  v_mfma_f32_16x16x32_bf16 a[32:35], v[36:39], v[64:67], a[32:35]
  ds_read_b64_tr_b16 v[128:129], v4 offset:49152
  v_mfma_f32_16x16x32_bf16 a[36:39], v[36:39], v[68:71], a[36:39]
  v_mfma_f32_16x16x32_bf16 a[8:11], v[32:35], v[72:75], a[8:11]
  ds_read_b64_tr_b16 v[130:131], v4 offset:51200
  v_mfma_f32_16x16x32_bf16 a[40:43], v[36:39], v[72:75], a[40:43]
  s_add_u32 m0, s55, 90112
  v_mfma_f32_16x16x32_bf16 a[64:67], v[40:43], v[64:67], a[64:67]
  buffer_load_dwordx4 v26, s[48:51], s53 offen lds
  v_mfma_f32_16x16x32_bf16 a[68:71], v[40:43], v[68:71], a[68:71]
  ds_read_b64_tr_b16 v[132:133], v5 offset:49152
  v_mfma_f32_16x16x32_bf16 a[72:75], v[40:43], v[72:75], a[72:75]
  s_waitcnt lgkmcnt(15)
  v_mfma_f32_16x16x32_bf16 a[12:15], v[32:35], v[76:79], a[12:15]
  ds_read_b64_tr_b16 v[134:135], v5 offset:51200
  v_mfma_f32_16x16x32_bf16 a[44:47], v[36:39], v[76:79], a[44:47]
  s_add_u32 m0, s55, 28672
  v_mfma_f32_16x16x32_bf16 a[76:79], v[40:43], v[76:79], a[76:79]
  buffer_load_dwordx4 v19, s[44:47], s52 offen  lds
  ds_read_b128 v[100:103], v3 offset:34816
  v_mfma_f32_16x16x32_bf16 a[96:99], v[44:47], v[64:67], a[96:99]
  v_mfma_f32_16x16x32_bf16 a[100:103], v[44:47], v[68:71], a[100:103]
  v_mfma_f32_16x16x32_bf16 a[104:107], v[44:47], v[72:75], a[104:107]
  ds_read_b64_tr_b16 v[136:137], v6 offset:49152
  v_mfma_f32_16x16x32_bf16 a[108:111], v[44:47], v[76:79], a[108:111]
  s_waitcnt lgkmcnt(15)
  s_add_u32 m0, s55, 94208
  v_mfma_f32_16x16x32_bf16 a[16:19], v[32:35], v[80:83], a[16:19]
  buffer_load_dwordx4 v27, s[48:51], s53 offen lds
  ds_read_b64_tr_b16 v[138:139], v6 offset:51200
  v_mfma_f32_16x16x32_bf16 a[48:51], v[36:39], v[80:83], a[48:51]
  v_mfma_f32_16x16x32_bf16 a[80:83], v[40:43], v[80:83], a[80:83]
  ds_read_b128 v[104:107], v3 offset:36864
  v_mfma_f32_16x16x32_bf16 a[112:115], v[44:47], v[80:83], a[112:115]
  v_mfma_f32_16x16x32_bf16 a[128:131], v[48:51], v[64:67], a[128:131]
  v_mfma_f32_16x16x32_bf16 a[132:135], v[48:51], v[68:71], a[132:135]
  ds_read_b64_tr_b16 v[140:141], v7 offset:49152
  v_mfma_f32_16x16x32_bf16 a[136:139], v[48:51], v[72:75], a[136:139]
  v_mfma_f32_16x16x32_bf16 a[140:143], v[48:51], v[76:79], a[140:143]
  ds_read_b64_tr_b16 v[142:143], v7 offset:51200
  v_mfma_f32_16x16x32_bf16 a[144:147], v[48:51], v[80:83], a[144:147]
  s_waitcnt lgkmcnt(15)
  v_mfma_f32_16x16x32_bf16 a[20:23], v[32:35], v[84:87], a[20:23]
  ds_read_b128 v[108:111], v3 offset:38912
  v_mfma_f32_16x16x32_bf16 a[52:55], v[36:39], v[84:87], a[52:55]
  v_mfma_f32_16x16x32_bf16 a[84:87], v[40:43], v[84:87], a[84:87]
  v_mfma_f32_16x16x32_bf16 a[116:119], v[44:47], v[84:87], a[116:119]
  ds_read_b64_tr_b16 v[144:145], v8 offset:49152
  v_mfma_f32_16x16x32_bf16 a[148:151], v[48:51], v[84:87], a[148:151]
  v_mfma_f32_16x16x32_bf16 a[160:163], v[52:55], v[64:67], a[160:163]
  ds_read_b64_tr_b16 v[146:147], v8 offset:51200
  v_mfma_f32_16x16x32_bf16 a[164:167], v[52:55], v[68:71], a[164:167]
  v_mfma_f32_16x16x32_bf16 a[168:171], v[52:55], v[72:75], a[168:171]
  ds_read_b128 v[112:115], v3 offset:40960
  v_mfma_f32_16x16x32_bf16 a[172:175], v[52:55], v[76:79], a[172:175]
  v_mfma_f32_16x16x32_bf16 a[176:179], v[52:55], v[80:83], a[176:179]
  v_mfma_f32_16x16x32_bf16 a[180:183], v[52:55], v[84:87], a[180:183]
  ds_read_b64_tr_b16 v[148:149], v9 offset:49152
  v_mfma_f32_16x16x32_bf16 a[24:27], v[32:35], v[88:91], a[24:27]
  v_mfma_f32_16x16x32_bf16 a[56:59], v[36:39], v[88:91], a[56:59]
  ds_read_b64_tr_b16 v[150:151], v9 offset:51200
  v_mfma_f32_16x16x32_bf16 a[88:91], v[40:43], v[88:91], a[88:91]
  v_mfma_f32_16x16x32_bf16 a[120:123], v[44:47], v[88:91], a[120:123]
  ds_read_b128 v[116:119], v3 offset:43008
  v_mfma_f32_16x16x32_bf16 a[152:155], v[48:51], v[88:91], a[152:155]
  v_mfma_f32_16x16x32_bf16 a[184:187], v[52:55], v[88:91], a[184:187]
  s_waitcnt lgkmcnt(15)
  v_mfma_f32_16x16x32_bf16 a[192:195], v[56:59], v[64:67], a[192:195]
  ds_read_b64_tr_b16 v[152:153], v10 offset:49152
  v_mfma_f32_16x16x32_bf16 a[196:199], v[56:59], v[68:71], a[196:199]
  v_mfma_f32_16x16x32_bf16 a[200:203], v[56:59], v[72:75], a[200:203]
  ds_read_b64_tr_b16 v[154:155], v10 offset:51200
  v_mfma_f32_16x16x32_bf16 a[204:207], v[56:59], v[76:79], a[204:207]
  v_mfma_f32_16x16x32_bf16 a[208:211], v[56:59], v[80:83], a[208:211]
  ds_read_b128 v[120:123], v3 offset:45056
  v_mfma_f32_16x16x32_bf16 a[212:215], v[56:59], v[84:87], a[212:215]
  v_mfma_f32_16x16x32_bf16 a[216:219], v[56:59], v[88:91], a[216:219]
  v_mfma_f32_16x16x32_bf16 a[28:31], v[32:35], v[92:95], a[28:31]
  ds_read_b64_tr_b16 v[156:157], v11 offset:49152
  v_mfma_f32_16x16x32_bf16 a[60:63], v[36:39], v[92:95], a[60:63]
  v_mfma_f32_16x16x32_bf16 a[92:95], v[40:43], v[92:95], a[92:95]
  ds_read_b64_tr_b16 v[158:159], v11 offset:51200
  v_mfma_f32_16x16x32_bf16 a[124:127], v[44:47], v[92:95], a[124:127]
  v_mfma_f32_16x16x32_bf16 a[156:159], v[48:51], v[92:95], a[156:159]
  ds_read_b128 v[124:127], v3 offset:47104
  v_mfma_f32_16x16x32_bf16 a[188:191], v[52:55], v[92:95], a[188:191]
  v_mfma_f32_16x16x32_bf16 a[220:223], v[56:59], v[92:95], a[220:223]
  v_mfma_f32_16x16x32_bf16 a[224:227], v[60:63], v[64:67], a[224:227]
  v_mfma_f32_16x16x32_bf16 a[228:231], v[60:63], v[68:71], a[228:231]
  v_mfma_f32_16x16x32_bf16 a[232:235], v[60:63], v[72:75], a[232:235]
  v_mfma_f32_16x16x32_bf16 a[236:239], v[60:63], v[76:79], a[236:239]
  v_mfma_f32_16x16x32_bf16 a[240:243], v[60:63], v[80:83], a[240:243]
  v_mfma_f32_16x16x32_bf16 a[244:247], v[60:63], v[84:87], a[244:247]
  v_mfma_f32_16x16x32_bf16 a[248:251], v[60:63], v[88:91], a[248:251]
  v_mfma_f32_16x16x32_bf16 a[252:255], v[60:63], v[92:95], a[252:255]
  s_add_u32 s52, s52, 128
  s_add_u32 s53, s53, s22
  v_mfma_f32_16x16x32_bf16 a[0:3], v[96:99], v[128:131], a[0:3]
  s_waitcnt lgkmcnt(15)
  v_mfma_f32_16x16x32_bf16 a[4:7], v[96:99], v[132:135], a[4:7]
  s_waitcnt vmcnt(0) lgkmcnt(0)
  s_barrier
  s_add_u32 m0, s55, 32768
  v_mfma_f32_16x16x32_bf16 a[32:35], v[100:103], v[128:131], a[32:35]
  buffer_load_dwordx4 v12, s[44:47], s52 offen  lds
  v_mfma_f32_16x16x32_bf16 a[36:39], v[100:103], v[132:135], a[36:39]
  ds_read_b128 v[32:35], v2 offset:0
  v_mfma_f32_16x16x32_bf16 a[8:11], v[96:99], v[136:139], a[8:11]
  v_mfma_f32_16x16x32_bf16 a[40:43], v[100:103], v[136:139], a[40:43]
  ds_read_b64_tr_b16 v[64:65], v4 offset:0
  v_mfma_f32_16x16x32_bf16 a[64:67], v[104:107], v[128:131], a[64:67]
  s_add_u32 m0, s55, 98304
  v_mfma_f32_16x16x32_bf16 a[68:71], v[104:107], v[132:135], a[68:71]
  buffer_load_dwordx4 v20, s[48:51], s53 offen lds
  ds_read_b64_tr_b16 v[66:67], v4 offset:2048
  v_mfma_f32_16x16x32_bf16 a[72:75], v[104:107], v[136:139], a[72:75]
  v_mfma_f32_16x16x32_bf16 a[12:15], v[96:99], v[140:143], a[12:15]
  v_mfma_f32_16x16x32_bf16 a[44:47], v[100:103], v[140:143], a[44:47]
  ds_read_b64_tr_b16 v[68:69], v5 offset:0
  v_mfma_f32_16x16x32_bf16 a[76:79], v[104:107], v[140:143], a[76:79]
  s_add_u32 m0, s55, 36864
  v_mfma_f32_16x16x32_bf16 a[96:99], v[108:111], v[128:131], a[96:99]
  buffer_load_dwordx4 v13, s[44:47], s52 offen  lds
  ds_read_b64_tr_b16 v[70:71], v5 offset:2048
  v_mfma_f32_16x16x32_bf16 a[100:103], v[108:111], v[132:135], a[100:103]
  v_mfma_f32_16x16x32_bf16 a[104:107], v[108:111], v[136:139], a[104:107]
  ds_read_b128 v[36:39], v2 offset:2048
  v_mfma_f32_16x16x32_bf16 a[108:111], v[108:111], v[140:143], a[108:111]
  v_mfma_f32_16x16x32_bf16 a[16:19], v[96:99], v[144:147], a[16:19]
  s_add_u32 m0, s55, 102400
  v_mfma_f32_16x16x32_bf16 a[48:51], v[100:103], v[144:147], a[48:51]
  buffer_load_dwordx4 v21, s[48:51], s53 offen lds
  ds_read_b64_tr_b16 v[72:73], v6 offset:0
  v_mfma_f32_16x16x32_bf16 a[80:83], v[104:107], v[144:147], a[80:83]
  v_mfma_f32_16x16x32_bf16 a[112:115], v[108:111], v[144:147], a[112:115]
  ds_read_b64_tr_b16 v[74:75], v6 offset:2048
  v_mfma_f32_16x16x32_bf16 a[128:131], v[112:115], v[128:131], a[128:131]
  v_mfma_f32_16x16x32_bf16 a[132:135], v[112:115], v[132:135], a[132:135]
  s_add_u32 m0, s55, 40960
  v_mfma_f32_16x16x32_bf16 a[136:139], v[112:115], v[136:139], a[136:139]
  buffer_load_dwordx4 v14, s[44:47], s52 offen  lds
  ds_read_b128 v[40:43], v2 offset:4096
  v_mfma_f32_16x16x32_bf16 a[140:143], v[112:115], v[140:143], a[140:143]
  v_mfma_f32_16x16x32_bf16 a[144:147], v[112:115], v[144:147], a[144:147]
  ds_read_b64_tr_b16 v[76:77], v7 offset:0
  v_mfma_f32_16x16x32_bf16 a[20:23], v[96:99], v[148:151], a[20:23]
  v_mfma_f32_16x16x32_bf16 a[52:55], v[100:103], v[148:151], a[52:55]
  ds_read_b64_tr_b16 v[78:79], v7 offset:2048
  s_add_u32 m0, s55, 106496
  v_mfma_f32_16x16x32_bf16 a[84:87], v[104:107], v[148:151], a[84:87]
  buffer_load_dwordx4 v22, s[48:51], s53 offen lds
  v_mfma_f32_16x16x32_bf16 a[116:119], v[108:111], v[148:151], a[116:119]
  v_mfma_f32_16x16x32_bf16 a[148:151], v[112:115], v[148:151], a[148:151]
  ds_read_b128 v[44:47], v2 offset:6144
  v_mfma_f32_16x16x32_bf16 a[160:163], v[116:119], v[128:131], a[160:163]
  v_mfma_f32_16x16x32_bf16 a[164:167], v[116:119], v[132:135], a[164:167]
  ds_read_b64_tr_b16 v[80:81], v8 offset:0
  v_mfma_f32_16x16x32_bf16 a[168:171], v[116:119], v[136:139], a[168:171]
  s_add_u32 m0, s55, 45056
  v_mfma_f32_16x16x32_bf16 a[172:175], v[116:119], v[140:143], a[172:175]
  buffer_load_dwordx4 v15, s[44:47], s52 offen  lds
  ds_read_b64_tr_b16 v[82:83], v8 offset:2048
  v_mfma_f32_16x16x32_bf16 a[176:179], v[116:119], v[144:147], a[176:179]
  v_mfma_f32_16x16x32_bf16 a[180:183], v[116:119], v[148:151], a[180:183]
  v_mfma_f32_16x16x32_bf16 a[24:27], v[96:99], v[152:155], a[24:27]
  ds_read_b128 v[48:51], v2 offset:8192
  v_mfma_f32_16x16x32_bf16 a[56:59], v[100:103], v[152:155], a[56:59]
  s_add_u32 m0, s55, 110592
  v_mfma_f32_16x16x32_bf16 a[88:91], v[104:107], v[152:155], a[88:91]
  buffer_load_dwordx4 v23, s[48:51], s53 offen lds
  ds_read_b64_tr_b16 v[84:85], v9 offset:0
  v_mfma_f32_16x16x32_bf16 a[120:123], v[108:111], v[152:155], a[120:123]
  v_mfma_f32_16x16x32_bf16 a[152:155], v[112:115], v[152:155], a[152:155]
  v_mfma_f32_16x16x32_bf16 a[184:187], v[116:119], v[152:155], a[184:187]
  ds_read_b64_tr_b16 v[86:87], v9 offset:2048
  v_mfma_f32_16x16x32_bf16 a[192:195], v[120:123], v[128:131], a[192:195]
  s_add_u32 m0, s55, 49152
  v_mfma_f32_16x16x32_bf16 a[196:199], v[120:123], v[132:135], a[196:199]
  buffer_load_dwordx4 v16, s[44:47], s52 offen  lds
  ds_read_b128 v[52:55], v2 offset:10240
  v_mfma_f32_16x16x32_bf16 a[200:203], v[120:123], v[136:139], a[200:203]
  v_mfma_f32_16x16x32_bf16 a[204:207], v[120:123], v[140:143], a[204:207]
  ds_read_b64_tr_b16 v[88:89], v10 offset:0
  v_mfma_f32_16x16x32_bf16 a[208:211], v[120:123], v[144:147], a[208:211]
  v_mfma_f32_16x16x32_bf16 a[212:215], v[120:123], v[148:151], a[212:215]
  s_add_u32 m0, s55, 114688
  v_mfma_f32_16x16x32_bf16 a[216:219], v[120:123], v[152:155], a[216:219]
  buffer_load_dwordx4 v24, s[48:51], s53 offen lds
  ds_read_b64_tr_b16 v[90:91], v10 offset:2048
  v_mfma_f32_16x16x32_bf16 a[28:31], v[96:99], v[156:159], a[28:31]
  v_mfma_f32_16x16x32_bf16 a[60:63], v[100:103], v[156:159], a[60:63]
  ds_read_b128 v[56:59], v2 offset:12288
  v_mfma_f32_16x16x32_bf16 a[92:95], v[104:107], v[156:159], a[92:95]
  v_mfma_f32_16x16x32_bf16 a[124:127], v[108:111], v[156:159], a[124:127]
  ds_read_b64_tr_b16 v[92:93], v11 offset:0
  s_add_u32 m0, s55, 53248
  v_mfma_f32_16x16x32_bf16 a[156:159], v[112:115], v[156:159], a[156:159]
  buffer_load_dwordx4 v17, s[44:47], s52 offen  lds
  v_mfma_f32_16x16x32_bf16 a[188:191], v[116:119], v[156:159], a[188:191]
  v_mfma_f32_16x16x32_bf16 a[220:223], v[120:123], v[156:159], a[220:223]
  ds_read_b64_tr_b16 v[94:95], v11 offset:2048
  v_mfma_f32_16x16x32_bf16 a[224:227], v[124:127], v[128:131], a[224:227]
  v_mfma_f32_16x16x32_bf16 a[228:231], v[124:127], v[132:135], a[228:231]
  ds_read_b128 v[60:63], v2 offset:14336
  s_add_u32 m0, s55, 118784
  v_mfma_f32_16x16x32_bf16 a[232:235], v[124:127], v[136:139], a[232:235]
  buffer_load_dwordx4 v25, s[48:51], s53 offen lds
  v_mfma_f32_16x16x32_bf16 a[236:239], v[124:127], v[140:143], a[236:239]
  v_mfma_f32_16x16x32_bf16 a[240:243], v[124:127], v[144:147], a[240:243]
  v_mfma_f32_16x16x32_bf16 a[244:247], v[124:127], v[148:151], a[244:247]
  v_mfma_f32_16x16x32_bf16 a[248:251], v[124:127], v[152:155], a[248:251]
  v_mfma_f32_16x16x32_bf16 a[252:255], v[124:127], v[156:159], a[252:255]
  s_sub_u32 s54, s54, 1
  s_cmp_lg_u32 s54, 0
  s_cbranch_scc1 gl_183
gl_183_e:
  s_waitcnt lgkmcnt(0)
  s_nop 7
  s_branch next_task
run_x:
  s_waitcnt vmcnt(0)
  s_barrier
  s_cmp_eq_u32 s38, 0
  s_cbranch_scc1 fr_186
  v_mov_b32 v160, s39
  v_mov_b32 v161, s38
  s_mov_b64 exec, 1
  buffer_atomic_add v160, v161, s[40:43], 0 offen sc1
  s_mov_b64 exec, -1
  s_mov_b32 s38, 0
fr_186:
  s_cmp_eq_u32 s26, 0
  s_cbranch_scc1 w_exit
  s_cmp_eq_u32 s26, 6
  s_cbranch_scc1 run_wo
  s_cmp_eq_u32 s26, 7
  s_cbranch_scc1 run_s
  s_lshl_b32 s36, s27, 1
  s_lshr_b32 s37, s61, 3
  s_add_u32 s36, s36, s37
  s_and_b32 s37, s61, 7
  s_lshl_b32 s37, s37, 8
  s_mov_b32 s44, s4
  s_mov_b32 s45, s5
  s_mov_b32 s46, 268435456
  s_mov_b32 s47, 0x00020000
  s_load_dwordx2 s[48:49], s[0:1], 80
  s_mov_b32 s50, 7340032
  s_mov_b32 s51, 0x00020000
  s_mul_i32 s52, s36, 1835008
  s_add_u32 s52, s52, 67108864
  s_mov_b32 s53, s37
  s_lshl_b32 s63, s36, 15
  s_add_u32 s63, s63, s37
  s_lshl_b32 s63, s63, 4
  s_add_u32 s63, s63, 88080384
  s_lshr_b32 s56, s14, 1
  s_and_b32 s57, s14, 1
  s_lshl_b32 s55, s14, 10
  v_and_b32 v28, 15, v1
  v_lshrrev_b32 v29, 4, v1
  v_lshrrev_b32 v30, 1, v28
  v_xor_b32 v30, v29, v30
  v_lshlrev_b32 v30, 4, v30
  v_lshl_add_u32 v2, v28, 7, v30
  s_mul_i32 s58, s56, 16384
  v_add_u32 v2, s58, v2
  v_xor_b32 v3, 64, v2
  v_bfe_u32 v30, v1, 2, 2
  v_lshl_add_u32 v31, v29, 3, v30
  v_mul_u32_u24 v31, 256, v31
  v_and_b32 v160, 3, v1
  v_lshl_add_u32 v31, v160, 3, v31
  v_add_u32 v31, 98304, v31
  v_and_b32 v160, 1, v29
  v_lshl_add_u32 v30, v160, 2, v30
  s_mul_i32 s58, s57, 4
  v_xor_b32 v160, s58, v30
  v_lshl_add_u32 v4, v160, 5, v31
  s_add_u32 s58, s58, 1
  v_xor_b32 v160, s58, v30
  v_lshl_add_u32 v5, v160, 5, v31
  s_add_u32 s58, s58, 1
  v_xor_b32 v160, s58, v30
  v_lshl_add_u32 v6, v160, 5, v31
  s_add_u32 s58, s58, 1
  v_xor_b32 v160, s58, v30
  v_lshl_add_u32 v7, v160, 5, v31
  s_add_u32 s58, s58, 1
  s_lshl_b32 s58, s57, 2
  v_or_b32 v30, s58, v29
  v_and_b32 v31, 7, v1
  v_xor_b32 v30, v30, v31
  v_lshrrev_b32 v31, 3, v1
  s_lshl_b32 s58, s14, 3
  v_add_u32 v31, s58, v31
  v_mul_u32_u24 v31, 7168, v31
  v_lshl_add_u32 v12, v30, 4, v31
  s_mul_i32 s58, s56, 16384
  v_lshl_add_u32 v2, v1, 4, s58
  v_add_u32 v3, 1024, v2
  s_mul_i32 s58, s56, 114688
  s_lshl_b32 s59, s57, 10
  s_add_u32 s58, s58, s59
  v_lshl_add_u32 v12, v1, 4, s58
  v_add_u32 v13, 229376, v12
  v_add_u32 v14, 458752, v12
  v_add_u32 v15, 688128, v12
  v_add_u32 v16, 917504, v12
  v_add_u32 v17, 1146880, v12
  v_add_u32 v18, 1376256, v12
  v_add_u32 v19, 1605632, v12
  s_mov_b32 s22, 131072
  v_add_u32 v8, 65536, v2
  v_add_u32 v9, 65536, v3
  s_mul_i32 s58, s14, 4
  v_lshrrev_b32 v30, 4, v1
  v_add_u32 v30, s58, v30
  v_and_b32 v31, 15, v1
  v_add_u32 v160, 0, v30
  v_bfe_u32 v161, v160, 3, 1
  v_and_b32 v162, 3, v160
  v_lshl_add_u32 v161, v161, 2, v162
  v_lshlrev_b32 v161, 1, v161
  v_xor_b32 v161, v161, v31
  v_mul_u32_u24 v160, 2048, v160
  v_lshl_add_u32 v20, v161, 4, v160
  v_add_u32 v160, 16, v30
  v_bfe_u32 v161, v160, 3, 1
  v_and_b32 v162, 3, v160
  v_lshl_add_u32 v161, v161, 2, v162
  v_lshlrev_b32 v161, 1, v161
  v_xor_b32 v161, v161, v31
  v_mul_u32_u24 v160, 2048, v160
  v_lshl_add_u32 v21, v161, 4, v160
  v_add_u32 v160, 32, v30
  v_bfe_u32 v161, v160, 3, 1
  v_and_b32 v162, 3, v160
  v_lshl_add_u32 v161, v161, 2, v162
  v_lshlrev_b32 v161, 1, v161
  v_xor_b32 v161, v161, v31
  v_mul_u32_u24 v160, 2048, v160
  v_lshl_add_u32 v22, v161, 4, v160
  v_add_u32 v160, 48, v30
  v_bfe_u32 v161, v160, 3, 1
  v_and_b32 v162, 3, v160
  v_lshl_add_u32 v161, v161, 2, v162
  v_lshlrev_b32 v161, 1, v161
  v_xor_b32 v161, v161, v31
  v_mul_u32_u24 v160, 2048, v160
  v_lshl_add_u32 v23, v161, 4, v160
  s_cmp_lg_u32 s14, 0
  s_cbranch_scc1 we_188
  s_lshl_b32 s58, s36, 2
  v_mov_b32 v161, s58
wt_187:
  s_sub_u32 s23, s23, 1
  s_cbranch_scc1 rec_exit
  buffer_load_dword v160, v161, s[40:43], 0 offen offset:128 sc1
  s_waitcnt vmcnt(0)
  v_cmp_gt_u32 vcc, 14, v160
  s_cbranch_vccz wt_187_ok
  s_sleep 8
  s_branch wt_187
wt_187_ok:
we_188:
  s_barrier
  s_waitcnt vmcnt(0) lgkmcnt(0)
  s_barrier
  s_load_dwordx2 s[8:9], s[0:1], 88
  s_mov_b32 s10, 2048
  s_mov_b32 s11, 0x00020000
  s_mul_i32 s58, s57, 128
  s_add_u32 s58, s58, s37
  v_lshlrev_b32 v160, 3, v29
  s_waitcnt lgkmcnt(0)
  buffer_load_dwordx2 v[176:177], v160, s[8:11], s58 offen offset:0
  buffer_load_dwordx2 v[178:179], v160, s[8:11], s58 offen offset:32
  buffer_load_dwordx2 v[180:181], v160, s[8:11], s58 offen offset:64
  buffer_load_dwordx2 v[182:183], v160, s[8:11], s58 offen offset:96
  s_add_u32 m0, s55, 0
  s_nop 0
  buffer_load_dwordx4 v12, s[44:47], s52 offen  lds
  s_add_u32 m0, s55, 98304
  s_nop 0
  buffer_load_dwordx4 v20, s[48:51], s53 offen lds
  s_add_u32 m0, s55, 4096
  s_nop 0
  buffer_load_dwordx4 v13, s[44:47], s52 offen  lds
  s_add_u32 m0, s55, 102400
  s_nop 0
  buffer_load_dwordx4 v21, s[48:51], s53 offen lds
  s_add_u32 m0, s55, 8192
  s_nop 0
  buffer_load_dwordx4 v14, s[44:47], s52 offen  lds
  s_add_u32 m0, s55, 106496
  s_nop 0
  buffer_load_dwordx4 v22, s[48:51], s53 offen lds
  s_add_u32 m0, s55, 12288
  s_nop 0
  buffer_load_dwordx4 v15, s[44:47], s52 offen  lds
  s_add_u32 m0, s55, 110592
  s_nop 0
  buffer_load_dwordx4 v23, s[48:51], s53 offen lds
  s_add_u32 m0, s55, 16384
  s_nop 0
  buffer_load_dwordx4 v16, s[44:47], s52 offen  lds
  s_add_u32 m0, s55, 20480
  s_nop 0
  buffer_load_dwordx4 v17, s[44:47], s52 offen  lds
  s_add_u32 m0, s55, 24576
  s_nop 0
  buffer_load_dwordx4 v18, s[44:47], s52 offen  lds
  s_add_u32 m0, s55, 28672
  s_nop 0
  buffer_load_dwordx4 v19, s[44:47], s52 offen  lds
  s_add_u32 s52, s52, 2048
  s_add_u32 s53, s53, s22
  s_add_u32 m0, s55, 32768
  s_nop 0
  buffer_load_dwordx4 v12, s[44:47], s52 offen  lds
  s_add_u32 m0, s55, 114688
  s_nop 0
  buffer_load_dwordx4 v20, s[48:51], s53 offen lds
  s_add_u32 m0, s55, 36864
  s_nop 0
  buffer_load_dwordx4 v13, s[44:47], s52 offen  lds
  s_add_u32 m0, s55, 118784
  s_nop 0
  buffer_load_dwordx4 v21, s[48:51], s53 offen lds
  s_add_u32 m0, s55, 40960
  s_nop 0
  buffer_load_dwordx4 v14, s[44:47], s52 offen  lds
  s_add_u32 m0, s55, 122880
  s_nop 0
  buffer_load_dwordx4 v22, s[48:51], s53 offen lds
  s_add_u32 m0, s55, 45056
  s_nop 0
  buffer_load_dwordx4 v15, s[44:47], s52 offen  lds
  s_add_u32 m0, s55, 126976
  s_nop 0
  buffer_load_dwordx4 v23, s[48:51], s53 offen lds
  s_add_u32 m0, s55, 49152
  s_nop 0
  buffer_load_dwordx4 v16, s[44:47], s52 offen  lds
  s_add_u32 m0, s55, 53248
  s_nop 0
  buffer_load_dwordx4 v17, s[44:47], s52 offen  lds
  s_add_u32 m0, s55, 57344
  s_nop 0
  buffer_load_dwordx4 v18, s[44:47], s52 offen  lds
  s_add_u32 m0, s55, 61440
  s_nop 0
  buffer_load_dwordx4 v19, s[44:47], s52 offen  lds
  s_add_u32 s52, s52, 2048
  s_add_u32 s53, s53, s22
  s_waitcnt vmcnt(24)
  v_lshlrev_b32 v192, 16, v176
  v_and_b32 v193, 0xffff0000, v176
  v_lshlrev_b32 v194, 16, v177
  v_and_b32 v195, 0xffff0000, v177
  v_lshlrev_b32 v196, 16, v178
  v_and_b32 v197, 0xffff0000, v178
  v_lshlrev_b32 v198, 16, v179
  v_and_b32 v199, 0xffff0000, v179
  v_lshlrev_b32 v200, 16, v180
  v_and_b32 v201, 0xffff0000, v180
  v_lshlrev_b32 v202, 16, v181
  v_and_b32 v203, 0xffff0000, v181
  v_lshlrev_b32 v204, 16, v182
  v_and_b32 v205, 0xffff0000, v182
  v_lshlrev_b32 v206, 16, v183
  v_and_b32 v207, 0xffff0000, v183
  v_accvgpr_write_b32 a0, v192
  v_accvgpr_write_b32 a1, v193
  v_accvgpr_write_b32 a2, v194
  v_accvgpr_write_b32 a3, v195
  v_accvgpr_write_b32 a4, v196
  v_accvgpr_write_b32 a5, v197
  v_accvgpr_write_b32 a6, v198
  v_accvgpr_write_b32 a7, v199
  v_accvgpr_write_b32 a8, v200
  v_accvgpr_write_b32 a9, v201
  v_accvgpr_write_b32 a10, v202
  v_accvgpr_write_b32 a11, v203
  v_accvgpr_write_b32 a12, v204
  v_accvgpr_write_b32 a13, v205
  v_accvgpr_write_b32 a14, v206
  v_accvgpr_write_b32 a15, v207
  v_accvgpr_write_b32 a16, v192
  v_accvgpr_write_b32 a17, v193
  v_accvgpr_write_b32 a18, v194
  v_accvgpr_write_b32 a19, v195
  v_accvgpr_write_b32 a20, v196
  v_accvgpr_write_b32 a21, v197
  v_accvgpr_write_b32 a22, v198
  v_accvgpr_write_b32 a23, v199
  v_accvgpr_write_b32 a24, v200
  v_accvgpr_write_b32 a25, v201
  v_accvgpr_write_b32 a26, v202
  v_accvgpr_write_b32 a27, v203
  v_accvgpr_write_b32 a28, v204
  v_accvgpr_write_b32 a29, v205
  v_accvgpr_write_b32 a30, v206
  v_accvgpr_write_b32 a31, v207
  v_accvgpr_write_b32 a32, v192
  v_accvgpr_write_b32 a33, v193
  v_accvgpr_write_b32 a34, v194
  v_accvgpr_write_b32 a35, v195
  v_accvgpr_write_b32 a36, v196
  v_accvgpr_write_b32 a37, v197
  v_accvgpr_write_b32 a38, v198
  v_accvgpr_write_b32 a39, v199
  v_accvgpr_write_b32 a40, v200
  v_accvgpr_write_b32 a41, v201
  v_accvgpr_write_b32 a42, v202
  v_accvgpr_write_b32 a43, v203
  v_accvgpr_write_b32 a44, v204
  v_accvgpr_write_b32 a45, v205
  v_accvgpr_write_b32 a46, v206
  v_accvgpr_write_b32 a47, v207
  v_accvgpr_write_b32 a48, v192
  v_accvgpr_write_b32 a49, v193
  v_accvgpr_write_b32 a50, v194
  v_accvgpr_write_b32 a51, v195
  v_accvgpr_write_b32 a52, v196
  v_accvgpr_write_b32 a53, v197
  v_accvgpr_write_b32 a54, v198
  v_accvgpr_write_b32 a55, v199
  v_accvgpr_write_b32 a56, v200
  v_accvgpr_write_b32 a57, v201
  v_accvgpr_write_b32 a58, v202
  v_accvgpr_write_b32 a59, v203
  v_accvgpr_write_b32 a60, v204
  v_accvgpr_write_b32 a61, v205
  v_accvgpr_write_b32 a62, v206
  v_accvgpr_write_b32 a63, v207
  v_accvgpr_write_b32 a64, v192
  v_accvgpr_write_b32 a65, v193
  v_accvgpr_write_b32 a66, v194
  v_accvgpr_write_b32 a67, v195
  v_accvgpr_write_b32 a68, v196
  v_accvgpr_write_b32 a69, v197
  v_accvgpr_write_b32 a70, v198
  v_accvgpr_write_b32 a71, v199
  v_accvgpr_write_b32 a72, v200
  v_accvgpr_write_b32 a73, v201
  v_accvgpr_write_b32 a74, v202
  v_accvgpr_write_b32 a75, v203
  v_accvgpr_write_b32 a76, v204
  v_accvgpr_write_b32 a77, v205
  v_accvgpr_write_b32 a78, v206
  v_accvgpr_write_b32 a79, v207
  v_accvgpr_write_b32 a80, v192
  v_accvgpr_write_b32 a81, v193
  v_accvgpr_write_b32 a82, v194
  v_accvgpr_write_b32 a83, v195
  v_accvgpr_write_b32 a84, v196
  v_accvgpr_write_b32 a85, v197
  v_accvgpr_write_b32 a86, v198
  v_accvgpr_write_b32 a87, v199
  v_accvgpr_write_b32 a88, v200
  v_accvgpr_write_b32 a89, v201
  v_accvgpr_write_b32 a90, v202
  v_accvgpr_write_b32 a91, v203
  v_accvgpr_write_b32 a92, v204
  v_accvgpr_write_b32 a93, v205
  v_accvgpr_write_b32 a94, v206
  v_accvgpr_write_b32 a95, v207
  v_accvgpr_write_b32 a96, v192
  v_accvgpr_write_b32 a97, v193
  v_accvgpr_write_b32 a98, v194
  v_accvgpr_write_b32 a99, v195
  v_accvgpr_write_b32 a100, v196
  v_accvgpr_write_b32 a101, v197
  v_accvgpr_write_b32 a102, v198
  v_accvgpr_write_b32 a103, v199
  v_accvgpr_write_b32 a104, v200
  v_accvgpr_write_b32 a105, v201
  v_accvgpr_write_b32 a106, v202
  v_accvgpr_write_b32 a107, v203
  v_accvgpr_write_b32 a108, v204
  v_accvgpr_write_b32 a109, v205
  v_accvgpr_write_b32 a110, v206
  v_accvgpr_write_b32 a111, v207
  v_accvgpr_write_b32 a112, v192
  v_accvgpr_write_b32 a113, v193
  v_accvgpr_write_b32 a114, v194
  v_accvgpr_write_b32 a115, v195
  v_accvgpr_write_b32 a116, v196
  v_accvgpr_write_b32 a117, v197
  v_accvgpr_write_b32 a118, v198
  v_accvgpr_write_b32 a119, v199
  v_accvgpr_write_b32 a120, v200
  v_accvgpr_write_b32 a121, v201
  v_accvgpr_write_b32 a122, v202
  v_accvgpr_write_b32 a123, v203
  v_accvgpr_write_b32 a124, v204
  v_accvgpr_write_b32 a125, v205
  v_accvgpr_write_b32 a126, v206
  v_accvgpr_write_b32 a127, v207
  s_waitcnt vmcnt(12)
  s_barrier
  ds_read_b128 v[32:35], v2 offset:0
  ds_read_b64_tr_b16 v[64:65], v4 offset:0
  ds_read_b64_tr_b16 v[66:67], v4 offset:1024
  ds_read_b64_tr_b16 v[68:69], v5 offset:0
  ds_read_b64_tr_b16 v[70:71], v5 offset:1024
  ds_read_b128 v[36:39], v2 offset:2048
  ds_read_b64_tr_b16 v[72:73], v6 offset:0
  ds_read_b64_tr_b16 v[74:75], v6 offset:1024
  ds_read_b128 v[40:43], v2 offset:4096
  ds_read_b64_tr_b16 v[76:77], v7 offset:0
  ds_read_b64_tr_b16 v[78:79], v7 offset:1024
  ds_read_b128 v[44:47], v2 offset:6144
  ds_read_b128 v[48:51], v2 offset:8192
  ds_read_b128 v[52:55], v2 offset:10240
  ds_read_b128 v[56:59], v2 offset:12288
  ds_read_b128 v[60:63], v2 offset:14336
  s_mov_b32 s54, 19
gl_189:
  s_cmp_eq_u32 s54, 1
  s_cselect_b32 s46, 0, s46
  s_cselect_b32 s50, 0, s50
  s_waitcnt lgkmcnt(13)
  s_add_u32 m0, s55, 65536
  v_mfma_f32_16x16x32_bf16 a[0:3], v[64:67], v[32:35], a[0:3]
  buffer_load_dwordx4 v12, s[44:47], s52 offen  lds
  s_waitcnt lgkmcnt(11)
  v_mfma_f32_16x16x32_bf16 a[4:7], v[68:71], v[32:35], a[4:7]
  s_waitcnt lgkmcnt(10)
  v_mfma_f32_16x16x32_bf16 a[16:19], v[64:67], v[36:39], a[16:19]
  s_add_u32 m0, s55, 131072
  v_mfma_f32_16x16x32_bf16 a[20:23], v[68:71], v[36:39], a[20:23]
  buffer_load_dwordx4 v20, s[48:51], s53 offen lds
  s_waitcnt lgkmcnt(8)
  v_mfma_f32_16x16x32_bf16 a[8:11], v[72:75], v[32:35], a[8:11]
  v_mfma_f32_16x16x32_bf16 a[24:27], v[72:75], v[36:39], a[24:27]
  s_waitcnt lgkmcnt(7)
  v_mfma_f32_16x16x32_bf16 a[32:35], v[64:67], v[40:43], a[32:35]
  s_add_u32 m0, s55, 69632
  v_mfma_f32_16x16x32_bf16 a[36:39], v[68:71], v[40:43], a[36:39]
  buffer_load_dwordx4 v13, s[44:47], s52 offen  lds
  v_mfma_f32_16x16x32_bf16 a[40:43], v[72:75], v[40:43], a[40:43]
  s_waitcnt lgkmcnt(5)
  v_mfma_f32_16x16x32_bf16 a[12:15], v[76:79], v[32:35], a[12:15]
  s_add_u32 m0, s55, 135168
  v_mfma_f32_16x16x32_bf16 a[28:31], v[76:79], v[36:39], a[28:31]
  buffer_load_dwordx4 v21, s[48:51], s53 offen lds
  v_mfma_f32_16x16x32_bf16 a[44:47], v[76:79], v[40:43], a[44:47]
  s_waitcnt lgkmcnt(4)
  v_mfma_f32_16x16x32_bf16 a[48:51], v[64:67], v[44:47], a[48:51]
  v_mfma_f32_16x16x32_bf16 a[52:55], v[68:71], v[44:47], a[52:55]
  ds_read_b128 v[96:99], v3 offset:0
  s_add_u32 m0, s55, 73728
  v_mfma_f32_16x16x32_bf16 a[56:59], v[72:75], v[44:47], a[56:59]
  buffer_load_dwordx4 v14, s[44:47], s52 offen  lds
  ds_read_b64_tr_b16 v[128:129], v4 offset:8192
  v_mfma_f32_16x16x32_bf16 a[60:63], v[76:79], v[44:47], a[60:63]
  ds_read_b64_tr_b16 v[130:131], v4 offset:9216
  s_waitcnt lgkmcnt(6)
  v_mfma_f32_16x16x32_bf16 a[64:67], v[64:67], v[48:51], a[64:67]
  ds_read_b64_tr_b16 v[132:133], v5 offset:8192
  s_add_u32 m0, s55, 139264
  v_mfma_f32_16x16x32_bf16 a[68:71], v[68:71], v[48:51], a[68:71]
  buffer_load_dwordx4 v22, s[48:51], s53 offen lds
  ds_read_b64_tr_b16 v[134:135], v5 offset:9216
  v_mfma_f32_16x16x32_bf16 a[72:75], v[72:75], v[48:51], a[72:75]
  ds_read_b128 v[100:103], v3 offset:2048
  v_mfma_f32_16x16x32_bf16 a[76:79], v[76:79], v[48:51], a[76:79]
  s_waitcnt lgkmcnt(8)
  v_mfma_f32_16x16x32_bf16 a[80:83], v[64:67], v[52:55], a[80:83]
  ds_read_b64_tr_b16 v[136:137], v6 offset:8192
  s_add_u32 m0, s55, 77824
  v_mfma_f32_16x16x32_bf16 a[84:87], v[68:71], v[52:55], a[84:87]
  buffer_load_dwordx4 v15, s[44:47], s52 offen  lds
  ds_read_b64_tr_b16 v[138:139], v6 offset:9216
  v_mfma_f32_16x16x32_bf16 a[88:91], v[72:75], v[52:55], a[88:91]
  ds_read_b128 v[104:107], v3 offset:4096
  v_mfma_f32_16x16x32_bf16 a[92:95], v[76:79], v[52:55], a[92:95]
  ds_read_b64_tr_b16 v[140:141], v7 offset:8192
  s_waitcnt lgkmcnt(11)
  s_add_u32 m0, s55, 143360
  v_mfma_f32_16x16x32_bf16 a[96:99], v[64:67], v[56:59], a[96:99]
  buffer_load_dwordx4 v23, s[48:51], s53 offen lds
  ds_read_b64_tr_b16 v[142:143], v7 offset:9216
  v_mfma_f32_16x16x32_bf16 a[100:103], v[68:71], v[56:59], a[100:103]
  v_mfma_f32_16x16x32_bf16 a[104:107], v[72:75], v[56:59], a[104:107]
  ds_read_b128 v[108:111], v3 offset:6144
  v_mfma_f32_16x16x32_bf16 a[108:111], v[76:79], v[56:59], a[108:111]
  ds_read_b128 v[112:115], v3 offset:8192
  s_waitcnt lgkmcnt(13)
  s_add_u32 m0, s55, 81920
  v_mfma_f32_16x16x32_bf16 a[112:115], v[64:67], v[60:63], a[112:115]
  buffer_load_dwordx4 v16, s[44:47], s52 offen  lds
  ds_read_b128 v[116:119], v3 offset:10240
  v_mfma_f32_16x16x32_bf16 a[116:119], v[68:71], v[60:63], a[116:119]
  ds_read_b128 v[120:123], v3 offset:12288
  v_mfma_f32_16x16x32_bf16 a[120:123], v[72:75], v[60:63], a[120:123]
  ds_read_b128 v[124:127], v3 offset:14336
  v_mfma_f32_16x16x32_bf16 a[124:127], v[76:79], v[60:63], a[124:127]
  s_waitcnt lgkmcnt(13)
  s_add_u32 m0, s55, 86016
  v_mfma_f32_16x16x32_bf16 a[0:3], v[128:131], v[96:99], a[0:3]
  buffer_load_dwordx4 v17, s[44:47], s52 offen  lds
  s_waitcnt lgkmcnt(11)
  v_mfma_f32_16x16x32_bf16 a[4:7], v[132:135], v[96:99], a[4:7]
  s_waitcnt lgkmcnt(10)
  v_mfma_f32_16x16x32_bf16 a[16:19], v[128:131], v[100:103], a[16:19]
  v_mfma_f32_16x16x32_bf16 a[20:23], v[132:135], v[100:103], a[20:23]
  s_waitcnt lgkmcnt(8)
  s_add_u32 m0, s55, 90112
  v_mfma_f32_16x16x32_bf16 a[8:11], v[136:139], v[96:99], a[8:11]
  buffer_load_dwordx4 v18, s[44:47], s52 offen  lds
  v_mfma_f32_16x16x32_bf16 a[24:27], v[136:139], v[100:103], a[24:27]
  s_waitcnt lgkmcnt(7)
  v_mfma_f32_16x16x32_bf16 a[32:35], v[128:131], v[104:107], a[32:35]
  v_mfma_f32_16x16x32_bf16 a[36:39], v[132:135], v[104:107], a[36:39]
  s_add_u32 m0, s55, 94208
  v_mfma_f32_16x16x32_bf16 a[40:43], v[136:139], v[104:107], a[40:43]
  buffer_load_dwordx4 v19, s[44:47], s52 offen  lds
  s_waitcnt lgkmcnt(5)
  v_mfma_f32_16x16x32_bf16 a[12:15], v[140:143], v[96:99], a[12:15]
  v_mfma_f32_16x16x32_bf16 a[28:31], v[140:143], v[100:103], a[28:31]
  v_mfma_f32_16x16x32_bf16 a[44:47], v[140:143], v[104:107], a[44:47]
  s_waitcnt lgkmcnt(4)
  v_mfma_f32_16x16x32_bf16 a[48:51], v[128:131], v[108:111], a[48:51]
  s_waitcnt vmcnt(12) lgkmcnt(0)
  s_barrier
  v_mfma_f32_16x16x32_bf16 a[52:55], v[132:135], v[108:111], a[52:55]
  ds_read_b128 v[32:35], v2 offset:32768
  v_mfma_f32_16x16x32_bf16 a[56:59], v[136:139], v[108:111], a[56:59]
  ds_read_b64_tr_b16 v[64:65], v4 offset:16384
  v_mfma_f32_16x16x32_bf16 a[60:63], v[140:143], v[108:111], a[60:63]
  ds_read_b64_tr_b16 v[66:67], v4 offset:17408
  v_mfma_f32_16x16x32_bf16 a[64:67], v[128:131], v[112:115], a[64:67]
  ds_read_b64_tr_b16 v[68:69], v5 offset:16384
  v_mfma_f32_16x16x32_bf16 a[68:71], v[132:135], v[112:115], a[68:71]
  ds_read_b64_tr_b16 v[70:71], v5 offset:17408
  v_mfma_f32_16x16x32_bf16 a[72:75], v[136:139], v[112:115], a[72:75]
  ds_read_b128 v[36:39], v2 offset:34816
  v_mfma_f32_16x16x32_bf16 a[76:79], v[140:143], v[112:115], a[76:79]
  v_mfma_f32_16x16x32_bf16 a[80:83], v[128:131], v[116:119], a[80:83]
  ds_read_b64_tr_b16 v[72:73], v6 offset:16384
  v_mfma_f32_16x16x32_bf16 a[84:87], v[132:135], v[116:119], a[84:87]
  ds_read_b64_tr_b16 v[74:75], v6 offset:17408
  v_mfma_f32_16x16x32_bf16 a[88:91], v[136:139], v[116:119], a[88:91]
  ds_read_b128 v[40:43], v2 offset:36864
  v_mfma_f32_16x16x32_bf16 a[92:95], v[140:143], v[116:119], a[92:95]
  ds_read_b64_tr_b16 v[76:77], v7 offset:16384
  v_mfma_f32_16x16x32_bf16 a[96:99], v[128:131], v[120:123], a[96:99]
  ds_read_b64_tr_b16 v[78:79], v7 offset:17408
  v_mfma_f32_16x16x32_bf16 a[100:103], v[132:135], v[120:123], a[100:103]
  v_mfma_f32_16x16x32_bf16 a[104:107], v[136:139], v[120:123], a[104:107]
  ds_read_b128 v[44:47], v2 offset:38912
  v_mfma_f32_16x16x32_bf16 a[108:111], v[140:143], v[120:123], a[108:111]
  ds_read_b128 v[48:51], v2 offset:40960
  v_mfma_f32_16x16x32_bf16 a[112:115], v[128:131], v[124:127], a[112:115]
  ds_read_b128 v[52:55], v2 offset:43008
  v_mfma_f32_16x16x32_bf16 a[116:119], v[132:135], v[124:127], a[116:119]
  ds_read_b128 v[56:59], v2 offset:45056
  v_mfma_f32_16x16x32_bf16 a[120:123], v[136:139], v[124:127], a[120:123]
  ds_read_b128 v[60:63], v2 offset:47104
  v_mfma_f32_16x16x32_bf16 a[124:127], v[140:143], v[124:127], a[124:127]
  s_add_u32 s52, s52, 2048
  s_add_u32 s53, s53, s22
  s_waitcnt lgkmcnt(13)
  s_add_u32 m0, s55, 0
  v_mfma_f32_16x16x32_bf16 a[0:3], v[64:67], v[32:35], a[0:3]
  buffer_load_dwordx4 v12, s[44:47], s52 offen  lds
  s_waitcnt lgkmcnt(11)
  v_mfma_f32_16x16x32_bf16 a[4:7], v[68:71], v[32:35], a[4:7]
  s_waitcnt lgkmcnt(10)
  v_mfma_f32_16x16x32_bf16 a[16:19], v[64:67], v[36:39], a[16:19]
  s_add_u32 m0, s55, 98304
  v_mfma_f32_16x16x32_bf16 a[20:23], v[68:71], v[36:39], a[20:23]
  buffer_load_dwordx4 v20, s[48:51], s53 offen lds
  s_waitcnt lgkmcnt(8)
  v_mfma_f32_16x16x32_bf16 a[8:11], v[72:75], v[32:35], a[8:11]
  v_mfma_f32_16x16x32_bf16 a[24:27], v[72:75], v[36:39], a[24:27]
  s_waitcnt lgkmcnt(7)
  v_mfma_f32_16x16x32_bf16 a[32:35], v[64:67], v[40:43], a[32:35]
  s_add_u32 m0, s55, 4096
  v_mfma_f32_16x16x32_bf16 a[36:39], v[68:71], v[40:43], a[36:39]
  buffer_load_dwordx4 v13, s[44:47], s52 offen  lds
  v_mfma_f32_16x16x32_bf16 a[40:43], v[72:75], v[40:43], a[40:43]
  s_waitcnt lgkmcnt(5)
  v_mfma_f32_16x16x32_bf16 a[12:15], v[76:79], v[32:35], a[12:15]
  s_add_u32 m0, s55, 102400
  v_mfma_f32_16x16x32_bf16 a[28:31], v[76:79], v[36:39], a[28:31]
  buffer_load_dwordx4 v21, s[48:51], s53 offen lds
  v_mfma_f32_16x16x32_bf16 a[44:47], v[76:79], v[40:43], a[44:47]
  s_waitcnt lgkmcnt(4)
  v_mfma_f32_16x16x32_bf16 a[48:51], v[64:67], v[44:47], a[48:51]
  v_mfma_f32_16x16x32_bf16 a[52:55], v[68:71], v[44:47], a[52:55]
  ds_read_b128 v[96:99], v3 offset:32768
  s_add_u32 m0, s55, 8192
  v_mfma_f32_16x16x32_bf16 a[56:59], v[72:75], v[44:47], a[56:59]
  buffer_load_dwordx4 v14, s[44:47], s52 offen  lds
  ds_read_b64_tr_b16 v[128:129], v4 offset:24576
  v_mfma_f32_16x16x32_bf16 a[60:63], v[76:79], v[44:47], a[60:63]
  ds_read_b64_tr_b16 v[130:131], v4 offset:25600
  s_waitcnt lgkmcnt(6)
  v_mfma_f32_16x16x32_bf16 a[64:67], v[64:67], v[48:51], a[64:67]
  ds_read_b64_tr_b16 v[132:133], v5 offset:24576
  s_add_u32 m0, s55, 106496
  v_mfma_f32_16x16x32_bf16 a[68:71], v[68:71], v[48:51], a[68:71]
  buffer_load_dwordx4 v22, s[48:51], s53 offen lds
  ds_read_b64_tr_b16 v[134:135], v5 offset:25600
  v_mfma_f32_16x16x32_bf16 a[72:75], v[72:75], v[48:51], a[72:75]
  ds_read_b128 v[100:103], v3 offset:34816
  v_mfma_f32_16x16x32_bf16 a[76:79], v[76:79], v[48:51], a[76:79]
  s_waitcnt lgkmcnt(8)
  v_mfma_f32_16x16x32_bf16 a[80:83], v[64:67], v[52:55], a[80:83]
  ds_read_b64_tr_b16 v[136:137], v6 offset:24576
  s_add_u32 m0, s55, 12288
  v_mfma_f32_16x16x32_bf16 a[84:87], v[68:71], v[52:55], a[84:87]
  buffer_load_dwordx4 v15, s[44:47], s52 offen  lds
  ds_read_b64_tr_b16 v[138:139], v6 offset:25600
  v_mfma_f32_16x16x32_bf16 a[88:91], v[72:75], v[52:55], a[88:91]
  ds_read_b128 v[104:107], v3 offset:36864
  v_mfma_f32_16x16x32_bf16 a[92:95], v[76:79], v[52:55], a[92:95]
  ds_read_b64_tr_b16 v[140:141], v7 offset:24576
  s_waitcnt lgkmcnt(11)
  s_add_u32 m0, s55, 110592
  v_mfma_f32_16x16x32_bf16 a[96:99], v[64:67], v[56:59], a[96:99]
  buffer_load_dwordx4 v23, s[48:51], s53 offen lds
  ds_read_b64_tr_b16 v[142:143], v7 offset:25600
  v_mfma_f32_16x16x32_bf16 a[100:103], v[68:71], v[56:59], a[100:103]
  v_mfma_f32_16x16x32_bf16 a[104:107], v[72:75], v[56:59], a[104:107]
  ds_read_b128 v[108:111], v3 offset:38912
  v_mfma_f32_16x16x32_bf16 a[108:111], v[76:79], v[56:59], a[108:111]
  ds_read_b128 v[112:115], v3 offset:40960
  s_waitcnt lgkmcnt(13)
  s_add_u32 m0, s55, 16384
  v_mfma_f32_16x16x32_bf16 a[112:115], v[64:67], v[60:63], a[112:115]
  buffer_load_dwordx4 v16, s[44:47], s52 offen  lds
  ds_read_b128 v[116:119], v3 offset:43008
  v_mfma_f32_16x16x32_bf16 a[116:119], v[68:71], v[60:63], a[116:119]
  ds_read_b128 v[120:123], v3 offset:45056
  v_mfma_f32_16x16x32_bf16 a[120:123], v[72:75], v[60:63], a[120:123]
  ds_read_b128 v[124:127], v3 offset:47104
  v_mfma_f32_16x16x32_bf16 a[124:127], v[76:79], v[60:63], a[124:127]
  s_waitcnt lgkmcnt(13)
  s_add_u32 m0, s55, 20480
  v_mfma_f32_16x16x32_bf16 a[0:3], v[128:131], v[96:99], a[0:3]
  buffer_load_dwordx4 v17, s[44:47], s52 offen  lds
  s_waitcnt lgkmcnt(11)
  v_mfma_f32_16x16x32_bf16 a[4:7], v[132:135], v[96:99], a[4:7]
  s_waitcnt lgkmcnt(10)
  v_mfma_f32_16x16x32_bf16 a[16:19], v[128:131], v[100:103], a[16:19]
  v_mfma_f32_16x16x32_bf16 a[20:23], v[132:135], v[100:103], a[20:23]
  s_waitcnt lgkmcnt(8)
  s_add_u32 m0, s55, 24576
  v_mfma_f32_16x16x32_bf16 a[8:11], v[136:139], v[96:99], a[8:11]
  buffer_load_dwordx4 v18, s[44:47], s52 offen  lds
  v_mfma_f32_16x16x32_bf16 a[24:27], v[136:139], v[100:103], a[24:27]
  s_waitcnt lgkmcnt(7)
  v_mfma_f32_16x16x32_bf16 a[32:35], v[128:131], v[104:107], a[32:35]
  v_mfma_f32_16x16x32_bf16 a[36:39], v[132:135], v[104:107], a[36:39]
  s_add_u32 m0, s55, 28672
  v_mfma_f32_16x16x32_bf16 a[40:43], v[136:139], v[104:107], a[40:43]
  buffer_load_dwordx4 v19, s[44:47], s52 offen  lds
  s_waitcnt lgkmcnt(5)
  v_mfma_f32_16x16x32_bf16 a[12:15], v[140:143], v[96:99], a[12:15]
  v_mfma_f32_16x16x32_bf16 a[28:31], v[140:143], v[100:103], a[28:31]
  v_mfma_f32_16x16x32_bf16 a[44:47], v[140:143], v[104:107], a[44:47]
  s_waitcnt lgkmcnt(4)
  v_mfma_f32_16x16x32_bf16 a[48:51], v[128:131], v[108:111], a[48:51]
  s_waitcnt vmcnt(12) lgkmcnt(0)
  s_barrier
  v_mfma_f32_16x16x32_bf16 a[52:55], v[132:135], v[108:111], a[52:55]
  ds_read_b128 v[32:35], v8 offset:0
  v_mfma_f32_16x16x32_bf16 a[56:59], v[136:139], v[108:111], a[56:59]
  ds_read_b64_tr_b16 v[64:65], v4 offset:32768
  v_mfma_f32_16x16x32_bf16 a[60:63], v[140:143], v[108:111], a[60:63]
  ds_read_b64_tr_b16 v[66:67], v4 offset:33792
  v_mfma_f32_16x16x32_bf16 a[64:67], v[128:131], v[112:115], a[64:67]
  ds_read_b64_tr_b16 v[68:69], v5 offset:32768
  v_mfma_f32_16x16x32_bf16 a[68:71], v[132:135], v[112:115], a[68:71]
  ds_read_b64_tr_b16 v[70:71], v5 offset:33792
  v_mfma_f32_16x16x32_bf16 a[72:75], v[136:139], v[112:115], a[72:75]
  ds_read_b128 v[36:39], v8 offset:2048
  v_mfma_f32_16x16x32_bf16 a[76:79], v[140:143], v[112:115], a[76:79]
  v_mfma_f32_16x16x32_bf16 a[80:83], v[128:131], v[116:119], a[80:83]
  ds_read_b64_tr_b16 v[72:73], v6 offset:32768
  v_mfma_f32_16x16x32_bf16 a[84:87], v[132:135], v[116:119], a[84:87]
  ds_read_b64_tr_b16 v[74:75], v6 offset:33792
  v_mfma_f32_16x16x32_bf16 a[88:91], v[136:139], v[116:119], a[88:91]
  ds_read_b128 v[40:43], v8 offset:4096
  v_mfma_f32_16x16x32_bf16 a[92:95], v[140:143], v[116:119], a[92:95]
  ds_read_b64_tr_b16 v[76:77], v7 offset:32768
  v_mfma_f32_16x16x32_bf16 a[96:99], v[128:131], v[120:123], a[96:99]
  ds_read_b64_tr_b16 v[78:79], v7 offset:33792
  v_mfma_f32_16x16x32_bf16 a[100:103], v[132:135], v[120:123], a[100:103]
  v_mfma_f32_16x16x32_bf16 a[104:107], v[136:139], v[120:123], a[104:107]
  ds_read_b128 v[44:47], v8 offset:6144
  v_mfma_f32_16x16x32_bf16 a[108:111], v[140:143], v[120:123], a[108:111]
  ds_read_b128 v[48:51], v8 offset:8192
  v_mfma_f32_16x16x32_bf16 a[112:115], v[128:131], v[124:127], a[112:115]
  ds_read_b128 v[52:55], v8 offset:10240
  v_mfma_f32_16x16x32_bf16 a[116:119], v[132:135], v[124:127], a[116:119]
  ds_read_b128 v[56:59], v8 offset:12288
  v_mfma_f32_16x16x32_bf16 a[120:123], v[136:139], v[124:127], a[120:123]
  ds_read_b128 v[60:63], v8 offset:14336
  v_mfma_f32_16x16x32_bf16 a[124:127], v[140:143], v[124:127], a[124:127]
  s_add_u32 s52, s52, 2048
  s_add_u32 s53, s53, s22
  s_cmp_eq_u32 s54, 1
  s_cbranch_scc1 gl_189_e
  s_waitcnt lgkmcnt(13)
  s_add_u32 m0, s55, 32768
  v_mfma_f32_16x16x32_bf16 a[0:3], v[64:67], v[32:35], a[0:3]
  buffer_load_dwordx4 v12, s[44:47], s52 offen  lds
  s_waitcnt lgkmcnt(11)
  v_mfma_f32_16x16x32_bf16 a[4:7], v[68:71], v[32:35], a[4:7]
  s_waitcnt lgkmcnt(10)
  v_mfma_f32_16x16x32_bf16 a[16:19], v[64:67], v[36:39], a[16:19]
  s_add_u32 m0, s55, 114688
  v_mfma_f32_16x16x32_bf16 a[20:23], v[68:71], v[36:39], a[20:23]
  buffer_load_dwordx4 v20, s[48:51], s53 offen lds
  s_waitcnt lgkmcnt(8)
  v_mfma_f32_16x16x32_bf16 a[8:11], v[72:75], v[32:35], a[8:11]
  v_mfma_f32_16x16x32_bf16 a[24:27], v[72:75], v[36:39], a[24:27]
  s_waitcnt lgkmcnt(7)
  v_mfma_f32_16x16x32_bf16 a[32:35], v[64:67], v[40:43], a[32:35]
  s_add_u32 m0, s55, 36864
  v_mfma_f32_16x16x32_bf16 a[36:39], v[68:71], v[40:43], a[36:39]
  buffer_load_dwordx4 v13, s[44:47], s52 offen  lds
  v_mfma_f32_16x16x32_bf16 a[40:43], v[72:75], v[40:43], a[40:43]
  s_waitcnt lgkmcnt(5)
  v_mfma_f32_16x16x32_bf16 a[12:15], v[76:79], v[32:35], a[12:15]
  s_add_u32 m0, s55, 118784
  v_mfma_f32_16x16x32_bf16 a[28:31], v[76:79], v[36:39], a[28:31]
  buffer_load_dwordx4 v21, s[48:51], s53 offen lds
  v_mfma_f32_16x16x32_bf16 a[44:47], v[76:79], v[40:43], a[44:47]
  s_waitcnt lgkmcnt(4)
  v_mfma_f32_16x16x32_bf16 a[48:51], v[64:67], v[44:47], a[48:51]
  v_mfma_f32_16x16x32_bf16 a[52:55], v[68:71], v[44:47], a[52:55]
  ds_read_b128 v[96:99], v9 offset:0
  s_add_u32 m0, s55, 40960
  v_mfma_f32_16x16x32_bf16 a[56:59], v[72:75], v[44:47], a[56:59]
  buffer_load_dwordx4 v14, s[44:47], s52 offen  lds
  ds_read_b64_tr_b16 v[128:129], v4 offset:40960
  v_mfma_f32_16x16x32_bf16 a[60:63], v[76:79], v[44:47], a[60:63]
  ds_read_b64_tr_b16 v[130:131], v4 offset:41984
  s_waitcnt lgkmcnt(6)
  v_mfma_f32_16x16x32_bf16 a[64:67], v[64:67], v[48:51], a[64:67]
  ds_read_b64_tr_b16 v[132:133], v5 offset:40960
  s_add_u32 m0, s55, 122880
  v_mfma_f32_16x16x32_bf16 a[68:71], v[68:71], v[48:51], a[68:71]
  buffer_load_dwordx4 v22, s[48:51], s53 offen lds
  ds_read_b64_tr_b16 v[134:135], v5 offset:41984
  v_mfma_f32_16x16x32_bf16 a[72:75], v[72:75], v[48:51], a[72:75]
  ds_read_b128 v[100:103], v9 offset:2048
  v_mfma_f32_16x16x32_bf16 a[76:79], v[76:79], v[48:51], a[76:79]
  s_waitcnt lgkmcnt(8)
  v_mfma_f32_16x16x32_bf16 a[80:83], v[64:67], v[52:55], a[80:83]
  ds_read_b64_tr_b16 v[136:137], v6 offset:40960
  s_add_u32 m0, s55, 45056
  v_mfma_f32_16x16x32_bf16 a[84:87], v[68:71], v[52:55], a[84:87]
  buffer_load_dwordx4 v15, s[44:47], s52 offen  lds
  ds_read_b64_tr_b16 v[138:139], v6 offset:41984
  v_mfma_f32_16x16x32_bf16 a[88:91], v[72:75], v[52:55], a[88:91]
  ds_read_b128 v[104:107], v9 offset:4096
  v_mfma_f32_16x16x32_bf16 a[92:95], v[76:79], v[52:55], a[92:95]
  ds_read_b64_tr_b16 v[140:141], v7 offset:40960
  s_waitcnt lgkmcnt(11)
  s_add_u32 m0, s55, 126976
  v_mfma_f32_16x16x32_bf16 a[96:99], v[64:67], v[56:59], a[96:99]
  buffer_load_dwordx4 v23, s[48:51], s53 offen lds
  ds_read_b64_tr_b16 v[142:143], v7 offset:41984
  v_mfma_f32_16x16x32_bf16 a[100:103], v[68:71], v[56:59], a[100:103]
  v_mfma_f32_16x16x32_bf16 a[104:107], v[72:75], v[56:59], a[104:107]
  ds_read_b128 v[108:111], v9 offset:6144
  v_mfma_f32_16x16x32_bf16 a[108:111], v[76:79], v[56:59], a[108:111]
  ds_read_b128 v[112:115], v9 offset:8192
  s_waitcnt lgkmcnt(13)
  s_add_u32 m0, s55, 49152
  v_mfma_f32_16x16x32_bf16 a[112:115], v[64:67], v[60:63], a[112:115]
  buffer_load_dwordx4 v16, s[44:47], s52 offen  lds
  ds_read_b128 v[116:119], v9 offset:10240
  v_mfma_f32_16x16x32_bf16 a[116:119], v[68:71], v[60:63], a[116:119]
  ds_read_b128 v[120:123], v9 offset:12288
  v_mfma_f32_16x16x32_bf16 a[120:123], v[72:75], v[60:63], a[120:123]
  ds_read_b128 v[124:127], v9 offset:14336
  v_mfma_f32_16x16x32_bf16 a[124:127], v[76:79], v[60:63], a[124:127]
  s_waitcnt lgkmcnt(13)
  s_add_u32 m0, s55, 53248
  v_mfma_f32_16x16x32_bf16 a[0:3], v[128:131], v[96:99], a[0:3]
  buffer_load_dwordx4 v17, s[44:47], s52 offen  lds
  s_waitcnt lgkmcnt(11)
  v_mfma_f32_16x16x32_bf16 a[4:7], v[132:135], v[96:99], a[4:7]
  s_waitcnt lgkmcnt(10)
  v_mfma_f32_16x16x32_bf16 a[16:19], v[128:131], v[100:103], a[16:19]
  v_mfma_f32_16x16x32_bf16 a[20:23], v[132:135], v[100:103], a[20:23]
  s_waitcnt lgkmcnt(8)
  s_add_u32 m0, s55, 57344
  v_mfma_f32_16x16x32_bf16 a[8:11], v[136:139], v[96:99], a[8:11]
  buffer_load_dwordx4 v18, s[44:47], s52 offen  lds
  v_mfma_f32_16x16x32_bf16 a[24:27], v[136:139], v[100:103], a[24:27]
  s_waitcnt lgkmcnt(7)
  v_mfma_f32_16x16x32_bf16 a[32:35], v[128:131], v[104:107], a[32:35]
  v_mfma_f32_16x16x32_bf16 a[36:39], v[132:135], v[104:107], a[36:39]
  s_add_u32 m0, s55, 61440
  v_mfma_f32_16x16x32_bf16 a[40:43], v[136:139], v[104:107], a[40:43]
  buffer_load_dwordx4 v19, s[44:47], s52 offen  lds
  s_waitcnt lgkmcnt(5)
  v_mfma_f32_16x16x32_bf16 a[12:15], v[140:143], v[96:99], a[12:15]
  v_mfma_f32_16x16x32_bf16 a[28:31], v[140:143], v[100:103], a[28:31]
  v_mfma_f32_16x16x32_bf16 a[44:47], v[140:143], v[104:107], a[44:47]
  s_waitcnt lgkmcnt(4)
  v_mfma_f32_16x16x32_bf16 a[48:51], v[128:131], v[108:111], a[48:51]
  s_waitcnt vmcnt(12) lgkmcnt(0)
  s_barrier
  v_mfma_f32_16x16x32_bf16 a[52:55], v[132:135], v[108:111], a[52:55]
  ds_read_b128 v[32:35], v2 offset:0
  v_mfma_f32_16x16x32_bf16 a[56:59], v[136:139], v[108:111], a[56:59]
  ds_read_b64_tr_b16 v[64:65], v4 offset:0
  v_mfma_f32_16x16x32_bf16 a[60:63], v[140:143], v[108:111], a[60:63]
  ds_read_b64_tr_b16 v[66:67], v4 offset:1024
  v_mfma_f32_16x16x32_bf16 a[64:67], v[128:131], v[112:115], a[64:67]
  ds_read_b64_tr_b16 v[68:69], v5 offset:0
  v_mfma_f32_16x16x32_bf16 a[68:71], v[132:135], v[112:115], a[68:71]
  ds_read_b64_tr_b16 v[70:71], v5 offset:1024
  v_mfma_f32_16x16x32_bf16 a[72:75], v[136:139], v[112:115], a[72:75]
  ds_read_b128 v[36:39], v2 offset:2048
  v_mfma_f32_16x16x32_bf16 a[76:79], v[140:143], v[112:115], a[76:79]
  v_mfma_f32_16x16x32_bf16 a[80:83], v[128:131], v[116:119], a[80:83]
  ds_read_b64_tr_b16 v[72:73], v6 offset:0
  v_mfma_f32_16x16x32_bf16 a[84:87], v[132:135], v[116:119], a[84:87]
  ds_read_b64_tr_b16 v[74:75], v6 offset:1024
  v_mfma_f32_16x16x32_bf16 a[88:91], v[136:139], v[116:119], a[88:91]
  ds_read_b128 v[40:43], v2 offset:4096
  v_mfma_f32_16x16x32_bf16 a[92:95], v[140:143], v[116:119], a[92:95]
  ds_read_b64_tr_b16 v[76:77], v7 offset:0
  v_mfma_f32_16x16x32_bf16 a[96:99], v[128:131], v[120:123], a[96:99]
  ds_read_b64_tr_b16 v[78:79], v7 offset:1024
  v_mfma_f32_16x16x32_bf16 a[100:103], v[132:135], v[120:123], a[100:103]
  v_mfma_f32_16x16x32_bf16 a[104:107], v[136:139], v[120:123], a[104:107]
  ds_read_b128 v[44:47], v2 offset:6144
  v_mfma_f32_16x16x32_bf16 a[108:111], v[140:143], v[120:123], a[108:111]
  ds_read_b128 v[48:51], v2 offset:8192
  v_mfma_f32_16x16x32_bf16 a[112:115], v[128:131], v[124:127], a[112:115]
  ds_read_b128 v[52:55], v2 offset:10240
  v_mfma_f32_16x16x32_bf16 a[116:119], v[132:135], v[124:127], a[116:119]
  ds_read_b128 v[56:59], v2 offset:12288
  v_mfma_f32_16x16x32_bf16 a[120:123], v[136:139], v[124:127], a[120:123]
  ds_read_b128 v[60:63], v2 offset:14336
  v_mfma_f32_16x16x32_bf16 a[124:127], v[140:143], v[124:127], a[124:127]
  s_add_u32 s52, s52, 2048
  s_add_u32 s53, s53, s22
  s_sub_u32 s54, s54, 1
  s_cmp_lg_u32 s54, 0
  s_cbranch_scc1 gl_189
gl_189_e:
  s_waitcnt lgkmcnt(0)
  s_nop 7
  s_branch next_task
run_wo:
  s_and_b32 s36, s61, 1
  s_lshl_b32 s36, s36, 7
  s_lshl_b32 s37, s27, 8
  s_add_u32 s36, s36, s37
  s_lshr_b32 s37, s61, 1
  s_lshl_b32 s37, s37, 8
  s_mov_b32 s44, s4
  s_mov_b32 s45, s5
  s_mov_b32 s46, 268435456
  s_mov_b32 s47, 0x00020000
  s_load_dwordx2 s[48:49], s[0:1], 40
  s_mov_b32 s50, 8388608
  s_mov_b32 s51, 0x00020000
  s_load_dwordx2 s[8:9], s[0:1], 104
  s_mov_b32 s10, 4194304
  s_mov_b32 s11, 0x00020000
  s_lshl_b32 s52, s36, 13
  s_add_u32 s52, s52, 50331648
  s_mov_b32 s53, s37
  s_lshl_b32 s63, s36, 11
  s_add_u32 s63, s63, s37
  s_lshr_b32 s35, s27, 1
  s_lshr_b32 s56, s14, 1
  s_and_b32 s57, s14, 1
  s_lshl_b32 s55, s14, 10
  v_and_b32 v28, 15, v1
  v_lshrrev_b32 v29, 4, v1
  v_lshrrev_b32 v30, 1, v28
  v_xor_b32 v30, v29, v30
  v_lshlrev_b32 v30, 4, v30
  v_lshl_add_u32 v2, v28, 7, v30
  s_mul_i32 s58, s56, 8192
  v_add_u32 v2, s58, v2
  v_xor_b32 v3, 64, v2
  v_bfe_u32 v30, v1, 2, 2
  v_lshl_add_u32 v31, v29, 3, v30
  v_mul_u32_u24 v31, 256, v31
  v_and_b32 v160, 3, v1
  v_lshl_add_u32 v31, v160, 3, v31
  v_add_u32 v31, 65536, v31
  v_and_b32 v160, 1, v29
  v_lshl_add_u32 v30, v160, 2, v30
  s_mul_i32 s58, s57, 4
  v_xor_b32 v160, s58, v30
  v_lshl_add_u32 v4, v160, 5, v31
  s_add_u32 s58, s58, 1
  v_xor_b32 v160, s58, v30
  v_lshl_add_u32 v5, v160, 5, v31
  s_add_u32 s58, s58, 1
  v_xor_b32 v160, s58, v30
  v_lshl_add_u32 v6, v160, 5, v31
  s_add_u32 s58, s58, 1
  v_xor_b32 v160, s58, v30
  v_lshl_add_u32 v7, v160, 5, v31
  s_add_u32 s58, s58, 1
  s_lshl_b32 s58, s57, 2
  v_or_b32 v30, s58, v29
  v_and_b32 v31, 7, v1
  v_xor_b32 v30, v30, v31
  v_lshrrev_b32 v31, 3, v1
  s_lshl_b32 s58, s14, 3
  v_add_u32 v31, s58, v31
  v_mul_u32_u24 v31, 8192, v31
  v_lshl_add_u32 v12, v30, 4, v31
  s_mul_i32 s58, s56, 8192
  v_lshl_add_u32 v2, v1, 4, s58
  v_add_u32 v3, 1024, v2
  s_mul_i32 s58, s56, 131072
  s_lshl_b32 s59, s57, 10
  s_add_u32 s58, s58, s59
  v_lshl_add_u32 v12, v1, 4, s58
  v_add_u32 v13, 262144, v12
  v_add_u32 v14, 524288, v12
  v_add_u32 v15, 786432, v12
  s_mov_b32 s22, 131072
  s_mul_i32 s58, s14, 4
  v_lshrrev_b32 v30, 4, v1
  v_add_u32 v30, s58, v30
  v_and_b32 v31, 15, v1
  v_add_u32 v160, 0, v30
  v_bfe_u32 v161, v160, 3, 1
  v_and_b32 v162, 3, v160
  v_lshl_add_u32 v161, v161, 2, v162
  v_lshlrev_b32 v161, 1, v161
  v_xor_b32 v161, v161, v31
  v_mul_u32_u24 v160, 2048, v160
  v_lshl_add_u32 v20, v161, 4, v160
  v_add_u32 v160, 16, v30
  v_bfe_u32 v161, v160, 3, 1
  v_and_b32 v162, 3, v160
  v_lshl_add_u32 v161, v161, 2, v162
  v_lshlrev_b32 v161, 1, v161
  v_xor_b32 v161, v161, v31
  v_mul_u32_u24 v160, 2048, v160
  v_lshl_add_u32 v21, v161, 4, v160
  v_add_u32 v160, 32, v30
  v_bfe_u32 v161, v160, 3, 1
  v_and_b32 v162, 3, v160
  v_lshl_add_u32 v161, v161, 2, v162
  v_lshlrev_b32 v161, 1, v161
  v_xor_b32 v161, v161, v31
  v_mul_u32_u24 v160, 2048, v160
  v_lshl_add_u32 v22, v161, 4, v160
  v_add_u32 v160, 48, v30
  v_bfe_u32 v161, v160, 3, 1
  v_and_b32 v162, 3, v160
  v_lshl_add_u32 v161, v161, 2, v162
  v_lshlrev_b32 v161, 1, v161
  v_xor_b32 v161, v161, v31
  v_mul_u32_u24 v160, 2048, v160
  v_lshl_add_u32 v23, v161, 4, v160
  s_cmp_lg_u32 s14, 0
  s_cbranch_scc1 we_191
  s_lshl_b32 s58, s35, 2
  v_mov_b32 v161, s58
wt_190:
  s_sub_u32 s23, s23, 1
  s_cbranch_scc1 rec_exit
  buffer_load_dword v160, v161, s[40:43], 0 offen offset:112 sc1
  s_waitcnt vmcnt(0)
  v_cmp_gt_u32 vcc, 16, v160
  s_cbranch_vccz wt_190_ok
  s_sleep 8
  s_branch wt_190
wt_190_ok:
we_191:
  s_barrier
  s_cmp_lg_u32 s14, 0
  s_cbranch_scc1 we_193
  s_lshl_b32 s58, s27, 2
  v_mov_b32 v161, s58
wt_192:
  s_sub_u32 s23, s23, 1
  s_cbranch_scc1 rec_exit
  buffer_load_dword v160, v161, s[40:43], 0 offen offset:160 sc1
  s_waitcnt vmcnt(0)
  v_cmp_gt_u32 vcc, 16, v160
  s_cbranch_vccz wt_192_ok
  s_sleep 8
  s_branch wt_192
wt_192_ok:
we_193:
  s_barrier
  s_waitcnt vmcnt(0) lgkmcnt(0)
  s_barrier
  v_and_b32 v30, 1, v29
  v_lshlrev_b32 v30, 5, v30
  v_lshrrev_b32 v160, 1, v29
  v_lshl_add_u32 v30, v160, 4, v30
  s_mul_i32 s58, s56, 131072
  s_mul_i32 s59, s57, 2048
  s_add_u32 s58, s58, s59
  v_add_u32 v30, v30, v28
  v_lshl_add_u32 v30, v30, 4, s58
  s_mul_i32 s58, s56, 64
  s_add_u32 s58, s58, s36
  s_lshl_b32 s58, s58, 2
  s_add_u32 s58, s58, 100663296
  v_lshlrev_b32 v31, 2, v28
  s_mul_i32 s59, s37, 15
  s_add_u32 s59, s59, s63
  s_add_u32 s59, s59, 88080384
  buffer_load_dword v224, v31, s[4:7], s58 offen offset:0 sc1
  buffer_load_dwordx4 v[192:195], v30, s[4:7], s59 offen offset:0 sc1
  buffer_load_dwordx4 v[196:199], v30, s[4:7], s59 offen offset:1024 sc1
  s_add_u32 s59, s59, 32768
  buffer_load_dword v225, v31, s[4:7], s58 offen offset:64 sc1
  buffer_load_dwordx4 v[200:203], v30, s[4:7], s59 offen offset:0 sc1
  buffer_load_dwordx4 v[204:207], v30, s[4:7], s59 offen offset:1024 sc1
  s_add_u32 s59, s59, 32768
  buffer_load_dword v226, v31, s[4:7], s58 offen offset:128 sc1
  buffer_load_dwordx4 v[208:211], v30, s[4:7], s59 offen offset:0 sc1
  buffer_load_dwordx4 v[212:215], v30, s[4:7], s59 offen offset:1024 sc1
  s_add_u32 s59, s59, 32768
  buffer_load_dword v227, v31, s[4:7], s58 offen offset:192 sc1
  buffer_load_dwordx4 v[216:219], v30, s[4:7], s59 offen offset:0 sc1
  buffer_load_dwordx4 v[220:223], v30, s[4:7], s59 offen offset:1024 sc1
  s_add_u32 s59, s59, 32768
  s_add_u32 m0, s55, 0
  s_nop 0
  buffer_load_dwordx4 v12, s[44:47], s52 offen  lds
  s_add_u32 m0, s55, 65536
  s_nop 0
  buffer_load_dwordx4 v20, s[48:51], s53 offen lds
  s_add_u32 m0, s55, 4096
  s_nop 0
  buffer_load_dwordx4 v13, s[44:47], s52 offen  lds
  s_add_u32 m0, s55, 69632
  s_nop 0
  buffer_load_dwordx4 v21, s[48:51], s53 offen lds
  s_add_u32 m0, s55, 8192
  s_nop 0
  buffer_load_dwordx4 v14, s[44:47], s52 offen  lds
  s_add_u32 m0, s55, 73728
  s_nop 0
  buffer_load_dwordx4 v22, s[48:51], s53 offen lds
  s_add_u32 m0, s55, 12288
  s_nop 0
  buffer_load_dwordx4 v15, s[44:47], s52 offen  lds
  s_add_u32 m0, s55, 77824
  s_nop 0
  buffer_load_dwordx4 v23, s[48:51], s53 offen lds
  s_add_u32 s52, s52, 2048
  s_add_u32 s53, s53, s22
  s_add_u32 m0, s55, 16384
  s_nop 0
  buffer_load_dwordx4 v12, s[44:47], s52 offen  lds
  s_add_u32 m0, s55, 81920
  s_nop 0
  buffer_load_dwordx4 v20, s[48:51], s53 offen lds
  s_add_u32 m0, s55, 20480
  s_nop 0
  buffer_load_dwordx4 v13, s[44:47], s52 offen  lds
  s_add_u32 m0, s55, 86016
  s_nop 0
  buffer_load_dwordx4 v21, s[48:51], s53 offen lds
  s_add_u32 m0, s55, 24576
  s_nop 0
  buffer_load_dwordx4 v14, s[44:47], s52 offen  lds
  s_add_u32 m0, s55, 90112
  s_nop 0
  buffer_load_dwordx4 v22, s[48:51], s53 offen lds
  s_add_u32 m0, s55, 28672
  s_nop 0
  buffer_load_dwordx4 v15, s[44:47], s52 offen  lds
  s_add_u32 m0, s55, 94208
  s_nop 0
  buffer_load_dwordx4 v23, s[48:51], s53 offen lds
  s_add_u32 s52, s52, 2048
  s_add_u32 s53, s53, s22
  s_add_u32 m0, s55, 32768
  s_nop 0
  buffer_load_dwordx4 v12, s[44:47], s52 offen  lds
  s_add_u32 m0, s55, 98304
  s_nop 0
  buffer_load_dwordx4 v20, s[48:51], s53 offen lds
  s_add_u32 m0, s55, 36864
  s_nop 0
  buffer_load_dwordx4 v13, s[44:47], s52 offen  lds
  s_add_u32 m0, s55, 102400
  s_nop 0
  buffer_load_dwordx4 v21, s[48:51], s53 offen lds
  s_add_u32 m0, s55, 40960
  s_nop 0
  buffer_load_dwordx4 v14, s[44:47], s52 offen  lds
  s_add_u32 m0, s55, 106496
  s_nop 0
  buffer_load_dwordx4 v22, s[48:51], s53 offen lds
  s_add_u32 m0, s55, 45056
  s_nop 0
  buffer_load_dwordx4 v15, s[44:47], s52 offen  lds
  s_add_u32 m0, s55, 110592
  s_nop 0
  buffer_load_dwordx4 v23, s[48:51], s53 offen lds
  s_add_u32 s52, s52, 2048
  s_add_u32 s53, s53, s22
  v_accvgpr_write_b32 a0, 0
  v_accvgpr_write_b32 a1, 0
  v_accvgpr_write_b32 a2, 0
  v_accvgpr_write_b32 a3, 0
  v_accvgpr_write_b32 a4, 0
  v_accvgpr_write_b32 a5, 0
  v_accvgpr_write_b32 a6, 0
  v_accvgpr_write_b32 a7, 0
  v_accvgpr_write_b32 a8, 0
  v_accvgpr_write_b32 a9, 0
  v_accvgpr_write_b32 a10, 0
  v_accvgpr_write_b32 a11, 0
  v_accvgpr_write_b32 a12, 0
  v_accvgpr_write_b32 a13, 0
  v_accvgpr_write_b32 a14, 0
  v_accvgpr_write_b32 a15, 0
  v_accvgpr_write_b32 a16, 0
  v_accvgpr_write_b32 a17, 0
  v_accvgpr_write_b32 a18, 0
  v_accvgpr_write_b32 a19, 0
  v_accvgpr_write_b32 a20, 0
  v_accvgpr_write_b32 a21, 0
  v_accvgpr_write_b32 a22, 0
  v_accvgpr_write_b32 a23, 0
  v_accvgpr_write_b32 a24, 0
  v_accvgpr_write_b32 a25, 0
  v_accvgpr_write_b32 a26, 0
  v_accvgpr_write_b32 a27, 0
  v_accvgpr_write_b32 a28, 0
  v_accvgpr_write_b32 a29, 0
  v_accvgpr_write_b32 a30, 0
  v_accvgpr_write_b32 a31, 0
  v_accvgpr_write_b32 a32, 0
  v_accvgpr_write_b32 a33, 0
  v_accvgpr_write_b32 a34, 0
  v_accvgpr_write_b32 a35, 0
  v_accvgpr_write_b32 a36, 0
  v_accvgpr_write_b32 a37, 0
  v_accvgpr_write_b32 a38, 0
  v_accvgpr_write_b32 a39, 0
  v_accvgpr_write_b32 a40, 0
  v_accvgpr_write_b32 a41, 0
  v_accvgpr_write_b32 a42, 0
  v_accvgpr_write_b32 a43, 0
  v_accvgpr_write_b32 a44, 0
  v_accvgpr_write_b32 a45, 0
  v_accvgpr_write_b32 a46, 0
  v_accvgpr_write_b32 a47, 0
  v_accvgpr_write_b32 a48, 0
  v_accvgpr_write_b32 a49, 0
  v_accvgpr_write_b32 a50, 0
  v_accvgpr_write_b32 a51, 0
  v_accvgpr_write_b32 a52, 0
  v_accvgpr_write_b32 a53, 0
  v_accvgpr_write_b32 a54, 0
  v_accvgpr_write_b32 a55, 0
  v_accvgpr_write_b32 a56, 0
  v_accvgpr_write_b32 a57, 0
  v_accvgpr_write_b32 a58, 0
  v_accvgpr_write_b32 a59, 0
  v_accvgpr_write_b32 a60, 0
  v_accvgpr_write_b32 a61, 0
  v_accvgpr_write_b32 a62, 0
  v_accvgpr_write_b32 a63, 0
  s_waitcnt vmcnt(16)
  s_barrier
  ds_read_b128 v[32:35], v2 offset:0
  ds_read_b64_tr_b16 v[64:65], v4 offset:0
  ds_read_b64_tr_b16 v[66:67], v4 offset:1024
  ds_read_b64_tr_b16 v[68:69], v5 offset:0
  ds_read_b64_tr_b16 v[70:71], v5 offset:1024
  ds_read_b128 v[36:39], v2 offset:2048
  ds_read_b64_tr_b16 v[72:73], v6 offset:0
  ds_read_b64_tr_b16 v[74:75], v6 offset:1024
  ds_read_b128 v[40:43], v2 offset:4096
  ds_read_b64_tr_b16 v[76:77], v7 offset:0
  ds_read_b64_tr_b16 v[78:79], v7 offset:1024
  ds_read_b128 v[44:47], v2 offset:6144
  s_mov_b32 s54, 16
gl_194:
  s_waitcnt lgkmcnt(9)
  s_add_u32 m0, s55, 49152
  v_mfma_f32_16x16x32_bf16 a[0:3], v[64:67], v[32:35], a[0:3]
  buffer_load_dwordx4 v12, s[44:47], s52 offen  lds
  s_waitcnt lgkmcnt(7)
  v_mfma_f32_16x16x32_bf16 a[4:7], v[68:71], v[32:35], a[4:7]
  s_waitcnt lgkmcnt(6)
  s_add_u32 m0, s55, 114688
  v_mfma_f32_16x16x32_bf16 a[16:19], v[64:67], v[36:39], a[16:19]
  buffer_load_dwordx4 v20, s[48:51], s53 offen lds
  v_mfma_f32_16x16x32_bf16 a[20:23], v[68:71], v[36:39], a[20:23]
  s_waitcnt lgkmcnt(4)
  v_mfma_f32_16x16x32_bf16 a[8:11], v[72:75], v[32:35], a[8:11]
  s_add_u32 m0, s55, 53248
  v_mfma_f32_16x16x32_bf16 a[24:27], v[72:75], v[36:39], a[24:27]
  buffer_load_dwordx4 v13, s[44:47], s52 offen  lds
  s_waitcnt lgkmcnt(3)
  v_mfma_f32_16x16x32_bf16 a[32:35], v[64:67], v[40:43], a[32:35]
  v_mfma_f32_16x16x32_bf16 a[36:39], v[68:71], v[40:43], a[36:39]
  s_add_u32 m0, s55, 118784
  v_mfma_f32_16x16x32_bf16 a[40:43], v[72:75], v[40:43], a[40:43]
  buffer_load_dwordx4 v21, s[48:51], s53 offen lds
  ds_read_b128 v[96:99], v3 offset:0
  ds_read_b64_tr_b16 v[128:129], v4 offset:8192
  s_waitcnt lgkmcnt(3)
  v_mfma_f32_16x16x32_bf16 a[12:15], v[76:79], v[32:35], a[12:15]
  ds_read_b64_tr_b16 v[130:131], v4 offset:9216
  s_add_u32 m0, s55, 57344
  v_mfma_f32_16x16x32_bf16 a[28:31], v[76:79], v[36:39], a[28:31]
  buffer_load_dwordx4 v14, s[44:47], s52 offen  lds
  ds_read_b64_tr_b16 v[132:133], v5 offset:8192
  ds_read_b64_tr_b16 v[134:135], v5 offset:9216
  v_mfma_f32_16x16x32_bf16 a[44:47], v[76:79], v[40:43], a[44:47]
  ds_read_b128 v[100:103], v3 offset:2048
  s_waitcnt lgkmcnt(6)
  v_mfma_f32_16x16x32_bf16 a[48:51], v[64:67], v[44:47], a[48:51]
  ds_read_b64_tr_b16 v[136:137], v6 offset:8192
  ds_read_b64_tr_b16 v[138:139], v6 offset:9216
  s_add_u32 m0, s55, 122880
  v_mfma_f32_16x16x32_bf16 a[52:55], v[68:71], v[44:47], a[52:55]
  buffer_load_dwordx4 v22, s[48:51], s53 offen lds
  ds_read_b128 v[104:107], v3 offset:4096
  v_mfma_f32_16x16x32_bf16 a[56:59], v[72:75], v[44:47], a[56:59]
  ds_read_b64_tr_b16 v[140:141], v7 offset:8192
  ds_read_b64_tr_b16 v[142:143], v7 offset:9216
  v_mfma_f32_16x16x32_bf16 a[60:63], v[76:79], v[44:47], a[60:63]
  ds_read_b128 v[108:111], v3 offset:6144
  s_waitcnt lgkmcnt(9)
  s_add_u32 m0, s55, 61440
  v_mfma_f32_16x16x32_bf16 a[0:3], v[128:131], v[96:99], a[0:3]
  buffer_load_dwordx4 v15, s[44:47], s52 offen  lds
  s_waitcnt lgkmcnt(7)
  v_mfma_f32_16x16x32_bf16 a[4:7], v[132:135], v[96:99], a[4:7]
  s_waitcnt lgkmcnt(6)
  v_mfma_f32_16x16x32_bf16 a[16:19], v[128:131], v[100:103], a[16:19]
  s_add_u32 m0, s55, 126976
  v_mfma_f32_16x16x32_bf16 a[20:23], v[132:135], v[100:103], a[20:23]
  buffer_load_dwordx4 v23, s[48:51], s53 offen lds
  s_waitcnt lgkmcnt(4)
  v_mfma_f32_16x16x32_bf16 a[8:11], v[136:139], v[96:99], a[8:11]
  v_mfma_f32_16x16x32_bf16 a[24:27], v[136:139], v[100:103], a[24:27]
  s_waitcnt lgkmcnt(3)
  v_mfma_f32_16x16x32_bf16 a[32:35], v[128:131], v[104:107], a[32:35]
  v_mfma_f32_16x16x32_bf16 a[36:39], v[132:135], v[104:107], a[36:39]
  s_waitcnt vmcnt(16) lgkmcnt(0)
  s_barrier
  v_mfma_f32_16x16x32_bf16 a[40:43], v[136:139], v[104:107], a[40:43]
  ds_read_b128 v[32:35], v2 offset:16384
  ds_read_b64_tr_b16 v[64:65], v4 offset:16384
  v_mfma_f32_16x16x32_bf16 a[12:15], v[140:143], v[96:99], a[12:15]
  ds_read_b64_tr_b16 v[66:67], v4 offset:17408
  v_mfma_f32_16x16x32_bf16 a[28:31], v[140:143], v[100:103], a[28:31]
  ds_read_b64_tr_b16 v[68:69], v5 offset:16384
  ds_read_b64_tr_b16 v[70:71], v5 offset:17408
  v_mfma_f32_16x16x32_bf16 a[44:47], v[140:143], v[104:107], a[44:47]
  ds_read_b128 v[36:39], v2 offset:18432
  v_mfma_f32_16x16x32_bf16 a[48:51], v[128:131], v[108:111], a[48:51]
  ds_read_b64_tr_b16 v[72:73], v6 offset:16384
  ds_read_b64_tr_b16 v[74:75], v6 offset:17408
  v_mfma_f32_16x16x32_bf16 a[52:55], v[132:135], v[108:111], a[52:55]
  ds_read_b128 v[40:43], v2 offset:20480
  v_mfma_f32_16x16x32_bf16 a[56:59], v[136:139], v[108:111], a[56:59]
  ds_read_b64_tr_b16 v[76:77], v7 offset:16384
  ds_read_b64_tr_b16 v[78:79], v7 offset:17408
  v_mfma_f32_16x16x32_bf16 a[60:63], v[140:143], v[108:111], a[60:63]
  ds_read_b128 v[44:47], v2 offset:22528
  s_add_u32 s52, s52, 2048
  s_add_u32 s53, s53, s22
  s_cmp_eq_u32 s54, 1
  s_cselect_b32 s46, 0, s46
  s_cselect_b32 s50, 0, s50
  s_waitcnt lgkmcnt(9)
  s_add_u32 m0, s55, 0
  v_mfma_f32_16x16x32_bf16 a[0:3], v[64:67], v[32:35], a[0:3]
  buffer_load_dwordx4 v12, s[44:47], s52 offen  lds
  s_waitcnt lgkmcnt(7)
  v_mfma_f32_16x16x32_bf16 a[4:7], v[68:71], v[32:35], a[4:7]
  s_waitcnt lgkmcnt(6)
  s_add_u32 m0, s55, 65536
  v_mfma_f32_16x16x32_bf16 a[16:19], v[64:67], v[36:39], a[16:19]
  buffer_load_dwordx4 v20, s[48:51], s53 offen lds
  v_mfma_f32_16x16x32_bf16 a[20:23], v[68:71], v[36:39], a[20:23]
  s_waitcnt lgkmcnt(4)
  v_mfma_f32_16x16x32_bf16 a[8:11], v[72:75], v[32:35], a[8:11]
  s_add_u32 m0, s55, 4096
  v_mfma_f32_16x16x32_bf16 a[24:27], v[72:75], v[36:39], a[24:27]
  buffer_load_dwordx4 v13, s[44:47], s52 offen  lds
  s_waitcnt lgkmcnt(3)
  v_mfma_f32_16x16x32_bf16 a[32:35], v[64:67], v[40:43], a[32:35]
  v_mfma_f32_16x16x32_bf16 a[36:39], v[68:71], v[40:43], a[36:39]
  s_add_u32 m0, s55, 69632
  v_mfma_f32_16x16x32_bf16 a[40:43], v[72:75], v[40:43], a[40:43]
  buffer_load_dwordx4 v21, s[48:51], s53 offen lds
  ds_read_b128 v[96:99], v3 offset:16384
  ds_read_b64_tr_b16 v[128:129], v4 offset:24576
  s_waitcnt lgkmcnt(3)
  v_mfma_f32_16x16x32_bf16 a[12:15], v[76:79], v[32:35], a[12:15]
  ds_read_b64_tr_b16 v[130:131], v4 offset:25600
  s_add_u32 m0, s55, 8192
  v_mfma_f32_16x16x32_bf16 a[28:31], v[76:79], v[36:39], a[28:31]
  buffer_load_dwordx4 v14, s[44:47], s52 offen  lds
  ds_read_b64_tr_b16 v[132:133], v5 offset:24576
  ds_read_b64_tr_b16 v[134:135], v5 offset:25600
  v_mfma_f32_16x16x32_bf16 a[44:47], v[76:79], v[40:43], a[44:47]
  ds_read_b128 v[100:103], v3 offset:18432
  s_waitcnt lgkmcnt(6)
  v_mfma_f32_16x16x32_bf16 a[48:51], v[64:67], v[44:47], a[48:51]
  ds_read_b64_tr_b16 v[136:137], v6 offset:24576
  ds_read_b64_tr_b16 v[138:139], v6 offset:25600
  s_add_u32 m0, s55, 73728
  v_mfma_f32_16x16x32_bf16 a[52:55], v[68:71], v[44:47], a[52:55]
  buffer_load_dwordx4 v22, s[48:51], s53 offen lds
  ds_read_b128 v[104:107], v3 offset:20480
  v_mfma_f32_16x16x32_bf16 a[56:59], v[72:75], v[44:47], a[56:59]
  ds_read_b64_tr_b16 v[140:141], v7 offset:24576
  ds_read_b64_tr_b16 v[142:143], v7 offset:25600
  v_mfma_f32_16x16x32_bf16 a[60:63], v[76:79], v[44:47], a[60:63]
  ds_read_b128 v[108:111], v3 offset:22528
  s_waitcnt lgkmcnt(9)
  s_add_u32 m0, s55, 12288
  v_mfma_f32_16x16x32_bf16 a[0:3], v[128:131], v[96:99], a[0:3]
  buffer_load_dwordx4 v15, s[44:47], s52 offen  lds
  s_waitcnt lgkmcnt(7)
  v_mfma_f32_16x16x32_bf16 a[4:7], v[132:135], v[96:99], a[4:7]
  s_waitcnt lgkmcnt(6)
  v_mfma_f32_16x16x32_bf16 a[16:19], v[128:131], v[100:103], a[16:19]
  s_add_u32 m0, s55, 77824
  v_mfma_f32_16x16x32_bf16 a[20:23], v[132:135], v[100:103], a[20:23]
  buffer_load_dwordx4 v23, s[48:51], s53 offen lds
  s_waitcnt lgkmcnt(4)
  v_mfma_f32_16x16x32_bf16 a[8:11], v[136:139], v[96:99], a[8:11]
  v_mfma_f32_16x16x32_bf16 a[24:27], v[136:139], v[100:103], a[24:27]
  s_waitcnt lgkmcnt(3)
  v_mfma_f32_16x16x32_bf16 a[32:35], v[128:131], v[104:107], a[32:35]
  v_mfma_f32_16x16x32_bf16 a[36:39], v[132:135], v[104:107], a[36:39]
  s_waitcnt vmcnt(16) lgkmcnt(0)
  s_barrier
  v_mfma_f32_16x16x32_bf16 a[40:43], v[136:139], v[104:107], a[40:43]
  ds_read_b128 v[32:35], v2 offset:32768
  ds_read_b64_tr_b16 v[64:65], v4 offset:32768
  v_mfma_f32_16x16x32_bf16 a[12:15], v[140:143], v[96:99], a[12:15]
  ds_read_b64_tr_b16 v[66:67], v4 offset:33792
  v_mfma_f32_16x16x32_bf16 a[28:31], v[140:143], v[100:103], a[28:31]
  ds_read_b64_tr_b16 v[68:69], v5 offset:32768
  ds_read_b64_tr_b16 v[70:71], v5 offset:33792
  v_mfma_f32_16x16x32_bf16 a[44:47], v[140:143], v[104:107], a[44:47]
  ds_read_b128 v[36:39], v2 offset:34816
  v_mfma_f32_16x16x32_bf16 a[48:51], v[128:131], v[108:111], a[48:51]
  ds_read_b64_tr_b16 v[72:73], v6 offset:32768
  ds_read_b64_tr_b16 v[74:75], v6 offset:33792
  v_mfma_f32_16x16x32_bf16 a[52:55], v[132:135], v[108:111], a[52:55]
  ds_read_b128 v[40:43], v2 offset:36864
  v_mfma_f32_16x16x32_bf16 a[56:59], v[136:139], v[108:111], a[56:59]
  ds_read_b64_tr_b16 v[76:77], v7 offset:32768
  ds_read_b64_tr_b16 v[78:79], v7 offset:33792
  v_mfma_f32_16x16x32_bf16 a[60:63], v[140:143], v[108:111], a[60:63]
  ds_read_b128 v[44:47], v2 offset:38912
  s_add_u32 s52, s52, 2048
  s_add_u32 s53, s53, s22
  s_waitcnt lgkmcnt(9)
  s_add_u32 m0, s55, 16384
  v_mfma_f32_16x16x32_bf16 a[0:3], v[64:67], v[32:35], a[0:3]
  buffer_load_dwordx4 v12, s[44:47], s52 offen  lds
  s_waitcnt lgkmcnt(7)
  v_mfma_f32_16x16x32_bf16 a[4:7], v[68:71], v[32:35], a[4:7]
  s_waitcnt lgkmcnt(6)
  s_add_u32 m0, s55, 81920
  v_mfma_f32_16x16x32_bf16 a[16:19], v[64:67], v[36:39], a[16:19]
  buffer_load_dwordx4 v20, s[48:51], s53 offen lds
  v_mfma_f32_16x16x32_bf16 a[20:23], v[68:71], v[36:39], a[20:23]
  s_waitcnt lgkmcnt(4)
  v_mfma_f32_16x16x32_bf16 a[8:11], v[72:75], v[32:35], a[8:11]
  s_add_u32 m0, s55, 20480
  v_mfma_f32_16x16x32_bf16 a[24:27], v[72:75], v[36:39], a[24:27]
  buffer_load_dwordx4 v13, s[44:47], s52 offen  lds
  s_waitcnt lgkmcnt(3)
  v_mfma_f32_16x16x32_bf16 a[32:35], v[64:67], v[40:43], a[32:35]
  v_mfma_f32_16x16x32_bf16 a[36:39], v[68:71], v[40:43], a[36:39]
  s_add_u32 m0, s55, 86016
  v_mfma_f32_16x16x32_bf16 a[40:43], v[72:75], v[40:43], a[40:43]
  buffer_load_dwordx4 v21, s[48:51], s53 offen lds
  ds_read_b128 v[96:99], v3 offset:32768
  ds_read_b64_tr_b16 v[128:129], v4 offset:40960
  s_waitcnt lgkmcnt(3)
  v_mfma_f32_16x16x32_bf16 a[12:15], v[76:79], v[32:35], a[12:15]
  ds_read_b64_tr_b16 v[130:131], v4 offset:41984
  s_add_u32 m0, s55, 24576
  v_mfma_f32_16x16x32_bf16 a[28:31], v[76:79], v[36:39], a[28:31]
  buffer_load_dwordx4 v14, s[44:47], s52 offen  lds
  ds_read_b64_tr_b16 v[132:133], v5 offset:40960
  ds_read_b64_tr_b16 v[134:135], v5 offset:41984
  v_mfma_f32_16x16x32_bf16 a[44:47], v[76:79], v[40:43], a[44:47]
  ds_read_b128 v[100:103], v3 offset:34816
  s_waitcnt lgkmcnt(6)
  v_mfma_f32_16x16x32_bf16 a[48:51], v[64:67], v[44:47], a[48:51]
  ds_read_b64_tr_b16 v[136:137], v6 offset:40960
  ds_read_b64_tr_b16 v[138:139], v6 offset:41984
  s_add_u32 m0, s55, 90112
  v_mfma_f32_16x16x32_bf16 a[52:55], v[68:71], v[44:47], a[52:55]
  buffer_load_dwordx4 v22, s[48:51], s53 offen lds
  ds_read_b128 v[104:107], v3 offset:36864
  v_mfma_f32_16x16x32_bf16 a[56:59], v[72:75], v[44:47], a[56:59]
  ds_read_b64_tr_b16 v[140:141], v7 offset:40960
  ds_read_b64_tr_b16 v[142:143], v7 offset:41984
  v_mfma_f32_16x16x32_bf16 a[60:63], v[76:79], v[44:47], a[60:63]
  ds_read_b128 v[108:111], v3 offset:38912
  s_waitcnt lgkmcnt(9)
  s_add_u32 m0, s55, 28672
  v_mfma_f32_16x16x32_bf16 a[0:3], v[128:131], v[96:99], a[0:3]
  buffer_load_dwordx4 v15, s[44:47], s52 offen  lds
  s_waitcnt lgkmcnt(7)
  v_mfma_f32_16x16x32_bf16 a[4:7], v[132:135], v[96:99], a[4:7]
  s_waitcnt lgkmcnt(6)
  v_mfma_f32_16x16x32_bf16 a[16:19], v[128:131], v[100:103], a[16:19]
  s_add_u32 m0, s55, 94208
  v_mfma_f32_16x16x32_bf16 a[20:23], v[132:135], v[100:103], a[20:23]
  buffer_load_dwordx4 v23, s[48:51], s53 offen lds
  s_waitcnt lgkmcnt(4)
  v_mfma_f32_16x16x32_bf16 a[8:11], v[136:139], v[96:99], a[8:11]
  v_mfma_f32_16x16x32_bf16 a[24:27], v[136:139], v[100:103], a[24:27]
  s_waitcnt lgkmcnt(3)
  v_mfma_f32_16x16x32_bf16 a[32:35], v[128:131], v[104:107], a[32:35]
  v_mfma_f32_16x16x32_bf16 a[36:39], v[132:135], v[104:107], a[36:39]
  s_waitcnt vmcnt(16) lgkmcnt(0)
  s_barrier
  v_mfma_f32_16x16x32_bf16 a[40:43], v[136:139], v[104:107], a[40:43]
  ds_read_b128 v[32:35], v2 offset:49152
  ds_read_b64_tr_b16 v[64:65], v4 offset:49152
  v_mfma_f32_16x16x32_bf16 a[12:15], v[140:143], v[96:99], a[12:15]
  ds_read_b64_tr_b16 v[66:67], v4 offset:50176
  v_mfma_f32_16x16x32_bf16 a[28:31], v[140:143], v[100:103], a[28:31]
  ds_read_b64_tr_b16 v[68:69], v5 offset:49152
  ds_read_b64_tr_b16 v[70:71], v5 offset:50176
  v_mfma_f32_16x16x32_bf16 a[44:47], v[140:143], v[104:107], a[44:47]
  ds_read_b128 v[36:39], v2 offset:51200
  v_mfma_f32_16x16x32_bf16 a[48:51], v[128:131], v[108:111], a[48:51]
  ds_read_b64_tr_b16 v[72:73], v6 offset:49152
  ds_read_b64_tr_b16 v[74:75], v6 offset:50176
  v_mfma_f32_16x16x32_bf16 a[52:55], v[132:135], v[108:111], a[52:55]
  ds_read_b128 v[40:43], v2 offset:53248
  v_mfma_f32_16x16x32_bf16 a[56:59], v[136:139], v[108:111], a[56:59]
  ds_read_b64_tr_b16 v[76:77], v7 offset:49152
  ds_read_b64_tr_b16 v[78:79], v7 offset:50176
  v_mfma_f32_16x16x32_bf16 a[60:63], v[140:143], v[108:111], a[60:63]
  ds_read_b128 v[44:47], v2 offset:55296
  s_add_u32 s52, s52, 2048
  s_add_u32 s53, s53, s22
  s_waitcnt lgkmcnt(9)
  s_add_u32 m0, s55, 32768
  v_mfma_f32_16x16x32_bf16 a[0:3], v[64:67], v[32:35], a[0:3]
  buffer_load_dwordx4 v12, s[44:47], s52 offen  lds
  s_waitcnt lgkmcnt(7)
  v_mfma_f32_16x16x32_bf16 a[4:7], v[68:71], v[32:35], a[4:7]
  s_waitcnt lgkmcnt(6)
  s_add_u32 m0, s55, 98304
  v_mfma_f32_16x16x32_bf16 a[16:19], v[64:67], v[36:39], a[16:19]
  buffer_load_dwordx4 v20, s[48:51], s53 offen lds
  v_mfma_f32_16x16x32_bf16 a[20:23], v[68:71], v[36:39], a[20:23]
  s_waitcnt lgkmcnt(4)
  v_mfma_f32_16x16x32_bf16 a[8:11], v[72:75], v[32:35], a[8:11]
  s_add_u32 m0, s55, 36864
  v_mfma_f32_16x16x32_bf16 a[24:27], v[72:75], v[36:39], a[24:27]
  buffer_load_dwordx4 v13, s[44:47], s52 offen  lds
  s_waitcnt lgkmcnt(3)
  v_mfma_f32_16x16x32_bf16 a[32:35], v[64:67], v[40:43], a[32:35]
  v_mfma_f32_16x16x32_bf16 a[36:39], v[68:71], v[40:43], a[36:39]
  s_add_u32 m0, s55, 102400
  v_mfma_f32_16x16x32_bf16 a[40:43], v[72:75], v[40:43], a[40:43]
  buffer_load_dwordx4 v21, s[48:51], s53 offen lds
  ds_read_b128 v[96:99], v3 offset:49152
  ds_read_b64_tr_b16 v[128:129], v4 offset:57344
  s_waitcnt lgkmcnt(3)
  v_mfma_f32_16x16x32_bf16 a[12:15], v[76:79], v[32:35], a[12:15]
  ds_read_b64_tr_b16 v[130:131], v4 offset:58368
  s_add_u32 m0, s55, 40960
  v_mfma_f32_16x16x32_bf16 a[28:31], v[76:79], v[36:39], a[28:31]
  buffer_load_dwordx4 v14, s[44:47], s52 offen  lds
  ds_read_b64_tr_b16 v[132:133], v5 offset:57344
  ds_read_b64_tr_b16 v[134:135], v5 offset:58368
  v_mfma_f32_16x16x32_bf16 a[44:47], v[76:79], v[40:43], a[44:47]
  ds_read_b128 v[100:103], v3 offset:51200
  s_waitcnt lgkmcnt(6)
  v_mfma_f32_16x16x32_bf16 a[48:51], v[64:67], v[44:47], a[48:51]
  ds_read_b64_tr_b16 v[136:137], v6 offset:57344
  ds_read_b64_tr_b16 v[138:139], v6 offset:58368
  s_add_u32 m0, s55, 106496
  v_mfma_f32_16x16x32_bf16 a[52:55], v[68:71], v[44:47], a[52:55]
  buffer_load_dwordx4 v22, s[48:51], s53 offen lds
  ds_read_b128 v[104:107], v3 offset:53248
  v_mfma_f32_16x16x32_bf16 a[56:59], v[72:75], v[44:47], a[56:59]
  ds_read_b64_tr_b16 v[140:141], v7 offset:57344
  ds_read_b64_tr_b16 v[142:143], v7 offset:58368
  v_mfma_f32_16x16x32_bf16 a[60:63], v[76:79], v[44:47], a[60:63]
  ds_read_b128 v[108:111], v3 offset:55296
  s_waitcnt lgkmcnt(9)
  s_add_u32 m0, s55, 45056
  v_mfma_f32_16x16x32_bf16 a[0:3], v[128:131], v[96:99], a[0:3]
  buffer_load_dwordx4 v15, s[44:47], s52 offen  lds
  s_waitcnt lgkmcnt(7)
  v_mfma_f32_16x16x32_bf16 a[4:7], v[132:135], v[96:99], a[4:7]
  s_waitcnt lgkmcnt(6)
  v_mfma_f32_16x16x32_bf16 a[16:19], v[128:131], v[100:103], a[16:19]
  s_add_u32 m0, s55, 110592
  v_mfma_f32_16x16x32_bf16 a[20:23], v[132:135], v[100:103], a[20:23]
  buffer_load_dwordx4 v23, s[48:51], s53 offen lds
  s_waitcnt lgkmcnt(4)
  v_mfma_f32_16x16x32_bf16 a[8:11], v[136:139], v[96:99], a[8:11]
  v_mfma_f32_16x16x32_bf16 a[24:27], v[136:139], v[100:103], a[24:27]
  s_waitcnt lgkmcnt(3)
  v_mfma_f32_16x16x32_bf16 a[32:35], v[128:131], v[104:107], a[32:35]
  v_mfma_f32_16x16x32_bf16 a[36:39], v[132:135], v[104:107], a[36:39]
  s_waitcnt vmcnt(16) lgkmcnt(0)
  s_barrier
  v_mfma_f32_16x16x32_bf16 a[40:43], v[136:139], v[104:107], a[40:43]
  ds_read_b128 v[32:35], v2 offset:0
  ds_read_b64_tr_b16 v[64:65], v4 offset:0
  v_mfma_f32_16x16x32_bf16 a[12:15], v[140:143], v[96:99], a[12:15]
  ds_read_b64_tr_b16 v[66:67], v4 offset:1024
  v_mfma_f32_16x16x32_bf16 a[28:31], v[140:143], v[100:103], a[28:31]
  ds_read_b64_tr_b16 v[68:69], v5 offset:0
  ds_read_b64_tr_b16 v[70:71], v5 offset:1024
  v_mfma_f32_16x16x32_bf16 a[44:47], v[140:143], v[104:107], a[44:47]
  ds_read_b128 v[36:39], v2 offset:2048
  v_mfma_f32_16x16x32_bf16 a[48:51], v[128:131], v[108:111], a[48:51]
  ds_read_b64_tr_b16 v[72:73], v6 offset:0
  ds_read_b64_tr_b16 v[74:75], v6 offset:1024
  v_mfma_f32_16x16x32_bf16 a[52:55], v[132:135], v[108:111], a[52:55]
  ds_read_b128 v[40:43], v2 offset:4096
  v_mfma_f32_16x16x32_bf16 a[56:59], v[136:139], v[108:111], a[56:59]
  ds_read_b64_tr_b16 v[76:77], v7 offset:0
  ds_read_b64_tr_b16 v[78:79], v7 offset:1024
  v_mfma_f32_16x16x32_bf16 a[60:63], v[140:143], v[108:111], a[60:63]
  ds_read_b128 v[44:47], v2 offset:6144
  s_add_u32 s52, s52, 2048
  s_add_u32 s53, s53, s22
  s_sub_u32 s54, s54, 1
  s_cmp_lg_u32 s54, 0
  s_cbranch_scc1 gl_194
gl_194_e:
  s_waitcnt lgkmcnt(0)
  s_nop 7
  s_branch next_task
run_s:
  s_load_dwordx2 s[48:49], s[0:1], 40
  s_mov_b32 s50, 8388608
  s_mov_b32 s51, 0x00020000
  s_load_dwordx2 s[8:9], s[0:1], 104
  s_mov_b32 s10, 4194304
  s_mov_b32 s11, 0x00020000
  s_and_b32 s36, s27, 1
  s_lshl_b32 s36, s36, 4
  s_add_u32 s36, s36, s61
  s_lshl_b32 s36, s36, 6
  s_lshl_b32 s30, s14, 15
  v_lshrrev_b32 v12, 2, v1
  v_and_b32 v13, 3, v1
  v_lshlrev_b32 v13, 4, v13
  v_lshlrev_b32 v14, 9, v29
  v_and_b32 v15, 3, v12
  v_lshl_add_u32 v14, v15, 6, v14
  v_add3_u32 v14, v14, v13, s30
  v_lshl_add_u32 v13, v12, 11, v13
  s_lshl_b32 s32, s14, 21
  s_add_u32 s32, s32, s36
  s_waitcnt lgkmcnt(0)
  s_add_u32 s35, s30, 0
  s_mov_b32 m0, s35
  s_add_u32 s35, s35, 1024
  buffer_load_dwordx4 v13, s[48:51], s32 offen lds
  s_add_u32 s32, s32, 32768
  s_mov_b32 m0, s35
  s_add_u32 s35, s35, 1024
  buffer_load_dwordx4 v13, s[48:51], s32 offen lds
  s_add_u32 s32, s32, 32768
  s_mov_b32 m0, s35
  s_add_u32 s35, s35, 1024
  buffer_load_dwordx4 v13, s[48:51], s32 offen lds
  s_add_u32 s32, s32, 32768
  s_mov_b32 m0, s35
  s_add_u32 s35, s35, 1024
  buffer_load_dwordx4 v13, s[48:51], s32 offen lds
  s_add_u32 s32, s32, 32768
  s_mov_b32 m0, s35
  s_add_u32 s35, s35, 1024
  buffer_load_dwordx4 v13, s[48:51], s32 offen lds
  s_add_u32 s32, s32, 32768
  s_mov_b32 m0, s35
  s_add_u32 s35, s35, 1024
  buffer_load_dwordx4 v13, s[48:51], s32 offen lds
  s_add_u32 s32, s32, 32768
  s_mov_b32 m0, s35
  s_add_u32 s35, s35, 1024
  buffer_load_dwordx4 v13, s[48:51], s32 offen lds
  s_add_u32 s32, s32, 32768
  s_mov_b32 m0, s35
  s_add_u32 s35, s35, 1024
  buffer_load_dwordx4 v13, s[48:51], s32 offen lds
  s_add_u32 s32, s32, 32768
  s_mov_b32 m0, s35
  s_add_u32 s35, s35, 1024
  buffer_load_dwordx4 v13, s[48:51], s32 offen lds
  s_add_u32 s32, s32, 32768
  s_mov_b32 m0, s35
  s_add_u32 s35, s35, 1024
  buffer_load_dwordx4 v13, s[48:51], s32 offen lds
  s_add_u32 s32, s32, 32768
  s_mov_b32 m0, s35
  s_add_u32 s35, s35, 1024
  buffer_load_dwordx4 v13, s[48:51], s32 offen lds
  s_add_u32 s32, s32, 32768
  s_mov_b32 m0, s35
  s_add_u32 s35, s35, 1024
  buffer_load_dwordx4 v13, s[48:51], s32 offen lds
  s_add_u32 s32, s32, 32768
  s_mov_b32 m0, s35
  s_add_u32 s35, s35, 1024
  buffer_load_dwordx4 v13, s[48:51], s32 offen lds
  s_add_u32 s32, s32, 32768
  s_mov_b32 m0, s35
  s_add_u32 s35, s35, 1024
  buffer_load_dwordx4 v13, s[48:51], s32 offen lds
  s_add_u32 s32, s32, 32768
  s_mov_b32 m0, s35
  s_add_u32 s35, s35, 1024
  buffer_load_dwordx4 v13, s[48:51], s32 offen lds
  s_add_u32 s32, s32, 32768
  s_mov_b32 m0, s35
  s_add_u32 s35, s35, 1024
  buffer_load_dwordx4 v13, s[48:51], s32 offen lds
  s_add_u32 s32, s32, 32768
  s_add_u32 s35, s30, 16384
  s_mov_b32 m0, s35
  s_add_u32 s35, s35, 1024
  buffer_load_dwordx4 v13, s[48:51], s32 offen lds
  s_add_u32 s32, s32, 32768
  s_mov_b32 m0, s35
  s_add_u32 s35, s35, 1024
  buffer_load_dwordx4 v13, s[48:51], s32 offen lds
  s_add_u32 s32, s32, 32768
  s_mov_b32 m0, s35
  s_add_u32 s35, s35, 1024
  buffer_load_dwordx4 v13, s[48:51], s32 offen lds
  s_add_u32 s32, s32, 32768
  s_mov_b32 m0, s35
  s_add_u32 s35, s35, 1024
  buffer_load_dwordx4 v13, s[48:51], s32 offen lds
  s_add_u32 s32, s32, 32768
  s_mov_b32 m0, s35
  s_add_u32 s35, s35, 1024
  buffer_load_dwordx4 v13, s[48:51], s32 offen lds
  s_add_u32 s32, s32, 32768
  s_mov_b32 m0, s35
  s_add_u32 s35, s35, 1024
  buffer_load_dwordx4 v13, s[48:51], s32 offen lds
  s_add_u32 s32, s32, 32768
  s_mov_b32 m0, s35
  s_add_u32 s35, s35, 1024
  buffer_load_dwordx4 v13, s[48:51], s32 offen lds
  s_add_u32 s32, s32, 32768
  s_mov_b32 m0, s35
  s_add_u32 s35, s35, 1024
  buffer_load_dwordx4 v13, s[48:51], s32 offen lds
  s_add_u32 s32, s32, 32768
  s_mov_b32 m0, s35
  s_add_u32 s35, s35, 1024
  buffer_load_dwordx4 v13, s[48:51], s32 offen lds
  s_add_u32 s32, s32, 32768
  s_mov_b32 m0, s35
  s_add_u32 s35, s35, 1024
  buffer_load_dwordx4 v13, s[48:51], s32 offen lds
  s_add_u32 s32, s32, 32768
  s_mov_b32 m0, s35
  s_add_u32 s35, s35, 1024
  buffer_load_dwordx4 v13, s[48:51], s32 offen lds
  s_add_u32 s32, s32, 32768
  s_mov_b32 m0, s35
  s_add_u32 s35, s35, 1024
  buffer_load_dwordx4 v13, s[48:51], s32 offen lds
  s_add_u32 s32, s32, 32768
  s_mov_b32 m0, s35
  s_add_u32 s35, s35, 1024
  buffer_load_dwordx4 v13, s[48:51], s32 offen lds
  s_add_u32 s32, s32, 32768
  s_mov_b32 m0, s35
  s_add_u32 s35, s35, 1024
  buffer_load_dwordx4 v13, s[48:51], s32 offen lds
  s_add_u32 s32, s32, 32768
  s_mov_b32 m0, s35
  s_add_u32 s35, s35, 1024
  buffer_load_dwordx4 v13, s[48:51], s32 offen lds
  s_add_u32 s32, s32, 32768
  s_mov_b32 m0, s35
  s_add_u32 s35, s35, 1024
  buffer_load_dwordx4 v13, s[48:51], s32 offen lds
  s_add_u32 s32, s32, 32768
  s_waitcnt vmcnt(16)
  ds_read_b64_tr_b16 a[0:1], v14 offset:0
  ds_read_b64_tr_b16 a[2:3], v14 offset:256
  ds_read_b64_tr_b16 a[4:5], v14 offset:8
  ds_read_b64_tr_b16 a[6:7], v14 offset:264
  ds_read_b64_tr_b16 a[8:9], v14 offset:2048
  ds_read_b64_tr_b16 a[10:11], v14 offset:2304
  ds_read_b64_tr_b16 a[12:13], v14 offset:2056
  ds_read_b64_tr_b16 a[14:15], v14 offset:2312
  s_waitcnt lgkmcnt(0)
  ds_read_b64_tr_b16 a[16:17], v14 offset:4096
  ds_read_b64_tr_b16 a[18:19], v14 offset:4352
  ds_read_b64_tr_b16 a[20:21], v14 offset:4104
  ds_read_b64_tr_b16 a[22:23], v14 offset:4360
  ds_read_b64_tr_b16 a[24:25], v14 offset:6144
  ds_read_b64_tr_b16 a[26:27], v14 offset:6400
  ds_read_b64_tr_b16 a[28:29], v14 offset:6152
  ds_read_b64_tr_b16 a[30:31], v14 offset:6408
  s_waitcnt lgkmcnt(0)
  ds_read_b64_tr_b16 a[32:33], v14 offset:8192
  ds_read_b64_tr_b16 a[34:35], v14 offset:8448
  ds_read_b64_tr_b16 a[36:37], v14 offset:8200
  ds_read_b64_tr_b16 a[38:39], v14 offset:8456
  ds_read_b64_tr_b16 a[40:41], v14 offset:10240
  ds_read_b64_tr_b16 a[42:43], v14 offset:10496
  ds_read_b64_tr_b16 a[44:45], v14 offset:10248
  ds_read_b64_tr_b16 a[46:47], v14 offset:10504
  s_waitcnt lgkmcnt(0)
  ds_read_b64_tr_b16 a[48:49], v14 offset:12288
  ds_read_b64_tr_b16 a[50:51], v14 offset:12544
  ds_read_b64_tr_b16 a[52:53], v14 offset:12296
  ds_read_b64_tr_b16 a[54:55], v14 offset:12552
  ds_read_b64_tr_b16 a[56:57], v14 offset:14336
  ds_read_b64_tr_b16 a[58:59], v14 offset:14592
  ds_read_b64_tr_b16 a[60:61], v14 offset:14344
  ds_read_b64_tr_b16 a[62:63], v14 offset:14600
  s_waitcnt lgkmcnt(0)
  s_add_u32 s35, s30, 0
  s_mov_b32 m0, s35
  s_add_u32 s35, s35, 1024
  buffer_load_dwordx4 v13, s[48:51], s32 offen lds
  s_add_u32 s32, s32, 32768
  s_mov_b32 m0, s35
  s_add_u32 s35, s35, 1024
  buffer_load_dwordx4 v13, s[48:51], s32 offen lds
  s_add_u32 s32, s32, 32768
  s_mov_b32 m0, s35
  s_add_u32 s35, s35, 1024
  buffer_load_dwordx4 v13, s[48:51], s32 offen lds
  s_add_u32 s32, s32, 32768
  s_mov_b32 m0, s35
  s_add_u32 s35, s35, 1024
  buffer_load_dwordx4 v13, s[48:51], s32 offen lds
  s_add_u32 s32, s32, 32768
  s_mov_b32 m0, s35
  s_add_u32 s35, s35, 1024
  buffer_load_dwordx4 v13, s[48:51], s32 offen lds
  s_add_u32 s32, s32, 32768
  s_mov_b32 m0, s35
  s_add_u32 s35, s35, 1024
  buffer_load_dwordx4 v13, s[48:51], s32 offen lds
  s_add_u32 s32, s32, 32768
  s_mov_b32 m0, s35
  s_add_u32 s35, s35, 1024
  buffer_load_dwordx4 v13, s[48:51], s32 offen lds
  s_add_u32 s32, s32, 32768
  s_mov_b32 m0, s35
  s_add_u32 s35, s35, 1024
  buffer_load_dwordx4 v13, s[48:51], s32 offen lds
  s_add_u32 s32, s32, 32768
  s_mov_b32 m0, s35
  s_add_u32 s35, s35, 1024
  buffer_load_dwordx4 v13, s[48:51], s32 offen lds
  s_add_u32 s32, s32, 32768
  s_mov_b32 m0, s35
  s_add_u32 s35, s35, 1024
  buffer_load_dwordx4 v13, s[48:51], s32 offen lds
  s_add_u32 s32, s32, 32768
  s_mov_b32 m0, s35
  s_add_u32 s35, s35, 1024
  buffer_load_dwordx4 v13, s[48:51], s32 offen lds
  s_add_u32 s32, s32, 32768
  s_mov_b32 m0, s35
  s_add_u32 s35, s35, 1024
  buffer_load_dwordx4 v13, s[48:51], s32 offen lds
  s_add_u32 s32, s32, 32768
  s_mov_b32 m0, s35
  s_add_u32 s35, s35, 1024
  buffer_load_dwordx4 v13, s[48:51], s32 offen lds
  s_add_u32 s32, s32, 32768
  s_mov_b32 m0, s35
  s_add_u32 s35, s35, 1024
  buffer_load_dwordx4 v13, s[48:51], s32 offen lds
  s_add_u32 s32, s32, 32768
  s_mov_b32 m0, s35
  s_add_u32 s35, s35, 1024
  buffer_load_dwordx4 v13, s[48:51], s32 offen lds
  s_add_u32 s32, s32, 32768
  s_mov_b32 m0, s35
  s_add_u32 s35, s35, 1024
  buffer_load_dwordx4 v13, s[48:51], s32 offen lds
  s_add_u32 s32, s32, 32768
  s_waitcnt vmcnt(16)
  ds_read_b64_tr_b16 a[64:65], v14 offset:16384
  ds_read_b64_tr_b16 a[66:67], v14 offset:16640
  ds_read_b64_tr_b16 a[68:69], v14 offset:16392
  ds_read_b64_tr_b16 a[70:71], v14 offset:16648
  ds_read_b64_tr_b16 a[72:73], v14 offset:18432
  ds_read_b64_tr_b16 a[74:75], v14 offset:18688
  ds_read_b64_tr_b16 a[76:77], v14 offset:18440
  ds_read_b64_tr_b16 a[78:79], v14 offset:18696
  s_waitcnt lgkmcnt(0)
  ds_read_b64_tr_b16 a[80:81], v14 offset:20480
  ds_read_b64_tr_b16 a[82:83], v14 offset:20736
  ds_read_b64_tr_b16 a[84:85], v14 offset:20488
  ds_read_b64_tr_b16 a[86:87], v14 offset:20744
  ds_read_b64_tr_b16 a[88:89], v14 offset:22528
  ds_read_b64_tr_b16 a[90:91], v14 offset:22784
  ds_read_b64_tr_b16 a[92:93], v14 offset:22536
  ds_read_b64_tr_b16 a[94:95], v14 offset:22792
  s_waitcnt lgkmcnt(0)
  ds_read_b64_tr_b16 a[96:97], v14 offset:24576
  ds_read_b64_tr_b16 a[98:99], v14 offset:24832
  ds_read_b64_tr_b16 a[100:101], v14 offset:24584
  ds_read_b64_tr_b16 a[102:103], v14 offset:24840
  ds_read_b64_tr_b16 a[104:105], v14 offset:26624
  ds_read_b64_tr_b16 a[106:107], v14 offset:26880
  ds_read_b64_tr_b16 a[108:109], v14 offset:26632
  ds_read_b64_tr_b16 a[110:111], v14 offset:26888
  s_waitcnt lgkmcnt(0)
  ds_read_b64_tr_b16 a[112:113], v14 offset:28672
  ds_read_b64_tr_b16 a[114:115], v14 offset:28928
  ds_read_b64_tr_b16 a[116:117], v14 offset:28680
  ds_read_b64_tr_b16 a[118:119], v14 offset:28936
  ds_read_b64_tr_b16 a[120:121], v14 offset:30720
  ds_read_b64_tr_b16 a[122:123], v14 offset:30976
  ds_read_b64_tr_b16 a[124:125], v14 offset:30728
  ds_read_b64_tr_b16 a[126:127], v14 offset:30984
  s_waitcnt lgkmcnt(0)
  s_add_u32 s35, s30, 16384
  s_mov_b32 m0, s35
  s_add_u32 s35, s35, 1024
  buffer_load_dwordx4 v13, s[48:51], s32 offen lds
  s_add_u32 s32, s32, 32768
  s_mov_b32 m0, s35
  s_add_u32 s35, s35, 1024
  buffer_load_dwordx4 v13, s[48:51], s32 offen lds
  s_add_u32 s32, s32, 32768
  s_mov_b32 m0, s35
  s_add_u32 s35, s35, 1024
  buffer_load_dwordx4 v13, s[48:51], s32 offen lds
  s_add_u32 s32, s32, 32768
  s_mov_b32 m0, s35
  s_add_u32 s35, s35, 1024
  buffer_load_dwordx4 v13, s[48:51], s32 offen lds
  s_add_u32 s32, s32, 32768
  s_mov_b32 m0, s35
  s_add_u32 s35, s35, 1024
  buffer_load_dwordx4 v13, s[48:51], s32 offen lds
  s_add_u32 s32, s32, 32768
  s_mov_b32 m0, s35
  s_add_u32 s35, s35, 1024
  buffer_load_dwordx4 v13, s[48:51], s32 offen lds
  s_add_u32 s32, s32, 32768
  s_mov_b32 m0, s35
  s_add_u32 s35, s35, 1024
  buffer_load_dwordx4 v13, s[48:51], s32 offen lds
  s_add_u32 s32, s32, 32768
  s_mov_b32 m0, s35
  s_add_u32 s35, s35, 1024
  buffer_load_dwordx4 v13, s[48:51], s32 offen lds
  s_add_u32 s32, s32, 32768
  s_mov_b32 m0, s35
  s_add_u32 s35, s35, 1024
  buffer_load_dwordx4 v13, s[48:51], s32 offen lds
  s_add_u32 s32, s32, 32768
  s_mov_b32 m0, s35
  s_add_u32 s35, s35, 1024
  buffer_load_dwordx4 v13, s[48:51], s32 offen lds
  s_add_u32 s32, s32, 32768
  s_mov_b32 m0, s35
  s_add_u32 s35, s35, 1024
  buffer_load_dwordx4 v13, s[48:51], s32 offen lds
  s_add_u32 s32, s32, 32768
  s_mov_b32 m0, s35
  s_add_u32 s35, s35, 1024
  buffer_load_dwordx4 v13, s[48:51], s32 offen lds
  s_add_u32 s32, s32, 32768
  s_mov_b32 m0, s35
  s_add_u32 s35, s35, 1024
  buffer_load_dwordx4 v13, s[48:51], s32 offen lds
  s_add_u32 s32, s32, 32768
  s_mov_b32 m0, s35
  s_add_u32 s35, s35, 1024
  buffer_load_dwordx4 v13, s[48:51], s32 offen lds
  s_add_u32 s32, s32, 32768
  s_mov_b32 m0, s35
  s_add_u32 s35, s35, 1024
  buffer_load_dwordx4 v13, s[48:51], s32 offen lds
  s_add_u32 s32, s32, 32768
  s_mov_b32 m0, s35
  s_add_u32 s35, s35, 1024
  buffer_load_dwordx4 v13, s[48:51], s32 offen lds
  s_add_u32 s32, s32, 32768
  s_waitcnt vmcnt(16)
  ds_read_b64_tr_b16 a[128:129], v14 offset:0
  ds_read_b64_tr_b16 a[130:131], v14 offset:256
  ds_read_b64_tr_b16 a[132:133], v14 offset:8
  ds_read_b64_tr_b16 a[134:135], v14 offset:264
  ds_read_b64_tr_b16 a[136:137], v14 offset:2048
  ds_read_b64_tr_b16 a[138:139], v14 offset:2304
  ds_read_b64_tr_b16 a[140:141], v14 offset:2056
  ds_read_b64_tr_b16 a[142:143], v14 offset:2312
  s_waitcnt lgkmcnt(0)
  ds_read_b64_tr_b16 a[144:145], v14 offset:4096
  ds_read_b64_tr_b16 a[146:147], v14 offset:4352
  ds_read_b64_tr_b16 a[148:149], v14 offset:4104
  ds_read_b64_tr_b16 a[150:151], v14 offset:4360
  ds_read_b64_tr_b16 a[152:153], v14 offset:6144
  ds_read_b64_tr_b16 a[154:155], v14 offset:6400
  ds_read_b64_tr_b16 a[156:157], v14 offset:6152
  ds_read_b64_tr_b16 a[158:159], v14 offset:6408
  s_waitcnt lgkmcnt(0)
  ds_read_b64_tr_b16 a[160:161], v14 offset:8192
  ds_read_b64_tr_b16 a[162:163], v14 offset:8448
  ds_read_b64_tr_b16 a[164:165], v14 offset:8200
  ds_read_b64_tr_b16 a[166:167], v14 offset:8456
  ds_read_b64_tr_b16 a[168:169], v14 offset:10240
  ds_read_b64_tr_b16 a[170:171], v14 offset:10496
  ds_read_b64_tr_b16 a[172:173], v14 offset:10248
  ds_read_b64_tr_b16 a[174:175], v14 offset:10504
  s_waitcnt lgkmcnt(0)
  ds_read_b64_tr_b16 a[176:177], v14 offset:12288
  ds_read_b64_tr_b16 a[178:179], v14 offset:12544
  ds_read_b64_tr_b16 a[180:181], v14 offset:12296
  ds_read_b64_tr_b16 a[182:183], v14 offset:12552
  ds_read_b64_tr_b16 a[184:185], v14 offset:14336
  ds_read_b64_tr_b16 a[186:187], v14 offset:14592
  ds_read_b64_tr_b16 a[188:189], v14 offset:14344
  ds_read_b64_tr_b16 a[190:191], v14 offset:14600
  s_waitcnt lgkmcnt(0)
  s_waitcnt vmcnt(0)
  ds_read_b64_tr_b16 a[192:193], v14 offset:16384
  ds_read_b64_tr_b16 a[194:195], v14 offset:16640
  ds_read_b64_tr_b16 a[196:197], v14 offset:16392
  ds_read_b64_tr_b16 a[198:199], v14 offset:16648
  ds_read_b64_tr_b16 a[200:201], v14 offset:18432
  ds_read_b64_tr_b16 a[202:203], v14 offset:18688
  ds_read_b64_tr_b16 a[204:205], v14 offset:18440
  ds_read_b64_tr_b16 a[206:207], v14 offset:18696
  s_waitcnt lgkmcnt(0)
  ds_read_b64_tr_b16 a[208:209], v14 offset:20480
  ds_read_b64_tr_b16 a[210:211], v14 offset:20736
  ds_read_b64_tr_b16 a[212:213], v14 offset:20488
  ds_read_b64_tr_b16 a[214:215], v14 offset:20744
  ds_read_b64_tr_b16 a[216:217], v14 offset:22528
  ds_read_b64_tr_b16 a[218:219], v14 offset:22784
  ds_read_b64_tr_b16 a[220:221], v14 offset:22536
  ds_read_b64_tr_b16 a[222:223], v14 offset:22792
  s_waitcnt lgkmcnt(0)
  ds_read_b64_tr_b16 a[224:225], v14 offset:24576
  ds_read_b64_tr_b16 a[226:227], v14 offset:24832
  ds_read_b64_tr_b16 a[228:229], v14 offset:24584
  ds_read_b64_tr_b16 a[230:231], v14 offset:24840
  ds_read_b64_tr_b16 a[232:233], v14 offset:26624
  ds_read_b64_tr_b16 a[234:235], v14 offset:26880
  ds_read_b64_tr_b16 a[236:237], v14 offset:26632
  ds_read_b64_tr_b16 a[238:239], v14 offset:26888
  s_waitcnt lgkmcnt(0)
  ds_read_b64_tr_b16 a[240:241], v14 offset:28672
  ds_read_b64_tr_b16 a[242:243], v14 offset:28928
  ds_read_b64_tr_b16 a[244:245], v14 offset:28680
  ds_read_b64_tr_b16 a[246:247], v14 offset:28936
  ds_read_b64_tr_b16 a[248:249], v14 offset:30720
  ds_read_b64_tr_b16 a[250:251], v14 offset:30976
  ds_read_b64_tr_b16 a[252:253], v14 offset:30728
  ds_read_b64_tr_b16 a[254:255], v14 offset:30984
  s_waitcnt lgkmcnt(0)
  s_cmp_lg_u32 s14, 0
  s_cbranch_scc1 we_196
  s_lshl_b32 s58, 3, 2
  v_mov_b32 v161, s58
wt_195:
  s_sub_u32 s23, s23, 1
  s_cbranch_scc1 rec_exit
  buffer_load_dword v160, v161, s[40:43], 0 offen offset:112 sc1
  s_waitcnt vmcnt(0)
  v_cmp_gt_u32 vcc, 16, v160
  s_cbranch_vccz wt_195_ok
  s_sleep 8
  s_branch wt_195
wt_195_ok:
we_196:
  s_barrier
  s_mov_b32 s37, 96
  s_mov_b32 s16, 2
  s_mov_b32 s17, 0
  s_mov_b32 s18, 2
  s_cmp_lt_u32 s27, 2
  s_cbranch_scc1 st_par
  s_mov_b32 s37, 97
  s_mov_b32 s16, 2
  s_mov_b32 s17, 0
  s_mov_b32 s18, 2
  s_cmp_lt_u32 s27, 4
  s_cbranch_scc1 st_par
  s_mov_b32 s37, 96
  s_mov_b32 s16, 1
  s_mov_b32 s17, 112
  s_mov_b32 s18, 2
  s_cmp_lt_u32 s27, 6
  s_cbranch_scc1 st_par
  s_mov_b32 s37, 113
  s_mov_b32 s16, 2
  s_mov_b32 s17, 0
  s_mov_b32 s18, 2
  s_cmp_lt_u32 s27, 8
  s_cbranch_scc1 st_par
st_par:
  s_lshl_b32 s58, s14, 11
  v_lshlrev_b32 v2, 4, v29
  v_lshl_add_u32 v3, v28, 11, v2
  v_add_u32 v3, s36, v3
  v_lshlrev_b32 v4, 2, v28
  v_lshlrev_b32 v5, 4, v1
  v_add_u32 v6, s58, v5
  v_add_u32 v21, s30, v5
  s_lshl_b32 s58, s36, 4
  v_add_u32 v5, s58, v5
  s_mov_b32 s20, 0
  v_add_u32 v216, 0, v21
  v_add_u32 v217, 4096, v21
  v_add_u32 v218, 8192, v21
  v_add_u32 v219, 12288, v21
  v_add_u32 v220, 16384, v21
  v_add_u32 v221, 20480, v21
  v_add_u32 v222, 24576, v21
  v_add_u32 v223, 28672, v21
st_poll:
  s_sub_u32 s23, s23, 1
  s_cbranch_scc1 rec_exit
  buffer_load_dword v7, v4, s[40:43], 0 offen offset:192 sc1
  s_waitcnt vmcnt(0)
  v_cmp_gt_u32 vcc, 32, v7
  s_or_b32 s20, vcc_lo, 0x10000
  s_ff1_i32_b32 s20, s20
  s_lshl_b32 s20, s20, 1
  s_add_u32 s20, s20, 96
  s_cmp_lt_u32 s37, s20
  s_cbranch_scc1 st_go
  s_sleep 4
  s_branch st_poll
st_go:
  s_lshl_b32 s30, s37, 17
  s_add_u32 s30, s30, 50331648
  s_lshl_b32 s31, s37, 15
  s_add_u32 s31, s31, 88080384
  s_lshl_b32 s33, s37, 6
  s_add_u32 s33, s33, 100663296
  buffer_load_dwordx4 v[16:19], v5, s[4:7], s31 offen sc1
  buffer_load_dword v20, v4, s[4:7], s33 offen sc1
  buffer_load_dwordx4 v[32:35], v216, s[4:7], s30 offen offset:0
  buffer_load_dwordx4 v[36:39], v216, s[4:7], s30 offen offset:1024
  buffer_load_dwordx4 v[40:43], v216, s[4:7], s30 offen offset:2048
  buffer_load_dwordx4 v[44:47], v216, s[4:7], s30 offen offset:3072
  buffer_load_dwordx4 v[48:51], v217, s[4:7], s30 offen offset:0
  buffer_load_dwordx4 v[52:55], v217, s[4:7], s30 offen offset:1024
  buffer_load_dwordx4 v[56:59], v217, s[4:7], s30 offen offset:2048
  buffer_load_dwordx4 v[60:63], v217, s[4:7], s30 offen offset:3072
  buffer_load_dwordx4 v[64:67], v218, s[4:7], s30 offen offset:0
  buffer_load_dwordx4 v[68:71], v218, s[4:7], s30 offen offset:1024
  buffer_load_dwordx4 v[72:75], v218, s[4:7], s30 offen offset:2048
  buffer_load_dwordx4 v[76:79], v218, s[4:7], s30 offen offset:3072
  buffer_load_dwordx4 v[80:83], v219, s[4:7], s30 offen offset:0
  buffer_load_dwordx4 v[84:87], v219, s[4:7], s30 offen offset:1024
  buffer_load_dwordx4 v[88:91], v219, s[4:7], s30 offen offset:2048
  buffer_load_dwordx4 v[92:95], v219, s[4:7], s30 offen offset:3072
  buffer_load_dwordx4 v[96:99], v220, s[4:7], s30 offen offset:0
  buffer_load_dwordx4 v[100:103], v220, s[4:7], s30 offen offset:1024
  buffer_load_dwordx4 v[104:107], v220, s[4:7], s30 offen offset:2048
  buffer_load_dwordx4 v[108:111], v220, s[4:7], s30 offen offset:3072
  buffer_load_dwordx4 v[112:115], v221, s[4:7], s30 offen offset:0
  buffer_load_dwordx4 v[116:119], v221, s[4:7], s30 offen offset:1024
  buffer_load_dwordx4 v[120:123], v221, s[4:7], s30 offen offset:2048
  buffer_load_dwordx4 v[124:127], v221, s[4:7], s30 offen offset:3072
  buffer_load_dwordx4 v[128:131], v222, s[4:7], s30 offen offset:0
  buffer_load_dwordx4 v[132:135], v222, s[4:7], s30 offen offset:1024
  buffer_load_dwordx4 v[136:139], v222, s[4:7], s30 offen offset:2048
  buffer_load_dwordx4 v[140:143], v222, s[4:7], s30 offen offset:3072
  buffer_load_dwordx4 v[144:147], v223, s[4:7], s30 offen offset:0
  buffer_load_dwordx4 v[148:151], v223, s[4:7], s30 offen offset:1024
  buffer_load_dwordx4 v[152:155], v223, s[4:7], s30 offen offset:2048
  buffer_load_dwordx4 v[156:159], v223, s[4:7], s30 offen offset:3072
st_top:
  s_lshl_b32 s34, s37, 15
  s_cmp_lt_u32 s37, s17
  s_cselect_b32 s58, s16, s18
  s_add_u32 s37, s37, s58
  s_cmp_lt_u32 s37, s20
  s_cbranch_scc0 st_drain
  s_lshl_b32 s30, s37, 17
  s_add_u32 s30, s30, 50331648
  s_lshl_b32 s31, s37, 15
  s_add_u32 s31, s31, 88080384
  s_lshl_b32 s33, s37, 6
  s_add_u32 s33, s33, 100663296
  s_waitcnt vmcnt(32)
  v_mov_b32 v8, v16
  v_mov_b32 v9, v17
  v_mov_b32 v10, v18
  v_mov_b32 v11, v19
  v_mov_b32 v12, v20
  buffer_load_dwordx4 v[16:19], v5, s[4:7], s31 offen sc1
  buffer_load_dword v20, v4, s[4:7], s33 offen sc1
  s_waitcnt vmcnt(33)
  v_mfma_f32_16x16x32_bf16 v[160:163], a[0:3], v[32:35], 0
  v_mfma_f32_16x16x32_bf16 v[164:167], a[4:7], v[32:35], 0
  buffer_load_dwordx4 v[32:35], v216, s[4:7], s30 offen offset:0
  s_waitcnt vmcnt(33)
  v_mfma_f32_16x16x32_bf16 v[160:163], a[8:11], v[36:39], v[160:163]
  v_mfma_f32_16x16x32_bf16 v[164:167], a[12:15], v[36:39], v[164:167]
  buffer_load_dwordx4 v[36:39], v216, s[4:7], s30 offen offset:1024
  s_waitcnt vmcnt(33)
  v_mfma_f32_16x16x32_bf16 v[160:163], a[16:19], v[40:43], v[160:163]
  v_mfma_f32_16x16x32_bf16 v[164:167], a[20:23], v[40:43], v[164:167]
  buffer_load_dwordx4 v[40:43], v216, s[4:7], s30 offen offset:2048
  s_waitcnt vmcnt(33)
  v_mfma_f32_16x16x32_bf16 v[160:163], a[24:27], v[44:47], v[160:163]
  v_mfma_f32_16x16x32_bf16 v[164:167], a[28:31], v[44:47], v[164:167]
  buffer_load_dwordx4 v[44:47], v216, s[4:7], s30 offen offset:3072
  s_waitcnt vmcnt(33)
  v_mfma_f32_16x16x32_bf16 v[160:163], a[32:35], v[48:51], v[160:163]
  v_mfma_f32_16x16x32_bf16 v[164:167], a[36:39], v[48:51], v[164:167]
  buffer_load_dwordx4 v[48:51], v217, s[4:7], s30 offen offset:0
  s_waitcnt vmcnt(33)
  v_mfma_f32_16x16x32_bf16 v[160:163], a[40:43], v[52:55], v[160:163]
  v_mfma_f32_16x16x32_bf16 v[164:167], a[44:47], v[52:55], v[164:167]
  buffer_load_dwordx4 v[52:55], v217, s[4:7], s30 offen offset:1024
  s_waitcnt vmcnt(33)
  v_mfma_f32_16x16x32_bf16 v[160:163], a[48:51], v[56:59], v[160:163]
  v_mfma_f32_16x16x32_bf16 v[164:167], a[52:55], v[56:59], v[164:167]
  buffer_load_dwordx4 v[56:59], v217, s[4:7], s30 offen offset:2048
  s_waitcnt vmcnt(33)
  v_mfma_f32_16x16x32_bf16 v[160:163], a[56:59], v[60:63], v[160:163]
  v_mfma_f32_16x16x32_bf16 v[164:167], a[60:63], v[60:63], v[164:167]
  buffer_load_dwordx4 v[60:63], v217, s[4:7], s30 offen offset:3072
  s_waitcnt vmcnt(33)
  v_mfma_f32_16x16x32_bf16 v[160:163], a[64:67], v[64:67], v[160:163]
  v_mfma_f32_16x16x32_bf16 v[164:167], a[68:71], v[64:67], v[164:167]
  buffer_load_dwordx4 v[64:67], v218, s[4:7], s30 offen offset:0
  s_waitcnt vmcnt(33)
  v_mfma_f32_16x16x32_bf16 v[160:163], a[72:75], v[68:71], v[160:163]
  v_mfma_f32_16x16x32_bf16 v[164:167], a[76:79], v[68:71], v[164:167]
  buffer_load_dwordx4 v[68:71], v218, s[4:7], s30 offen offset:1024
  s_waitcnt vmcnt(33)
  v_mfma_f32_16x16x32_bf16 v[160:163], a[80:83], v[72:75], v[160:163]
  v_mfma_f32_16x16x32_bf16 v[164:167], a[84:87], v[72:75], v[164:167]
  buffer_load_dwordx4 v[72:75], v218, s[4:7], s30 offen offset:2048
  s_waitcnt vmcnt(33)
  v_mfma_f32_16x16x32_bf16 v[160:163], a[88:91], v[76:79], v[160:163]
  v_mfma_f32_16x16x32_bf16 v[164:167], a[92:95], v[76:79], v[164:167]
  buffer_load_dwordx4 v[76:79], v218, s[4:7], s30 offen offset:3072
  s_waitcnt vmcnt(33)
  v_mfma_f32_16x16x32_bf16 v[160:163], a[96:99], v[80:83], v[160:163]
  v_mfma_f32_16x16x32_bf16 v[164:167], a[100:103], v[80:83], v[164:167]
  buffer_load_dwordx4 v[80:83], v219, s[4:7], s30 offen offset:0
  s_waitcnt vmcnt(33)
  v_mfma_f32_16x16x32_bf16 v[160:163], a[104:107], v[84:87], v[160:163]
  v_mfma_f32_16x16x32_bf16 v[164:167], a[108:111], v[84:87], v[164:167]
  buffer_load_dwordx4 v[84:87], v219, s[4:7], s30 offen offset:1024
  s_waitcnt vmcnt(33)
  v_mfma_f32_16x16x32_bf16 v[160:163], a[112:115], v[88:91], v[160:163]
  v_mfma_f32_16x16x32_bf16 v[164:167], a[116:119], v[88:91], v[164:167]
  buffer_load_dwordx4 v[88:91], v219, s[4:7], s30 offen offset:2048
  s_waitcnt vmcnt(33)
  v_mfma_f32_16x16x32_bf16 v[160:163], a[120:123], v[92:95], v[160:163]
  v_mfma_f32_16x16x32_bf16 v[164:167], a[124:127], v[92:95], v[164:167]
  buffer_load_dwordx4 v[92:95], v219, s[4:7], s30 offen offset:3072
  s_waitcnt vmcnt(33)
  v_mfma_f32_16x16x32_bf16 v[160:163], a[128:131], v[96:99], v[160:163]
  v_mfma_f32_16x16x32_bf16 v[164:167], a[132:135], v[96:99], v[164:167]
  buffer_load_dwordx4 v[96:99], v220, s[4:7], s30 offen offset:0
  s_waitcnt vmcnt(33)
  v_mfma_f32_16x16x32_bf16 v[160:163], a[136:139], v[100:103], v[160:163]
  v_mfma_f32_16x16x32_bf16 v[164:167], a[140:143], v[100:103], v[164:167]
  buffer_load_dwordx4 v[100:103], v220, s[4:7], s30 offen offset:1024
  s_waitcnt vmcnt(33)
  v_mfma_f32_16x16x32_bf16 v[160:163], a[144:147], v[104:107], v[160:163]
  v_mfma_f32_16x16x32_bf16 v[164:167], a[148:151], v[104:107], v[164:167]
  buffer_load_dwordx4 v[104:107], v220, s[4:7], s30 offen offset:2048
  s_waitcnt vmcnt(33)
  v_mfma_f32_16x16x32_bf16 v[160:163], a[152:155], v[108:111], v[160:163]
  v_mfma_f32_16x16x32_bf16 v[164:167], a[156:159], v[108:111], v[164:167]
  buffer_load_dwordx4 v[108:111], v220, s[4:7], s30 offen offset:3072
  s_waitcnt vmcnt(33)
  v_mfma_f32_16x16x32_bf16 v[160:163], a[160:163], v[112:115], v[160:163]
  v_mfma_f32_16x16x32_bf16 v[164:167], a[164:167], v[112:115], v[164:167]
  buffer_load_dwordx4 v[112:115], v221, s[4:7], s30 offen offset:0
  s_waitcnt vmcnt(33)
  v_mfma_f32_16x16x32_bf16 v[160:163], a[168:171], v[116:119], v[160:163]
  v_mfma_f32_16x16x32_bf16 v[164:167], a[172:175], v[116:119], v[164:167]
  buffer_load_dwordx4 v[116:119], v221, s[4:7], s30 offen offset:1024
  s_waitcnt vmcnt(33)
  v_mfma_f32_16x16x32_bf16 v[160:163], a[176:179], v[120:123], v[160:163]
  v_mfma_f32_16x16x32_bf16 v[164:167], a[180:183], v[120:123], v[164:167]
  buffer_load_dwordx4 v[120:123], v221, s[4:7], s30 offen offset:2048
  s_waitcnt vmcnt(33)
  v_mfma_f32_16x16x32_bf16 v[160:163], a[184:187], v[124:127], v[160:163]
  v_mfma_f32_16x16x32_bf16 v[164:167], a[188:191], v[124:127], v[164:167]
  buffer_load_dwordx4 v[124:127], v221, s[4:7], s30 offen offset:3072
  s_waitcnt vmcnt(33)
  v_mfma_f32_16x16x32_bf16 v[160:163], a[192:195], v[128:131], v[160:163]
  v_mfma_f32_16x16x32_bf16 v[164:167], a[196:199], v[128:131], v[164:167]
  buffer_load_dwordx4 v[128:131], v222, s[4:7], s30 offen offset:0
  s_waitcnt vmcnt(33)
  v_mfma_f32_16x16x32_bf16 v[160:163], a[200:203], v[132:135], v[160:163]
  v_mfma_f32_16x16x32_bf16 v[164:167], a[204:207], v[132:135], v[164:167]
  buffer_load_dwordx4 v[132:135], v222, s[4:7], s30 offen offset:1024
  s_waitcnt vmcnt(33)
  v_mfma_f32_16x16x32_bf16 v[160:163], a[208:211], v[136:139], v[160:163]
  v_mfma_f32_16x16x32_bf16 v[164:167], a[212:215], v[136:139], v[164:167]
  buffer_load_dwordx4 v[136:139], v222, s[4:7], s30 offen offset:2048
  s_waitcnt vmcnt(33)
  v_mfma_f32_16x16x32_bf16 v[160:163], a[216:219], v[140:143], v[160:163]
  v_mfma_f32_16x16x32_bf16 v[164:167], a[220:223], v[140:143], v[164:167]
  buffer_load_dwordx4 v[140:143], v222, s[4:7], s30 offen offset:3072
  s_waitcnt vmcnt(33)
  v_mfma_f32_16x16x32_bf16 v[160:163], a[224:227], v[144:147], v[160:163]
  v_mfma_f32_16x16x32_bf16 v[164:167], a[228:231], v[144:147], v[164:167]
  buffer_load_dwordx4 v[144:147], v223, s[4:7], s30 offen offset:0
  s_waitcnt vmcnt(33)
  v_mfma_f32_16x16x32_bf16 v[160:163], a[232:235], v[148:151], v[160:163]
  v_mfma_f32_16x16x32_bf16 v[164:167], a[236:239], v[148:151], v[164:167]
  buffer_load_dwordx4 v[148:151], v223, s[4:7], s30 offen offset:1024
  s_waitcnt vmcnt(33)
  v_mfma_f32_16x16x32_bf16 v[160:163], a[240:243], v[152:155], v[160:163]
  v_mfma_f32_16x16x32_bf16 v[164:167], a[244:247], v[152:155], v[164:167]
  buffer_load_dwordx4 v[152:155], v223, s[4:7], s30 offen offset:2048
  s_waitcnt vmcnt(33)
  v_mfma_f32_16x16x32_bf16 v[160:163], a[248:251], v[156:159], v[160:163]
  v_mfma_f32_16x16x32_bf16 v[164:167], a[252:255], v[156:159], v[164:167]
  buffer_load_dwordx4 v[156:159], v223, s[4:7], s30 offen offset:3072
  s_branch st_red
st_drain:
  s_waitcnt vmcnt(32)
  v_mov_b32 v8, v16
  v_mov_b32 v9, v17
  v_mov_b32 v10, v18
  v_mov_b32 v11, v19
  v_mov_b32 v12, v20
  s_waitcnt vmcnt(31)
  v_mfma_f32_16x16x32_bf16 v[160:163], a[0:3], v[32:35], 0
  v_mfma_f32_16x16x32_bf16 v[164:167], a[4:7], v[32:35], 0
  s_waitcnt vmcnt(30)
  v_mfma_f32_16x16x32_bf16 v[160:163], a[8:11], v[36:39], v[160:163]
  v_mfma_f32_16x16x32_bf16 v[164:167], a[12:15], v[36:39], v[164:167]
  s_waitcnt vmcnt(29)
  v_mfma_f32_16x16x32_bf16 v[160:163], a[16:19], v[40:43], v[160:163]
  v_mfma_f32_16x16x32_bf16 v[164:167], a[20:23], v[40:43], v[164:167]
  s_waitcnt vmcnt(28)
  v_mfma_f32_16x16x32_bf16 v[160:163], a[24:27], v[44:47], v[160:163]
  v_mfma_f32_16x16x32_bf16 v[164:167], a[28:31], v[44:47], v[164:167]
  s_waitcnt vmcnt(27)
  v_mfma_f32_16x16x32_bf16 v[160:163], a[32:35], v[48:51], v[160:163]
  v_mfma_f32_16x16x32_bf16 v[164:167], a[36:39], v[48:51], v[164:167]
  s_waitcnt vmcnt(26)
  v_mfma_f32_16x16x32_bf16 v[160:163], a[40:43], v[52:55], v[160:163]
  v_mfma_f32_16x16x32_bf16 v[164:167], a[44:47], v[52:55], v[164:167]
  s_waitcnt vmcnt(25)
  v_mfma_f32_16x16x32_bf16 v[160:163], a[48:51], v[56:59], v[160:163]
  v_mfma_f32_16x16x32_bf16 v[164:167], a[52:55], v[56:59], v[164:167]
  s_waitcnt vmcnt(24)
  v_mfma_f32_16x16x32_bf16 v[160:163], a[56:59], v[60:63], v[160:163]
  v_mfma_f32_16x16x32_bf16 v[164:167], a[60:63], v[60:63], v[164:167]
  s_waitcnt vmcnt(23)
  v_mfma_f32_16x16x32_bf16 v[160:163], a[64:67], v[64:67], v[160:163]
  v_mfma_f32_16x16x32_bf16 v[164:167], a[68:71], v[64:67], v[164:167]
  s_waitcnt vmcnt(22)
  v_mfma_f32_16x16x32_bf16 v[160:163], a[72:75], v[68:71], v[160:163]
  v_mfma_f32_16x16x32_bf16 v[164:167], a[76:79], v[68:71], v[164:167]
  s_waitcnt vmcnt(21)
  v_mfma_f32_16x16x32_bf16 v[160:163], a[80:83], v[72:75], v[160:163]
  v_mfma_f32_16x16x32_bf16 v[164:167], a[84:87], v[72:75], v[164:167]
  s_waitcnt vmcnt(20)
  v_mfma_f32_16x16x32_bf16 v[160:163], a[88:91], v[76:79], v[160:163]
  v_mfma_f32_16x16x32_bf16 v[164:167], a[92:95], v[76:79], v[164:167]
  s_waitcnt vmcnt(19)
  v_mfma_f32_16x16x32_bf16 v[160:163], a[96:99], v[80:83], v[160:163]
  v_mfma_f32_16x16x32_bf16 v[164:167], a[100:103], v[80:83], v[164:167]
  s_waitcnt vmcnt(18)
  v_mfma_f32_16x16x32_bf16 v[160:163], a[104:107], v[84:87], v[160:163]
  v_mfma_f32_16x16x32_bf16 v[164:167], a[108:111], v[84:87], v[164:167]
  s_waitcnt vmcnt(17)
  v_mfma_f32_16x16x32_bf16 v[160:163], a[112:115], v[88:91], v[160:163]
  v_mfma_f32_16x16x32_bf16 v[164:167], a[116:119], v[88:91], v[164:167]
  s_waitcnt vmcnt(16)
  v_mfma_f32_16x16x32_bf16 v[160:163], a[120:123], v[92:95], v[160:163]
  v_mfma_f32_16x16x32_bf16 v[164:167], a[124:127], v[92:95], v[164:167]
  s_waitcnt vmcnt(15)
  v_mfma_f32_16x16x32_bf16 v[160:163], a[128:131], v[96:99], v[160:163]
  v_mfma_f32_16x16x32_bf16 v[164:167], a[132:135], v[96:99], v[164:167]
  s_waitcnt vmcnt(14)
  v_mfma_f32_16x16x32_bf16 v[160:163], a[136:139], v[100:103], v[160:163]
  v_mfma_f32_16x16x32_bf16 v[164:167], a[140:143], v[100:103], v[164:167]
  s_waitcnt vmcnt(13)
  v_mfma_f32_16x16x32_bf16 v[160:163], a[144:147], v[104:107], v[160:163]
  v_mfma_f32_16x16x32_bf16 v[164:167], a[148:151], v[104:107], v[164:167]
  s_waitcnt vmcnt(12)
  v_mfma_f32_16x16x32_bf16 v[160:163], a[152:155], v[108:111], v[160:163]
  v_mfma_f32_16x16x32_bf16 v[164:167], a[156:159], v[108:111], v[164:167]
  s_waitcnt vmcnt(11)
  v_mfma_f32_16x16x32_bf16 v[160:163], a[160:163], v[112:115], v[160:163]
  v_mfma_f32_16x16x32_bf16 v[164:167], a[164:167], v[112:115], v[164:167]
  s_waitcnt vmcnt(10)
  v_mfma_f32_16x16x32_bf16 v[160:163], a[168:171], v[116:119], v[160:163]
  v_mfma_f32_16x16x32_bf16 v[164:167], a[172:175], v[116:119], v[164:167]
  s_waitcnt vmcnt(9)
  v_mfma_f32_16x16x32_bf16 v[160:163], a[176:179], v[120:123], v[160:163]
  v_mfma_f32_16x16x32_bf16 v[164:167], a[180:183], v[120:123], v[164:167]
  s_waitcnt vmcnt(8)
  v_mfma_f32_16x16x32_bf16 v[160:163], a[184:187], v[124:127], v[160:163]
  v_mfma_f32_16x16x32_bf16 v[164:167], a[188:191], v[124:127], v[164:167]
  s_waitcnt vmcnt(7)
  v_mfma_f32_16x16x32_bf16 v[160:163], a[192:195], v[128:131], v[160:163]
  v_mfma_f32_16x16x32_bf16 v[164:167], a[196:199], v[128:131], v[164:167]
  s_waitcnt vmcnt(6)
  v_mfma_f32_16x16x32_bf16 v[160:163], a[200:203], v[132:135], v[160:163]
  v_mfma_f32_16x16x32_bf16 v[164:167], a[204:207], v[132:135], v[164:167]
  s_waitcnt vmcnt(5)
  v_mfma_f32_16x16x32_bf16 v[160:163], a[208:211], v[136:139], v[160:163]
  v_mfma_f32_16x16x32_bf16 v[164:167], a[212:215], v[136:139], v[164:167]
  s_waitcnt vmcnt(4)
  v_mfma_f32_16x16x32_bf16 v[160:163], a[216:219], v[140:143], v[160:163]
  v_mfma_f32_16x16x32_bf16 v[164:167], a[220:223], v[140:143], v[164:167]
  s_waitcnt vmcnt(3)
  v_mfma_f32_16x16x32_bf16 v[160:163], a[224:227], v[144:147], v[160:163]
  v_mfma_f32_16x16x32_bf16 v[164:167], a[228:231], v[144:147], v[164:167]
  s_waitcnt vmcnt(2)
  v_mfma_f32_16x16x32_bf16 v[160:163], a[232:235], v[148:151], v[160:163]
  v_mfma_f32_16x16x32_bf16 v[164:167], a[236:239], v[148:151], v[164:167]
  s_waitcnt vmcnt(1)
  v_mfma_f32_16x16x32_bf16 v[160:163], a[240:243], v[152:155], v[160:163]
  v_mfma_f32_16x16x32_bf16 v[164:167], a[244:247], v[152:155], v[164:167]
  s_waitcnt vmcnt(0)
  v_mfma_f32_16x16x32_bf16 v[160:163], a[248:251], v[156:159], v[160:163]
  v_mfma_f32_16x16x32_bf16 v[164:167], a[252:255], v[156:159], v[164:167]
st_red:
  s_nop 7
  s_cmp_eq_u32 s14, 0
  s_cbranch_scc1 st_r0
  ds_write_b128 v6, v[160:163]
  ds_write_b128 v6, v[164:167] offset:1024
  s_waitcnt lgkmcnt(0)
  s_barrier
  s_branch st_nx
st_r0:
  v_lshlrev_b32 v200, 16, v8
  v_and_b32 v201, 0xffff0000, v8
  v_lshlrev_b32 v202, 16, v9
  v_and_b32 v203, 0xffff0000, v9
  v_lshlrev_b32 v204, 16, v10
  v_and_b32 v205, 0xffff0000, v10
  v_lshlrev_b32 v206, 16, v11
  v_and_b32 v207, 0xffff0000, v11
  s_barrier
  ds_read_b128 v[168:171], v6 offset:2048
  ds_read_b128 v[172:175], v6 offset:3072
  ds_read_b128 v[176:179], v6 offset:4096
  ds_read_b128 v[180:183], v6 offset:5120
  ds_read_b128 v[184:187], v6 offset:6144
  ds_read_b128 v[188:191], v6 offset:7168
  s_waitcnt lgkmcnt(4)
  v_pk_add_f32 v[160:161], v[160:161], v[168:169]
  v_pk_add_f32 v[162:163], v[162:163], v[170:171]
  v_pk_add_f32 v[164:165], v[164:165], v[172:173]
  v_pk_add_f32 v[166:167], v[166:167], v[174:175]
  s_waitcnt lgkmcnt(2)
  v_pk_add_f32 v[160:161], v[160:161], v[176:177]
  v_pk_add_f32 v[162:163], v[162:163], v[178:179]
  v_pk_add_f32 v[164:165], v[164:165], v[180:181]
  v_pk_add_f32 v[166:167], v[166:167], v[182:183]
  s_waitcnt lgkmcnt(0)
  v_pk_add_f32 v[160:161], v[160:161], v[184:185]
  v_pk_add_f32 v[162:163], v[162:163], v[186:187]
  v_pk_add_f32 v[164:165], v[164:165], v[188:189]
  v_pk_add_f32 v[166:167], v[166:167], v[190:191]
  v_sub_f32 v160, v160, v200
  v_sub_f32 v161, v161, v201
  v_sub_f32 v162, v162, v202
  v_sub_f32 v163, v163, v203
  v_sub_f32 v164, v164, v204
  v_sub_f32 v165, v165, v205
  v_sub_f32 v166, v166, v206
  v_sub_f32 v167, v167, v207
  v_fmac_f32 v200, v160, v12
  v_fmac_f32 v201, v161, v12
  v_fmac_f32 v202, v162, v12
  v_fmac_f32 v203, v163, v12
  v_fmac_f32 v204, v164, v12
  v_fmac_f32 v205, v165, v12
  v_fmac_f32 v206, v166, v12
  v_fmac_f32 v207, v167, v12
  v_cvt_pk_bf16_f32 v208, v200, v201
  v_cvt_pk_bf16_f32 v209, v202, v203
  v_cvt_pk_bf16_f32 v210, v204, v205
  v_cvt_pk_bf16_f32 v211, v206, v207
  buffer_store_dwordx4 v[208:211], v3, s[8:11], s34 offen
st_nx:
  v_xor_b32 v6, 8192, v6
  s_cmp_lt_u32 s37, s20
  s_cbranch_scc1 st_top
  s_cmp_lt_u32 s37, 128
  s_cbranch_scc1 st_poll
w_exit:
  s_waitcnt vmcnt(0)
  s_endpgm
.section .rodata,"a"
.p2align 6
.amdhsa_kernel gated_mix__memory_aug_recurrent_mem_tr__mixer_channel_mlp__prompt_kernel
  .amdhsa_next_free_vgpr 512
  .amdhsa_next_free_sgpr 102
  .amdhsa_accum_offset 256
  .amdhsa_group_segment_fixed_size 0
  .amdhsa_kernarg_size 128
  .amdhsa_user_sgpr_count 2
  .amdhsa_user_sgpr_kernarg_segment_ptr 1
  .amdhsa_system_sgpr_workgroup_id_x 1
.end_amdhsa_kernel
```
